```python
import torch

def _softmax(x, axis=-1):
    return torch.softmax(x, dim=axis)

def _gelu(x):
    return torch.nn.functional.gelu(x, approximate='tanh')

def _silu(x):
    return torch.nn.functional.silu(x)

def _sigmoid(x):
    return torch.sigmoid(x)

def _layernorm(x, axis=-1, eps=1e-05):
    m = x.mean(dim=axis, keepdim=True)
    v = x.var(dim=axis, keepdim=True, unbiased=False)
    return (x - m) / torch.sqrt(v + eps)

def _scatter_add(tgt, idx, src, axis=0):
    return tgt.clone().index_add_(axis, idx, src)

def _segment_sum(src, seg, n):
    out = torch.zeros((n,) + src.shape[1:], dtype=src.dtype)
    return out.index_add_(0, seg, src)

def _pad(x, pw):
    flat = tuple((v for pair in reversed(pw) for v in pair))
    return torch.nn.functional.pad(x, flat)
kernel_name = 'standalone__window_attn_davit__vision'

def setup_inputs():

    _w = lambda a: (lambda t: t.to(torch.bfloat16) if t.is_floating_point() else t)(torch.as_tensor(a))
    HW = 384
    C0 = 384
    ws = 7
    nh = 4
    H = W = max(HW // ws * ws, ws)
    C = max(C0 // nh * nh, nh)
    k = 3
    return {'x': _w((lambda *s: torch.randn(*s, dtype=torch.bfloat16) * 1.6)(1, H, W, C)), 'dw_pe': _w((lambda *s: torch.randn(*s, dtype=torch.bfloat16) * 1.6)(k, k, C) * 0.1), 'w_qkv': _w((lambda *s: torch.randn(*s, dtype=torch.bfloat16) * 1.6)(C, 3 * C) * C ** (-0.5)), 'w_o': _w((lambda *s: torch.randn(*s, dtype=torch.bfloat16) * 0.8)(C, C) * C ** (-0.5))}

def reference(x, dw_pe, w_qkv, w_o):
    B, H, W, C = x.shape
    ws = 7
    nh = 4
    dh = C // nh
    kk = dw_pe.shape[0]
    pad = kk // 2
    xp = _pad(x, ((0, 0), (pad, pad), (pad, pad), (0, 0)))
    pe = torch.zeros_like(x)
    for i in range(kk):
        for j in range(kk):
            pe = pe + xp[:, i:i + H, j:j + W, :] * dw_pe[i, j][None, None, None, :]
    x0 = x + pe
    h = _layernorm(x0, axis=-1)
    hw = h.reshape(B, H // ws, ws, W // ws, ws, C)
    hw = (lambda x, *d: x.permute(*d))(hw, 0, 1, 3, 2, 4, 5)
    hw = hw.reshape(-1, ws * ws, C)
    qkv = (hw @ w_qkv).reshape(-1, ws * ws, 3, nh, dh)
    q = qkv[:, :, 0].clone()
    k = qkv[:, :, 1].clone()
    v = qkv[:, :, 2].clone()
    scale = dh ** (-0.5)
    attn = torch.einsum('wnhd,wmhd->whnm', q, k) * scale
    attn = _softmax(attn, axis=-1)
    out = torch.einsum('whnm,wmhd->wnhd', attn, v)
    out = out.reshape(-1, ws * ws, C) @ w_o
    out = out.reshape(B, H // ws, W // ws, ws, ws, C)
    out = (lambda x, *d: x.permute(*d))(out, 0, 1, 3, 2, 4, 5)
    out = out.reshape(B, H, W, C)
    return x0 + out
```

```asm
; @launch grid=(243,1,1) block=(256,1,1) lds=163232
.amdgcn_target "amdgcn-amd-amdhsa--gfx950"
.text
.globl standalone__window_attn_davit__vision_kernel
.p2align 8
.type standalone__window_attn_davit__vision_kernel,@function
standalone__window_attn_davit__vision_kernel:
  s_cmp_ge_u32 s2, 243
  s_cbranch_scc1 L_help
  s_getpc_b64 s[50:51]
L_cpf:
  s_lshr_b32 s52, s2, 3
  s_mul_i32 s52, s52, 20
  v_and_b32 v200, 63, v0
  v_min_u32 v200, 20-1, v200
  v_add_u32 v200, s52, v200
  v_min_u32 v200, (L_end-L_cpf)/128, v200
  v_lshlrev_b32 v200, 7, v200
  v_mov_b32 v201, s51
  v_add_co_u32 v200, vcc, s50, v200
  s_nop 1
  v_addc_co_u32 v201, vcc, 0, v201, vcc
  global_load_dword v202, v[200:201], off
  s_cmp_ge_u32 s2, 120
  s_cbranch_scc1 L_prep1_end
  v_mov_b32 v128, v0
  s_load_dwordx2 s[82:83], s[0:1], 8
  s_load_dwordx4 s[88:91], s[0:1], 16
  s_load_dwordx2 s[84:85], s[0:1], 48
  v_and_b32 v129, 63, v128
  v_lshrrev_b32 v130, 6, v128
  v_and_b32 v131, 15, v129
  v_lshrrev_b32 v132, 4, v129
  v_readfirstlane_b32 s80, v130
  s_waitcnt lgkmcnt(0)
  s_mov_b32 s72, s84
  s_mov_b32 s73, s85
  s_mov_b32 s74, 1253376
  s_mov_b32 s75, 0x20000
  s_cmp_ge_u32 s2, 96
  s_cbranch_scc1 L_prep_conv
  s_cmp_ge_u32 s2, 72
  s_cbranch_scc1 L_prep_o
  s_mul_i32 s81, s2, 3641
  s_lshr_b32 s81, s81, 16
  s_mul_i32 s86, s81, 18
  s_sub_u32 s86, s2, s86
  s_mul_i32 s87, s86, 10923
  s_lshr_b32 s87, s87, 16
  s_mul_i32 s82, s87, 6
  s_sub_u32 s82, s86, s82
  s_mov_b32 s92, s88
  s_mov_b32 s93, s89
  s_mov_b32 s94, 884736
  s_mov_b32 s95, 0x20000
  s_mov_b32 s91, 2304
  s_mul_i32 s86, s87, 384
  s_mov_b32 s83, 0x3b2aaaab
  s_branch L_prep_common
L_prep_o:
  s_sub_u32 s86, s2, 72
  s_mul_i32 s81, s86, 10923
  s_lshr_b32 s81, s81, 16
  s_mul_i32 s82, s81, 6
  s_sub_u32 s82, s86, s82
  s_mov_b32 s87, 3
  s_mov_b32 s92, s90
  s_mov_b32 s93, s91
  s_mov_b32 s94, 294912
  s_mov_b32 s95, 0x20000
  s_mov_b32 s91, 768
  s_mov_b32 s86, 0
  s_mov_b32 s83, 0
L_prep_common:
  s_lshl_b32 s88, s82, 4
  v_add_u32 v133, s88, v131
  s_lshr_b32 s88, s82, 1
  s_lshl_b32 s88, s88, 5
  s_and_b32 s89, s82, 1
  s_lshl_b32 s89, s89, 2
  s_add_u32 s88, s88, s89
  v_lshrrev_b32 v134, 2, v131
  v_lshlrev_b32 v134, 3, v134
  v_and_b32 v135, 3, v131
  v_add_u32 v134, v134, v135
  v_add_u32 v134, s88, v134
  s_cmp_ge_u32 s87, 2
  s_cselect_b64 s[84:85], -1, 0
  v_cndmask_b32 v133, v133, v134, s[84:85]
  s_mul_i32 s88, s81, 96
  s_add_u32 s88, s88, s86
  v_add_u32 v133, s88, v133
  v_lshlrev_b32 v133, 1, v133
  s_mul_i32 s88, s80, 96
  v_lshlrev_b32 v134, 3, v132
  v_add_u32 v134, s88, v134
  v_mul_lo_u32 v134, v134, s91
  v_add_u32 v133, v133, v134
  s_mul_i32 s88, s91, 0
  buffer_load_ushort v144, v133, s[92:95], s88 offen
  s_mul_i32 s88, s91, 1
  buffer_load_ushort v145, v133, s[92:95], s88 offen
  s_mul_i32 s88, s91, 2
  buffer_load_ushort v146, v133, s[92:95], s88 offen
  s_mul_i32 s88, s91, 3
  buffer_load_ushort v147, v133, s[92:95], s88 offen
  s_mul_i32 s88, s91, 4
  buffer_load_ushort v148, v133, s[92:95], s88 offen
  s_mul_i32 s88, s91, 5
  buffer_load_ushort v149, v133, s[92:95], s88 offen
  s_mul_i32 s88, s91, 6
  buffer_load_ushort v150, v133, s[92:95], s88 offen
  s_mul_i32 s88, s91, 7
  buffer_load_ushort v151, v133, s[92:95], s88 offen
  s_mul_i32 s88, s91, 32
  buffer_load_ushort v152, v133, s[92:95], s88 offen
  s_mul_i32 s88, s91, 33
  buffer_load_ushort v153, v133, s[92:95], s88 offen
  s_mul_i32 s88, s91, 34
  buffer_load_ushort v154, v133, s[92:95], s88 offen
  s_mul_i32 s88, s91, 35
  buffer_load_ushort v155, v133, s[92:95], s88 offen
  s_mul_i32 s88, s91, 36
  buffer_load_ushort v156, v133, s[92:95], s88 offen
  s_mul_i32 s88, s91, 37
  buffer_load_ushort v157, v133, s[92:95], s88 offen
  s_mul_i32 s88, s91, 38
  buffer_load_ushort v158, v133, s[92:95], s88 offen
  s_mul_i32 s88, s91, 39
  buffer_load_ushort v159, v133, s[92:95], s88 offen
  s_mul_i32 s88, s91, 64
  buffer_load_ushort v160, v133, s[92:95], s88 offen
  s_mul_i32 s88, s91, 65
  buffer_load_ushort v161, v133, s[92:95], s88 offen
  s_mul_i32 s88, s91, 66
  buffer_load_ushort v162, v133, s[92:95], s88 offen
  s_mul_i32 s88, s91, 67
  buffer_load_ushort v163, v133, s[92:95], s88 offen
  s_mul_i32 s88, s91, 68
  buffer_load_ushort v164, v133, s[92:95], s88 offen
  s_mul_i32 s88, s91, 69
  buffer_load_ushort v165, v133, s[92:95], s88 offen
  s_mul_i32 s88, s91, 70
  buffer_load_ushort v166, v133, s[92:95], s88 offen
  s_mul_i32 s88, s91, 71
  buffer_load_ushort v167, v133, s[92:95], s88 offen
  s_branch L_prep1_end
L_prep_conv:
  s_cmp_ge_u32 s80, 3
  s_cbranch_scc1 L_prep1_end
  s_sub_u32 s81, s2, 96
  s_mov_b32 s92, s82
  s_mov_b32 s93, s83
  s_mov_b32 s94, 6912
  s_mov_b32 s95, 0x20000
  s_mov_b32 s86, 0x1100
  s_cmp_eq_u32 s80, 1
  s_cselect_b32 s86, 0x5443, s86
  s_cmp_eq_u32 s80, 2
  s_cselect_b32 s86, 0x8276, s86
  v_lshlrev_b32 v133, 2, v132
  v_lshrrev_b32 v133, v133, s86
  v_and_b32 v133, 15, v133
  v_mul_u32_u24 v133, 384, v133
  s_lshl_b32 s87, s81, 4
  v_add_u32 v133, s87, v133
  v_add_u32 v133, v133, v131
  v_lshlrev_b32 v133, 1, v133
  buffer_load_ushort v134, v133, s[92:95], 0 offen
L_prep1_end:
  s_load_dwordx2 s[4:5], s[0:1], 0
  s_load_dwordx2 s[12:13], s[0:1], 32
  s_load_dwordx2 s[8:9], s[0:1], 48
  v_lshrrev_b32 v5, 6, v0
  v_and_b32 v4, 63, v0
  v_readfirstlane_b32 s16, v5
  s_waitcnt lgkmcnt(0)
  s_mov_b32 s6, 109734912
  s_mov_b32 s7, 0x20000
  s_mov_b32 s10, 1253376
  s_mov_b32 s11, 0x20000
  s_mov_b32 s14, 109734912
  s_mov_b32 s15, 0x20000
  s_and_b32 s50, s2, 7
  s_mul_i32 s51, s50, 30
  s_min_u32 s50, s50, 3
  s_add_u32 s51, s51, s50
  s_lshr_b32 s50, s2, 3
  s_add_u32 s17, s51, s50
  s_lshl_b32 s54, s16, 2
  s_lshr_b32 s55, 0x3216, s54
  s_and_b32 s55, s55, 15
  s_lshr_b32 s56, 0xf450, s54
  s_and_b32 s56, s56, 15
  s_lshl_b32 s61, s55, 10
  s_add_u32 s61, s61, 118400
  s_lshl_b32 s62, s56, 10
  s_add_u32 s62, s62, 118400
  s_cmp_eq_u32 s56, 15
  s_cselect_b32 s62, 0x30000, s62
  s_lshl_b32 s49, s55, 5
  s_lshl_b32 s71, s56, 5
  s_mul_i32 s52, s17, 3237
  s_lshr_b32 s52, s52, 20
  s_mul_i32 s53, s52, 324
  s_sub_u32 s53, s17, s53
  s_mul_i32 s50, s53, 10923
  s_lshr_b32 s50, s50, 16
  s_mul_i32 s51, s50, 6
  s_sub_u32 s51, s53, s51
  s_mul_i32 s52, s52, 6
  s_add_u32 s51, s51, s52
  s_mul_i32 s52, s50, 2646
  s_mul_i32 s53, s51, 21
  s_add_u32 s52, s52, s53
  s_mul_i32 s52, s52, 768
  s_mul_i32 s53, s16, 192
  s_add_u32 s65, s52, s53
  s_sub_u32 s22, s52, 291072
  s_mov_b32 s23, 99
  s_cmp_eq_u32 s50, 0
  s_cselect_b32 s23, 0, s23
  s_cmp_eq_u32 s50, 53
  s_cselect_b32 s23, 8, s23
  s_mov_b32 s66, 99
  s_cmp_eq_u32 s51, 0
  s_cselect_b32 s66, 0, s66
  s_cmp_eq_u32 s51, 17
  s_cselect_b32 s66, 22, s66
  s_cmp_ge_u32 s17, 972
  s_cselect_b32 s22, 0x80000000, s22
  v_lshrrev_b32 v36, 1, v4
  v_add_u32 v36, s49, v36
  v_mul_u32_u24 v37, 2850, v36
  v_lshrrev_b32 v37, 16, v37
  v_mul_u32_u24 v38, 23, v37
  v_sub_u32 v38, v36, v38
  v_mul_u32_u24 v39, 378, v37
  v_add_u32 v39, v39, v38
  v_mul_u32_u24 v39, 768, v39
  v_and_b32 v17, 1, v4
  v_lshl_add_u32 v39, v17, 4, v39
  v_add_u32 v17, s22, v39
  v_mov_b32 v22, 0xc0000000
  v_cmp_le_u32 vcc, 207, v36
  s_nop 1
  v_cndmask_b32 v17, v17, v22, vcc
  v_cmp_eq_u32 vcc, s23, v37
  s_nop 1
  v_cndmask_b32 v17, v17, v22, vcc
  v_cmp_eq_u32 vcc, s66, v38
  s_nop 1
  v_cndmask_b32 v17, v17, v22, vcc
  v_lshrrev_b32 v36, 1, v4
  v_add_u32 v36, s71, v36
  v_mul_u32_u24 v37, 2850, v36
  v_lshrrev_b32 v37, 16, v37
  v_mul_u32_u24 v38, 23, v37
  v_sub_u32 v38, v36, v38
  v_mul_u32_u24 v39, 378, v37
  v_add_u32 v39, v39, v38
  v_mul_u32_u24 v39, 768, v39
  v_and_b32 v18, 1, v4
  v_lshl_add_u32 v39, v18, 4, v39
  v_add_u32 v18, s22, v39
  v_mov_b32 v22, 0xc0000000
  v_cmp_le_u32 vcc, 207, v36
  s_nop 1
  v_cndmask_b32 v18, v18, v22, vcc
  v_cmp_eq_u32 vcc, s23, v37
  s_nop 1
  v_cndmask_b32 v18, v18, v22, vcc
  v_cmp_eq_u32 vcc, s66, v38
  s_nop 1
  v_cndmask_b32 v18, v18, v22, vcc
  s_max_i32 s57, s22, 0
  s_lshl_b32 s51, s16, 6
  v_add_u32 v46, s51, v4
  v_mul_u32_u24 v47, 2850, v46
  v_lshrrev_b32 v47, 16, v47
  v_mul_u32_u24 v7, 355, v47
  v_add_u32 v7, v7, v46
  v_mul_u32_u24 v7, 768, v7
  v_mov_b32 v47, 0x40000000
  v_cmp_le_u32 vcc, 207, v46
  s_nop 1
  v_cndmask_b32 v7, v7, v47, vcc
  s_cmp_ge_u32 s2, 120
  s_cbranch_scc1 L_st_np
  s_load_dwordx2 s[72:73], s[0:1], 48
  s_mov_b32 s74, 1253376
  s_mov_b32 s75, 0x20000
  s_waitcnt vmcnt(0) lgkmcnt(0)
  s_cmp_ge_u32 s2, 96
  s_cbranch_scc1 L_prep2_conv
  v_lshlrev_b32 v144, 16, v144
  v_lshlrev_b32 v145, 16, v145
  v_lshlrev_b32 v146, 16, v146
  v_lshlrev_b32 v147, 16, v147
  v_lshlrev_b32 v148, 16, v148
  v_lshlrev_b32 v149, 16, v149
  v_lshlrev_b32 v150, 16, v150
  v_lshlrev_b32 v151, 16, v151
  v_lshlrev_b32 v152, 16, v152
  v_lshlrev_b32 v153, 16, v153
  v_lshlrev_b32 v154, 16, v154
  v_lshlrev_b32 v155, 16, v155
  v_lshlrev_b32 v156, 16, v156
  v_lshlrev_b32 v157, 16, v157
  v_lshlrev_b32 v158, 16, v158
  v_lshlrev_b32 v159, 16, v159
  v_lshlrev_b32 v160, 16, v160
  v_lshlrev_b32 v161, 16, v161
  v_lshlrev_b32 v162, 16, v162
  v_lshlrev_b32 v163, 16, v163
  v_lshlrev_b32 v164, 16, v164
  v_lshlrev_b32 v165, 16, v165
  v_lshlrev_b32 v166, 16, v166
  v_lshlrev_b32 v167, 16, v167
  v_add_f32 v136, v144, v145
  v_add_f32 v136, v136, v146
  v_add_f32 v136, v136, v147
  v_add_f32 v136, v136, v148
  v_add_f32 v136, v136, v149
  v_add_f32 v136, v136, v150
  v_add_f32 v136, v136, v151
  v_add_f32 v136, v136, v152
  v_add_f32 v136, v136, v153
  v_add_f32 v136, v136, v154
  v_add_f32 v136, v136, v155
  v_add_f32 v136, v136, v156
  v_add_f32 v136, v136, v157
  v_add_f32 v136, v136, v158
  v_add_f32 v136, v136, v159
  v_add_f32 v136, v136, v160
  v_add_f32 v136, v136, v161
  v_add_f32 v136, v136, v162
  v_add_f32 v136, v136, v163
  v_add_f32 v136, v136, v164
  v_add_f32 v136, v136, v165
  v_add_f32 v136, v136, v166
  v_add_f32 v136, v136, v167
  v_lshlrev_b32 v137, 2, v128
  ds_write_b32 v137, v136
  s_waitcnt lgkmcnt(0)
  s_barrier
  v_lshlrev_b32 v137, 2, v131
  ds_read_b32 v176, v137 offset:0
  ds_read_b32 v177, v137 offset:64
  ds_read_b32 v178, v137 offset:128
  ds_read_b32 v179, v137 offset:192
  ds_read_b32 v180, v137 offset:256
  ds_read_b32 v181, v137 offset:320
  ds_read_b32 v182, v137 offset:384
  ds_read_b32 v183, v137 offset:448
  ds_read_b32 v184, v137 offset:512
  ds_read_b32 v185, v137 offset:576
  ds_read_b32 v186, v137 offset:640
  ds_read_b32 v187, v137 offset:704
  ds_read_b32 v188, v137 offset:768
  ds_read_b32 v189, v137 offset:832
  ds_read_b32 v190, v137 offset:896
  ds_read_b32 v191, v137 offset:960
  s_waitcnt lgkmcnt(0)
  v_add_f32 v136, v176, v177
  v_add_f32 v136, v136, v178
  v_add_f32 v136, v136, v179
  v_add_f32 v136, v136, v180
  v_add_f32 v136, v136, v181
  v_add_f32 v136, v136, v182
  v_add_f32 v136, v136, v183
  v_add_f32 v136, v136, v184
  v_add_f32 v136, v136, v185
  v_add_f32 v136, v136, v186
  v_add_f32 v136, v136, v187
  v_add_f32 v136, v136, v188
  v_add_f32 v136, v136, v189
  v_add_f32 v136, v136, v190
  v_add_f32 v136, v136, v191
  v_mul_f32 v136, s83, v136
  v_sub_f32 v137, 0, v136
  v_add_f32 v138, v144, v137
  v_cvt_pk_bf16_f32 v139, v138, v138
  v_lshlrev_b32 v144, 16, v139
  v_sub_f32 v137, v138, v144
  v_sub_f32 v137, v137, v136
  v_add_f32 v138, v145, v137
  v_cvt_pk_bf16_f32 v139, v138, v138
  v_lshlrev_b32 v145, 16, v139
  v_sub_f32 v137, v138, v145
  v_sub_f32 v137, v137, v136
  v_add_f32 v138, v146, v137
  v_cvt_pk_bf16_f32 v139, v138, v138
  v_lshlrev_b32 v146, 16, v139
  v_sub_f32 v137, v138, v146
  v_sub_f32 v137, v137, v136
  v_add_f32 v138, v147, v137
  v_cvt_pk_bf16_f32 v139, v138, v138
  v_lshlrev_b32 v147, 16, v139
  v_sub_f32 v137, v138, v147
  v_sub_f32 v137, v137, v136
  v_add_f32 v138, v148, v137
  v_cvt_pk_bf16_f32 v139, v138, v138
  v_lshlrev_b32 v148, 16, v139
  v_sub_f32 v137, v138, v148
  v_sub_f32 v137, v137, v136
  v_add_f32 v138, v149, v137
  v_cvt_pk_bf16_f32 v139, v138, v138
  v_lshlrev_b32 v149, 16, v139
  v_sub_f32 v137, v138, v149
  v_sub_f32 v137, v137, v136
  v_add_f32 v138, v150, v137
  v_cvt_pk_bf16_f32 v139, v138, v138
  v_lshlrev_b32 v150, 16, v139
  v_sub_f32 v137, v138, v150
  v_sub_f32 v137, v137, v136
  v_add_f32 v138, v151, v137
  v_cvt_pk_bf16_f32 v139, v138, v138
  v_lshlrev_b32 v151, 16, v139
  v_sub_f32 v137, v138, v151
  v_sub_f32 v137, v137, v136
  v_add_f32 v138, v152, v137
  v_cvt_pk_bf16_f32 v139, v138, v138
  v_lshlrev_b32 v152, 16, v139
  v_sub_f32 v137, v138, v152
  v_sub_f32 v137, v137, v136
  v_add_f32 v138, v153, v137
  v_cvt_pk_bf16_f32 v139, v138, v138
  v_lshlrev_b32 v153, 16, v139
  v_sub_f32 v137, v138, v153
  v_sub_f32 v137, v137, v136
  v_add_f32 v138, v154, v137
  v_cvt_pk_bf16_f32 v139, v138, v138
  v_lshlrev_b32 v154, 16, v139
  v_sub_f32 v137, v138, v154
  v_sub_f32 v137, v137, v136
  v_add_f32 v138, v155, v137
  v_cvt_pk_bf16_f32 v139, v138, v138
  v_lshlrev_b32 v155, 16, v139
  v_sub_f32 v137, v138, v155
  v_sub_f32 v137, v137, v136
  v_add_f32 v138, v156, v137
  v_cvt_pk_bf16_f32 v139, v138, v138
  v_lshlrev_b32 v156, 16, v139
  v_sub_f32 v137, v138, v156
  v_sub_f32 v137, v137, v136
  v_add_f32 v138, v157, v137
  v_cvt_pk_bf16_f32 v139, v138, v138
  v_lshlrev_b32 v157, 16, v139
  v_sub_f32 v137, v138, v157
  v_sub_f32 v137, v137, v136
  v_add_f32 v138, v158, v137
  v_cvt_pk_bf16_f32 v139, v138, v138
  v_lshlrev_b32 v158, 16, v139
  v_sub_f32 v137, v138, v158
  v_sub_f32 v137, v137, v136
  v_add_f32 v138, v159, v137
  v_cvt_pk_bf16_f32 v139, v138, v138
  v_lshlrev_b32 v159, 16, v139
  v_sub_f32 v137, v138, v159
  v_sub_f32 v137, v137, v136
  v_add_f32 v138, v160, v137
  v_cvt_pk_bf16_f32 v139, v138, v138
  v_lshlrev_b32 v160, 16, v139
  v_sub_f32 v137, v138, v160
  v_sub_f32 v137, v137, v136
  v_add_f32 v138, v161, v137
  v_cvt_pk_bf16_f32 v139, v138, v138
  v_lshlrev_b32 v161, 16, v139
  v_sub_f32 v137, v138, v161
  v_sub_f32 v137, v137, v136
  v_add_f32 v138, v162, v137
  v_cvt_pk_bf16_f32 v139, v138, v138
  v_lshlrev_b32 v162, 16, v139
  v_sub_f32 v137, v138, v162
  v_sub_f32 v137, v137, v136
  v_add_f32 v138, v163, v137
  v_cvt_pk_bf16_f32 v139, v138, v138
  v_lshlrev_b32 v163, 16, v139
  v_sub_f32 v137, v138, v163
  v_sub_f32 v137, v137, v136
  v_add_f32 v138, v164, v137
  v_cvt_pk_bf16_f32 v139, v138, v138
  v_lshlrev_b32 v164, 16, v139
  v_sub_f32 v137, v138, v164
  v_sub_f32 v137, v137, v136
  v_add_f32 v138, v165, v137
  v_cvt_pk_bf16_f32 v139, v138, v138
  v_lshlrev_b32 v165, 16, v139
  v_sub_f32 v137, v138, v165
  v_sub_f32 v137, v137, v136
  v_add_f32 v138, v166, v137
  v_cvt_pk_bf16_f32 v139, v138, v138
  v_lshlrev_b32 v166, 16, v139
  v_sub_f32 v137, v138, v166
  v_sub_f32 v137, v137, v136
  v_add_f32 v138, v167, v137
  v_cvt_pk_bf16_f32 v139, v138, v138
  v_lshlrev_b32 v167, 16, v139
  v_sub_f32 v137, v138, v167
  v_sub_f32 v137, v137, v136
  v_cvt_pk_bf16_f32 v176, v144, v145
  v_cvt_pk_bf16_f32 v177, v146, v147
  v_cvt_pk_bf16_f32 v178, v148, v149
  v_cvt_pk_bf16_f32 v179, v150, v151
  v_cvt_pk_bf16_f32 v180, v152, v153
  v_cvt_pk_bf16_f32 v181, v154, v155
  v_cvt_pk_bf16_f32 v182, v156, v157
  v_cvt_pk_bf16_f32 v183, v158, v159
  v_cvt_pk_bf16_f32 v184, v160, v161
  v_cvt_pk_bf16_f32 v185, v162, v163
  v_cvt_pk_bf16_f32 v186, v164, v165
  v_cvt_pk_bf16_f32 v187, v166, v167
  s_lshl_b32 s88, s81, 2
  s_add_u32 s88, s88, s87
  s_mul_i32 s88, s88, 72
  s_mul_i32 s89, s80, 3
  s_mul_i32 s90, s89, 6
  s_add_u32 s90, s90, s82
  s_lshr_b32 s91, s82, 1
  s_mul_i32 s91, s91, 24
  s_lshl_b32 s84, s89, 1
  s_add_u32 s91, s91, s84
  s_and_b32 s84, s82, 1
  s_add_u32 s91, s91, s84
  s_mov_b32 s84, 6144
  s_cmp_eq_u32 s87, 3
  s_cselect_b32 s90, s91, s90
  s_cselect_b32 s84, 2048, s84
  s_add_u32 s88, s88, s90
  s_lshl_b32 s88, s88, 10
  v_lshlrev_b32 v137, 4, v129
  buffer_store_dwordx4 v[176:179], v137, s[72:75], s88 offen sc1
  s_add_u32 s88, s88, s84
  buffer_store_dwordx4 v[180:183], v137, s[72:75], s88 offen sc1
  s_add_u32 s88, s88, s84
  buffer_store_dwordx4 v[184:187], v137, s[72:75], s88 offen sc1
  s_add_u32 s88, s88, s84
  s_branch L_prep2_end
L_prep2_conv:
  s_cmp_ge_u32 s80, 3
  s_cbranch_scc1 L_prep2_end
  s_cmp_eq_u32 s80, 1
  s_cselect_b32 s87, 2, 99
  v_mov_b32 v135, 0x3f80
  v_cmp_eq_u32 vcc, s87, v132
  s_nop 1
  v_cndmask_b32 v134, v134, v135, vcc
  s_cmp_eq_u32 s80, 0
  s_cselect_b64 s[84:85], -1, 0
  v_and_b32 v136, 1, v132
  v_lshrrev_b32 v137, 3, v131
  v_cmp_eq_u32 vcc, v136, v137
  v_and_b32 v138, 1, v131
  v_lshlrev_b32 v138, 4, v138
  v_lshlrev_b32 v139, v138, v134
  v_cndmask_b32 v139, 0, v139, vcc
  v_cndmask_b32 v139, v134, v139, s[84:85]
  v_and_b32 v140, 7, v131
  v_lshrrev_b32 v140, 1, v140
  v_lshrrev_b32 v141, 2, v131
  v_cndmask_b32 v140, v141, v140, s[84:85]
  v_cmp_eq_u32 vcc, 0, v140
  s_nop 1
  v_cndmask_b32 v144, 0, v139, vcc
  v_cmp_eq_u32 vcc, 1, v140
  s_nop 1
  v_cndmask_b32 v145, 0, v139, vcc
  v_cmp_eq_u32 vcc, 2, v140
  s_nop 1
  v_cndmask_b32 v146, 0, v139, vcc
  v_cmp_eq_u32 vcc, 3, v140
  s_nop 1
  v_cndmask_b32 v147, 0, v139, vcc
  s_mul_i32 s87, s81, 3
  s_add_u32 s87, s87, s80
  s_lshl_b32 s87, s87, 10
  s_add_u32 s87, s87, 1179648
  v_lshlrev_b32 v137, 4, v129
  buffer_store_dwordx4 v[144:147], v137, s[72:75], s87 offen sc1
  s_branch L_prep2_end
L_prep2_end:
  s_mov_b32 s18, 0
  s_mov_b32 s19, 0x80000000
  s_mov_b32 s20, 0x80000000
  s_mov_b32 s21, 0x80000000
  s_mov_b32 s38, 0xffff
  s_mov_b32 s39, 0
  s_mov_b32 s40, 0x10001
  s_mov_b32 s41, 0x10001
  s_mov_b32 s42, 0x20002
  s_mov_b32 s43, 0x20002
  s_mov_b32 s44, 0x40004
  s_mov_b32 s45, 0x40004
  s_mov_b32 s46, 0x3e16c740
  s_mov_b32 s47, 0x3b2aaaab
  s_mov_b32 s48, 0x3727c5ac
  s_mov_b32 s64, 0xff800000
  s_and_b32 s50, s16, 1
  s_mul_i32 s50, s50, 3072
  s_mul_i32 s51, s16, 294912
  s_add_u32 s50, s50, 1179648
  s_sub_u32 s24, s50, s51
  s_mul_i32 s37, s16, 192
  s_mul_i32 s52, s2, 21846
  s_lshr_b32 s52, s52, 16
  s_mul_i32 s52, s52, 3
  s_sub_u32 s31, s2, s52
  s_mov_b32 s67, 0x40000000
  s_mov_b32 s68, 162976
  v_lshlrev_b32 v3, 4, v4
  v_add_u32 v3, s51, v3
  v_and_b32 v8, 15, v4
  v_lshrrev_b32 v9, 4, v4
  v_lshrrev_b32 v10, 2, v8
  v_xor_b32 v10, v9, v10
  v_lshlrev_b32 v10, 4, v10
  v_mul_u32_u24 v0, 800, v8
  v_add_u32 v0, v0, v10
  v_add_u32 v1, 64000, v0
  v_min_u32 v10, 3, v8
  v_lshlrev_b32 v11, 4, v9
  v_add_u32 v10, 144, v10
  v_mul_u32_u24 v2, 800, v10
  v_add_u32 v2, v2, v11
  v_add_u32 v10, 0, v8
  v_mul_u32_u24 v11, 9363, v10
  v_lshrrev_b32 v11, 16, v11
  v_mul_u32_u24 v12, 7, v11
  v_sub_u32 v12, v10, v12
  v_mul_u32_u24 v11, 378, v11
  v_add_u32 v11, v11, v12
  v_mul_u32_u24 v11, 768, v11
  v_lshl_add_u32 v11, v9, 4, v11
  v_accvgpr_write_b32 a4, v11
  v_add_u32 v10, 16, v8
  v_mul_u32_u24 v11, 9363, v10
  v_lshrrev_b32 v11, 16, v11
  v_mul_u32_u24 v12, 7, v11
  v_sub_u32 v12, v10, v12
  v_mul_u32_u24 v11, 378, v11
  v_add_u32 v11, v11, v12
  v_mul_u32_u24 v11, 768, v11
  v_lshl_add_u32 v11, v9, 4, v11
  v_accvgpr_write_b32 a5, v11
  v_add_u32 v10, 32, v8
  v_mul_u32_u24 v11, 9363, v10
  v_lshrrev_b32 v11, 16, v11
  v_mul_u32_u24 v12, 7, v11
  v_sub_u32 v12, v10, v12
  v_mul_u32_u24 v11, 378, v11
  v_add_u32 v11, v11, v12
  v_mul_u32_u24 v11, 768, v11
  v_lshl_add_u32 v11, v9, 4, v11
  v_accvgpr_write_b32 a6, v11
  v_mul_u32_u24 v11, 7, v8
  v_add_u32 v11, 2274, v11
  v_mul_u32_u24 v11, 768, v11
  v_lshl_add_u32 v11, v9, 4, v11
  v_mov_b32 v15, 0x40000000
  v_cmp_le_u32 vcc, 3, v8
  s_nop 1
  v_cndmask_b32 v11, v11, v15, vcc
  v_accvgpr_write_b32 a7, v11
  v_lshrrev_b32 v10, 2, v8
  v_cmp_eq_u32 vcc, v10, v9
  v_and_b32 v11, 1, v8
  v_lshlrev_b32 v11, 4, v11
  v_mov_b32 v12, 0x3f80
  v_lshlrev_b32 v12, v11, v12
  v_cndmask_b32 v12, 0, v12, vcc
  v_and_b32 v13, 2, v8
  v_cmp_eq_u32 vcc, 0, v13
  s_nop 1
  v_cndmask_b32 v14, 0, v12, vcc
  v_cndmask_b32 v15, v12, 0, vcc
  v_mov_b32 v13, 0
  v_accvgpr_write_b32 a8, v14
  v_accvgpr_write_b32 a9, v15
  v_accvgpr_write_b32 a10, v13
  v_accvgpr_write_b32 a11, v13
  v_accvgpr_write_b32 a12, v13
  v_accvgpr_write_b32 a13, v13
  v_accvgpr_write_b32 a14, v14
  v_accvgpr_write_b32 a15, v15
  v_lshlrev_b32 v10, 4, v4
  v_add_u32 v10, 117600, v10
  v_mov_b32 v11, 0x30000
  v_cmp_le_u32 vcc, 50, v4
  s_nop 1
  v_cndmask_b32 v10, v10, v11, vcc
  v_mov_b32 v12, 0
  v_mov_b32 v13, 0
  v_mov_b32 v14, 0
  v_mov_b32 v15, 0
  ds_write_b128 v10, v[12:15]
  v_and_b32 v36, 15, v4
  v_lshrrev_b32 v37, 4, v4
  v_lshrrev_b32 v39, 1, v37
  v_mul_u32_u24 v16, 1440, v39
  v_lshlrev_b32 v39, 5, v39
  v_and_b32 v38, 1, v37
  v_lshl_add_u32 v39, v38, 4, v39
  s_and_b32 s50, s16, 1
  s_mul_i32 s51, s50, 6624
  s_add_u32 s51, s51, 118400
  v_add_u32 v39, s51, v39
  s_lshr_b32 s51, s16, 1
  s_cmp_eq_u32 s51, 0
  s_cselect_b64 s[52:53], -1, 0
  v_add_u32 v38, 0, v36
  v_mul_u32_u24 v22, 9363, v38
  v_lshrrev_b32 v22, 16, v22
  v_lshl_add_u32 v22, v22, 4, v38
  v_add_u32 v22, 0, v22
  v_add_u32 v38, 32, v36
  v_mul_u32_u24 v23, 9363, v38
  v_lshrrev_b32 v23, 16, v23
  v_lshl_add_u32 v23, v23, 4, v38
  v_add_u32 v23, 7, v23
  v_cndmask_b32 v22, v23, v22, s[52:53]
  v_lshl_add_u32 v8, v22, 5, v39
  v_add_u32 v38, 16, v36
  v_mul_u32_u24 v22, 9363, v38
  v_lshrrev_b32 v22, 16, v22
  v_lshl_add_u32 v22, v22, 4, v38
  v_add_u32 v22, 0, v22
  v_add_u32 v38, 0, v36
  v_mul_u32_u24 v23, 9363, v38
  v_lshrrev_b32 v23, 16, v23
  v_lshl_add_u32 v23, v23, 4, v38
  v_add_u32 v23, 14, v23
  v_cndmask_b32 v22, v23, v22, s[52:53]
  v_lshl_add_u32 v9, v22, 5, v39
  v_add_u32 v38, 32, v36
  v_mul_u32_u24 v22, 9363, v38
  v_lshrrev_b32 v22, 16, v22
  v_lshl_add_u32 v22, v22, 4, v38
  v_add_u32 v22, 0, v22
  v_add_u32 v38, 16, v36
  v_mul_u32_u24 v23, 9363, v38
  v_lshrrev_b32 v23, 16, v23
  v_lshl_add_u32 v23, v23, 4, v38
  v_add_u32 v23, 14, v23
  v_cndmask_b32 v22, v23, v22, s[52:53]
  v_lshl_add_u32 v10, v22, 5, v39
  v_add_u32 v38, 0, v36
  v_mul_u32_u24 v22, 9363, v38
  v_lshrrev_b32 v22, 16, v22
  v_lshl_add_u32 v22, v22, 4, v38
  v_add_u32 v22, 7, v22
  v_add_u32 v38, 32, v36
  v_mul_u32_u24 v23, 9363, v38
  v_lshrrev_b32 v23, 16, v23
  v_lshl_add_u32 v23, v23, 4, v38
  v_add_u32 v23, 14, v23
  v_cndmask_b32 v22, v23, v22, s[52:53]
  v_lshl_add_u32 v11, v22, 5, v39
  v_add_u32 v38, 16, v36
  v_mul_u32_u24 v22, 9363, v38
  v_lshrrev_b32 v22, 16, v22
  v_lshl_add_u32 v22, v22, 4, v38
  v_add_u32 v22, 7, v22
  v_min_u32 v23, 2, v36
  v_mul_u32_u24 v23, 7, v23
  v_add_u32 v23, 144, v23
  v_cndmask_b32 v22, v23, v22, s[52:53]
  v_lshl_add_u32 v12, v22, 5, v39
  v_lshrrev_b32 v38, 1, v37
  s_lshl_b32 s50, s50, 1
  v_add_u32 v38, s50, v38
  v_and_b32 v39, 1, v37
  v_lshlrev_b32 v39, 3, v39
  v_lshrrev_b32 v22, 2, v36
  v_xor_b32 v22, v38, v22
  v_lshl_add_u32 v22, v22, 4, v39
  v_mul_u32_u24 v37, 800, v36
  v_add_u32 v22, v22, v37
  s_mul_i32 s50, s51, 64000
  v_add_u32 v13, s50, v22
  v_add_u32 v22, 51200, v22
  v_min_u32 v14, 3, v36
  v_lshrrev_b32 v23, 2, v14
  v_xor_b32 v23, v38, v23
  v_lshl_add_u32 v23, v23, 4, v39
  v_mul_u32_u24 v37, 800, v14
  v_add_u32 v23, v23, v37
  v_add_u32 v23, 115200, v23
  v_mov_b32 v37, 0x30000
  v_cmp_le_u32 vcc, 3, v36
  s_nop 1
  v_cndmask_b32 v23, v23, v37, vcc
  v_cndmask_b32 v14, v23, v22, s[52:53]
  s_mul_i32 s51, s51, 640
  s_and_b32 s50, s16, 1
  s_mul_i32 s50, s50, 1280
  s_add_u32 s51, s51, s50
  s_add_u32 s51, s51, 159776
  v_lshlrev_b32 v21, 3, v36
  v_add_u32 v21, s51, v21
  v_lshrrev_b32 v22, 2, v36
  v_lshlrev_b32 v22, 2, v22
  v_and_b32 v23, 3, v36
  v_lshlrev_b32 v15, v22, v23
  s_add_u32 s58, s65, 0
  s_add_u32 s59, s65, 5376
  s_add_u32 s60, s65, 10752
  s_load_dwordx2 s[72:73], s[0:1], 40
  s_waitcnt lgkmcnt(0)
  s_mov_b32 s74, 256
  s_mov_b32 s75, 0x20000
  v_mov_b32 v41, 0
  v_mov_b32 v40, 0x40000000
  v_cmp_eq_u32 vcc, 0, v4
  s_nop 1
  v_cndmask_b32 v40, v40, 0, vcc
  s_waitcnt vmcnt(0)
  s_barrier
  s_cmp_lg_u32 s16, 0
  s_cbranch_scc1 L_st_a
  v_mov_b32 v41, 1
  buffer_atomic_add v41, v40, s[72:75], 0 offen sc0 sc1
  s_waitcnt vmcnt(0)
  v_readfirstlane_b32 s52, v41
  s_nop 3
  s_cmp_lg_u32 s52, 119
  s_cbranch_scc1 L_st_a
  v_mov_b32 v41, 1
  buffer_store_dword v41, v40, s[72:75], 0 offen offset:128 sc0 sc1
L_st_a:
  s_barrier
  s_load_dwordx2 s[76:77], s[0:1], 8
  v_and_b32 v48, 15, v4
  v_lshrrev_b32 v49, 4, v4
  v_lshlrev_b32 v50, 2, v49
  s_and_b32 s50, s16, 1
  s_lshl_b32 s50, s50, 4
  s_waitcnt lgkmcnt(0)
  s_mov_b32 s78, 6912
  s_mov_b32 s79, 0x20000
  s_mov_b32 s51, 0x1100
  v_lshrrev_b32 v51, v50, s51
  v_and_b32 v51, 15, v51
  v_mul_u32_u24 v51, 384, v51
  v_add_u32 v51, s50, v51
  v_add_u32 v51, v51, v48
  v_lshlrev_b32 v52, 1, v51
  buffer_load_ushort v56, v52, s[76:79], 0 offen offset:0
  buffer_load_ushort v59, v52, s[76:79], 0 offen offset:64
  s_mov_b32 s51, 0x5443
  v_lshrrev_b32 v51, v50, s51
  v_and_b32 v51, 15, v51
  v_mul_u32_u24 v51, 384, v51
  v_add_u32 v51, s50, v51
  v_add_u32 v51, v51, v48
  v_lshlrev_b32 v53, 1, v51
  buffer_load_ushort v57, v53, s[76:79], 0 offen offset:0
  buffer_load_ushort v60, v53, s[76:79], 0 offen offset:64
  s_mov_b32 s51, 0x8276
  v_lshrrev_b32 v51, v50, s51
  v_and_b32 v51, 15, v51
  v_mul_u32_u24 v51, 384, v51
  v_add_u32 v51, s50, v51
  v_add_u32 v51, v51, v48
  v_lshlrev_b32 v54, 1, v51
  buffer_load_ushort v58, v54, s[76:79], 0 offen offset:0
  buffer_load_ushort v61, v54, s[76:79], 0 offen offset:64
  s_mov_b32 s32, 0
  s_add_u32 m0, s61, 0
  s_nop 0
  buffer_load_dwordx4 v17, s[4:7], s32 offen offset:0 lds
  s_add_u32 m0, s61, 6592
  s_nop 0
  buffer_load_dwordx4 v17, s[4:7], s32 offen offset:32 lds
  s_add_u32 m0, s62, 0
  s_nop 0
  buffer_load_dwordx4 v18, s[4:7], s32 offen offset:0 lds
  s_add_u32 m0, s62, 6592
  s_nop 0
  buffer_load_dwordx4 v18, s[4:7], s32 offen offset:32 lds
  s_mov_b32 s33, 64
  s_add_u32 m0, s61, 13792
  s_nop 0
  buffer_load_dwordx4 v17, s[4:7], s33 offen offset:0 lds
  s_add_u32 m0, s61, 20384
  s_nop 0
  buffer_load_dwordx4 v17, s[4:7], s33 offen offset:32 lds
  s_add_u32 m0, s62, 13792
  s_nop 0
  buffer_load_dwordx4 v18, s[4:7], s33 offen offset:0 lds
  s_add_u32 m0, s62, 20384
  s_nop 0
  buffer_load_dwordx4 v18, s[4:7], s33 offen offset:32 lds
  s_mov_b32 s34, 128
  s_add_u32 m0, s61, 27584
  s_nop 0
  buffer_load_dwordx4 v17, s[4:7], s34 offen offset:0 lds
  s_add_u32 m0, s61, 34176
  s_nop 0
  buffer_load_dwordx4 v17, s[4:7], s34 offen offset:32 lds
  s_add_u32 m0, s62, 27584
  s_nop 0
  buffer_load_dwordx4 v18, s[4:7], s34 offen offset:0 lds
  s_add_u32 m0, s62, 34176
  s_nop 0
  buffer_load_dwordx4 v18, s[4:7], s34 offen offset:32 lds
  s_mov_b32 m0, 162720
  s_nop 0
  buffer_load_dword v7, s[4:7], s57 offen offset:256 lds
  s_mov_b32 m0, 162592
  s_nop 0
  buffer_load_dword v7, s[4:7], s57 offen offset:384 lds
  s_mov_b32 m0, 162464
  s_nop 0
  buffer_load_dword v7, s[4:7], s57 offen offset:512 lds
  s_branch L_st_j
L_st_np:
  s_load_dwordx2 s[76:77], s[0:1], 8
  v_and_b32 v48, 15, v4
  v_lshrrev_b32 v49, 4, v4
  v_lshlrev_b32 v50, 2, v49
  s_and_b32 s50, s16, 1
  s_lshl_b32 s50, s50, 4
  s_waitcnt lgkmcnt(0)
  s_mov_b32 s78, 6912
  s_mov_b32 s79, 0x20000
  s_mov_b32 s51, 0x1100
  v_lshrrev_b32 v51, v50, s51
  v_and_b32 v51, 15, v51
  v_mul_u32_u24 v51, 384, v51
  v_add_u32 v51, s50, v51
  v_add_u32 v51, v51, v48
  v_lshlrev_b32 v52, 1, v51
  buffer_load_ushort v56, v52, s[76:79], 0 offen offset:0
  buffer_load_ushort v59, v52, s[76:79], 0 offen offset:64
  s_mov_b32 s51, 0x5443
  v_lshrrev_b32 v51, v50, s51
  v_and_b32 v51, 15, v51
  v_mul_u32_u24 v51, 384, v51
  v_add_u32 v51, s50, v51
  v_add_u32 v51, v51, v48
  v_lshlrev_b32 v53, 1, v51
  buffer_load_ushort v57, v53, s[76:79], 0 offen offset:0
  buffer_load_ushort v60, v53, s[76:79], 0 offen offset:64
  s_mov_b32 s51, 0x8276
  v_lshrrev_b32 v51, v50, s51
  v_and_b32 v51, 15, v51
  v_mul_u32_u24 v51, 384, v51
  v_add_u32 v51, s50, v51
  v_add_u32 v51, v51, v48
  v_lshlrev_b32 v54, 1, v51
  buffer_load_ushort v58, v54, s[76:79], 0 offen offset:0
  buffer_load_ushort v61, v54, s[76:79], 0 offen offset:64
  s_mov_b32 s32, 0
  s_add_u32 m0, s61, 0
  s_nop 0
  buffer_load_dwordx4 v17, s[4:7], s32 offen offset:0 lds
  s_add_u32 m0, s61, 6592
  s_nop 0
  buffer_load_dwordx4 v17, s[4:7], s32 offen offset:32 lds
  s_add_u32 m0, s62, 0
  s_nop 0
  buffer_load_dwordx4 v18, s[4:7], s32 offen offset:0 lds
  s_add_u32 m0, s62, 6592
  s_nop 0
  buffer_load_dwordx4 v18, s[4:7], s32 offen offset:32 lds
  s_mov_b32 s33, 64
  s_add_u32 m0, s61, 13792
  s_nop 0
  buffer_load_dwordx4 v17, s[4:7], s33 offen offset:0 lds
  s_add_u32 m0, s61, 20384
  s_nop 0
  buffer_load_dwordx4 v17, s[4:7], s33 offen offset:32 lds
  s_add_u32 m0, s62, 13792
  s_nop 0
  buffer_load_dwordx4 v18, s[4:7], s33 offen offset:0 lds
  s_add_u32 m0, s62, 20384
  s_nop 0
  buffer_load_dwordx4 v18, s[4:7], s33 offen offset:32 lds
  s_mov_b32 s34, 128
  s_add_u32 m0, s61, 27584
  s_nop 0
  buffer_load_dwordx4 v17, s[4:7], s34 offen offset:0 lds
  s_add_u32 m0, s61, 34176
  s_nop 0
  buffer_load_dwordx4 v17, s[4:7], s34 offen offset:32 lds
  s_add_u32 m0, s62, 27584
  s_nop 0
  buffer_load_dwordx4 v18, s[4:7], s34 offen offset:0 lds
  s_add_u32 m0, s62, 34176
  s_nop 0
  buffer_load_dwordx4 v18, s[4:7], s34 offen offset:32 lds
  s_mov_b32 m0, 162720
  s_nop 0
  buffer_load_dword v7, s[4:7], s57 offen offset:256 lds
  s_mov_b32 m0, 162592
  s_nop 0
  buffer_load_dword v7, s[4:7], s57 offen offset:384 lds
  s_mov_b32 m0, 162464
  s_nop 0
  buffer_load_dword v7, s[4:7], s57 offen offset:512 lds
  s_mov_b32 s18, 0
  s_mov_b32 s19, 0x80000000
  s_mov_b32 s20, 0x80000000
  s_mov_b32 s21, 0x80000000
  s_mov_b32 s38, 0xffff
  s_mov_b32 s39, 0
  s_mov_b32 s40, 0x10001
  s_mov_b32 s41, 0x10001
  s_mov_b32 s42, 0x20002
  s_mov_b32 s43, 0x20002
  s_mov_b32 s44, 0x40004
  s_mov_b32 s45, 0x40004
  s_mov_b32 s46, 0x3e16c740
  s_mov_b32 s47, 0x3b2aaaab
  s_mov_b32 s48, 0x3727c5ac
  s_mov_b32 s64, 0xff800000
  s_and_b32 s50, s16, 1
  s_mul_i32 s50, s50, 3072
  s_mul_i32 s51, s16, 294912
  s_add_u32 s50, s50, 1179648
  s_sub_u32 s24, s50, s51
  s_mul_i32 s37, s16, 192
  s_mul_i32 s52, s2, 21846
  s_lshr_b32 s52, s52, 16
  s_mul_i32 s52, s52, 3
  s_sub_u32 s31, s2, s52
  s_mov_b32 s67, 0x40000000
  s_mov_b32 s68, 162976
  v_lshlrev_b32 v3, 4, v4
  v_add_u32 v3, s51, v3
  v_and_b32 v8, 15, v4
  v_lshrrev_b32 v9, 4, v4
  v_lshrrev_b32 v10, 2, v8
  v_xor_b32 v10, v9, v10
  v_lshlrev_b32 v10, 4, v10
  v_mul_u32_u24 v0, 800, v8
  v_add_u32 v0, v0, v10
  v_add_u32 v1, 64000, v0
  v_min_u32 v10, 3, v8
  v_lshlrev_b32 v11, 4, v9
  v_add_u32 v10, 144, v10
  v_mul_u32_u24 v2, 800, v10
  v_add_u32 v2, v2, v11
  v_add_u32 v10, 0, v8
  v_mul_u32_u24 v11, 9363, v10
  v_lshrrev_b32 v11, 16, v11
  v_mul_u32_u24 v12, 7, v11
  v_sub_u32 v12, v10, v12
  v_mul_u32_u24 v11, 378, v11
  v_add_u32 v11, v11, v12
  v_mul_u32_u24 v11, 768, v11
  v_lshl_add_u32 v11, v9, 4, v11
  v_accvgpr_write_b32 a4, v11
  v_add_u32 v10, 16, v8
  v_mul_u32_u24 v11, 9363, v10
  v_lshrrev_b32 v11, 16, v11
  v_mul_u32_u24 v12, 7, v11
  v_sub_u32 v12, v10, v12
  v_mul_u32_u24 v11, 378, v11
  v_add_u32 v11, v11, v12
  v_mul_u32_u24 v11, 768, v11
  v_lshl_add_u32 v11, v9, 4, v11
  v_accvgpr_write_b32 a5, v11
  v_add_u32 v10, 32, v8
  v_mul_u32_u24 v11, 9363, v10
  v_lshrrev_b32 v11, 16, v11
  v_mul_u32_u24 v12, 7, v11
  v_sub_u32 v12, v10, v12
  v_mul_u32_u24 v11, 378, v11
  v_add_u32 v11, v11, v12
  v_mul_u32_u24 v11, 768, v11
  v_lshl_add_u32 v11, v9, 4, v11
  v_accvgpr_write_b32 a6, v11
  v_mul_u32_u24 v11, 7, v8
  v_add_u32 v11, 2274, v11
  v_mul_u32_u24 v11, 768, v11
  v_lshl_add_u32 v11, v9, 4, v11
  v_mov_b32 v15, 0x40000000
  v_cmp_le_u32 vcc, 3, v8
  s_nop 1
  v_cndmask_b32 v11, v11, v15, vcc
  v_accvgpr_write_b32 a7, v11
  v_lshrrev_b32 v10, 2, v8
  v_cmp_eq_u32 vcc, v10, v9
  v_and_b32 v11, 1, v8
  v_lshlrev_b32 v11, 4, v11
  v_mov_b32 v12, 0x3f80
  v_lshlrev_b32 v12, v11, v12
  v_cndmask_b32 v12, 0, v12, vcc
  v_and_b32 v13, 2, v8
  v_cmp_eq_u32 vcc, 0, v13
  s_nop 1
  v_cndmask_b32 v14, 0, v12, vcc
  v_cndmask_b32 v15, v12, 0, vcc
  v_mov_b32 v13, 0
  v_accvgpr_write_b32 a8, v14
  v_accvgpr_write_b32 a9, v15
  v_accvgpr_write_b32 a10, v13
  v_accvgpr_write_b32 a11, v13
  v_accvgpr_write_b32 a12, v13
  v_accvgpr_write_b32 a13, v13
  v_accvgpr_write_b32 a14, v14
  v_accvgpr_write_b32 a15, v15
  v_lshlrev_b32 v10, 4, v4
  v_add_u32 v10, 117600, v10
  v_mov_b32 v11, 0x30000
  v_cmp_le_u32 vcc, 50, v4
  s_nop 1
  v_cndmask_b32 v10, v10, v11, vcc
  v_mov_b32 v12, 0
  v_mov_b32 v13, 0
  v_mov_b32 v14, 0
  v_mov_b32 v15, 0
  ds_write_b128 v10, v[12:15]
  v_and_b32 v36, 15, v4
  v_lshrrev_b32 v37, 4, v4
  v_lshrrev_b32 v39, 1, v37
  v_mul_u32_u24 v16, 1440, v39
  v_lshlrev_b32 v39, 5, v39
  v_and_b32 v38, 1, v37
  v_lshl_add_u32 v39, v38, 4, v39
  s_and_b32 s50, s16, 1
  s_mul_i32 s51, s50, 6624
  s_add_u32 s51, s51, 118400
  v_add_u32 v39, s51, v39
  s_lshr_b32 s51, s16, 1
  s_cmp_eq_u32 s51, 0
  s_cselect_b64 s[52:53], -1, 0
  v_add_u32 v38, 0, v36
  v_mul_u32_u24 v22, 9363, v38
  v_lshrrev_b32 v22, 16, v22
  v_lshl_add_u32 v22, v22, 4, v38
  v_add_u32 v22, 0, v22
  v_add_u32 v38, 32, v36
  v_mul_u32_u24 v23, 9363, v38
  v_lshrrev_b32 v23, 16, v23
  v_lshl_add_u32 v23, v23, 4, v38
  v_add_u32 v23, 7, v23
  v_cndmask_b32 v22, v23, v22, s[52:53]
  v_lshl_add_u32 v8, v22, 5, v39
  v_add_u32 v38, 16, v36
  v_mul_u32_u24 v22, 9363, v38
  v_lshrrev_b32 v22, 16, v22
  v_lshl_add_u32 v22, v22, 4, v38
  v_add_u32 v22, 0, v22
  v_add_u32 v38, 0, v36
  v_mul_u32_u24 v23, 9363, v38
  v_lshrrev_b32 v23, 16, v23
  v_lshl_add_u32 v23, v23, 4, v38
  v_add_u32 v23, 14, v23
  v_cndmask_b32 v22, v23, v22, s[52:53]
  v_lshl_add_u32 v9, v22, 5, v39
  v_add_u32 v38, 32, v36
  v_mul_u32_u24 v22, 9363, v38
  v_lshrrev_b32 v22, 16, v22
  v_lshl_add_u32 v22, v22, 4, v38
  v_add_u32 v22, 0, v22
  v_add_u32 v38, 16, v36
  v_mul_u32_u24 v23, 9363, v38
  v_lshrrev_b32 v23, 16, v23
  v_lshl_add_u32 v23, v23, 4, v38
  v_add_u32 v23, 14, v23
  v_cndmask_b32 v22, v23, v22, s[52:53]
  v_lshl_add_u32 v10, v22, 5, v39
  v_add_u32 v38, 0, v36
  v_mul_u32_u24 v22, 9363, v38
  v_lshrrev_b32 v22, 16, v22
  v_lshl_add_u32 v22, v22, 4, v38
  v_add_u32 v22, 7, v22
  v_add_u32 v38, 32, v36
  v_mul_u32_u24 v23, 9363, v38
  v_lshrrev_b32 v23, 16, v23
  v_lshl_add_u32 v23, v23, 4, v38
  v_add_u32 v23, 14, v23
  v_cndmask_b32 v22, v23, v22, s[52:53]
  v_lshl_add_u32 v11, v22, 5, v39
  v_add_u32 v38, 16, v36
  v_mul_u32_u24 v22, 9363, v38
  v_lshrrev_b32 v22, 16, v22
  v_lshl_add_u32 v22, v22, 4, v38
  v_add_u32 v22, 7, v22
  v_min_u32 v23, 2, v36
  v_mul_u32_u24 v23, 7, v23
  v_add_u32 v23, 144, v23
  v_cndmask_b32 v22, v23, v22, s[52:53]
  v_lshl_add_u32 v12, v22, 5, v39
  v_lshrrev_b32 v38, 1, v37
  s_lshl_b32 s50, s50, 1
  v_add_u32 v38, s50, v38
  v_and_b32 v39, 1, v37
  v_lshlrev_b32 v39, 3, v39
  v_lshrrev_b32 v22, 2, v36
  v_xor_b32 v22, v38, v22
  v_lshl_add_u32 v22, v22, 4, v39
  v_mul_u32_u24 v37, 800, v36
  v_add_u32 v22, v22, v37
  s_mul_i32 s50, s51, 64000
  v_add_u32 v13, s50, v22
  v_add_u32 v22, 51200, v22
  v_min_u32 v14, 3, v36
  v_lshrrev_b32 v23, 2, v14
  v_xor_b32 v23, v38, v23
  v_lshl_add_u32 v23, v23, 4, v39
  v_mul_u32_u24 v37, 800, v14
  v_add_u32 v23, v23, v37
  v_add_u32 v23, 115200, v23
  v_mov_b32 v37, 0x30000
  v_cmp_le_u32 vcc, 3, v36
  s_nop 1
  v_cndmask_b32 v23, v23, v37, vcc
  v_cndmask_b32 v14, v23, v22, s[52:53]
  s_mul_i32 s51, s51, 640
  s_and_b32 s50, s16, 1
  s_mul_i32 s50, s50, 1280
  s_add_u32 s51, s51, s50
  s_add_u32 s51, s51, 159776
  v_lshlrev_b32 v21, 3, v36
  v_add_u32 v21, s51, v21
  v_lshrrev_b32 v22, 2, v36
  v_lshlrev_b32 v22, 2, v22
  v_and_b32 v23, 3, v36
  v_lshlrev_b32 v15, v22, v23
  s_add_u32 s58, s65, 0
  s_add_u32 s59, s65, 5376
  s_add_u32 s60, s65, 10752
  s_load_dwordx2 s[72:73], s[0:1], 40
  s_waitcnt lgkmcnt(0)
  s_mov_b32 s74, 256
  s_mov_b32 s75, 0x20000
  v_mov_b32 v41, 0
  v_mov_b32 v40, 0x40000000
  v_cmp_eq_u32 vcc, 0, v4
  s_nop 1
  v_cndmask_b32 v40, v40, 0, vcc
L_st_j:
  s_waitcnt vmcnt(15)
  v_and_b32 v62, 1, v49
  v_lshrrev_b32 v63, 3, v48
  v_cmp_eq_u32 s[50:51], v62, v63
  v_and_b32 v64, 1, v48
  v_lshlrev_b32 v64, 4, v64
  v_and_b32 v65, 7, v48
  v_lshrrev_b32 v65, 1, v65
  v_lshrrev_b32 v66, 2, v48
  v_mov_b32 v67, 0x3f80
  v_cmp_eq_u32 s[52:53], 2, v49
  v_lshlrev_b32 v68, v64, v56
  v_cndmask_b32 v68, 0, v68, s[50:51]
  v_cndmask_b32 v69, v57, v67, s[52:53]
  v_cmp_eq_u32 vcc, 0, v65
  s_nop 1
  v_cndmask_b32 v70, 0, v68, vcc
  v_accvgpr_write_b32 a176, v70
  v_cmp_eq_u32 vcc, 1, v65
  s_nop 1
  v_cndmask_b32 v70, 0, v68, vcc
  v_accvgpr_write_b32 a177, v70
  v_cmp_eq_u32 vcc, 2, v65
  s_nop 1
  v_cndmask_b32 v70, 0, v68, vcc
  v_accvgpr_write_b32 a178, v70
  v_cmp_eq_u32 vcc, 3, v65
  s_nop 1
  v_cndmask_b32 v70, 0, v68, vcc
  v_accvgpr_write_b32 a179, v70
  v_cmp_eq_u32 vcc, 0, v66
  s_nop 1
  v_cndmask_b32 v70, 0, v69, vcc
  v_accvgpr_write_b32 a180, v70
  v_cmp_eq_u32 vcc, 1, v66
  s_nop 1
  v_cndmask_b32 v70, 0, v69, vcc
  v_accvgpr_write_b32 a181, v70
  v_cmp_eq_u32 vcc, 2, v66
  s_nop 1
  v_cndmask_b32 v70, 0, v69, vcc
  v_accvgpr_write_b32 a182, v70
  v_cmp_eq_u32 vcc, 3, v66
  s_nop 1
  v_cndmask_b32 v70, 0, v69, vcc
  v_accvgpr_write_b32 a183, v70
  v_cmp_eq_u32 vcc, 0, v66
  s_nop 1
  v_cndmask_b32 v70, 0, v58, vcc
  v_accvgpr_write_b32 a184, v70
  v_cmp_eq_u32 vcc, 1, v66
  s_nop 1
  v_cndmask_b32 v70, 0, v58, vcc
  v_accvgpr_write_b32 a185, v70
  v_cmp_eq_u32 vcc, 2, v66
  s_nop 1
  v_cndmask_b32 v70, 0, v58, vcc
  v_accvgpr_write_b32 a186, v70
  v_cmp_eq_u32 vcc, 3, v66
  s_nop 1
  v_cndmask_b32 v70, 0, v58, vcc
  v_accvgpr_write_b32 a187, v70
  v_lshlrev_b32 v68, v64, v59
  v_cndmask_b32 v68, 0, v68, s[50:51]
  v_cndmask_b32 v69, v60, v67, s[52:53]
  v_cmp_eq_u32 vcc, 0, v65
  s_nop 1
  v_cndmask_b32 v70, 0, v68, vcc
  v_accvgpr_write_b32 a188, v70
  v_cmp_eq_u32 vcc, 1, v65
  s_nop 1
  v_cndmask_b32 v70, 0, v68, vcc
  v_accvgpr_write_b32 a189, v70
  v_cmp_eq_u32 vcc, 2, v65
  s_nop 1
  v_cndmask_b32 v70, 0, v68, vcc
  v_accvgpr_write_b32 a190, v70
  v_cmp_eq_u32 vcc, 3, v65
  s_nop 1
  v_cndmask_b32 v70, 0, v68, vcc
  v_accvgpr_write_b32 a191, v70
  v_cmp_eq_u32 vcc, 0, v66
  s_nop 1
  v_cndmask_b32 v70, 0, v69, vcc
  v_accvgpr_write_b32 a192, v70
  v_cmp_eq_u32 vcc, 1, v66
  s_nop 1
  v_cndmask_b32 v70, 0, v69, vcc
  v_accvgpr_write_b32 a193, v70
  v_cmp_eq_u32 vcc, 2, v66
  s_nop 1
  v_cndmask_b32 v70, 0, v69, vcc
  v_accvgpr_write_b32 a194, v70
  v_cmp_eq_u32 vcc, 3, v66
  s_nop 1
  v_cndmask_b32 v70, 0, v69, vcc
  v_accvgpr_write_b32 a195, v70
  v_cmp_eq_u32 vcc, 0, v66
  s_nop 1
  v_cndmask_b32 v70, 0, v61, vcc
  v_accvgpr_write_b32 a196, v70
  v_cmp_eq_u32 vcc, 1, v66
  s_nop 1
  v_cndmask_b32 v70, 0, v61, vcc
  v_accvgpr_write_b32 a197, v70
  v_cmp_eq_u32 vcc, 2, v66
  s_nop 1
  v_cndmask_b32 v70, 0, v61, vcc
  v_accvgpr_write_b32 a198, v70
  v_cmp_eq_u32 vcc, 3, v66
  s_nop 1
  v_cndmask_b32 v70, 0, v61, vcc
  v_accvgpr_write_b32 a199, v70
  s_waitcnt vmcnt(3)
  s_barrier
  ds_read_b128 a[116:119], v8 offset:0
  v_add_u32 v22, v8, v16
  ds_read_b128 a[120:123], v8 offset:736
  v_add_u32 v23, v9, v16
  s_mov_b32 s32, 192
  s_add_u32 m0, s61, 0
  ds_read_b128 a[124:127], v8 offset:768
  ds_read_b128 a[128:131], v8 offset:1472
  ds_read_b128 a[132:135], v22 offset:64
  v_add_u32 v22, v10, v16
  ds_read_b128 a[136:139], v9 offset:0
  ds_read_b128 a[140:143], v9 offset:736
  ds_read_b128 a[144:147], v9 offset:768
  ds_read_b128 a[148:151], v9 offset:1472
  ds_read_b128 a[152:155], v23 offset:64
  v_add_u32 v23, v11, v16
  ds_read_b128 a[156:159], v10 offset:0
  ds_read_b128 a[160:163], v10 offset:736
  ds_read_b128 a[164:167], v10 offset:768
  s_waitcnt lgkmcnt(12)
  v_mfma_f32_16x16x32_bf16 v[24:27], a[176:179], a[116:119], 0
  ds_read_b128 a[168:171], v10 offset:1472
  ds_read_b128 a[172:175], v22 offset:64
  v_add_u32 v22, v12, v16
  s_waitcnt lgkmcnt(12)
  v_smfmac_f32_16x16x64_bf16 v[24:27], a[180:183], a[120:127], v15
  s_waitcnt lgkmcnt(10)
  ds_read_b128 a[116:119], v11 offset:0
  ds_read_b128 a[120:123], v11 offset:736
  v_smfmac_f32_16x16x64_bf16 v[24:27], a[184:187], a[128:135], v15
  s_waitcnt lgkmcnt(11)
  ds_read_b128 a[124:127], v11 offset:768
  v_mfma_f32_16x16x32_bf16 v[28:31], a[176:179], a[136:139], 0
  ds_read_b128 a[128:131], v11 offset:1472
  ds_read_b128 a[132:135], v23 offset:64
  v_add_u32 v23, v8, v16
  s_nop 0
  v_mul_f32 v37, v24, v24
  s_waitcnt lgkmcnt(12)
  v_smfmac_f32_16x16x64_bf16 v[28:31], a[180:183], a[140:147], v15
  ds_read_b128 a[136:139], v12 offset:0
  v_add_f32 v36, v24, v25
  ds_read_b128 a[140:143], v12 offset:736
  v_fmac_f32 v37, v25, v25
  v_add_f32 v36, v36, v26
  s_waitcnt lgkmcnt(12)
  v_smfmac_f32_16x16x64_bf16 v[28:31], a[184:187], a[148:155], v15
  ds_read_b128 a[144:147], v12 offset:768
  v_fmac_f32 v37, v26, v26
  ds_read_b128 a[148:151], v12 offset:1472
  v_cvt_pk_bf16_f32 v32, v24, v25
  v_cvt_pk_bf16_f32 v33, v26, v27
  v_add_f32 v36, v36, v27
  ds_read_b128 a[152:155], v22 offset:64
  v_fmac_f32 v37, v27, v27
  s_waitcnt lgkmcnt(14)
  v_mfma_f32_16x16x32_bf16 v[24:27], a[176:179], a[156:159], 0
  s_waitcnt lgkmcnt(12)
  v_mul_f32 v39, v28, v28
  v_add_f32 v38, v28, v29
  v_smfmac_f32_16x16x64_bf16 v[24:27], a[180:183], a[160:167], v15
  s_waitcnt lgkmcnt(10)
  v_fmac_f32 v39, v29, v29
  v_add_f32 v38, v38, v30
  v_smfmac_f32_16x16x64_bf16 v[24:27], a[184:187], a[168:175], v15
  v_fmac_f32 v39, v30, v30
  v_cvt_pk_bf16_f32 v34, v28, v29
  v_cvt_pk_bf16_f32 v35, v30, v31
  v_add_f32 v38, v38, v31
  v_fmac_f32 v39, v31, v31
  s_waitcnt lgkmcnt(9)
  v_mfma_f32_16x16x32_bf16 v[28:31], a[176:179], a[116:119], 0
  ds_read_b128 a[156:159], v8 offset:13792
  v_add_u32 v22, v9, v16
  ds_read_b128 a[160:163], v8 offset:14528
  s_waitcnt lgkmcnt(9)
  v_smfmac_f32_16x16x64_bf16 v[28:31], a[180:183], a[120:127], v15
  ds_read_b128 a[116:119], v9 offset:13792
  v_mul_f32 v41, v24, v24
  v_add_f32 v40, v24, v25
  v_fmac_f32 v41, v25, v25
  ds_read_b128 a[164:167], v8 offset:14560
  s_waitcnt lgkmcnt(9)
  v_smfmac_f32_16x16x64_bf16 v[28:31], a[184:187], a[128:135], v15
  ds_read_b128 a[120:123], v9 offset:14528
  v_add_f32 v40, v40, v26
  v_fmac_f32 v41, v26, v26
  v_add_f32 v40, v40, v27
  ds_read_b128 a[124:127], v9 offset:14560
  v_fmac_f32 v41, v27, v27
  ds_read_b128 a[168:171], v8 offset:15264
  s_nop 0
  v_mul_f32 v43, v28, v28
  v_add_f32 v42, v28, v29
  v_fmac_f32 v43, v29, v29
  ds_read_b128 a[172:175], v23 offset:13856
  v_add_u32 v23, v10, v16
  v_add_f32 v42, v42, v30
  v_fmac_f32 v43, v30, v30
  ds_read_b128 a[128:131], v9 offset:15264
  v_add_f32 v42, v42, v31
  v_fmac_f32 v43, v31, v31
  ds_read_b128 a[132:135], v22 offset:13856
  v_add_u32 v22, v11, v16
  ds_write_b64 v13, v[32:33] offset:0
  v_cvt_pk_bf16_f32 v32, v24, v25
  v_cvt_pk_bf16_f32 v33, v26, v27
  s_waitcnt lgkmcnt(15)
  v_mfma_f32_16x16x32_bf16 v[24:27], a[176:179], a[136:139], 0
  s_waitcnt lgkmcnt(13)
  ds_write_b64 v13, v[34:35] offset:12800
  v_smfmac_f32_16x16x64_bf16 v[24:27], a[180:183], a[140:147], v15
  s_waitcnt lgkmcnt(12)
  v_cvt_pk_bf16_f32 v34, v28, v29
  v_smfmac_f32_16x16x64_bf16 v[24:27], a[184:187], a[148:155], v15
  s_waitcnt lgkmcnt(11)
  ds_read_b128 a[136:139], v10 offset:13792
  v_cvt_pk_bf16_f32 v35, v30, v31
  v_mfma_f32_16x16x32_bf16 v[28:31], a[188:191], a[156:159], 0
  s_waitcnt lgkmcnt(9)
  ds_read_b128 a[140:143], v10 offset:14528
  v_smfmac_f32_16x16x64_bf16 v[28:31], a[192:195], a[160:167], v15
  ds_read_b128 a[144:147], v10 offset:14560
  v_mul_f32 v45, v24, v24
  ds_read_b128 a[148:151], v10 offset:15264
  v_add_f32 v44, v24, v25
  v_fmac_f32 v45, v25, v25
  v_add_f32 v44, v44, v26
  ds_read_b128 a[152:155], v23 offset:13856
  v_fmac_f32 v45, v26, v26
  v_add_f32 v44, v44, v27
  v_fmac_f32 v45, v27, v27
  ds_write_b64 v13, v[32:33] offset:25600
  s_waitcnt lgkmcnt(10)
  v_smfmac_f32_16x16x64_bf16 v[28:31], a[196:199], a[168:175], v15
  v_cvt_pk_bf16_f32 v32, v24, v25
  v_cvt_pk_bf16_f32 v33, v26, v27
  v_mfma_f32_16x16x32_bf16 v[24:27], a[188:191], a[116:119], 0
  ds_read_b128 a[156:159], v11 offset:13792
  v_add_u32 v23, v12, v16
  v_smfmac_f32_16x16x64_bf16 v[24:27], a[192:195], a[120:127], v15
  s_waitcnt lgkmcnt(8)
  ds_read_b128 a[116:119], v12 offset:13792
  v_smfmac_f32_16x16x64_bf16 v[24:27], a[196:199], a[128:135], v15
  ds_read_b128 a[160:163], v11 offset:14528
  v_add_f32 v36, v36, v28
  ds_read_b128 a[164:167], v11 offset:14560
  v_fmac_f32 v37, v28, v28
  v_add_f32 v36, v36, v29
  v_fmac_f32 v37, v29, v29
  ds_read_b128 a[120:123], v12 offset:14528
  v_add_f32 v36, v36, v30
  v_fmac_f32 v37, v30, v30
  v_add_f32 v36, v36, v31
  ds_read_b128 a[124:127], v12 offset:14560
  v_fmac_f32 v37, v31, v31
  v_add_f32 v38, v38, v24
  v_fmac_f32 v39, v24, v24
  ds_read_b128 a[168:171], v11 offset:15264
  v_add_f32 v38, v38, v25
  v_fmac_f32 v39, v25, v25
  v_add_f32 v38, v38, v26
  ds_read_b128 a[172:175], v22 offset:13856
  v_fmac_f32 v39, v26, v26
  v_add_f32 v38, v38, v27
  v_fmac_f32 v39, v27, v27
  ds_read_b128 a[128:131], v12 offset:15264
  ds_read_b128 a[132:135], v23 offset:13856
  ds_write_b64 v13, v[34:35] offset:38400
  v_cvt_pk_bf16_f32 v34, v28, v29
  v_cvt_pk_bf16_f32 v35, v30, v31
  s_waitcnt lgkmcnt(15)
  v_mfma_f32_16x16x32_bf16 v[28:31], a[188:191], a[136:139], 0
  s_waitcnt lgkmcnt(14)
  ds_write_b64 v14, v[32:33] offset:0
  v_smfmac_f32_16x16x64_bf16 v[28:31], a[192:195], a[140:147], v15
  s_waitcnt lgkmcnt(12)
  v_cvt_pk_bf16_f32 v32, v24, v25
  v_smfmac_f32_16x16x64_bf16 v[28:31], a[196:199], a[148:155], v15
  s_waitcnt lgkmcnt(11)
  ds_write_b64 v13, v[34:35] offset:64
  v_cvt_pk_bf16_f32 v33, v26, v27
  v_mfma_f32_16x16x32_bf16 v[24:27], a[188:191], a[156:159], 0
  s_waitcnt lgkmcnt(9)
  ds_write_b64 v13, v[32:33] offset:12864
  v_smfmac_f32_16x16x64_bf16 v[24:27], a[192:195], a[160:167], v15
  v_add_f32 v40, v40, v28
  v_fmac_f32 v41, v28, v28
  v_add_f32 v40, v40, v29
  v_fmac_f32 v41, v29, v29
  v_add_f32 v40, v40, v30
  v_fmac_f32 v41, v30, v30
  v_cvt_pk_bf16_f32 v34, v28, v29
  v_cvt_pk_bf16_f32 v35, v30, v31
  v_add_f32 v40, v40, v31
  v_fmac_f32 v41, v31, v31
  s_waitcnt lgkmcnt(6)
  v_smfmac_f32_16x16x64_bf16 v[24:27], a[196:199], a[168:175], v15
  ds_write_b64 v13, v[34:35] offset:25664
  v_mfma_f32_16x16x32_bf16 v[28:31], a[188:191], a[116:119], 0
  v_smfmac_f32_16x16x64_bf16 v[28:31], a[192:195], a[120:127], v15
  s_waitcnt lgkmcnt(4)
  v_cvt_pk_bf16_f32 v32, v24, v25
  v_smfmac_f32_16x16x64_bf16 v[28:31], a[196:199], a[128:135], v15
  v_cvt_pk_bf16_f32 v33, v26, v27
  ds_write_b64 v13, v[32:33] offset:38464
  v_add_f32 v42, v42, v24
  v_fmac_f32 v43, v24, v24
  v_add_f32 v42, v42, v25
  v_fmac_f32 v43, v25, v25
  s_nop 1
  v_cvt_pk_bf16_f32 v34, v28, v29
  v_cvt_pk_bf16_f32 v35, v30, v31
  ds_write_b64 v14, v[34:35] offset:64
  v_add_f32 v44, v44, v28
  v_fmac_f32 v45, v28, v28
  v_add_f32 v44, v44, v29
  v_fmac_f32 v45, v29, v29
  v_add_f32 v42, v42, v26
  v_fmac_f32 v43, v26, v26
  v_add_f32 v44, v44, v30
  v_fmac_f32 v45, v30, v30
  v_add_f32 v42, v42, v27
  v_fmac_f32 v43, v27, v27
  v_add_f32 v44, v44, v31
  v_fmac_f32 v45, v31, v31
  s_waitcnt lgkmcnt(0)
  s_barrier
  buffer_load_dwordx4 v17, s[4:7], s32 offen offset:0 lds
  s_add_u32 m0, s61, 6592
  s_nop 0
  buffer_load_dwordx4 v17, s[4:7], s32 offen offset:32 lds
  s_add_u32 m0, s62, 0
  s_nop 0
  buffer_load_dwordx4 v18, s[4:7], s32 offen offset:0 lds
  s_add_u32 m0, s62, 6592
  s_nop 0
  buffer_load_dwordx4 v18, s[4:7], s32 offen offset:32 lds
  s_cmp_lg_u32 s16, 0
  s_cbranch_scc1 L_acq_join
  s_mov_b32 s51, 100000
  v_mov_b32 v46, 0
L_pub_poll:
  buffer_load_dword v47, v46, s[72:75], 0 offen offset:128 sc0 sc1
  s_waitcnt vmcnt(0)
  v_readfirstlane_b32 s52, v47
  s_nop 3
  s_cmp_ge_u32 s52, 1
  s_cbranch_scc1 L_pub_ok
  s_sleep 8
  s_sub_u32 s51, s51, 1
  s_cmp_lg_u32 s51, 0
  s_cbranch_scc1 L_pub_poll
L_pub_ok:
  buffer_inv sc1
L_acq_join:
  s_barrier
  s_add_u32 s35, s24, 12288
  buffer_load_dwordx4 a[176:179], v3, s[8:11], s35 offen offset:0 sc1
  buffer_load_dwordx4 a[180:183], v3, s[8:11], s35 offen offset:1024 sc1
  buffer_load_dwordx4 a[184:187], v3, s[8:11], s35 offen offset:2048 sc1
  s_mov_b32 s26, 0
  s_mov_b32 s27, 4096
  buffer_load_dwordx4 a[36:39], v3, s[8:11], s26 offen offset:0 sc1
  buffer_load_dwordx4 a[40:43], v3, s[8:11], s26 offen offset:1024 sc1
  buffer_load_dwordx4 a[44:47], v3, s[8:11], s26 offen offset:2048 sc1
  buffer_load_dwordx4 a[48:51], v3, s[8:11], s26 offen offset:3072 sc1
  buffer_load_dwordx4 a[52:55], v3, s[8:11], s27 offen offset:0 sc1
  buffer_load_dwordx4 a[56:59], v3, s[8:11], s27 offen offset:1024 sc1
  s_addk_i32 s26, 6144
  s_addk_i32 s27, 6144
  buffer_load_dwordx4 a[60:63], v3, s[8:11], s26 offen offset:0 sc1
  buffer_load_dwordx4 a[64:67], v3, s[8:11], s26 offen offset:1024 sc1
  buffer_load_dwordx4 a[68:71], v3, s[8:11], s26 offen offset:2048 sc1
  buffer_load_dwordx4 a[72:75], v3, s[8:11], s26 offen offset:3072 sc1
  buffer_load_dwordx4 a[76:79], v3, s[8:11], s27 offen offset:0 sc1
  buffer_load_dwordx4 a[80:83], v3, s[8:11], s27 offen offset:1024 sc1
  s_waitcnt vmcnt(0) lgkmcnt(0)
  s_mov_b32 m0, 162336
  s_nop 0
  buffer_load_dword v7, s[4:7], s57 offen offset:640 lds
  s_barrier
  s_nop 0
.p2align 6
L_loop:
  ds_read_b128 a[16:19], v0 offset:0
  s_barrier
  ds_read_b128 a[20:23], v0 offset:12800
  v_add_u32 v22, v8, v16
  s_add_u32 s63, s17, 243
  s_cmp_ge_u32 s18, 3
  ds_read_b128 a[24:27], v0 offset:25600
  s_cselect_b32 s63, 9999, s63
  s_mul_i32 s52, s63, 3237
  s_lshr_b32 s52, s52, 20
  ds_read_b128 a[28:31], v0 offset:38400
  s_mul_i32 s53, s52, 324
  s_sub_u32 s53, s63, s53
  s_mul_i32 s50, s53, 10923
  ds_read_b128 a[136:139], v8 offset:27584
  s_lshr_b32 s50, s50, 16
  s_mul_i32 s51, s50, 6
  s_sub_u32 s51, s53, s51
  ds_read_b128 a[140:143], v8 offset:28320
  s_mul_i32 s52, s52, 6
  s_add_u32 s51, s51, s52
  s_mul_i32 s52, s50, 2646
  ds_read_b128 a[144:147], v8 offset:28352
  s_mul_i32 s53, s51, 21
  s_add_u32 s52, s52, s53
  v_add_u32 v23, v9, v16
  ds_read_b128 a[148:151], v8 offset:29056
  s_mul_i32 s25, s52, 768
  s_sub_u32 s25, s25, 291072
  s_add_u32 s36, s24, 18432
  ds_read_b128 a[152:155], v22 offset:27648
  buffer_load_dwordx4 a[196:199], v3, s[8:11], s36 offen offset:2048
  s_mov_b32 s32, 256
  s_add_u32 m0, s61, 13792
  s_mov_b32 s33, 320
  s_mov_b32 s34, 384
  ds_read_b128 a[0:3], v0 offset:51200
  buffer_load_dwordx4 v17, s[4:7], s32 offen offset:0 lds
  s_add_u32 m0, s61, 20384
  s_mov_b32 s29, s25
  s_mul_i32 s56, s16, 35
  s_mov_b32 s28, 221184
  v_add_u32 v22, v10, v16
  v_accvgpr_read_b32 v5, a4
  ds_read_b128 a[156:159], v9 offset:27584
  v_cmp_gt_u32 vcc, 35, v4
  v_mov_b32 v7, 162336
  s_mul_i32 s52, s63, 3237
  ds_read_b128 a[160:163], v9 offset:28320
  s_mov_b32 s23, 99
  s_waitcnt lgkmcnt(11)
  v_mfma_f32_16x16x32_bf16 v[48:51], a[36:39], a[16:19], 0
  s_mov_b32 s66, 99
  buffer_load_dwordx4 v17, s[4:7], s32 offen offset:32 lds
  s_add_u32 m0, s62, 13792
  s_mov_b32 s57, s67
  v_mfma_f32_16x16x32_bf16 v[52:55], a[40:43], a[16:19], 0
  buffer_load_dwordx4 v18, s[4:7], s32 offen offset:0 lds
  s_add_u32 m0, s62, 20384
  s_addk_i32 s26, 6144
  v_mfma_f32_16x16x32_bf16 v[56:59], a[44:47], a[16:19], 0
  s_addk_i32 s27, 6144
  s_add_u32 s35, s24, 24576
  ds_read_b128 a[164:167], v9 offset:28352
  v_mfma_f32_16x16x32_bf16 v[60:63], a[48:51], a[16:19], 0
  s_waitcnt vmcnt(4)
  ds_read_b128 a[168:171], v9 offset:29056
  v_mfma_f32_16x16x32_bf16 v[64:67], a[52:55], a[16:19], 0
  ds_read_b128 a[172:175], v23 offset:27648
  v_mfma_f32_16x16x32_bf16 v[68:71], a[56:59], a[16:19], 0
  s_waitcnt lgkmcnt(13)
  v_add_u32 v23, v11, v16
  ds_read_b128 a[116:119], v10 offset:27584
  v_mfma_f32_16x16x32_bf16 v[72:75], a[36:39], a[20:23], 0
  buffer_load_dwordx4 v18, s[4:7], s32 offen offset:32 lds
  s_add_u32 m0, s61, 27584
  s_mov_b32 s32, 448
  v_mfma_f32_16x16x32_bf16 v[76:79], a[40:43], a[20:23], 0
  v_mfma_f32_16x16x32_bf16 v[80:83], a[44:47], a[20:23], 0
  ds_read_b128 a[16:19], v1 offset:0
  v_mfma_f32_16x16x32_bf16 v[84:87], a[48:51], a[20:23], 0
  ds_read_b128 a[120:123], v10 offset:28320
  v_mfma_f32_16x16x32_bf16 v[88:91], a[52:55], a[20:23], 0
  buffer_load_dwordx4 a[188:191], v3, s[8:11], s36 offen offset:0
  v_mfma_f32_16x16x32_bf16 v[92:95], a[56:59], a[20:23], 0
  s_waitcnt lgkmcnt(12)
  ds_read_b128 a[124:127], v10 offset:28352
  v_mfma_f32_16x16x32_bf16 v[96:99], a[36:39], a[24:27], 0
  ds_read_b128 a[128:131], v10 offset:29056
  v_mfma_f32_16x16x32_bf16 v[100:103], a[40:43], a[24:27], 0
  ds_read_b128 a[132:135], v22 offset:27648
  v_add_u32 v22, v12, v16
  v_mfma_f32_16x16x32_bf16 v[104:107], a[44:47], a[24:27], 0
  buffer_load_dwordx4 a[192:195], v3, s[8:11], s36 offen offset:1024
  v_mfma_f32_16x16x32_bf16 v[108:111], a[48:51], a[24:27], 0
  ds_read_b128 a[20:23], v1 offset:12800
  v_mfma_f32_16x16x32_bf16 v[112:115], a[52:55], a[24:27], 0
  v_mfma_f32_16x16x32_bf16 v[116:119], a[56:59], a[24:27], 0
  buffer_store_dwordx4 a[200:203], v5, s[12:15], s19 offen offset:128 nt
  v_mfma_f32_16x16x32_bf16 v[120:123], a[36:39], a[28:31], 0
  ds_read_b128 a[24:27], v1 offset:25600
  v_mfma_f32_16x16x32_bf16 v[124:127], a[40:43], a[28:31], 0
  v_mfma_f32_16x16x32_bf16 v[128:131], a[44:47], a[28:31], 0
  v_mfma_f32_16x16x32_bf16 v[132:135], a[48:51], a[28:31], 0
  buffer_load_dwordx4 a[32:35], v3, s[8:11], s26 offen offset:0
  v_mfma_f32_16x16x32_bf16 v[136:139], a[52:55], a[28:31], 0
  v_mfma_f32_16x16x32_bf16 v[140:143], a[56:59], a[28:31], 0
  v_mfma_f32_16x16x32_bf16 v[24:27], a[176:179], a[136:139], 0
  s_waitcnt lgkmcnt(7)
  ds_read_b128 a[28:31], v1 offset:38400
  v_smfmac_f32_16x16x64_bf16 v[24:27], a[180:183], a[140:147], v15
  ds_read_b128 a[136:139], v11 offset:27584
  v_smfmac_f32_16x16x64_bf16 v[24:27], a[184:187], a[148:155], v15
  ds_read_b128 a[140:143], v11 offset:28320
  v_mfma_f32_16x16x32_bf16 v[144:147], a[36:39], a[0:3], 0
  ds_read_b128 a[144:147], v11 offset:28352
  v_mfma_f32_16x16x32_bf16 v[148:151], a[40:43], a[0:3], 0
  ds_read_b128 a[148:151], v11 offset:29056
  v_add_f32 v36, v36, v24
  v_mfma_f32_16x16x32_bf16 v[152:155], a[44:47], a[0:3], 0
  v_fmac_f32 v37, v24, v24
  ds_read_b128 a[152:155], v23 offset:27648
  v_mfma_f32_16x16x32_bf16 v[156:159], a[48:51], a[0:3], 0
  v_add_f32 v36, v36, v25
  v_fmac_f32 v37, v25, v25
  v_mfma_f32_16x16x32_bf16 v[160:163], a[52:55], a[0:3], 0
  v_add_f32 v36, v36, v26
  v_fmac_f32 v37, v26, v26
  v_mfma_f32_16x16x32_bf16 v[164:167], a[56:59], a[0:3], 0
  v_cvt_pk_bf16_f32 v32, v24, v25
  v_cvt_pk_bf16_f32 v33, v26, v27
  v_mfma_f32_16x16x32_bf16 v[28:31], a[176:179], a[156:159], 0
  v_add_f32 v36, v36, v27
  v_fmac_f32 v37, v27, v27
  v_smfmac_f32_16x16x64_bf16 v[28:31], a[180:183], a[160:167], v15
  ds_read_b128 a[156:159], v12 offset:27584
  v_smfmac_f32_16x16x64_bf16 v[28:31], a[184:187], a[168:175], v15
  s_waitcnt lgkmcnt(8)
  ds_read_b128 a[160:163], v12 offset:28320
  v_mfma_f32_16x16x32_bf16 v[168:171], a[36:39], a[16:19], 0
  buffer_load_dwordx4 a[240:243], v3, s[8:11], s26 offen offset:1024
  v_mfma_f32_16x16x32_bf16 v[172:175], a[40:43], a[16:19], 0
  ds_read_b128 a[164:167], v12 offset:28352
  v_add_f32 v38, v38, v28
  v_mfma_f32_16x16x32_bf16 v[176:179], a[44:47], a[16:19], 0
  v_fmac_f32 v39, v28, v28
  v_add_f32 v38, v38, v29
  v_mfma_f32_16x16x32_bf16 v[180:183], a[48:51], a[16:19], 0
  v_fmac_f32 v39, v29, v29
  v_add_f32 v38, v38, v30
  v_mfma_f32_16x16x32_bf16 v[184:187], a[52:55], a[16:19], 0
  v_fmac_f32 v39, v30, v30
  v_cvt_pk_bf16_f32 v34, v28, v29
  v_mfma_f32_16x16x32_bf16 v[188:191], a[56:59], a[16:19], 0
  v_cvt_pk_bf16_f32 v35, v30, v31
  v_add_f32 v38, v38, v31
  v_mfma_f32_16x16x32_bf16 v[24:27], a[176:179], a[116:119], 0
  v_fmac_f32 v39, v31, v31
  ds_read_b128 a[168:171], v12 offset:29056
  v_smfmac_f32_16x16x64_bf16 v[24:27], a[180:183], a[120:127], v15
  ds_read_b128 a[172:175], v22 offset:27648
  v_smfmac_f32_16x16x64_bf16 v[24:27], a[184:187], a[128:135], v15
  ds_read_b128 a[0:3], v2 offset:0
  v_mfma_f32_16x16x32_bf16 v[192:195], a[36:39], a[20:23], 0
  buffer_load_dwordx4 a[244:247], v3, s[8:11], s26 offen offset:2048
  v_mfma_f32_16x16x32_bf16 v[196:199], a[40:43], a[20:23], 0
  v_add_f32 v40, v40, v24
  v_fmac_f32 v41, v24, v24
  v_mfma_f32_16x16x32_bf16 v[200:203], a[44:47], a[20:23], 0
  v_add_f32 v40, v40, v25
  v_fmac_f32 v41, v25, v25
  v_mfma_f32_16x16x32_bf16 v[204:207], a[48:51], a[20:23], 0
  ds_write_b64 v13, v[32:33] offset:128
  v_mfma_f32_16x16x32_bf16 v[208:211], a[52:55], a[20:23], 0
  v_add_f32 v40, v40, v26
  v_fmac_f32 v41, v26, v26
  v_mfma_f32_16x16x32_bf16 v[212:215], a[56:59], a[20:23], 0
  s_waitcnt lgkmcnt(7)
  v_cvt_pk_bf16_f32 v32, v24, v25
  v_cvt_pk_bf16_f32 v33, v26, v27
  v_mfma_f32_16x16x32_bf16 v[28:31], a[176:179], a[136:139], 0
  v_add_f32 v40, v40, v27
  v_fmac_f32 v41, v27, v27
  v_smfmac_f32_16x16x64_bf16 v[28:31], a[180:183], a[140:147], v15
  ds_read_b128 a[16:19], v0 offset:64
  v_smfmac_f32_16x16x64_bf16 v[28:31], a[184:187], a[148:155], v15
  ds_read_b128 a[20:23], v0 offset:12864
  v_mfma_f32_16x16x32_bf16 v[216:219], a[36:39], a[24:27], 0
  buffer_load_dwordx4 a[248:251], v3, s[8:11], s26 offen offset:3072
  v_mfma_f32_16x16x32_bf16 v[220:223], a[40:43], a[24:27], 0
  ds_write_b64 v13, v[34:35] offset:12928
  v_mfma_f32_16x16x32_bf16 v[224:227], a[44:47], a[24:27], 0
  v_cvt_pk_bf16_f32 v34, v28, v29
  ds_write_b64 v13, v[32:33] offset:25728
  v_mfma_f32_16x16x32_bf16 v[228:231], a[48:51], a[24:27], 0
  v_cvt_pk_bf16_f32 v35, v30, v31
  v_add_u32 v23, v8, v16
  v_mfma_f32_16x16x32_bf16 v[232:235], a[52:55], a[24:27], 0
  ds_write_b64 v13, v[34:35] offset:38528
  v_mfma_f32_16x16x32_bf16 v[236:239], a[56:59], a[24:27], 0
  s_waitcnt lgkmcnt(9)
  v_add_u32 v22, v9, v16
  v_add_f32 v42, v42, v28
  v_mfma_f32_16x16x32_bf16 v[24:27], a[176:179], a[156:159], 0
  ds_read_b128 a[24:27], v0 offset:25664
  v_fmac_f32 v43, v28, v28
  v_smfmac_f32_16x16x64_bf16 v[24:27], a[180:183], a[160:167], v15
  s_waitcnt lgkmcnt(8)
  v_add_f32 v42, v42, v29
  v_smfmac_f32_16x16x64_bf16 v[24:27], a[184:187], a[168:175], v15
  v_fmac_f32 v43, v29, v29
  v_mfma_f32_16x16x32_bf16 v[240:243], a[36:39], a[28:31], 0
  buffer_load_dwordx4 a[252:255], v3, s[8:11], s27 offen offset:0
  v_mfma_f32_16x16x32_bf16 v[244:247], a[40:43], a[28:31], 0
  buffer_load_dwordx4 a[184:187], v3, s[8:11], s35 offen offset:2048
  v_mfma_f32_16x16x32_bf16 v[248:251], a[44:47], a[28:31], 0
  buffer_load_dwordx4 a[176:179], v3, s[8:11], s35 offen offset:0
  v_mfma_f32_16x16x32_bf16 v[252:255], a[48:51], a[28:31], 0
  v_cvt_pk_bf16_f32 v32, v24, v25
  v_cvt_pk_bf16_f32 v33, v26, v27
  v_mfma_f32_16x16x32_bf16 a[84:87], a[52:55], a[28:31], 0
  ds_write_b64 v14, v[32:33] offset:128
  v_mfma_f32_16x16x32_bf16 a[88:91], a[56:59], a[28:31], 0
  s_waitcnt lgkmcnt(7)
  buffer_load_dwordx4 a[180:183], v3, s[8:11], s35 offen offset:1024
  v_mfma_f32_16x16x32_bf16 a[92:95], a[36:39], a[0:3], 0
  ds_read_b128 a[28:31], v0 offset:38464
  v_add_f32 v42, v42, v30
  v_mfma_f32_16x16x32_bf16 a[96:99], a[40:43], a[0:3], 0
  v_fmac_f32 v43, v30, v30
  v_add_f32 v42, v42, v31
  v_mfma_f32_16x16x32_bf16 a[100:103], a[44:47], a[0:3], 0
  v_fmac_f32 v43, v31, v31
  v_add_f32 v44, v44, v24
  v_mfma_f32_16x16x32_bf16 a[104:107], a[48:51], a[0:3], 0
  s_waitcnt lgkmcnt(1)
  s_barrier
  buffer_load_dwordx4 a[200:203], v3, s[8:11], s27 offen offset:1024
  v_mfma_f32_16x16x32_bf16 a[108:111], a[52:55], a[0:3], 0
  ds_read_b128 a[116:119], v8 offset:0
  v_fmac_f32 v45, v24, v24
  v_mfma_f32_16x16x32_bf16 a[112:115], a[56:59], a[0:3], 0
  ds_read_b128 a[120:123], v8 offset:736
  v_add_f32 v44, v44, v25
  v_mfma_f32_16x16x32_bf16 v[48:51], a[60:63], a[16:19], v[48:51]
  ds_read_b128 a[124:127], v8 offset:768
  v_fmac_f32 v45, v25, v25
  v_mfma_f32_16x16x32_bf16 v[52:55], a[64:67], a[16:19], v[52:55]
  buffer_load_dwordx4 v17, s[4:7], s33 offen offset:0 lds
  s_add_u32 m0, s61, 34176
  v_mfma_f32_16x16x32_bf16 v[56:59], a[68:71], a[16:19], v[56:59]
  ds_read_b128 a[128:131], v8 offset:1472
  v_add_f32 v44, v44, v26
  v_mfma_f32_16x16x32_bf16 v[60:63], a[72:75], a[16:19], v[60:63]
  ds_read_b128 a[132:135], v23 offset:64
  v_add_u32 v23, v10, v16
  v_mfma_f32_16x16x32_bf16 v[64:67], a[76:79], a[16:19], v[64:67]
  ds_read_b128 a[0:3], v0 offset:51264
  v_fmac_f32 v45, v26, v26
  v_mfma_f32_16x16x32_bf16 v[68:71], a[80:83], a[16:19], v[68:71]
  buffer_load_dwordx4 v17, s[4:7], s33 offen offset:32 lds
  s_add_u32 m0, s62, 27584
  v_mfma_f32_16x16x32_bf16 v[72:75], a[60:63], a[20:23], v[72:75]
  ds_read_b128 a[136:139], v9 offset:0
  v_add_f32 v44, v44, v27
  v_mfma_f32_16x16x32_bf16 v[76:79], a[64:67], a[20:23], v[76:79]
  ds_read_b128 a[140:143], v9 offset:736
  v_fmac_f32 v45, v27, v27
  v_mfma_f32_16x16x32_bf16 v[80:83], a[68:71], a[20:23], v[80:83]
  ds_read_b128 a[144:147], v9 offset:768
  v_mfma_f32_16x16x32_bf16 v[84:87], a[72:75], a[20:23], v[84:87]
  buffer_load_dwordx4 v18, s[4:7], s33 offen offset:0 lds
  s_add_u32 m0, s62, 34176
  s_addk_i32 s26, 6144
  v_mfma_f32_16x16x32_bf16 v[88:91], a[76:79], a[20:23], v[88:91]
  s_addk_i32 s27, 6144
  s_add_u32 s36, s24, 30720
  ds_read_b128 a[148:151], v9 offset:1472
  v_mfma_f32_16x16x32_bf16 v[92:95], a[80:83], a[20:23], v[92:95]
  ds_read_b128 a[152:155], v22 offset:64
  v_mfma_f32_16x16x32_bf16 v[96:99], a[60:63], a[24:27], v[96:99]
  v_add_u32 v22, v11, v16
  ds_read_b128 a[16:19], v1 offset:64
  v_mfma_f32_16x16x32_bf16 v[100:103], a[64:67], a[24:27], v[100:103]
  buffer_load_dwordx4 v18, s[4:7], s33 offen offset:32 lds
  s_add_u32 m0, s61, 0
  s_mov_b32 s33, 512
  v_mfma_f32_16x16x32_bf16 v[104:107], a[68:71], a[24:27], v[104:107]
  v_mfma_f32_16x16x32_bf16 v[108:111], a[72:75], a[24:27], v[108:111]
  ds_read_b128 a[156:159], v10 offset:0
  v_mfma_f32_16x16x32_bf16 v[112:115], a[76:79], a[24:27], v[112:115]
  ds_read_b128 a[160:163], v10 offset:736
  v_mfma_f32_16x16x32_bf16 v[116:119], a[80:83], a[24:27], v[116:119]
  s_waitcnt lgkmcnt(14)
  ds_read_b128 a[164:167], v10 offset:768
  v_mfma_f32_16x16x32_bf16 v[120:123], a[60:63], a[28:31], v[120:123]
  buffer_load_dwordx4 a[36:39], v3, s[8:11], s26 offen offset:0
  v_mfma_f32_16x16x32_bf16 v[124:127], a[64:67], a[28:31], v[124:127]
  ds_read_b128 a[168:171], v10 offset:1472
  v_mfma_f32_16x16x32_bf16 v[128:131], a[68:71], a[28:31], v[128:131]
  ds_read_b128 a[172:175], v23 offset:64
  v_add_u32 v23, v12, v16
  v_mfma_f32_16x16x32_bf16 v[132:135], a[72:75], a[28:31], v[132:135]
  ds_read_b128 a[20:23], v1 offset:12864
  v_mfma_f32_16x16x32_bf16 v[136:139], a[76:79], a[28:31], v[136:139]
  ds_read_b128 a[24:27], v1 offset:25664
  v_mfma_f32_16x16x32_bf16 v[140:143], a[80:83], a[28:31], v[140:143]
  s_waitcnt vmcnt(15) lgkmcnt(14)
  v_mfma_f32_16x16x32_bf16 v[28:31], a[188:191], a[116:119], 0
  s_waitcnt vmcnt(14)
  ds_read_b128 a[28:31], v1 offset:38464
  v_smfmac_f32_16x16x64_bf16 v[28:31], a[192:195], a[120:127], v15
  ds_read_b128 a[116:119], v11 offset:0
  v_smfmac_f32_16x16x64_bf16 v[28:31], a[196:199], a[128:135], v15
  s_waitcnt lgkmcnt(14)
  ds_read_b128 a[120:123], v11 offset:736
  v_mfma_f32_16x16x32_bf16 v[144:147], a[60:63], a[0:3], v[144:147]
  ds_read_b128 a[124:127], v11 offset:768
  v_mfma_f32_16x16x32_bf16 v[148:151], a[64:67], a[0:3], v[148:151]
  ds_read_b128 a[128:131], v11 offset:1472
  v_add_f32 v36, v36, v28
  v_mfma_f32_16x16x32_bf16 v[152:155], a[68:71], a[0:3], v[152:155]
  v_fmac_f32 v37, v28, v28
  ds_read_b128 a[132:135], v22 offset:64
  v_mfma_f32_16x16x32_bf16 v[156:159], a[72:75], a[0:3], v[156:159]
  v_add_f32 v36, v36, v29
  v_fmac_f32 v37, v29, v29
  v_mfma_f32_16x16x32_bf16 v[160:163], a[76:79], a[0:3], v[160:163]
  v_add_f32 v36, v36, v30
  v_fmac_f32 v37, v30, v30
  v_mfma_f32_16x16x32_bf16 v[164:167], a[80:83], a[0:3], v[164:167]
  v_cvt_pk_bf16_f32 v34, v28, v29
  v_cvt_pk_bf16_f32 v35, v30, v31
  v_mfma_f32_16x16x32_bf16 v[24:27], a[188:191], a[136:139], 0
  s_waitcnt lgkmcnt(13)
  v_add_f32 v36, v36, v31
  v_fmac_f32 v37, v31, v31
  v_smfmac_f32_16x16x64_bf16 v[24:27], a[192:195], a[140:147], v15
  ds_read_b128 a[136:139], v12 offset:0
  v_smfmac_f32_16x16x64_bf16 v[24:27], a[196:199], a[148:155], v15
  ds_read_b128 a[140:143], v12 offset:736
  v_mfma_f32_16x16x32_bf16 v[168:171], a[60:63], a[16:19], v[168:171]
  buffer_load_dwordx4 a[40:43], v3, s[8:11], s26 offen offset:1024
  v_mfma_f32_16x16x32_bf16 v[172:175], a[64:67], a[16:19], v[172:175]
  ds_read_b128 a[144:147], v12 offset:768
  v_add_f32 v38, v38, v24
  v_mfma_f32_16x16x32_bf16 v[176:179], a[68:71], a[16:19], v[176:179]
  v_fmac_f32 v39, v24, v24
  v_add_f32 v38, v38, v25
  v_mfma_f32_16x16x32_bf16 v[180:183], a[72:75], a[16:19], v[180:183]
  v_fmac_f32 v39, v25, v25
  v_add_f32 v38, v38, v26
  v_mfma_f32_16x16x32_bf16 v[184:187], a[76:79], a[16:19], v[184:187]
  v_fmac_f32 v39, v26, v26
  v_cvt_pk_bf16_f32 v32, v24, v25
  v_mfma_f32_16x16x32_bf16 v[188:191], a[80:83], a[16:19], v[188:191]
  s_waitcnt lgkmcnt(10)
  v_cvt_pk_bf16_f32 v33, v26, v27
  v_add_f32 v38, v38, v27
  v_mfma_f32_16x16x32_bf16 v[28:31], a[188:191], a[156:159], 0
  v_fmac_f32 v39, v27, v27
  ds_read_b128 a[148:151], v12 offset:1472
  v_smfmac_f32_16x16x64_bf16 v[28:31], a[192:195], a[160:167], v15
  ds_read_b128 a[152:155], v23 offset:64
  v_smfmac_f32_16x16x64_bf16 v[28:31], a[196:199], a[168:175], v15
  ds_read_b128 a[0:3], v2 offset:64
  v_mfma_f32_16x16x32_bf16 v[192:195], a[60:63], a[20:23], v[192:195]
  buffer_load_dwordx4 a[44:47], v3, s[8:11], s26 offen offset:2048
  v_mfma_f32_16x16x32_bf16 v[196:199], a[64:67], a[20:23], v[196:199]
  v_add_f32 v40, v40, v28
  v_fmac_f32 v41, v28, v28
  v_mfma_f32_16x16x32_bf16 v[200:203], a[68:71], a[20:23], v[200:203]
  v_add_f32 v40, v40, v29
  v_fmac_f32 v41, v29, v29
  v_mfma_f32_16x16x32_bf16 v[204:207], a[72:75], a[20:23], v[204:207]
  ds_write_b64 v13, v[34:35] offset:192
  v_mfma_f32_16x16x32_bf16 v[208:211], a[76:79], a[20:23], v[208:211]
  v_add_f32 v40, v40, v30
  v_fmac_f32 v41, v30, v30
  v_mfma_f32_16x16x32_bf16 v[212:215], a[80:83], a[20:23], v[212:215]
  s_waitcnt lgkmcnt(7)
  v_cvt_pk_bf16_f32 v34, v28, v29
  v_cvt_pk_bf16_f32 v35, v30, v31
  v_mfma_f32_16x16x32_bf16 v[24:27], a[188:191], a[116:119], 0
  v_add_f32 v40, v40, v31
  v_fmac_f32 v41, v31, v31
  v_smfmac_f32_16x16x64_bf16 v[24:27], a[192:195], a[120:127], v15
  ds_read_b128 a[16:19], v0 offset:128
  v_smfmac_f32_16x16x64_bf16 v[24:27], a[196:199], a[128:135], v15
  ds_read_b128 a[20:23], v0 offset:12928
  v_mfma_f32_16x16x32_bf16 v[216:219], a[60:63], a[24:27], v[216:219]
  buffer_load_dwordx4 a[48:51], v3, s[8:11], s26 offen offset:3072
  v_mfma_f32_16x16x32_bf16 v[220:223], a[64:67], a[24:27], v[220:223]
  ds_write_b64 v13, v[32:33] offset:12992
  v_mfma_f32_16x16x32_bf16 v[224:227], a[68:71], a[24:27], v[224:227]
  v_cvt_pk_bf16_f32 v32, v24, v25
  ds_write_b64 v13, v[34:35] offset:25792
  v_mfma_f32_16x16x32_bf16 v[228:231], a[72:75], a[24:27], v[228:231]
  v_cvt_pk_bf16_f32 v33, v26, v27
  v_add_u32 v22, v8, v16
  v_mfma_f32_16x16x32_bf16 v[232:235], a[76:79], a[24:27], v[232:235]
  ds_write_b64 v13, v[32:33] offset:38592
  v_mfma_f32_16x16x32_bf16 v[236:239], a[80:83], a[24:27], v[236:239]
  s_waitcnt lgkmcnt(9)
  v_add_u32 v23, v9, v16
  v_add_f32 v42, v42, v24
  v_mfma_f32_16x16x32_bf16 v[28:31], a[188:191], a[136:139], 0
  ds_read_b128 a[24:27], v0 offset:25728
  v_fmac_f32 v43, v24, v24
  v_smfmac_f32_16x16x64_bf16 v[28:31], a[192:195], a[140:147], v15
  s_waitcnt lgkmcnt(8)
  v_add_f32 v42, v42, v25
  v_smfmac_f32_16x16x64_bf16 v[28:31], a[196:199], a[148:155], v15
  v_fmac_f32 v43, v25, v25
  v_mfma_f32_16x16x32_bf16 v[240:243], a[60:63], a[28:31], v[240:243]
  buffer_load_dwordx4 a[52:55], v3, s[8:11], s27 offen offset:0
  v_mfma_f32_16x16x32_bf16 v[244:247], a[64:67], a[28:31], v[244:247]
  buffer_load_dwordx4 a[196:199], v3, s[8:11], s36 offen offset:2048
  v_mfma_f32_16x16x32_bf16 v[248:251], a[68:71], a[28:31], v[248:251]
  buffer_load_dwordx4 a[188:191], v3, s[8:11], s36 offen offset:0
  v_mfma_f32_16x16x32_bf16 v[252:255], a[72:75], a[28:31], v[252:255]
  v_accvgpr_read_b32 v6, a5
  v_cvt_pk_bf16_f32 v34, v28, v29
  v_mfma_f32_16x16x32_bf16 a[84:87], a[76:79], a[28:31], a[84:87]
  v_cvt_pk_bf16_f32 v35, v30, v31
  ds_write_b64 v14, v[34:35] offset:192
  v_mfma_f32_16x16x32_bf16 a[88:91], a[80:83], a[28:31], a[88:91]
  s_waitcnt lgkmcnt(7)
  buffer_store_dwordx4 a[204:207], v6, s[12:15], s19 offen offset:128 nt
  v_mfma_f32_16x16x32_bf16 a[92:95], a[60:63], a[0:3], a[92:95]
  ds_read_b128 a[28:31], v0 offset:38528
  v_add_f32 v42, v42, v26
  v_mfma_f32_16x16x32_bf16 a[96:99], a[64:67], a[0:3], a[96:99]
  v_fmac_f32 v43, v26, v26
  v_add_f32 v42, v42, v27
  v_mfma_f32_16x16x32_bf16 a[100:103], a[68:71], a[0:3], a[100:103]
  s_waitcnt lgkmcnt(1)
  s_barrier
  ds_read_b128 a[156:159], v8 offset:13792
  v_mfma_f32_16x16x32_bf16 a[104:107], a[72:75], a[0:3], a[104:107]
  buffer_load_dwordx4 a[56:59], v3, s[8:11], s27 offen offset:1024
  v_mfma_f32_16x16x32_bf16 a[108:111], a[76:79], a[0:3], a[108:111]
  ds_read_b128 a[160:163], v8 offset:14528
  v_fmac_f32 v43, v27, v27
  v_mfma_f32_16x16x32_bf16 a[112:115], a[80:83], a[0:3], a[112:115]
  s_waitcnt vmcnt(17)
  ds_read_b128 a[164:167], v8 offset:14560
  v_add_f32 v44, v44, v28
  v_mfma_f32_16x16x32_bf16 v[48:51], a[32:35], a[16:19], v[48:51]
  ds_read_b128 a[168:171], v8 offset:15264
  v_fmac_f32 v45, v28, v28
  v_mfma_f32_16x16x32_bf16 v[52:55], a[240:243], a[16:19], v[52:55]
  buffer_load_dwordx4 v17, s[4:7], s34 offen offset:0 lds
  s_add_u32 m0, s61, 6592
  v_mfma_f32_16x16x32_bf16 v[56:59], a[244:247], a[16:19], v[56:59]
  ds_read_b128 a[172:175], v22 offset:13856
  v_add_u32 v22, v10, v16
  v_mfma_f32_16x16x32_bf16 v[60:63], a[248:251], a[16:19], v[60:63]
  s_waitcnt vmcnt(15)
  ds_read_b128 a[0:3], v0 offset:51328
  v_add_f32 v44, v44, v29
  v_mfma_f32_16x16x32_bf16 v[64:67], a[252:255], a[16:19], v[64:67]
  s_waitcnt vmcnt(13)
  ds_read_b128 a[116:119], v9 offset:13792
  v_fmac_f32 v45, v29, v29
  v_mfma_f32_16x16x32_bf16 v[68:71], a[200:203], a[16:19], v[68:71]
  buffer_load_dwordx4 v17, s[4:7], s34 offen offset:32 lds
  s_add_u32 m0, s62, 0
  v_mfma_f32_16x16x32_bf16 v[72:75], a[32:35], a[20:23], v[72:75]
  ds_read_b128 a[120:123], v9 offset:14528
  v_add_f32 v44, v44, v30
  v_mfma_f32_16x16x32_bf16 v[76:79], a[240:243], a[20:23], v[76:79]
  ds_read_b128 a[124:127], v9 offset:14560
  v_fmac_f32 v45, v30, v30
  v_mfma_f32_16x16x32_bf16 v[80:83], a[244:247], a[20:23], v[80:83]
  ds_read_b128 a[128:131], v9 offset:15264
  v_add_f32 v44, v44, v31
  v_mfma_f32_16x16x32_bf16 v[84:87], a[248:251], a[20:23], v[84:87]
  buffer_load_dwordx4 v18, s[4:7], s34 offen offset:0 lds
  s_add_u32 m0, s62, 6592
  s_addk_i32 s26, 6144
  v_mfma_f32_16x16x32_bf16 v[88:91], a[252:255], a[20:23], v[88:91]
  s_addk_i32 s27, 6144
  v_fmac_f32 v45, v31, v31
  ds_read_b128 a[132:135], v23 offset:13856
  v_mfma_f32_16x16x32_bf16 v[92:95], a[200:203], a[20:23], v[92:95]
  s_add_u32 s35, s24, 36864
  v_add_u32 v23, v11, v16
  ds_read_b128 a[16:19], v1 offset:128
  v_mfma_f32_16x16x32_bf16 v[96:99], a[32:35], a[24:27], v[96:99]
  ds_read_b128 a[136:139], v10 offset:13792
  v_mfma_f32_16x16x32_bf16 v[100:103], a[240:243], a[24:27], v[100:103]
  buffer_load_dwordx4 v18, s[4:7], s34 offen offset:32 lds
  s_add_u32 m0, s61, 13792
  s_mov_b32 s34, 576
  v_mfma_f32_16x16x32_bf16 v[104:107], a[244:247], a[24:27], v[104:107]
  ds_read_b128 a[140:143], v10 offset:14528
  v_mfma_f32_16x16x32_bf16 v[108:111], a[248:251], a[24:27], v[108:111]
  ds_read_b128 a[144:147], v10 offset:14560
  v_mfma_f32_16x16x32_bf16 v[112:115], a[252:255], a[24:27], v[112:115]
  ds_read_b128 a[148:151], v10 offset:15264
  v_mfma_f32_16x16x32_bf16 v[116:119], a[200:203], a[24:27], v[116:119]
  s_waitcnt lgkmcnt(14)
  buffer_load_dwordx4 a[192:195], v3, s[8:11], s36 offen offset:1024
  v_mfma_f32_16x16x32_bf16 v[120:123], a[32:35], a[28:31], v[120:123]
  ds_read_b128 a[152:155], v22 offset:13856
  v_add_u32 v22, v12, v16
  v_mfma_f32_16x16x32_bf16 v[124:127], a[240:243], a[28:31], v[124:127]
  ds_read_b128 a[20:23], v1 offset:12928
  v_mfma_f32_16x16x32_bf16 v[128:131], a[244:247], a[28:31], v[128:131]
  ds_read_b128 a[24:27], v1 offset:25728
  v_mfma_f32_16x16x32_bf16 v[132:135], a[248:251], a[28:31], v[132:135]
  buffer_load_dwordx4 a[60:63], v3, s[8:11], s26 offen offset:0
  v_mfma_f32_16x16x32_bf16 v[136:139], a[252:255], a[28:31], v[136:139]
  v_mfma_f32_16x16x32_bf16 v[140:143], a[200:203], a[28:31], v[140:143]
  v_mfma_f32_16x16x32_bf16 v[24:27], a[176:179], a[156:159], 0
  s_waitcnt lgkmcnt(12)
  ds_read_b128 a[28:31], v1 offset:38528
  v_smfmac_f32_16x16x64_bf16 v[24:27], a[180:183], a[160:167], v15
  ds_read_b128 a[156:159], v11 offset:13792
  v_smfmac_f32_16x16x64_bf16 v[24:27], a[184:187], a[168:175], v15
  ds_read_b128 a[160:163], v11 offset:14528
  v_mfma_f32_16x16x32_bf16 v[144:147], a[32:35], a[0:3], v[144:147]
  ds_read_b128 a[164:167], v11 offset:14560
  v_mfma_f32_16x16x32_bf16 v[148:151], a[240:243], a[0:3], v[148:151]
  ds_read_b128 a[168:171], v11 offset:15264
  v_add_f32 v36, v36, v24
  v_mfma_f32_16x16x32_bf16 v[152:155], a[244:247], a[0:3], v[152:155]
  v_fmac_f32 v37, v24, v24
  v_add_f32 v36, v36, v25
  v_mfma_f32_16x16x32_bf16 v[156:159], a[248:251], a[0:3], v[156:159]
  v_fmac_f32 v37, v25, v25
  ds_read_b128 a[172:175], v23 offset:13856
  v_mfma_f32_16x16x32_bf16 v[160:163], a[252:255], a[0:3], v[160:163]
  v_add_f32 v36, v36, v26
  v_fmac_f32 v37, v26, v26
  v_mfma_f32_16x16x32_bf16 v[164:167], a[200:203], a[0:3], v[164:167]
  v_cvt_pk_bf16_f32 v32, v24, v25
  v_cvt_pk_bf16_f32 v33, v26, v27
  v_mfma_f32_16x16x32_bf16 v[28:31], a[176:179], a[116:119], 0
  s_waitcnt lgkmcnt(12)
  v_add_f32 v36, v36, v27
  v_fmac_f32 v37, v27, v27
  v_smfmac_f32_16x16x64_bf16 v[28:31], a[180:183], a[120:127], v15
  ds_read_b128 a[116:119], v12 offset:13792
  v_smfmac_f32_16x16x64_bf16 v[28:31], a[184:187], a[128:135], v15
  ds_read_b128 a[120:123], v12 offset:14528
  v_mfma_f32_16x16x32_bf16 v[168:171], a[32:35], a[16:19], v[168:171]
  buffer_load_dwordx4 a[64:67], v3, s[8:11], s26 offen offset:1024
  v_mfma_f32_16x16x32_bf16 v[172:175], a[240:243], a[16:19], v[172:175]
  ds_read_b128 a[124:127], v12 offset:14560
  v_add_f32 v38, v38, v28
  v_mfma_f32_16x16x32_bf16 v[176:179], a[244:247], a[16:19], v[176:179]
  v_fmac_f32 v39, v28, v28
  v_add_f32 v38, v38, v29
  v_mfma_f32_16x16x32_bf16 v[180:183], a[248:251], a[16:19], v[180:183]
  v_fmac_f32 v39, v29, v29
  v_add_f32 v38, v38, v30
  v_mfma_f32_16x16x32_bf16 v[184:187], a[252:255], a[16:19], v[184:187]
  v_fmac_f32 v39, v30, v30
  v_cvt_pk_bf16_f32 v34, v28, v29
  v_mfma_f32_16x16x32_bf16 v[188:191], a[200:203], a[16:19], v[188:191]
  v_cvt_pk_bf16_f32 v35, v30, v31
  v_add_f32 v38, v38, v31
  v_mfma_f32_16x16x32_bf16 v[24:27], a[176:179], a[136:139], 0
  s_waitcnt lgkmcnt(9)
  v_fmac_f32 v39, v31, v31
  ds_read_b128 a[128:131], v12 offset:15264
  v_smfmac_f32_16x16x64_bf16 v[24:27], a[180:183], a[140:147], v15
  ds_read_b128 a[132:135], v22 offset:13856
  v_smfmac_f32_16x16x64_bf16 v[24:27], a[184:187], a[148:155], v15
  ds_read_b128 a[0:3], v2 offset:128
  v_mfma_f32_16x16x32_bf16 v[192:195], a[32:35], a[20:23], v[192:195]
  buffer_load_dwordx4 a[68:71], v3, s[8:11], s26 offen offset:2048
  v_mfma_f32_16x16x32_bf16 v[196:199], a[240:243], a[20:23], v[196:199]
  v_add_f32 v40, v40, v24
  v_fmac_f32 v41, v24, v24
  v_mfma_f32_16x16x32_bf16 v[200:203], a[244:247], a[20:23], v[200:203]
  v_add_f32 v40, v40, v25
  v_fmac_f32 v41, v25, v25
  v_mfma_f32_16x16x32_bf16 v[204:207], a[248:251], a[20:23], v[204:207]
  ds_write_b64 v13, v[32:33] offset:256
  v_mfma_f32_16x16x32_bf16 v[208:211], a[252:255], a[20:23], v[208:211]
  v_add_f32 v40, v40, v26
  v_fmac_f32 v41, v26, v26
  v_mfma_f32_16x16x32_bf16 v[212:215], a[200:203], a[20:23], v[212:215]
  s_waitcnt lgkmcnt(7)
  v_cvt_pk_bf16_f32 v32, v24, v25
  v_cvt_pk_bf16_f32 v33, v26, v27
  v_mfma_f32_16x16x32_bf16 v[28:31], a[176:179], a[156:159], 0
  v_add_f32 v40, v40, v27
  v_fmac_f32 v41, v27, v27
  v_smfmac_f32_16x16x64_bf16 v[28:31], a[180:183], a[160:167], v15
  ds_read_b128 a[16:19], v0 offset:192
  v_smfmac_f32_16x16x64_bf16 v[28:31], a[184:187], a[168:175], v15
  ds_read_b128 a[20:23], v0 offset:12992
  v_mfma_f32_16x16x32_bf16 v[216:219], a[32:35], a[24:27], v[216:219]
  buffer_load_dwordx4 a[72:75], v3, s[8:11], s26 offen offset:3072
  v_mfma_f32_16x16x32_bf16 v[220:223], a[240:243], a[24:27], v[220:223]
  ds_write_b64 v13, v[34:35] offset:13056
  v_mfma_f32_16x16x32_bf16 v[224:227], a[244:247], a[24:27], v[224:227]
  v_cvt_pk_bf16_f32 v34, v28, v29
  ds_write_b64 v13, v[32:33] offset:25856
  v_mfma_f32_16x16x32_bf16 v[228:231], a[248:251], a[24:27], v[228:231]
  v_cvt_pk_bf16_f32 v35, v30, v31
  v_add_u32 v23, v8, v16
  v_mfma_f32_16x16x32_bf16 v[232:235], a[252:255], a[24:27], v[232:235]
  ds_write_b64 v13, v[34:35] offset:38656
  v_mfma_f32_16x16x32_bf16 v[236:239], a[200:203], a[24:27], v[236:239]
  s_waitcnt lgkmcnt(9)
  v_add_u32 v22, v9, v16
  v_add_f32 v42, v42, v28
  v_mfma_f32_16x16x32_bf16 v[24:27], a[176:179], a[116:119], 0
  ds_read_b128 a[24:27], v0 offset:25792
  v_fmac_f32 v43, v28, v28
  v_smfmac_f32_16x16x64_bf16 v[24:27], a[180:183], a[120:127], v15
  s_waitcnt lgkmcnt(8)
  v_add_f32 v42, v42, v29
  v_smfmac_f32_16x16x64_bf16 v[24:27], a[184:187], a[128:135], v15
  v_fmac_f32 v43, v29, v29
  v_mfma_f32_16x16x32_bf16 v[240:243], a[32:35], a[28:31], v[240:243]
  buffer_load_dwordx4 a[76:79], v3, s[8:11], s27 offen offset:0
  v_mfma_f32_16x16x32_bf16 v[244:247], a[240:243], a[28:31], v[244:247]
  buffer_load_dwordx4 a[184:187], v3, s[8:11], s35 offen offset:2048
  v_mfma_f32_16x16x32_bf16 v[248:251], a[244:247], a[28:31], v[248:251]
  buffer_load_dwordx4 a[176:179], v3, s[8:11], s35 offen offset:0
  v_mfma_f32_16x16x32_bf16 v[252:255], a[248:251], a[28:31], v[252:255]
  v_accvgpr_read_b32 v5, a6
  v_cvt_pk_bf16_f32 v32, v24, v25
  v_mfma_f32_16x16x32_bf16 a[84:87], a[252:255], a[28:31], a[84:87]
  v_cvt_pk_bf16_f32 v33, v26, v27
  ds_write_b64 v14, v[32:33] offset:256
  v_mfma_f32_16x16x32_bf16 a[88:91], a[200:203], a[28:31], a[88:91]
  s_waitcnt lgkmcnt(7)
  buffer_store_dwordx4 a[208:211], v5, s[12:15], s19 offen offset:128 nt
  v_mfma_f32_16x16x32_bf16 a[92:95], a[32:35], a[0:3], a[92:95]
  ds_read_b128 a[28:31], v0 offset:38592
  v_add_f32 v42, v42, v30
  v_mfma_f32_16x16x32_bf16 a[96:99], a[240:243], a[0:3], a[96:99]
  v_fmac_f32 v43, v30, v30
  v_add_f32 v42, v42, v31
  v_mfma_f32_16x16x32_bf16 a[100:103], a[244:247], a[0:3], a[100:103]
  s_waitcnt vmcnt(16) lgkmcnt(1)
  s_barrier
  ds_read_b128 a[136:139], v8 offset:27584
  v_mfma_f32_16x16x32_bf16 a[104:107], a[248:251], a[0:3], a[104:107]
  buffer_load_dwordx4 a[80:83], v3, s[8:11], s27 offen offset:1024
  v_mfma_f32_16x16x32_bf16 a[108:111], a[252:255], a[0:3], a[108:111]
  ds_read_b128 a[140:143], v8 offset:28320
  v_fmac_f32 v43, v31, v31
  v_mfma_f32_16x16x32_bf16 a[112:115], a[200:203], a[0:3], a[112:115]
  ds_read_b128 a[144:147], v8 offset:28352
  v_add_f32 v44, v44, v24
  v_mfma_f32_16x16x32_bf16 v[48:51], a[36:39], a[16:19], v[48:51]
  ds_read_b128 a[148:151], v8 offset:29056
  v_fmac_f32 v45, v24, v24
  v_mfma_f32_16x16x32_bf16 v[52:55], a[40:43], a[16:19], v[52:55]
  buffer_load_dwordx4 v17, s[4:7], s32 offen offset:0 lds
  s_add_u32 m0, s61, 20384
  v_mfma_f32_16x16x32_bf16 v[56:59], a[44:47], a[16:19], v[56:59]
  ds_read_b128 a[152:155], v23 offset:27648
  v_add_u32 v23, v10, v16
  v_mfma_f32_16x16x32_bf16 v[60:63], a[48:51], a[16:19], v[60:63]
  s_waitcnt vmcnt(15)
  ds_read_b128 a[0:3], v0 offset:51392
  v_add_f32 v44, v44, v25
  v_mfma_f32_16x16x32_bf16 v[64:67], a[52:55], a[16:19], v[64:67]
  s_waitcnt vmcnt(14)
  ds_read_b128 a[156:159], v9 offset:27584
  v_fmac_f32 v45, v25, v25
  v_mfma_f32_16x16x32_bf16 v[68:71], a[56:59], a[16:19], v[68:71]
  buffer_load_dwordx4 v17, s[4:7], s32 offen offset:32 lds
  s_add_u32 m0, s62, 13792
  v_mfma_f32_16x16x32_bf16 v[72:75], a[36:39], a[20:23], v[72:75]
  ds_read_b128 a[160:163], v9 offset:28320
  v_add_f32 v44, v44, v26
  v_mfma_f32_16x16x32_bf16 v[76:79], a[40:43], a[20:23], v[76:79]
  ds_read_b128 a[164:167], v9 offset:28352
  v_fmac_f32 v45, v26, v26
  v_mfma_f32_16x16x32_bf16 v[80:83], a[44:47], a[20:23], v[80:83]
  ds_read_b128 a[168:171], v9 offset:29056
  v_add_f32 v44, v44, v27
  v_mfma_f32_16x16x32_bf16 v[84:87], a[48:51], a[20:23], v[84:87]
  buffer_load_dwordx4 v18, s[4:7], s32 offen offset:0 lds
  s_add_u32 m0, s62, 20384
  s_addk_i32 s26, 6144
  v_mfma_f32_16x16x32_bf16 v[88:91], a[52:55], a[20:23], v[88:91]
  s_addk_i32 s27, 6144
  v_fmac_f32 v45, v27, v27
  ds_read_b128 a[172:175], v22 offset:27648
  v_mfma_f32_16x16x32_bf16 v[92:95], a[56:59], a[20:23], v[92:95]
  s_add_u32 s36, s24, 43008
  v_add_u32 v22, v11, v16
  ds_read_b128 a[16:19], v1 offset:192
  v_mfma_f32_16x16x32_bf16 v[96:99], a[36:39], a[24:27], v[96:99]
  ds_read_b128 a[116:119], v10 offset:27584
  v_mfma_f32_16x16x32_bf16 v[100:103], a[40:43], a[24:27], v[100:103]
  buffer_load_dwordx4 v18, s[4:7], s32 offen offset:32 lds
  s_add_u32 m0, s61, 27584
  s_mov_b32 s32, 640
  v_mfma_f32_16x16x32_bf16 v[104:107], a[44:47], a[24:27], v[104:107]
  ds_read_b128 a[120:123], v10 offset:28320
  v_mfma_f32_16x16x32_bf16 v[108:111], a[48:51], a[24:27], v[108:111]
  ds_read_b128 a[124:127], v10 offset:28352
  v_mfma_f32_16x16x32_bf16 v[112:115], a[52:55], a[24:27], v[112:115]
  ds_read_b128 a[128:131], v10 offset:29056
  v_mfma_f32_16x16x32_bf16 v[116:119], a[56:59], a[24:27], v[116:119]
  s_waitcnt lgkmcnt(14)
  buffer_load_dwordx4 a[180:183], v3, s[8:11], s35 offen offset:1024
  v_mfma_f32_16x16x32_bf16 v[120:123], a[36:39], a[28:31], v[120:123]
  ds_read_b128 a[132:135], v23 offset:27648
  v_add_u32 v23, v12, v16
  v_mfma_f32_16x16x32_bf16 v[124:127], a[40:43], a[28:31], v[124:127]
  ds_read_b128 a[20:23], v1 offset:12992
  v_mfma_f32_16x16x32_bf16 v[128:131], a[44:47], a[28:31], v[128:131]
  ds_read_b128 a[24:27], v1 offset:25792
  v_mfma_f32_16x16x32_bf16 v[132:135], a[48:51], a[28:31], v[132:135]
  buffer_load_dwordx4 a[32:35], v3, s[8:11], s26 offen offset:0
  v_mfma_f32_16x16x32_bf16 v[136:139], a[52:55], a[28:31], v[136:139]
  v_mfma_f32_16x16x32_bf16 v[140:143], a[56:59], a[28:31], v[140:143]
  v_mfma_f32_16x16x32_bf16 v[28:31], a[188:191], a[136:139], 0
  s_waitcnt vmcnt(14) lgkmcnt(12)
  ds_read_b128 a[28:31], v1 offset:38592
  v_smfmac_f32_16x16x64_bf16 v[28:31], a[192:195], a[140:147], v15
  ds_read_b128 a[136:139], v11 offset:27584
  v_smfmac_f32_16x16x64_bf16 v[28:31], a[196:199], a[148:155], v15
  ds_read_b128 a[140:143], v11 offset:28320
  v_mfma_f32_16x16x32_bf16 v[144:147], a[36:39], a[0:3], v[144:147]
  ds_read_b128 a[144:147], v11 offset:28352
  v_mfma_f32_16x16x32_bf16 v[148:151], a[40:43], a[0:3], v[148:151]
  ds_read_b128 a[148:151], v11 offset:29056
  v_add_f32 v36, v36, v28
  v_mfma_f32_16x16x32_bf16 v[152:155], a[44:47], a[0:3], v[152:155]
  v_fmac_f32 v37, v28, v28
  ds_read_b128 a[152:155], v22 offset:27648
  v_mfma_f32_16x16x32_bf16 v[156:159], a[48:51], a[0:3], v[156:159]
  v_add_f32 v36, v36, v29
  v_fmac_f32 v37, v29, v29
  v_mfma_f32_16x16x32_bf16 v[160:163], a[52:55], a[0:3], v[160:163]
  v_add_f32 v36, v36, v30
  v_fmac_f32 v37, v30, v30
  v_mfma_f32_16x16x32_bf16 v[164:167], a[56:59], a[0:3], v[164:167]
  v_cvt_pk_bf16_f32 v34, v28, v29
  v_cvt_pk_bf16_f32 v35, v30, v31
  v_mfma_f32_16x16x32_bf16 v[24:27], a[188:191], a[156:159], 0
  s_waitcnt lgkmcnt(12)
  v_add_f32 v36, v36, v31
  v_fmac_f32 v37, v31, v31
  v_smfmac_f32_16x16x64_bf16 v[24:27], a[192:195], a[160:167], v15
  ds_read_b128 a[156:159], v12 offset:27584
  v_smfmac_f32_16x16x64_bf16 v[24:27], a[196:199], a[168:175], v15
  ds_read_b128 a[160:163], v12 offset:28320
  v_mfma_f32_16x16x32_bf16 v[168:171], a[36:39], a[16:19], v[168:171]
  buffer_load_dwordx4 a[240:243], v3, s[8:11], s26 offen offset:1024
  v_mfma_f32_16x16x32_bf16 v[172:175], a[40:43], a[16:19], v[172:175]
  ds_read_b128 a[164:167], v12 offset:28352
  v_add_f32 v38, v38, v24
  v_mfma_f32_16x16x32_bf16 v[176:179], a[44:47], a[16:19], v[176:179]
  v_fmac_f32 v39, v24, v24
  v_add_f32 v38, v38, v25
  v_mfma_f32_16x16x32_bf16 v[180:183], a[48:51], a[16:19], v[180:183]
  v_fmac_f32 v39, v25, v25
  v_add_f32 v38, v38, v26
  v_mfma_f32_16x16x32_bf16 v[184:187], a[52:55], a[16:19], v[184:187]
  v_fmac_f32 v39, v26, v26
  v_cvt_pk_bf16_f32 v32, v24, v25
  v_mfma_f32_16x16x32_bf16 v[188:191], a[56:59], a[16:19], v[188:191]
  v_cvt_pk_bf16_f32 v33, v26, v27
  v_add_f32 v38, v38, v27
  v_mfma_f32_16x16x32_bf16 v[28:31], a[188:191], a[116:119], 0
  s_waitcnt lgkmcnt(9)
  v_fmac_f32 v39, v27, v27
  ds_read_b128 a[168:171], v12 offset:29056
  v_smfmac_f32_16x16x64_bf16 v[28:31], a[192:195], a[120:127], v15
  ds_read_b128 a[172:175], v23 offset:27648
  v_smfmac_f32_16x16x64_bf16 v[28:31], a[196:199], a[128:135], v15
  ds_read_b128 a[0:3], v2 offset:192
  v_mfma_f32_16x16x32_bf16 v[192:195], a[36:39], a[20:23], v[192:195]
  buffer_load_dwordx4 a[244:247], v3, s[8:11], s26 offen offset:2048
  v_mfma_f32_16x16x32_bf16 v[196:199], a[40:43], a[20:23], v[196:199]
  v_add_f32 v40, v40, v28
  v_fmac_f32 v41, v28, v28
  v_mfma_f32_16x16x32_bf16 v[200:203], a[44:47], a[20:23], v[200:203]
  v_add_f32 v40, v40, v29
  v_fmac_f32 v41, v29, v29
  v_mfma_f32_16x16x32_bf16 v[204:207], a[48:51], a[20:23], v[204:207]
  ds_write_b64 v13, v[34:35] offset:320
  v_mfma_f32_16x16x32_bf16 v[208:211], a[52:55], a[20:23], v[208:211]
  v_add_f32 v40, v40, v30
  v_fmac_f32 v41, v30, v30
  v_mfma_f32_16x16x32_bf16 v[212:215], a[56:59], a[20:23], v[212:215]
  s_waitcnt lgkmcnt(7)
  v_cvt_pk_bf16_f32 v34, v28, v29
  v_cvt_pk_bf16_f32 v35, v30, v31
  v_mfma_f32_16x16x32_bf16 v[24:27], a[188:191], a[136:139], 0
  v_add_f32 v40, v40, v31
  v_fmac_f32 v41, v31, v31
  v_smfmac_f32_16x16x64_bf16 v[24:27], a[192:195], a[140:147], v15
  ds_read_b128 a[16:19], v0 offset:256
  v_smfmac_f32_16x16x64_bf16 v[24:27], a[196:199], a[148:155], v15
  ds_read_b128 a[20:23], v0 offset:13056
  v_mfma_f32_16x16x32_bf16 v[216:219], a[36:39], a[24:27], v[216:219]
  buffer_load_dwordx4 a[248:251], v3, s[8:11], s26 offen offset:3072
  v_mfma_f32_16x16x32_bf16 v[220:223], a[40:43], a[24:27], v[220:223]
  ds_write_b64 v13, v[32:33] offset:13120
  v_mfma_f32_16x16x32_bf16 v[224:227], a[44:47], a[24:27], v[224:227]
  v_cvt_pk_bf16_f32 v32, v24, v25
  ds_write_b64 v13, v[34:35] offset:25920
  v_mfma_f32_16x16x32_bf16 v[228:231], a[48:51], a[24:27], v[228:231]
  v_cvt_pk_bf16_f32 v33, v26, v27
  v_add_u32 v22, v8, v16
  v_mfma_f32_16x16x32_bf16 v[232:235], a[52:55], a[24:27], v[232:235]
  ds_write_b64 v13, v[32:33] offset:38720
  v_mfma_f32_16x16x32_bf16 v[236:239], a[56:59], a[24:27], v[236:239]
  s_waitcnt lgkmcnt(9)
  v_add_u32 v23, v9, v16
  v_add_f32 v42, v42, v24
  v_mfma_f32_16x16x32_bf16 v[28:31], a[188:191], a[156:159], 0
  ds_read_b128 a[24:27], v0 offset:25856
  v_fmac_f32 v43, v24, v24
  v_smfmac_f32_16x16x64_bf16 v[28:31], a[192:195], a[160:167], v15
  s_waitcnt lgkmcnt(8)
  v_add_f32 v42, v42, v25
  v_smfmac_f32_16x16x64_bf16 v[28:31], a[196:199], a[168:175], v15
  v_fmac_f32 v43, v25, v25
  v_mfma_f32_16x16x32_bf16 v[240:243], a[36:39], a[28:31], v[240:243]
  buffer_load_dwordx4 a[252:255], v3, s[8:11], s27 offen offset:0
  v_mfma_f32_16x16x32_bf16 v[244:247], a[40:43], a[28:31], v[244:247]
  buffer_load_dwordx4 a[196:199], v3, s[8:11], s36 offen offset:2048
  v_mfma_f32_16x16x32_bf16 v[248:251], a[44:47], a[28:31], v[248:251]
  buffer_load_dwordx4 a[188:191], v3, s[8:11], s36 offen offset:0
  v_mfma_f32_16x16x32_bf16 v[252:255], a[48:51], a[28:31], v[252:255]
  v_accvgpr_read_b32 v6, a4
  v_cvt_pk_bf16_f32 v34, v28, v29
  v_mfma_f32_16x16x32_bf16 a[84:87], a[52:55], a[28:31], a[84:87]
  v_cvt_pk_bf16_f32 v35, v30, v31
  ds_write_b64 v14, v[34:35] offset:320
  v_mfma_f32_16x16x32_bf16 a[88:91], a[56:59], a[28:31], a[88:91]
  s_waitcnt lgkmcnt(7)
  buffer_store_dwordx4 a[212:215], v6, s[12:15], s20 offen offset:128 nt
  v_mfma_f32_16x16x32_bf16 a[92:95], a[36:39], a[0:3], a[92:95]
  ds_read_b128 a[28:31], v0 offset:38656
  v_add_f32 v42, v42, v26
  v_mfma_f32_16x16x32_bf16 a[96:99], a[40:43], a[0:3], a[96:99]
  v_fmac_f32 v43, v26, v26
  v_add_f32 v42, v42, v27
  v_mfma_f32_16x16x32_bf16 a[100:103], a[44:47], a[0:3], a[100:103]
  s_waitcnt lgkmcnt(1)
  s_barrier
  ds_read_b128 a[116:119], v8 offset:0
  v_mfma_f32_16x16x32_bf16 a[104:107], a[48:51], a[0:3], a[104:107]
  buffer_load_dwordx4 a[200:203], v3, s[8:11], s27 offen offset:1024
  v_mfma_f32_16x16x32_bf16 a[108:111], a[52:55], a[0:3], a[108:111]
  ds_read_b128 a[120:123], v8 offset:736
  v_fmac_f32 v43, v27, v27
  v_mfma_f32_16x16x32_bf16 a[112:115], a[56:59], a[0:3], a[112:115]
  s_waitcnt vmcnt(15)
  ds_read_b128 a[124:127], v8 offset:768
  v_add_f32 v44, v44, v28
  v_mfma_f32_16x16x32_bf16 v[48:51], a[60:63], a[16:19], v[48:51]
  ds_read_b128 a[128:131], v8 offset:1472
  v_fmac_f32 v45, v28, v28
  v_mfma_f32_16x16x32_bf16 v[52:55], a[64:67], a[16:19], v[52:55]
  buffer_load_dwordx4 v17, s[4:7], s33 offen offset:0 lds
  s_add_u32 m0, s61, 34176
  v_mfma_f32_16x16x32_bf16 v[56:59], a[68:71], a[16:19], v[56:59]
  ds_read_b128 a[132:135], v22 offset:64
  v_add_u32 v22, v10, v16
  v_mfma_f32_16x16x32_bf16 v[60:63], a[72:75], a[16:19], v[60:63]
  ds_read_b128 a[0:3], v0 offset:51456
  v_add_f32 v44, v44, v29
  v_mfma_f32_16x16x32_bf16 v[64:67], a[76:79], a[16:19], v[64:67]
  s_waitcnt vmcnt(14)
  ds_read_b128 a[136:139], v9 offset:0
  v_fmac_f32 v45, v29, v29
  v_mfma_f32_16x16x32_bf16 v[68:71], a[80:83], a[16:19], v[68:71]
  buffer_load_dwordx4 v17, s[4:7], s33 offen offset:32 lds
  s_add_u32 m0, s62, 27584
  v_mfma_f32_16x16x32_bf16 v[72:75], a[60:63], a[20:23], v[72:75]
  ds_read_b128 a[140:143], v9 offset:736
  v_add_f32 v44, v44, v30
  v_mfma_f32_16x16x32_bf16 v[76:79], a[64:67], a[20:23], v[76:79]
  ds_read_b128 a[144:147], v9 offset:768
  v_fmac_f32 v45, v30, v30
  v_mfma_f32_16x16x32_bf16 v[80:83], a[68:71], a[20:23], v[80:83]
  ds_read_b128 a[148:151], v9 offset:1472
  v_add_f32 v44, v44, v31
  v_mfma_f32_16x16x32_bf16 v[84:87], a[72:75], a[20:23], v[84:87]
  buffer_load_dwordx4 v18, s[4:7], s33 offen offset:0 lds
  s_add_u32 m0, s62, 34176
  s_addk_i32 s26, 6144
  v_mfma_f32_16x16x32_bf16 v[88:91], a[76:79], a[20:23], v[88:91]
  s_addk_i32 s27, 6144
  v_fmac_f32 v45, v31, v31
  ds_read_b128 a[152:155], v23 offset:64
  v_mfma_f32_16x16x32_bf16 v[92:95], a[80:83], a[20:23], v[92:95]
  s_add_u32 s35, s24, 49152
  v_add_u32 v23, v11, v16
  ds_read_b128 a[16:19], v1 offset:256
  v_mfma_f32_16x16x32_bf16 v[96:99], a[60:63], a[24:27], v[96:99]
  ds_read_b128 a[156:159], v10 offset:0
  v_mfma_f32_16x16x32_bf16 v[100:103], a[64:67], a[24:27], v[100:103]
  buffer_load_dwordx4 v18, s[4:7], s33 offen offset:32 lds
  s_add_u32 m0, s61, 0
  s_mov_b32 s33, 704
  v_mfma_f32_16x16x32_bf16 v[104:107], a[68:71], a[24:27], v[104:107]
  ds_read_b128 a[160:163], v10 offset:736
  v_mfma_f32_16x16x32_bf16 v[108:111], a[72:75], a[24:27], v[108:111]
  ds_read_b128 a[164:167], v10 offset:768
  v_mfma_f32_16x16x32_bf16 v[112:115], a[76:79], a[24:27], v[112:115]
  ds_read_b128 a[168:171], v10 offset:1472
  v_mfma_f32_16x16x32_bf16 v[116:119], a[80:83], a[24:27], v[116:119]
  s_waitcnt lgkmcnt(14)
  buffer_load_dwordx4 a[192:195], v3, s[8:11], s36 offen offset:1024
  v_mfma_f32_16x16x32_bf16 v[120:123], a[60:63], a[28:31], v[120:123]
  ds_read_b128 a[172:175], v22 offset:64
  v_add_u32 v22, v12, v16
  v_mfma_f32_16x16x32_bf16 v[124:127], a[64:67], a[28:31], v[124:127]
  ds_read_b128 a[20:23], v1 offset:13056
  v_mfma_f32_16x16x32_bf16 v[128:131], a[68:71], a[28:31], v[128:131]
  ds_read_b128 a[24:27], v1 offset:25856
  v_mfma_f32_16x16x32_bf16 v[132:135], a[72:75], a[28:31], v[132:135]
  buffer_load_dwordx4 a[36:39], v3, s[8:11], s26 offen offset:0
  v_mfma_f32_16x16x32_bf16 v[136:139], a[76:79], a[28:31], v[136:139]
  v_mfma_f32_16x16x32_bf16 v[140:143], a[80:83], a[28:31], v[140:143]
  v_mfma_f32_16x16x32_bf16 v[24:27], a[176:179], a[116:119], 0
  s_waitcnt vmcnt(14) lgkmcnt(12)
  ds_read_b128 a[28:31], v1 offset:38656
  v_smfmac_f32_16x16x64_bf16 v[24:27], a[180:183], a[120:127], v15
  ds_read_b128 a[116:119], v11 offset:0
  v_smfmac_f32_16x16x64_bf16 v[24:27], a[184:187], a[128:135], v15
  ds_read_b128 a[120:123], v11 offset:736
  v_mfma_f32_16x16x32_bf16 v[144:147], a[60:63], a[0:3], v[144:147]
  ds_read_b128 a[124:127], v11 offset:768
  v_mfma_f32_16x16x32_bf16 v[148:151], a[64:67], a[0:3], v[148:151]
  ds_read_b128 a[128:131], v11 offset:1472
  v_add_f32 v36, v36, v24
  v_mfma_f32_16x16x32_bf16 v[152:155], a[68:71], a[0:3], v[152:155]
  v_fmac_f32 v37, v24, v24
  ds_read_b128 a[132:135], v23 offset:64
  v_mfma_f32_16x16x32_bf16 v[156:159], a[72:75], a[0:3], v[156:159]
  v_add_f32 v36, v36, v25
  v_fmac_f32 v37, v25, v25
  v_mfma_f32_16x16x32_bf16 v[160:163], a[76:79], a[0:3], v[160:163]
  v_add_f32 v36, v36, v26
  v_fmac_f32 v37, v26, v26
  v_mfma_f32_16x16x32_bf16 v[164:167], a[80:83], a[0:3], v[164:167]
  v_cvt_pk_bf16_f32 v32, v24, v25
  v_cvt_pk_bf16_f32 v33, v26, v27
  v_mfma_f32_16x16x32_bf16 v[28:31], a[176:179], a[136:139], 0
  s_waitcnt lgkmcnt(12)
  v_add_f32 v36, v36, v27
  v_fmac_f32 v37, v27, v27
  v_smfmac_f32_16x16x64_bf16 v[28:31], a[180:183], a[140:147], v15
  ds_read_b128 a[136:139], v12 offset:0
  v_smfmac_f32_16x16x64_bf16 v[28:31], a[184:187], a[148:155], v15
  ds_read_b128 a[140:143], v12 offset:736
  v_mfma_f32_16x16x32_bf16 v[168:171], a[60:63], a[16:19], v[168:171]
  buffer_load_dwordx4 a[40:43], v3, s[8:11], s26 offen offset:1024
  v_mfma_f32_16x16x32_bf16 v[172:175], a[64:67], a[16:19], v[172:175]
  ds_read_b128 a[144:147], v12 offset:768
  v_add_f32 v38, v38, v28
  v_mfma_f32_16x16x32_bf16 v[176:179], a[68:71], a[16:19], v[176:179]
  v_fmac_f32 v39, v28, v28
  v_add_f32 v38, v38, v29
  v_mfma_f32_16x16x32_bf16 v[180:183], a[72:75], a[16:19], v[180:183]
  v_fmac_f32 v39, v29, v29
  v_add_f32 v38, v38, v30
  v_mfma_f32_16x16x32_bf16 v[184:187], a[76:79], a[16:19], v[184:187]
  v_fmac_f32 v39, v30, v30
  v_cvt_pk_bf16_f32 v34, v28, v29
  v_mfma_f32_16x16x32_bf16 v[188:191], a[80:83], a[16:19], v[188:191]
  v_cvt_pk_bf16_f32 v35, v30, v31
  v_add_f32 v38, v38, v31
  v_mfma_f32_16x16x32_bf16 v[24:27], a[176:179], a[156:159], 0
  s_waitcnt lgkmcnt(9)
  v_fmac_f32 v39, v31, v31
  ds_read_b128 a[148:151], v12 offset:1472
  v_smfmac_f32_16x16x64_bf16 v[24:27], a[180:183], a[160:167], v15
  ds_read_b128 a[152:155], v22 offset:64
  v_smfmac_f32_16x16x64_bf16 v[24:27], a[184:187], a[168:175], v15
  ds_read_b128 a[0:3], v2 offset:256
  v_mfma_f32_16x16x32_bf16 v[192:195], a[60:63], a[20:23], v[192:195]
  buffer_load_dwordx4 a[44:47], v3, s[8:11], s26 offen offset:2048
  v_mfma_f32_16x16x32_bf16 v[196:199], a[64:67], a[20:23], v[196:199]
  v_add_f32 v40, v40, v24
  v_fmac_f32 v41, v24, v24
  v_mfma_f32_16x16x32_bf16 v[200:203], a[68:71], a[20:23], v[200:203]
  v_add_f32 v40, v40, v25
  v_fmac_f32 v41, v25, v25
  v_mfma_f32_16x16x32_bf16 v[204:207], a[72:75], a[20:23], v[204:207]
  ds_write_b64 v13, v[32:33] offset:384
  v_mfma_f32_16x16x32_bf16 v[208:211], a[76:79], a[20:23], v[208:211]
  v_add_f32 v40, v40, v26
  v_fmac_f32 v41, v26, v26
  v_mfma_f32_16x16x32_bf16 v[212:215], a[80:83], a[20:23], v[212:215]
  s_waitcnt lgkmcnt(7)
  v_cvt_pk_bf16_f32 v32, v24, v25
  v_cvt_pk_bf16_f32 v33, v26, v27
  v_mfma_f32_16x16x32_bf16 v[28:31], a[176:179], a[116:119], 0
  v_add_f32 v40, v40, v27
  v_fmac_f32 v41, v27, v27
  v_smfmac_f32_16x16x64_bf16 v[28:31], a[180:183], a[120:127], v15
  ds_read_b128 a[16:19], v0 offset:320
  v_smfmac_f32_16x16x64_bf16 v[28:31], a[184:187], a[128:135], v15
  ds_read_b128 a[20:23], v0 offset:13120
  v_mfma_f32_16x16x32_bf16 v[216:219], a[60:63], a[24:27], v[216:219]
  buffer_load_dwordx4 a[48:51], v3, s[8:11], s26 offen offset:3072
  v_mfma_f32_16x16x32_bf16 v[220:223], a[64:67], a[24:27], v[220:223]
  ds_write_b64 v13, v[34:35] offset:13184
  v_mfma_f32_16x16x32_bf16 v[224:227], a[68:71], a[24:27], v[224:227]
  v_cvt_pk_bf16_f32 v34, v28, v29
  ds_write_b64 v13, v[32:33] offset:25984
  v_mfma_f32_16x16x32_bf16 v[228:231], a[72:75], a[24:27], v[228:231]
  v_cvt_pk_bf16_f32 v35, v30, v31
  v_add_u32 v23, v8, v16
  v_mfma_f32_16x16x32_bf16 v[232:235], a[76:79], a[24:27], v[232:235]
  ds_write_b64 v13, v[34:35] offset:38784
  v_mfma_f32_16x16x32_bf16 v[236:239], a[80:83], a[24:27], v[236:239]
  s_waitcnt lgkmcnt(9)
  v_add_u32 v22, v9, v16
  v_add_f32 v42, v42, v28
  v_mfma_f32_16x16x32_bf16 v[24:27], a[176:179], a[136:139], 0
  ds_read_b128 a[24:27], v0 offset:25920
  v_fmac_f32 v43, v28, v28
  v_smfmac_f32_16x16x64_bf16 v[24:27], a[180:183], a[140:147], v15
  s_waitcnt lgkmcnt(8)
  v_add_f32 v42, v42, v29
  v_smfmac_f32_16x16x64_bf16 v[24:27], a[184:187], a[148:155], v15
  v_fmac_f32 v43, v29, v29
  v_mfma_f32_16x16x32_bf16 v[240:243], a[60:63], a[28:31], v[240:243]
  buffer_load_dwordx4 a[52:55], v3, s[8:11], s27 offen offset:0
  v_mfma_f32_16x16x32_bf16 v[244:247], a[64:67], a[28:31], v[244:247]
  buffer_load_dwordx4 a[184:187], v3, s[8:11], s35 offen offset:2048
  v_mfma_f32_16x16x32_bf16 v[248:251], a[68:71], a[28:31], v[248:251]
  buffer_load_dwordx4 a[176:179], v3, s[8:11], s35 offen offset:0
  v_mfma_f32_16x16x32_bf16 v[252:255], a[72:75], a[28:31], v[252:255]
  v_accvgpr_read_b32 v5, a5
  v_cvt_pk_bf16_f32 v32, v24, v25
  v_mfma_f32_16x16x32_bf16 a[84:87], a[76:79], a[28:31], a[84:87]
  v_cvt_pk_bf16_f32 v33, v26, v27
  ds_write_b64 v14, v[32:33] offset:384
  v_mfma_f32_16x16x32_bf16 a[88:91], a[80:83], a[28:31], a[88:91]
  s_waitcnt lgkmcnt(7)
  buffer_store_dwordx4 a[216:219], v5, s[12:15], s20 offen offset:128 nt
  v_mfma_f32_16x16x32_bf16 a[92:95], a[60:63], a[0:3], a[92:95]
  ds_read_b128 a[28:31], v0 offset:38720
  v_add_f32 v42, v42, v30
  v_mfma_f32_16x16x32_bf16 a[96:99], a[64:67], a[0:3], a[96:99]
  v_fmac_f32 v43, v30, v30
  v_add_f32 v42, v42, v31
  v_mfma_f32_16x16x32_bf16 a[100:103], a[68:71], a[0:3], a[100:103]
  s_waitcnt lgkmcnt(1)
  s_barrier
  ds_read_b128 a[156:159], v8 offset:13792
  v_mfma_f32_16x16x32_bf16 a[104:107], a[72:75], a[0:3], a[104:107]
  buffer_load_dwordx4 a[56:59], v3, s[8:11], s27 offen offset:1024
  v_mfma_f32_16x16x32_bf16 a[108:111], a[76:79], a[0:3], a[108:111]
  ds_read_b128 a[160:163], v8 offset:14528
  v_fmac_f32 v43, v31, v31
  v_mfma_f32_16x16x32_bf16 a[112:115], a[80:83], a[0:3], a[112:115]
  s_waitcnt vmcnt(15)
  ds_read_b128 a[164:167], v8 offset:14560
  v_add_f32 v44, v44, v24
  v_mfma_f32_16x16x32_bf16 v[48:51], a[32:35], a[16:19], v[48:51]
  ds_read_b128 a[168:171], v8 offset:15264
  v_fmac_f32 v45, v24, v24
  v_mfma_f32_16x16x32_bf16 v[52:55], a[240:243], a[16:19], v[52:55]
  buffer_load_dwordx4 v17, s[4:7], s34 offen offset:0 lds
  s_add_u32 m0, s61, 6592
  v_mfma_f32_16x16x32_bf16 v[56:59], a[244:247], a[16:19], v[56:59]
  ds_read_b128 a[172:175], v23 offset:13856
  v_add_u32 v23, v10, v16
  v_mfma_f32_16x16x32_bf16 v[60:63], a[248:251], a[16:19], v[60:63]
  ds_read_b128 a[0:3], v0 offset:51520
  v_add_f32 v44, v44, v25
  v_mfma_f32_16x16x32_bf16 v[64:67], a[252:255], a[16:19], v[64:67]
  s_waitcnt vmcnt(14)
  ds_read_b128 a[116:119], v9 offset:13792
  v_fmac_f32 v45, v25, v25
  v_mfma_f32_16x16x32_bf16 v[68:71], a[200:203], a[16:19], v[68:71]
  buffer_load_dwordx4 v17, s[4:7], s34 offen offset:32 lds
  s_add_u32 m0, s62, 0
  v_mfma_f32_16x16x32_bf16 v[72:75], a[32:35], a[20:23], v[72:75]
  ds_read_b128 a[120:123], v9 offset:14528
  v_add_f32 v44, v44, v26
  v_mfma_f32_16x16x32_bf16 v[76:79], a[240:243], a[20:23], v[76:79]
  ds_read_b128 a[124:127], v9 offset:14560
  v_fmac_f32 v45, v26, v26
  v_mfma_f32_16x16x32_bf16 v[80:83], a[244:247], a[20:23], v[80:83]
  ds_read_b128 a[128:131], v9 offset:15264
  v_add_f32 v44, v44, v27
  v_mfma_f32_16x16x32_bf16 v[84:87], a[248:251], a[20:23], v[84:87]
  buffer_load_dwordx4 v18, s[4:7], s34 offen offset:0 lds
  s_add_u32 m0, s62, 6592
  s_addk_i32 s26, 6144
  v_mfma_f32_16x16x32_bf16 v[88:91], a[252:255], a[20:23], v[88:91]
  s_addk_i32 s27, 6144
  v_fmac_f32 v45, v27, v27
  ds_read_b128 a[132:135], v22 offset:13856
  v_mfma_f32_16x16x32_bf16 v[92:95], a[200:203], a[20:23], v[92:95]
  s_add_u32 s36, s24, 55296
  v_add_u32 v22, v11, v16
  ds_read_b128 a[16:19], v1 offset:320
  v_mfma_f32_16x16x32_bf16 v[96:99], a[32:35], a[24:27], v[96:99]
  ds_read_b128 a[136:139], v10 offset:13792
  v_mfma_f32_16x16x32_bf16 v[100:103], a[240:243], a[24:27], v[100:103]
  buffer_load_dwordx4 v18, s[4:7], s34 offen offset:32 lds
  s_add_u32 m0, s61, 13792
  s_mov_b32 s34, 0
  v_mfma_f32_16x16x32_bf16 v[104:107], a[244:247], a[24:27], v[104:107]
  ds_read_b128 a[140:143], v10 offset:14528
  v_mfma_f32_16x16x32_bf16 v[108:111], a[248:251], a[24:27], v[108:111]
  ds_read_b128 a[144:147], v10 offset:14560
  v_mfma_f32_16x16x32_bf16 v[112:115], a[252:255], a[24:27], v[112:115]
  ds_read_b128 a[148:151], v10 offset:15264
  v_mfma_f32_16x16x32_bf16 v[116:119], a[200:203], a[24:27], v[116:119]
  s_waitcnt lgkmcnt(14)
  buffer_load_dwordx4 a[180:183], v3, s[8:11], s35 offen offset:1024
  v_mfma_f32_16x16x32_bf16 v[120:123], a[32:35], a[28:31], v[120:123]
  ds_read_b128 a[152:155], v23 offset:13856
  v_add_u32 v23, v12, v16
  v_mfma_f32_16x16x32_bf16 v[124:127], a[240:243], a[28:31], v[124:127]
  ds_read_b128 a[20:23], v1 offset:13120
  v_mfma_f32_16x16x32_bf16 v[128:131], a[244:247], a[28:31], v[128:131]
  ds_read_b128 a[24:27], v1 offset:25920
  v_mfma_f32_16x16x32_bf16 v[132:135], a[248:251], a[28:31], v[132:135]
  buffer_load_dwordx4 a[60:63], v3, s[8:11], s26 offen offset:0
  v_mfma_f32_16x16x32_bf16 v[136:139], a[252:255], a[28:31], v[136:139]
  v_mfma_f32_16x16x32_bf16 v[140:143], a[200:203], a[28:31], v[140:143]
  v_mfma_f32_16x16x32_bf16 v[28:31], a[188:191], a[156:159], 0
  s_waitcnt vmcnt(14) lgkmcnt(12)
  ds_read_b128 a[28:31], v1 offset:38720
  v_smfmac_f32_16x16x64_bf16 v[28:31], a[192:195], a[160:167], v15
  ds_read_b128 a[156:159], v11 offset:13792
  v_smfmac_f32_16x16x64_bf16 v[28:31], a[196:199], a[168:175], v15
  ds_read_b128 a[160:163], v11 offset:14528
  v_mfma_f32_16x16x32_bf16 v[144:147], a[32:35], a[0:3], v[144:147]
  ds_read_b128 a[164:167], v11 offset:14560
  v_mfma_f32_16x16x32_bf16 v[148:151], a[240:243], a[0:3], v[148:151]
  ds_read_b128 a[168:171], v11 offset:15264
  v_add_f32 v36, v36, v28
  v_mfma_f32_16x16x32_bf16 v[152:155], a[244:247], a[0:3], v[152:155]
  v_fmac_f32 v37, v28, v28
  ds_read_b128 a[172:175], v22 offset:13856
  v_mfma_f32_16x16x32_bf16 v[156:159], a[248:251], a[0:3], v[156:159]
  v_add_f32 v36, v36, v29
  v_fmac_f32 v37, v29, v29
  v_mfma_f32_16x16x32_bf16 v[160:163], a[252:255], a[0:3], v[160:163]
  v_add_f32 v36, v36, v30
  v_fmac_f32 v37, v30, v30
  v_mfma_f32_16x16x32_bf16 v[164:167], a[200:203], a[0:3], v[164:167]
  v_cvt_pk_bf16_f32 v34, v28, v29
  v_cvt_pk_bf16_f32 v35, v30, v31
  v_mfma_f32_16x16x32_bf16 v[24:27], a[188:191], a[116:119], 0
  s_waitcnt lgkmcnt(12)
  v_add_f32 v36, v36, v31
  v_fmac_f32 v37, v31, v31
  v_smfmac_f32_16x16x64_bf16 v[24:27], a[192:195], a[120:127], v15
  ds_read_b128 a[116:119], v12 offset:13792
  v_smfmac_f32_16x16x64_bf16 v[24:27], a[196:199], a[128:135], v15
  ds_read_b128 a[120:123], v12 offset:14528
  v_mfma_f32_16x16x32_bf16 v[168:171], a[32:35], a[16:19], v[168:171]
  buffer_load_dwordx4 a[64:67], v3, s[8:11], s26 offen offset:1024
  v_mfma_f32_16x16x32_bf16 v[172:175], a[240:243], a[16:19], v[172:175]
  ds_read_b128 a[124:127], v12 offset:14560
  v_add_f32 v38, v38, v24
  v_mfma_f32_16x16x32_bf16 v[176:179], a[244:247], a[16:19], v[176:179]
  v_fmac_f32 v39, v24, v24
  v_add_f32 v38, v38, v25
  v_mfma_f32_16x16x32_bf16 v[180:183], a[248:251], a[16:19], v[180:183]
  v_fmac_f32 v39, v25, v25
  v_add_f32 v38, v38, v26
  v_mfma_f32_16x16x32_bf16 v[184:187], a[252:255], a[16:19], v[184:187]
  v_fmac_f32 v39, v26, v26
  v_cvt_pk_bf16_f32 v32, v24, v25
  v_mfma_f32_16x16x32_bf16 v[188:191], a[200:203], a[16:19], v[188:191]
  v_cvt_pk_bf16_f32 v33, v26, v27
  v_add_f32 v38, v38, v27
  v_mfma_f32_16x16x32_bf16 v[28:31], a[188:191], a[136:139], 0
  s_waitcnt lgkmcnt(9)
  v_fmac_f32 v39, v27, v27
  ds_read_b128 a[128:131], v12 offset:15264
  v_smfmac_f32_16x16x64_bf16 v[28:31], a[192:195], a[140:147], v15
  ds_read_b128 a[132:135], v23 offset:13856
  v_smfmac_f32_16x16x64_bf16 v[28:31], a[196:199], a[148:155], v15
  ds_read_b128 a[0:3], v2 offset:320
  v_mfma_f32_16x16x32_bf16 v[192:195], a[32:35], a[20:23], v[192:195]
  buffer_load_dwordx4 a[68:71], v3, s[8:11], s26 offen offset:2048
  v_mfma_f32_16x16x32_bf16 v[196:199], a[240:243], a[20:23], v[196:199]
  v_add_f32 v40, v40, v28
  v_fmac_f32 v41, v28, v28
  v_mfma_f32_16x16x32_bf16 v[200:203], a[244:247], a[20:23], v[200:203]
  v_add_f32 v40, v40, v29
  v_fmac_f32 v41, v29, v29
  v_mfma_f32_16x16x32_bf16 v[204:207], a[248:251], a[20:23], v[204:207]
  ds_write_b64 v13, v[34:35] offset:448
  v_mfma_f32_16x16x32_bf16 v[208:211], a[252:255], a[20:23], v[208:211]
  v_add_f32 v40, v40, v30
  v_fmac_f32 v41, v30, v30
  v_mfma_f32_16x16x32_bf16 v[212:215], a[200:203], a[20:23], v[212:215]
  s_waitcnt lgkmcnt(7)
  v_cvt_pk_bf16_f32 v34, v28, v29
  v_cvt_pk_bf16_f32 v35, v30, v31
  v_mfma_f32_16x16x32_bf16 v[24:27], a[188:191], a[156:159], 0
  v_add_f32 v40, v40, v31
  v_fmac_f32 v41, v31, v31
  v_smfmac_f32_16x16x64_bf16 v[24:27], a[192:195], a[160:167], v15
  ds_read_b128 a[16:19], v0 offset:384
  v_smfmac_f32_16x16x64_bf16 v[24:27], a[196:199], a[168:175], v15
  ds_read_b128 a[20:23], v0 offset:13184
  v_mfma_f32_16x16x32_bf16 v[216:219], a[32:35], a[24:27], v[216:219]
  buffer_load_dwordx4 a[72:75], v3, s[8:11], s26 offen offset:3072
  v_mfma_f32_16x16x32_bf16 v[220:223], a[240:243], a[24:27], v[220:223]
  ds_write_b64 v13, v[32:33] offset:13248
  v_mfma_f32_16x16x32_bf16 v[224:227], a[244:247], a[24:27], v[224:227]
  v_cvt_pk_bf16_f32 v32, v24, v25
  ds_write_b64 v13, v[34:35] offset:26048
  v_mfma_f32_16x16x32_bf16 v[228:231], a[248:251], a[24:27], v[228:231]
  v_cvt_pk_bf16_f32 v33, v26, v27
  v_add_u32 v22, v8, v16
  v_mfma_f32_16x16x32_bf16 v[232:235], a[252:255], a[24:27], v[232:235]
  ds_write_b64 v13, v[32:33] offset:38848
  v_mfma_f32_16x16x32_bf16 v[236:239], a[200:203], a[24:27], v[236:239]
  s_waitcnt lgkmcnt(9)
  v_add_u32 v23, v9, v16
  v_add_f32 v42, v42, v24
  v_mfma_f32_16x16x32_bf16 v[28:31], a[188:191], a[116:119], 0
  ds_read_b128 a[24:27], v0 offset:25984
  v_fmac_f32 v43, v24, v24
  v_smfmac_f32_16x16x64_bf16 v[28:31], a[192:195], a[120:127], v15
  s_waitcnt lgkmcnt(8)
  v_add_f32 v42, v42, v25
  v_smfmac_f32_16x16x64_bf16 v[28:31], a[196:199], a[128:135], v15
  v_fmac_f32 v43, v25, v25
  v_mfma_f32_16x16x32_bf16 v[240:243], a[32:35], a[28:31], v[240:243]
  buffer_load_dwordx4 a[76:79], v3, s[8:11], s27 offen offset:0
  v_mfma_f32_16x16x32_bf16 v[244:247], a[240:243], a[28:31], v[244:247]
  buffer_load_dwordx4 a[196:199], v3, s[8:11], s36 offen offset:2048
  v_mfma_f32_16x16x32_bf16 v[248:251], a[244:247], a[28:31], v[248:251]
  buffer_load_dwordx4 a[188:191], v3, s[8:11], s36 offen offset:0
  v_mfma_f32_16x16x32_bf16 v[252:255], a[248:251], a[28:31], v[252:255]
  v_accvgpr_read_b32 v6, a6
  v_cvt_pk_bf16_f32 v34, v28, v29
  v_mfma_f32_16x16x32_bf16 a[84:87], a[252:255], a[28:31], a[84:87]
  v_cvt_pk_bf16_f32 v35, v30, v31
  ds_write_b64 v14, v[34:35] offset:448
  v_mfma_f32_16x16x32_bf16 a[88:91], a[200:203], a[28:31], a[88:91]
  buffer_store_dwordx4 a[220:223], v6, s[12:15], s20 offen offset:128 nt
  s_mov_b32 s20, s59
  s_waitcnt lgkmcnt(7)
  v_mfma_f32_16x16x32_bf16 a[92:95], a[32:35], a[0:3], a[92:95]
  ds_read_b128 a[28:31], v0 offset:38784
  v_add_f32 v42, v42, v26
  v_mfma_f32_16x16x32_bf16 a[96:99], a[240:243], a[0:3], a[96:99]
  v_fmac_f32 v43, v26, v26
  v_add_f32 v42, v42, v27
  v_mfma_f32_16x16x32_bf16 a[100:103], a[244:247], a[0:3], a[100:103]
  s_waitcnt lgkmcnt(1)
  s_barrier
  ds_read_b128 a[136:139], v8 offset:27584
  v_mfma_f32_16x16x32_bf16 a[104:107], a[248:251], a[0:3], a[104:107]
  buffer_load_dwordx4 a[80:83], v3, s[8:11], s27 offen offset:1024
  v_mfma_f32_16x16x32_bf16 a[108:111], a[252:255], a[0:3], a[108:111]
  ds_read_b128 a[140:143], v8 offset:28320
  v_fmac_f32 v43, v27, v27
  v_mfma_f32_16x16x32_bf16 a[112:115], a[200:203], a[0:3], a[112:115]
  s_waitcnt vmcnt(15)
  ds_read_b128 a[144:147], v8 offset:28352
  v_add_f32 v44, v44, v28
  v_mfma_f32_16x16x32_bf16 v[48:51], a[36:39], a[16:19], v[48:51]
  ds_read_b128 a[148:151], v8 offset:29056
  v_fmac_f32 v45, v28, v28
  v_mfma_f32_16x16x32_bf16 v[52:55], a[40:43], a[16:19], v[52:55]
  buffer_load_dwordx4 v17, s[4:7], s32 offen offset:0 lds
  s_add_u32 m0, s61, 20384
  v_mfma_f32_16x16x32_bf16 v[56:59], a[44:47], a[16:19], v[56:59]
  ds_read_b128 a[152:155], v22 offset:27648
  v_add_u32 v22, v10, v16
  v_mfma_f32_16x16x32_bf16 v[60:63], a[48:51], a[16:19], v[60:63]
  ds_read_b128 a[0:3], v0 offset:51584
  v_add_f32 v44, v44, v29
  v_mfma_f32_16x16x32_bf16 v[64:67], a[52:55], a[16:19], v[64:67]
  s_waitcnt vmcnt(14)
  ds_read_b128 a[156:159], v9 offset:27584
  v_fmac_f32 v45, v29, v29
  v_mfma_f32_16x16x32_bf16 v[68:71], a[56:59], a[16:19], v[68:71]
  buffer_load_dwordx4 v17, s[4:7], s32 offen offset:32 lds
  s_add_u32 m0, s62, 13792
  v_mfma_f32_16x16x32_bf16 v[72:75], a[36:39], a[20:23], v[72:75]
  ds_read_b128 a[160:163], v9 offset:28320
  v_add_f32 v44, v44, v30
  v_mfma_f32_16x16x32_bf16 v[76:79], a[40:43], a[20:23], v[76:79]
  ds_read_b128 a[164:167], v9 offset:28352
  v_fmac_f32 v45, v30, v30
  v_mfma_f32_16x16x32_bf16 v[80:83], a[44:47], a[20:23], v[80:83]
  ds_read_b128 a[168:171], v9 offset:29056
  v_add_f32 v44, v44, v31
  v_mfma_f32_16x16x32_bf16 v[84:87], a[48:51], a[20:23], v[84:87]
  buffer_load_dwordx4 v18, s[4:7], s32 offen offset:0 lds
  s_add_u32 m0, s62, 20384
  s_addk_i32 s26, 6144
  v_mfma_f32_16x16x32_bf16 v[88:91], a[52:55], a[20:23], v[88:91]
  s_addk_i32 s27, 6144
  v_fmac_f32 v45, v31, v31
  ds_read_b128 a[172:175], v23 offset:27648
  v_mfma_f32_16x16x32_bf16 v[92:95], a[56:59], a[20:23], v[92:95]
  s_add_u32 s35, s24, 61440
  v_add_u32 v23, v11, v16
  ds_read_b128 a[16:19], v1 offset:384
  v_mfma_f32_16x16x32_bf16 v[96:99], a[36:39], a[24:27], v[96:99]
  ds_read_b128 a[116:119], v10 offset:27584
  v_mfma_f32_16x16x32_bf16 v[100:103], a[40:43], a[24:27], v[100:103]
  buffer_load_dwordx4 v18, s[4:7], s32 offen offset:32 lds
  s_add_u32 m0, s61, 27584
  s_mov_b32 s32, 64
  v_mfma_f32_16x16x32_bf16 v[104:107], a[44:47], a[24:27], v[104:107]
  ds_read_b128 a[120:123], v10 offset:28320
  v_mfma_f32_16x16x32_bf16 v[108:111], a[48:51], a[24:27], v[108:111]
  ds_read_b128 a[124:127], v10 offset:28352
  v_mfma_f32_16x16x32_bf16 v[112:115], a[52:55], a[24:27], v[112:115]
  ds_read_b128 a[128:131], v10 offset:29056
  v_mfma_f32_16x16x32_bf16 v[116:119], a[56:59], a[24:27], v[116:119]
  s_waitcnt lgkmcnt(14)
  buffer_load_dwordx4 a[192:195], v3, s[8:11], s36 offen offset:1024
  v_mfma_f32_16x16x32_bf16 v[120:123], a[36:39], a[28:31], v[120:123]
  ds_read_b128 a[132:135], v22 offset:27648
  v_add_u32 v22, v12, v16
  v_mfma_f32_16x16x32_bf16 v[124:127], a[40:43], a[28:31], v[124:127]
  ds_read_b128 a[20:23], v1 offset:13184
  v_mfma_f32_16x16x32_bf16 v[128:131], a[44:47], a[28:31], v[128:131]
  ds_read_b128 a[24:27], v1 offset:25984
  v_mfma_f32_16x16x32_bf16 v[132:135], a[48:51], a[28:31], v[132:135]
  buffer_load_dwordx4 a[32:35], v3, s[8:11], s26 offen offset:0
  v_mfma_f32_16x16x32_bf16 v[136:139], a[52:55], a[28:31], v[136:139]
  v_mfma_f32_16x16x32_bf16 v[140:143], a[56:59], a[28:31], v[140:143]
  v_mfma_f32_16x16x32_bf16 v[24:27], a[176:179], a[136:139], 0
  s_waitcnt vmcnt(14) lgkmcnt(12)
  ds_read_b128 a[28:31], v1 offset:38784
  v_smfmac_f32_16x16x64_bf16 v[24:27], a[180:183], a[140:147], v15
  ds_read_b128 a[136:139], v11 offset:27584
  v_smfmac_f32_16x16x64_bf16 v[24:27], a[184:187], a[148:155], v15
  ds_read_b128 a[140:143], v11 offset:28320
  v_mfma_f32_16x16x32_bf16 v[144:147], a[36:39], a[0:3], v[144:147]
  ds_read_b128 a[144:147], v11 offset:28352
  v_mfma_f32_16x16x32_bf16 v[148:151], a[40:43], a[0:3], v[148:151]
  ds_read_b128 a[148:151], v11 offset:29056
  v_add_f32 v36, v36, v24
  v_mfma_f32_16x16x32_bf16 v[152:155], a[44:47], a[0:3], v[152:155]
  v_fmac_f32 v37, v24, v24
  ds_read_b128 a[152:155], v23 offset:27648
  v_mfma_f32_16x16x32_bf16 v[156:159], a[48:51], a[0:3], v[156:159]
  v_add_f32 v36, v36, v25
  v_fmac_f32 v37, v25, v25
  v_mfma_f32_16x16x32_bf16 v[160:163], a[52:55], a[0:3], v[160:163]
  v_add_f32 v36, v36, v26
  v_fmac_f32 v37, v26, v26
  v_mfma_f32_16x16x32_bf16 v[164:167], a[56:59], a[0:3], v[164:167]
  v_cvt_pk_bf16_f32 v32, v24, v25
  v_cvt_pk_bf16_f32 v33, v26, v27
  v_mfma_f32_16x16x32_bf16 v[28:31], a[176:179], a[156:159], 0
  s_waitcnt lgkmcnt(12)
  v_add_f32 v36, v36, v27
  v_fmac_f32 v37, v27, v27
  v_smfmac_f32_16x16x64_bf16 v[28:31], a[180:183], a[160:167], v15
  ds_read_b128 a[156:159], v12 offset:27584
  v_smfmac_f32_16x16x64_bf16 v[28:31], a[184:187], a[168:175], v15
  ds_read_b128 a[160:163], v12 offset:28320
  v_mfma_f32_16x16x32_bf16 v[168:171], a[36:39], a[16:19], v[168:171]
  buffer_load_dwordx4 a[240:243], v3, s[8:11], s26 offen offset:1024
  v_mfma_f32_16x16x32_bf16 v[172:175], a[40:43], a[16:19], v[172:175]
  ds_read_b128 a[164:167], v12 offset:28352
  v_add_f32 v38, v38, v28
  v_mfma_f32_16x16x32_bf16 v[176:179], a[44:47], a[16:19], v[176:179]
  v_fmac_f32 v39, v28, v28
  v_add_f32 v38, v38, v29
  v_mfma_f32_16x16x32_bf16 v[180:183], a[48:51], a[16:19], v[180:183]
  v_fmac_f32 v39, v29, v29
  v_add_f32 v38, v38, v30
  v_mfma_f32_16x16x32_bf16 v[184:187], a[52:55], a[16:19], v[184:187]
  v_fmac_f32 v39, v30, v30
  v_cvt_pk_bf16_f32 v34, v28, v29
  v_mfma_f32_16x16x32_bf16 v[188:191], a[56:59], a[16:19], v[188:191]
  v_cvt_pk_bf16_f32 v35, v30, v31
  v_add_f32 v38, v38, v31
  v_mfma_f32_16x16x32_bf16 v[24:27], a[176:179], a[116:119], 0
  s_waitcnt lgkmcnt(9)
  v_fmac_f32 v39, v31, v31
  ds_read_b128 a[168:171], v12 offset:29056
  v_smfmac_f32_16x16x64_bf16 v[24:27], a[180:183], a[120:127], v15
  ds_read_b128 a[172:175], v22 offset:27648
  v_smfmac_f32_16x16x64_bf16 v[24:27], a[184:187], a[128:135], v15
  ds_read_b128 a[0:3], v2 offset:384
  v_mfma_f32_16x16x32_bf16 v[192:195], a[36:39], a[20:23], v[192:195]
  buffer_load_dwordx4 a[244:247], v3, s[8:11], s26 offen offset:2048
  v_mfma_f32_16x16x32_bf16 v[196:199], a[40:43], a[20:23], v[196:199]
  v_add_f32 v40, v40, v24
  v_fmac_f32 v41, v24, v24
  v_mfma_f32_16x16x32_bf16 v[200:203], a[44:47], a[20:23], v[200:203]
  v_add_f32 v40, v40, v25
  v_fmac_f32 v41, v25, v25
  v_mfma_f32_16x16x32_bf16 v[204:207], a[48:51], a[20:23], v[204:207]
  ds_write_b64 v13, v[32:33] offset:512
  v_mfma_f32_16x16x32_bf16 v[208:211], a[52:55], a[20:23], v[208:211]
  v_add_f32 v40, v40, v26
  v_fmac_f32 v41, v26, v26
  v_mfma_f32_16x16x32_bf16 v[212:215], a[56:59], a[20:23], v[212:215]
  s_waitcnt lgkmcnt(7)
  v_cvt_pk_bf16_f32 v32, v24, v25
  v_cvt_pk_bf16_f32 v33, v26, v27
  v_mfma_f32_16x16x32_bf16 v[28:31], a[176:179], a[136:139], 0
  v_add_f32 v40, v40, v27
  v_fmac_f32 v41, v27, v27
  v_smfmac_f32_16x16x64_bf16 v[28:31], a[180:183], a[140:147], v15
  ds_read_b128 a[16:19], v0 offset:448
  v_smfmac_f32_16x16x64_bf16 v[28:31], a[184:187], a[148:155], v15
  ds_read_b128 a[20:23], v0 offset:13248
  v_mfma_f32_16x16x32_bf16 v[216:219], a[36:39], a[24:27], v[216:219]
  buffer_load_dwordx4 a[248:251], v3, s[8:11], s26 offen offset:3072
  v_mfma_f32_16x16x32_bf16 v[220:223], a[40:43], a[24:27], v[220:223]
  ds_write_b64 v13, v[34:35] offset:13312
  v_mfma_f32_16x16x32_bf16 v[224:227], a[44:47], a[24:27], v[224:227]
  v_cvt_pk_bf16_f32 v34, v28, v29
  ds_write_b64 v13, v[32:33] offset:26112
  v_mfma_f32_16x16x32_bf16 v[228:231], a[48:51], a[24:27], v[228:231]
  v_cvt_pk_bf16_f32 v35, v30, v31
  v_add_u32 v23, v8, v16
  v_mfma_f32_16x16x32_bf16 v[232:235], a[52:55], a[24:27], v[232:235]
  ds_write_b64 v13, v[34:35] offset:38912
  v_mfma_f32_16x16x32_bf16 v[236:239], a[56:59], a[24:27], v[236:239]
  s_waitcnt lgkmcnt(9)
  v_add_u32 v22, v9, v16
  v_add_f32 v42, v42, v28
  v_mfma_f32_16x16x32_bf16 v[24:27], a[176:179], a[156:159], 0
  ds_read_b128 a[24:27], v0 offset:26048
  v_fmac_f32 v43, v28, v28
  v_smfmac_f32_16x16x64_bf16 v[24:27], a[180:183], a[160:167], v15
  s_waitcnt lgkmcnt(8)
  v_add_f32 v42, v42, v29
  v_smfmac_f32_16x16x64_bf16 v[24:27], a[184:187], a[168:175], v15
  v_fmac_f32 v43, v29, v29
  v_mfma_f32_16x16x32_bf16 v[240:243], a[36:39], a[28:31], v[240:243]
  buffer_load_dwordx4 a[252:255], v3, s[8:11], s27 offen offset:0
  v_mfma_f32_16x16x32_bf16 v[244:247], a[40:43], a[28:31], v[244:247]
  buffer_load_dwordx4 a[184:187], v3, s[8:11], s35 offen offset:2048
  v_mfma_f32_16x16x32_bf16 v[248:251], a[44:47], a[28:31], v[248:251]
  buffer_load_dwordx4 a[176:179], v3, s[8:11], s35 offen offset:0
  v_mfma_f32_16x16x32_bf16 v[252:255], a[48:51], a[28:31], v[252:255]
  v_accvgpr_read_b32 v5, a4
  v_cvt_pk_bf16_f32 v32, v24, v25
  v_mfma_f32_16x16x32_bf16 a[84:87], a[52:55], a[28:31], a[84:87]
  v_cvt_pk_bf16_f32 v33, v26, v27
  ds_write_b64 v14, v[32:33] offset:512
  v_mfma_f32_16x16x32_bf16 a[88:91], a[56:59], a[28:31], a[88:91]
  s_waitcnt lgkmcnt(7)
  buffer_store_dwordx4 a[224:227], v5, s[12:15], s21 offen offset:128 nt
  v_mfma_f32_16x16x32_bf16 a[92:95], a[36:39], a[0:3], a[92:95]
  ds_read_b128 a[28:31], v0 offset:38848
  v_add_f32 v42, v42, v30
  v_mfma_f32_16x16x32_bf16 a[96:99], a[40:43], a[0:3], a[96:99]
  v_fmac_f32 v43, v30, v30
  v_add_f32 v42, v42, v31
  v_mfma_f32_16x16x32_bf16 a[100:103], a[44:47], a[0:3], a[100:103]
  s_waitcnt lgkmcnt(1)
  s_barrier
  ds_read_b128 a[116:119], v8 offset:0
  v_mfma_f32_16x16x32_bf16 a[104:107], a[48:51], a[0:3], a[104:107]
  buffer_load_dwordx4 a[200:203], v3, s[8:11], s27 offen offset:1024
  v_mfma_f32_16x16x32_bf16 a[108:111], a[52:55], a[0:3], a[108:111]
  ds_read_b128 a[120:123], v8 offset:736
  v_fmac_f32 v43, v31, v31
  v_mfma_f32_16x16x32_bf16 a[112:115], a[56:59], a[0:3], a[112:115]
  s_waitcnt vmcnt(15)
  ds_read_b128 a[124:127], v8 offset:768
  v_add_f32 v44, v44, v24
  v_mfma_f32_16x16x32_bf16 v[48:51], a[60:63], a[16:19], v[48:51]
  ds_read_b128 a[128:131], v8 offset:1472
  v_fmac_f32 v45, v24, v24
  v_mfma_f32_16x16x32_bf16 v[52:55], a[64:67], a[16:19], v[52:55]
  buffer_load_dwordx4 v17, s[4:7], s33 offen offset:0 lds
  s_add_u32 m0, s61, 34176
  v_mfma_f32_16x16x32_bf16 v[56:59], a[68:71], a[16:19], v[56:59]
  ds_read_b128 a[132:135], v23 offset:64
  v_add_u32 v23, v10, v16
  v_mfma_f32_16x16x32_bf16 v[60:63], a[72:75], a[16:19], v[60:63]
  ds_read_b128 a[0:3], v0 offset:51648
  v_add_f32 v44, v44, v25
  v_mfma_f32_16x16x32_bf16 v[64:67], a[76:79], a[16:19], v[64:67]
  s_waitcnt vmcnt(14)
  ds_read_b128 a[136:139], v9 offset:0
  v_fmac_f32 v45, v25, v25
  v_mfma_f32_16x16x32_bf16 v[68:71], a[80:83], a[16:19], v[68:71]
  buffer_load_dwordx4 v17, s[4:7], s33 offen offset:32 lds
  s_add_u32 m0, s62, 27584
  v_mfma_f32_16x16x32_bf16 v[72:75], a[60:63], a[20:23], v[72:75]
  ds_read_b128 a[140:143], v9 offset:736
  v_add_f32 v44, v44, v26
  v_mfma_f32_16x16x32_bf16 v[76:79], a[64:67], a[20:23], v[76:79]
  ds_read_b128 a[144:147], v9 offset:768
  v_fmac_f32 v45, v26, v26
  v_mfma_f32_16x16x32_bf16 v[80:83], a[68:71], a[20:23], v[80:83]
  ds_read_b128 a[148:151], v9 offset:1472
  v_add_f32 v44, v44, v27
  v_mfma_f32_16x16x32_bf16 v[84:87], a[72:75], a[20:23], v[84:87]
  buffer_load_dwordx4 v18, s[4:7], s33 offen offset:0 lds
  s_add_u32 m0, s62, 34176
  s_addk_i32 s26, 6144
  v_mfma_f32_16x16x32_bf16 v[88:91], a[76:79], a[20:23], v[88:91]
  s_addk_i32 s27, 6144
  v_fmac_f32 v45, v27, v27
  ds_read_b128 a[152:155], v22 offset:64
  v_mfma_f32_16x16x32_bf16 v[92:95], a[80:83], a[20:23], v[92:95]
  s_add_u32 s36, s24, 67584
  v_add_u32 v22, v11, v16
  ds_read_b128 a[16:19], v1 offset:448
  v_mfma_f32_16x16x32_bf16 v[96:99], a[60:63], a[24:27], v[96:99]
  ds_read_b128 a[156:159], v10 offset:0
  v_mfma_f32_16x16x32_bf16 v[100:103], a[64:67], a[24:27], v[100:103]
  buffer_load_dwordx4 v18, s[4:7], s33 offen offset:32 lds
  s_mov_b32 m0, s68
  s_mov_b32 s33, 128
  v_mfma_f32_16x16x32_bf16 v[104:107], a[68:71], a[24:27], v[104:107]
  ds_read_b128 a[160:163], v10 offset:736
  v_mfma_f32_16x16x32_bf16 v[108:111], a[72:75], a[24:27], v[108:111]
  ds_read_b128 a[164:167], v10 offset:768
  v_mfma_f32_16x16x32_bf16 v[112:115], a[76:79], a[24:27], v[112:115]
  ds_read_b128 a[168:171], v10 offset:1472
  v_mfma_f32_16x16x32_bf16 v[116:119], a[80:83], a[24:27], v[116:119]
  s_waitcnt lgkmcnt(14)
  buffer_load_dwordx4 a[180:183], v3, s[8:11], s35 offen offset:1024
  v_mfma_f32_16x16x32_bf16 v[120:123], a[60:63], a[28:31], v[120:123]
  ds_read_b128 a[172:175], v23 offset:64
  v_add_u32 v23, v12, v16
  v_mfma_f32_16x16x32_bf16 v[124:127], a[64:67], a[28:31], v[124:127]
  ds_read_b128 a[20:23], v1 offset:13248
  v_mfma_f32_16x16x32_bf16 v[128:131], a[68:71], a[28:31], v[128:131]
  ds_read_b128 a[24:27], v1 offset:26048
  v_mfma_f32_16x16x32_bf16 v[132:135], a[72:75], a[28:31], v[132:135]
  buffer_load_dwordx4 a[36:39], v3, s[8:11], s26 offen offset:0
  v_mfma_f32_16x16x32_bf16 v[136:139], a[76:79], a[28:31], v[136:139]
  v_mfma_f32_16x16x32_bf16 v[140:143], a[80:83], a[28:31], v[140:143]
  v_mfma_f32_16x16x32_bf16 v[28:31], a[188:191], a[116:119], 0
  s_waitcnt vmcnt(14) lgkmcnt(12)
  ds_read_b128 a[28:31], v1 offset:38848
  v_smfmac_f32_16x16x64_bf16 v[28:31], a[192:195], a[120:127], v15
  ds_read_b128 a[116:119], v11 offset:0
  v_smfmac_f32_16x16x64_bf16 v[28:31], a[196:199], a[128:135], v15
  ds_read_b128 a[120:123], v11 offset:736
  v_mfma_f32_16x16x32_bf16 v[144:147], a[60:63], a[0:3], v[144:147]
  ds_read_b128 a[124:127], v11 offset:768
  v_mfma_f32_16x16x32_bf16 v[148:151], a[64:67], a[0:3], v[148:151]
  ds_read_b128 a[128:131], v11 offset:1472
  v_add_f32 v36, v36, v28
  v_mfma_f32_16x16x32_bf16 v[152:155], a[68:71], a[0:3], v[152:155]
  v_fmac_f32 v37, v28, v28
  ds_read_b128 a[132:135], v22 offset:64
  v_mfma_f32_16x16x32_bf16 v[156:159], a[72:75], a[0:3], v[156:159]
  v_add_f32 v36, v36, v29
  v_fmac_f32 v37, v29, v29
  v_mfma_f32_16x16x32_bf16 v[160:163], a[76:79], a[0:3], v[160:163]
  v_add_f32 v36, v36, v30
  v_fmac_f32 v37, v30, v30
  v_mfma_f32_16x16x32_bf16 v[164:167], a[80:83], a[0:3], v[164:167]
  v_cvt_pk_bf16_f32 v34, v28, v29
  v_cvt_pk_bf16_f32 v35, v30, v31
  v_mfma_f32_16x16x32_bf16 v[24:27], a[188:191], a[136:139], 0
  s_waitcnt lgkmcnt(12)
  v_add_f32 v36, v36, v31
  v_fmac_f32 v37, v31, v31
  v_smfmac_f32_16x16x64_bf16 v[24:27], a[192:195], a[140:147], v15
  ds_read_b128 a[136:139], v12 offset:0
  v_smfmac_f32_16x16x64_bf16 v[24:27], a[196:199], a[148:155], v15
  ds_read_b128 a[140:143], v12 offset:736
  v_mfma_f32_16x16x32_bf16 v[168:171], a[60:63], a[16:19], v[168:171]
  buffer_load_dwordx4 a[40:43], v3, s[8:11], s26 offen offset:1024
  v_mfma_f32_16x16x32_bf16 v[172:175], a[64:67], a[16:19], v[172:175]
  ds_read_b128 a[144:147], v12 offset:768
  v_add_f32 v38, v38, v24
  v_mfma_f32_16x16x32_bf16 v[176:179], a[68:71], a[16:19], v[176:179]
  v_fmac_f32 v39, v24, v24
  v_add_f32 v38, v38, v25
  v_mfma_f32_16x16x32_bf16 v[180:183], a[72:75], a[16:19], v[180:183]
  v_fmac_f32 v39, v25, v25
  v_add_f32 v38, v38, v26
  v_mfma_f32_16x16x32_bf16 v[184:187], a[76:79], a[16:19], v[184:187]
  v_fmac_f32 v39, v26, v26
  v_cvt_pk_bf16_f32 v32, v24, v25
  v_mfma_f32_16x16x32_bf16 v[188:191], a[80:83], a[16:19], v[188:191]
  v_cvt_pk_bf16_f32 v33, v26, v27
  v_add_f32 v38, v38, v27
  v_mfma_f32_16x16x32_bf16 v[28:31], a[188:191], a[156:159], 0
  s_waitcnt lgkmcnt(9)
  v_fmac_f32 v39, v27, v27
  ds_read_b128 a[148:151], v12 offset:1472
  v_smfmac_f32_16x16x64_bf16 v[28:31], a[192:195], a[160:167], v15
  ds_read_b128 a[152:155], v23 offset:64
  v_smfmac_f32_16x16x64_bf16 v[28:31], a[196:199], a[168:175], v15
  ds_read_b128 a[0:3], v2 offset:448
  v_mfma_f32_16x16x32_bf16 v[192:195], a[60:63], a[20:23], v[192:195]
  buffer_load_dwordx4 a[44:47], v3, s[8:11], s26 offen offset:2048
  v_mfma_f32_16x16x32_bf16 v[196:199], a[64:67], a[20:23], v[196:199]
  v_add_f32 v40, v40, v28
  v_fmac_f32 v41, v28, v28
  v_mfma_f32_16x16x32_bf16 v[200:203], a[68:71], a[20:23], v[200:203]
  v_add_f32 v40, v40, v29
  v_fmac_f32 v41, v29, v29
  v_mfma_f32_16x16x32_bf16 v[204:207], a[72:75], a[20:23], v[204:207]
  ds_write_b64 v13, v[34:35] offset:576
  v_mfma_f32_16x16x32_bf16 v[208:211], a[76:79], a[20:23], v[208:211]
  v_add_f32 v40, v40, v30
  v_fmac_f32 v41, v30, v30
  v_mfma_f32_16x16x32_bf16 v[212:215], a[80:83], a[20:23], v[212:215]
  s_waitcnt lgkmcnt(7)
  v_cvt_pk_bf16_f32 v34, v28, v29
  v_cvt_pk_bf16_f32 v35, v30, v31
  v_mfma_f32_16x16x32_bf16 v[24:27], a[188:191], a[116:119], 0
  v_add_f32 v40, v40, v31
  v_fmac_f32 v41, v31, v31
  v_smfmac_f32_16x16x64_bf16 v[24:27], a[192:195], a[120:127], v15
  ds_read_b128 a[16:19], v0 offset:512
  v_smfmac_f32_16x16x64_bf16 v[24:27], a[196:199], a[128:135], v15
  ds_read_b128 a[20:23], v0 offset:13312
  v_mfma_f32_16x16x32_bf16 v[216:219], a[60:63], a[24:27], v[216:219]
  buffer_load_dwordx4 a[48:51], v3, s[8:11], s26 offen offset:3072
  s_addk_i32 s26, 6144
  v_mfma_f32_16x16x32_bf16 v[220:223], a[64:67], a[24:27], v[220:223]
  ds_write_b64 v13, v[32:33] offset:13376
  v_mfma_f32_16x16x32_bf16 v[224:227], a[68:71], a[24:27], v[224:227]
  v_cvt_pk_bf16_f32 v32, v24, v25
  ds_write_b64 v13, v[34:35] offset:26176
  v_mfma_f32_16x16x32_bf16 v[228:231], a[72:75], a[24:27], v[228:231]
  v_cvt_pk_bf16_f32 v33, v26, v27
  v_add_u32 v22, v8, v16
  v_mfma_f32_16x16x32_bf16 v[232:235], a[76:79], a[24:27], v[232:235]
  ds_write_b64 v13, v[32:33] offset:38976
  v_mfma_f32_16x16x32_bf16 v[236:239], a[80:83], a[24:27], v[236:239]
  s_waitcnt lgkmcnt(9)
  v_add_u32 v23, v9, v16
  v_add_f32 v42, v42, v24
  v_mfma_f32_16x16x32_bf16 v[28:31], a[188:191], a[136:139], 0
  ds_read_b128 a[24:27], v0 offset:26112
  v_fmac_f32 v43, v24, v24
  v_smfmac_f32_16x16x64_bf16 v[28:31], a[192:195], a[140:147], v15
  s_waitcnt lgkmcnt(8)
  v_add_f32 v42, v42, v25
  v_smfmac_f32_16x16x64_bf16 v[28:31], a[196:199], a[148:155], v15
  v_fmac_f32 v43, v25, v25
  v_mfma_f32_16x16x32_bf16 v[240:243], a[60:63], a[28:31], v[240:243]
  buffer_load_dwordx4 a[52:55], v3, s[8:11], s27 offen offset:0
  v_mfma_f32_16x16x32_bf16 v[244:247], a[64:67], a[28:31], v[244:247]
  buffer_load_dwordx4 a[188:191], v3, s[8:11], s36 offen offset:0
  v_mfma_f32_16x16x32_bf16 v[248:251], a[68:71], a[28:31], v[248:251]
  buffer_load_dwordx4 a[192:195], v3, s[8:11], s36 offen offset:1024
  v_mfma_f32_16x16x32_bf16 v[252:255], a[72:75], a[28:31], v[252:255]
  v_accvgpr_read_b32 v6, a5
  v_cvt_pk_bf16_f32 v34, v28, v29
  v_mfma_f32_16x16x32_bf16 a[84:87], a[76:79], a[28:31], a[84:87]
  v_cvt_pk_bf16_f32 v35, v30, v31
  ds_write_b64 v14, v[34:35] offset:576
  v_mfma_f32_16x16x32_bf16 a[88:91], a[80:83], a[28:31], a[88:91]
  s_waitcnt lgkmcnt(7)
  buffer_store_dwordx4 a[228:231], v6, s[12:15], s21 offen offset:128 nt
  v_mfma_f32_16x16x32_bf16 a[92:95], a[60:63], a[0:3], a[92:95]
  ds_read_b128 a[28:31], v0 offset:38912
  v_add_f32 v42, v42, v26
  v_mfma_f32_16x16x32_bf16 a[96:99], a[64:67], a[0:3], a[96:99]
  v_fmac_f32 v43, v26, v26
  v_add_f32 v42, v42, v27
  v_mfma_f32_16x16x32_bf16 a[100:103], a[68:71], a[0:3], a[100:103]
  s_waitcnt lgkmcnt(1)
  s_barrier
  ds_read_b128 a[156:159], v8 offset:13792
  v_mfma_f32_16x16x32_bf16 a[104:107], a[72:75], a[0:3], a[104:107]
  buffer_load_dwordx4 a[56:59], v3, s[8:11], s27 offen offset:1024
  s_addk_i32 s27, 6144
  v_mfma_f32_16x16x32_bf16 a[108:111], a[76:79], a[0:3], a[108:111]
  ds_read_b128 a[160:163], v8 offset:14528
  v_fmac_f32 v43, v27, v27
  v_mfma_f32_16x16x32_bf16 a[112:115], a[80:83], a[0:3], a[112:115]
  s_waitcnt vmcnt(15)
  ds_read_b128 a[164:167], v8 offset:14560
  v_add_f32 v44, v44, v28
  v_mfma_f32_16x16x32_bf16 v[48:51], a[32:35], a[16:19], v[48:51]
  ds_read_b128 a[168:171], v8 offset:15264
  v_fmac_f32 v45, v28, v28
  v_mfma_f32_16x16x32_bf16 v[52:55], a[240:243], a[16:19], v[52:55]
  buffer_load_dwordx4 a[196:199], v3, s[8:11], s36 offen offset:2048
  v_mfma_f32_16x16x32_bf16 v[56:59], a[244:247], a[16:19], v[56:59]
  ds_read_b128 a[172:175], v22 offset:13856
  v_add_u32 v22, v10, v16
  v_mfma_f32_16x16x32_bf16 v[60:63], a[248:251], a[16:19], v[60:63]
  ds_read_b128 a[0:3], v0 offset:51712
  v_add_f32 v44, v44, v29
  v_mfma_f32_16x16x32_bf16 v[64:67], a[252:255], a[16:19], v[64:67]
  s_waitcnt vmcnt(14)
  ds_read_b128 a[116:119], v9 offset:13792
  v_fmac_f32 v45, v29, v29
  v_mfma_f32_16x16x32_bf16 v[68:71], a[200:203], a[16:19], v[68:71]
  ds_read_b128 a[120:123], v9 offset:14528
  v_add_f32 v44, v44, v30
  v_mfma_f32_16x16x32_bf16 v[72:75], a[32:35], a[20:23], v[72:75]
  ds_read_b128 a[124:127], v9 offset:14560
  v_fmac_f32 v45, v30, v30
  v_mfma_f32_16x16x32_bf16 v[76:79], a[240:243], a[20:23], v[76:79]
  ds_read_b128 a[128:131], v9 offset:15264
  v_add_f32 v44, v44, v31
  v_mfma_f32_16x16x32_bf16 v[80:83], a[244:247], a[20:23], v[80:83]
  ds_read_b128 a[132:135], v23 offset:13856
  v_fmac_f32 v45, v31, v31
  v_mfma_f32_16x16x32_bf16 v[84:87], a[248:251], a[20:23], v[84:87]
  ds_read_b128 a[16:19], v1 offset:512
  v_add_u32 v23, v11, v16
  v_mfma_f32_16x16x32_bf16 v[88:91], a[252:255], a[20:23], v[88:91]
  ds_read_b128 a[136:139], v10 offset:13792
  v_mfma_f32_16x16x32_bf16 v[92:95], a[200:203], a[20:23], v[92:95]
  ds_read_b128 a[140:143], v10 offset:14528
  v_mfma_f32_16x16x32_bf16 v[96:99], a[32:35], a[24:27], v[96:99]
  ds_read_b128 a[144:147], v10 offset:14560
  v_mfma_f32_16x16x32_bf16 v[100:103], a[240:243], a[24:27], v[100:103]
  ds_read_b128 a[148:151], v10 offset:15264
  v_mfma_f32_16x16x32_bf16 v[104:107], a[244:247], a[24:27], v[104:107]
  ds_read_b128 a[152:155], v22 offset:13856
  v_add_u32 v22, v12, v16
  v_mfma_f32_16x16x32_bf16 v[108:111], a[248:251], a[24:27], v[108:111]
  ds_read_b128 a[20:23], v1 offset:13312
  v_mfma_f32_16x16x32_bf16 v[112:115], a[252:255], a[24:27], v[112:115]
  v_mfma_f32_16x16x32_bf16 v[116:119], a[200:203], a[24:27], v[116:119]
  s_waitcnt lgkmcnt(15)
  v_mfma_f32_16x16x32_bf16 v[120:123], a[32:35], a[28:31], v[120:123]
  buffer_load_dwordx4 a[60:63], v3, s[8:11], s26 offen offset:0
  v_mfma_f32_16x16x32_bf16 v[124:127], a[240:243], a[28:31], v[124:127]
  ds_read_b128 a[24:27], v1 offset:26112
  v_mfma_f32_16x16x32_bf16 v[128:131], a[244:247], a[28:31], v[128:131]
  v_mfma_f32_16x16x32_bf16 v[132:135], a[248:251], a[28:31], v[132:135]
  v_mfma_f32_16x16x32_bf16 v[136:139], a[252:255], a[28:31], v[136:139]
  v_mfma_f32_16x16x32_bf16 v[140:143], a[200:203], a[28:31], v[140:143]
  v_mfma_f32_16x16x32_bf16 v[24:27], a[176:179], a[156:159], 0
  s_waitcnt vmcnt(10)
  ds_read_b128 a[28:31], v1 offset:38912
  v_smfmac_f32_16x16x64_bf16 v[24:27], a[180:183], a[160:167], v15
  s_waitcnt lgkmcnt(12)
  ds_read_b128 a[156:159], v11 offset:13792
  v_smfmac_f32_16x16x64_bf16 v[24:27], a[184:187], a[168:175], v15
  ds_read_b128 a[160:163], v11 offset:14528
  v_mfma_f32_16x16x32_bf16 v[144:147], a[32:35], a[0:3], v[144:147]
  ds_read_b128 a[164:167], v11 offset:14560
  v_mfma_f32_16x16x32_bf16 v[148:151], a[240:243], a[0:3], v[148:151]
  ds_read_b128 a[168:171], v11 offset:15264
  v_add_f32 v36, v36, v24
  v_mfma_f32_16x16x32_bf16 v[152:155], a[244:247], a[0:3], v[152:155]
  v_fmac_f32 v37, v24, v24
  ds_read_b128 a[172:175], v23 offset:13856
  v_mfma_f32_16x16x32_bf16 v[156:159], a[248:251], a[0:3], v[156:159]
  v_add_f32 v36, v36, v25
  v_fmac_f32 v37, v25, v25
  v_mfma_f32_16x16x32_bf16 v[160:163], a[252:255], a[0:3], v[160:163]
  v_add_f32 v36, v36, v26
  v_fmac_f32 v37, v26, v26
  v_mfma_f32_16x16x32_bf16 v[164:167], a[200:203], a[0:3], v[164:167]
  v_cvt_pk_bf16_f32 v32, v24, v25
  v_cvt_pk_bf16_f32 v33, v26, v27
  v_mfma_f32_16x16x32_bf16 v[28:31], a[176:179], a[116:119], 0
  s_waitcnt lgkmcnt(9)
  v_add_f32 v36, v36, v27
  v_fmac_f32 v37, v27, v27
  v_smfmac_f32_16x16x64_bf16 v[28:31], a[180:183], a[120:127], v15
  ds_read_b128 a[116:119], v12 offset:13792
  v_smfmac_f32_16x16x64_bf16 v[28:31], a[184:187], a[128:135], v15
  ds_read_b128 a[120:123], v12 offset:14528
  v_mfma_f32_16x16x32_bf16 v[168:171], a[32:35], a[16:19], v[168:171]
  buffer_load_dwordx4 a[64:67], v3, s[8:11], s26 offen offset:1024
  v_mfma_f32_16x16x32_bf16 v[172:175], a[240:243], a[16:19], v[172:175]
  ds_read_b128 a[124:127], v12 offset:14560
  v_add_f32 v38, v38, v28
  v_mfma_f32_16x16x32_bf16 v[176:179], a[244:247], a[16:19], v[176:179]
  v_fmac_f32 v39, v28, v28
  v_add_f32 v38, v38, v29
  v_mfma_f32_16x16x32_bf16 v[180:183], a[248:251], a[16:19], v[180:183]
  v_fmac_f32 v39, v29, v29
  v_add_f32 v38, v38, v30
  v_mfma_f32_16x16x32_bf16 v[184:187], a[252:255], a[16:19], v[184:187]
  v_fmac_f32 v39, v30, v30
  v_cvt_pk_bf16_f32 v34, v28, v29
  v_mfma_f32_16x16x32_bf16 v[188:191], a[200:203], a[16:19], v[188:191]
  v_cvt_pk_bf16_f32 v35, v30, v31
  v_add_f32 v38, v38, v31
  v_mfma_f32_16x16x32_bf16 v[24:27], a[176:179], a[136:139], 0
  v_fmac_f32 v39, v31, v31
  ds_read_b128 a[128:131], v12 offset:15264
  v_smfmac_f32_16x16x64_bf16 v[24:27], a[180:183], a[140:147], v15
  s_waitcnt lgkmcnt(10)
  ds_read_b128 a[132:135], v22 offset:13856
  v_smfmac_f32_16x16x64_bf16 v[24:27], a[184:187], a[148:155], v15
  ds_read_b128 a[0:3], v2 offset:512
  v_mfma_f32_16x16x32_bf16 v[192:195], a[32:35], a[20:23], v[192:195]
  buffer_load_dwordx4 a[68:71], v3, s[8:11], s26 offen offset:2048
  v_mfma_f32_16x16x32_bf16 v[196:199], a[240:243], a[20:23], v[196:199]
  v_add_f32 v40, v40, v24
  v_fmac_f32 v41, v24, v24
  v_mfma_f32_16x16x32_bf16 v[200:203], a[244:247], a[20:23], v[200:203]
  v_add_f32 v40, v40, v25
  v_fmac_f32 v41, v25, v25
  v_mfma_f32_16x16x32_bf16 v[204:207], a[248:251], a[20:23], v[204:207]
  ds_write_b64 v13, v[32:33] offset:640
  v_mfma_f32_16x16x32_bf16 v[208:211], a[252:255], a[20:23], v[208:211]
  v_add_f32 v40, v40, v26
  v_fmac_f32 v41, v26, v26
  v_mfma_f32_16x16x32_bf16 v[212:215], a[200:203], a[20:23], v[212:215]
  s_waitcnt lgkmcnt(7)
  v_cvt_pk_bf16_f32 v32, v24, v25
  v_cvt_pk_bf16_f32 v33, v26, v27
  v_mfma_f32_16x16x32_bf16 v[28:31], a[176:179], a[156:159], 0
  v_add_f32 v40, v40, v27
  v_fmac_f32 v41, v27, v27
  v_smfmac_f32_16x16x64_bf16 v[28:31], a[180:183], a[160:167], v15
  ds_read_b128 a[16:19], v0 offset:576
  v_smfmac_f32_16x16x64_bf16 v[28:31], a[184:187], a[168:175], v15
  ds_read_b128 a[20:23], v0 offset:13376
  v_mfma_f32_16x16x32_bf16 v[216:219], a[32:35], a[24:27], v[216:219]
  buffer_load_dwordx4 a[72:75], v3, s[8:11], s26 offen offset:3072
  s_addk_i32 s26, 6144
  v_mfma_f32_16x16x32_bf16 v[220:223], a[240:243], a[24:27], v[220:223]
  ds_write_b64 v13, v[34:35] offset:13440
  v_mfma_f32_16x16x32_bf16 v[224:227], a[244:247], a[24:27], v[224:227]
  v_cvt_pk_bf16_f32 v34, v28, v29
  ds_write_b64 v13, v[32:33] offset:26240
  v_mfma_f32_16x16x32_bf16 v[228:231], a[248:251], a[24:27], v[228:231]
  v_cvt_pk_bf16_f32 v35, v30, v31
  v_add_u32 v23, v8, v16
  v_mfma_f32_16x16x32_bf16 v[232:235], a[252:255], a[24:27], v[232:235]
  ds_write_b64 v13, v[34:35] offset:39040
  v_mfma_f32_16x16x32_bf16 v[236:239], a[200:203], a[24:27], v[236:239]
  s_waitcnt lgkmcnt(9)
  v_add_u32 v22, v9, v16
  v_add_f32 v42, v42, v28
  v_mfma_f32_16x16x32_bf16 v[24:27], a[176:179], a[116:119], 0
  ds_read_b128 a[24:27], v0 offset:26176
  v_fmac_f32 v43, v28, v28
  v_smfmac_f32_16x16x64_bf16 v[24:27], a[180:183], a[120:127], v15
  s_waitcnt lgkmcnt(8)
  v_add_f32 v42, v42, v29
  v_smfmac_f32_16x16x64_bf16 v[24:27], a[184:187], a[128:135], v15
  v_fmac_f32 v43, v29, v29
  v_mfma_f32_16x16x32_bf16 v[240:243], a[32:35], a[28:31], v[240:243]
  buffer_load_dwordx4 a[76:79], v3, s[8:11], s27 offen offset:0
  v_mfma_f32_16x16x32_bf16 v[244:247], a[240:243], a[28:31], v[244:247]
  v_accvgpr_read_b32 v5, a6
  v_cvt_pk_bf16_f32 v32, v24, v25
  v_mfma_f32_16x16x32_bf16 v[248:251], a[244:247], a[28:31], v[248:251]
  buffer_store_dwordx4 a[232:235], v5, s[12:15], s21 offen offset:128 nt
  s_mov_b32 s21, s60
  v_mfma_f32_16x16x32_bf16 v[252:255], a[248:251], a[28:31], v[252:255]
  v_cvt_pk_bf16_f32 v33, v26, v27
  ds_write_b64 v14, v[32:33] offset:640
  v_mfma_f32_16x16x32_bf16 a[84:87], a[252:255], a[28:31], a[84:87]
  v_add_f32 v42, v42, v30
  v_fmac_f32 v43, v30, v30
  v_mfma_f32_16x16x32_bf16 a[88:91], a[200:203], a[28:31], a[88:91]
  s_waitcnt lgkmcnt(7)
  v_add_f32 v42, v42, v31
  v_fmac_f32 v43, v31, v31
  v_mfma_f32_16x16x32_bf16 a[92:95], a[32:35], a[0:3], a[92:95]
  buffer_load_dwordx4 a[80:83], v3, s[8:11], s27 offen offset:1024
  s_addk_i32 s27, 6144
  v_mfma_f32_16x16x32_bf16 a[96:99], a[240:243], a[0:3], a[96:99]
  ds_read_b128 a[28:31], v0 offset:38976
  v_add_f32 v44, v44, v24
  v_mfma_f32_16x16x32_bf16 a[100:103], a[244:247], a[0:3], a[100:103]
  s_waitcnt lgkmcnt(1)
  s_barrier
  ds_read_b128 a[136:139], v8 offset:27584
  v_fmac_f32 v45, v24, v24
  v_mfma_f32_16x16x32_bf16 a[104:107], a[248:251], a[0:3], a[104:107]
  ds_read_b128 a[140:143], v8 offset:28320
  v_add_f32 v44, v44, v25
  v_mfma_f32_16x16x32_bf16 a[108:111], a[252:255], a[0:3], a[108:111]
  ds_read_b128 a[144:147], v8 offset:28352
  v_fmac_f32 v45, v25, v25
  v_mfma_f32_16x16x32_bf16 a[112:115], a[200:203], a[0:3], a[112:115]
  s_waitcnt vmcnt(11)
  ds_read_b128 a[148:151], v8 offset:29056
  v_add_f32 v44, v44, v26
  v_mfma_f32_16x16x32_bf16 v[48:51], a[36:39], a[16:19], v[48:51]
  ds_read_b128 a[152:155], v23 offset:27648
  v_fmac_f32 v45, v26, v26
  v_mfma_f32_16x16x32_bf16 v[52:55], a[40:43], a[16:19], v[52:55]
  ds_read_b128 a[0:3], v0 offset:51776
  v_add_f32 v44, v44, v27
  v_mfma_f32_16x16x32_bf16 v[56:59], a[44:47], a[16:19], v[56:59]
  ds_read_b128 a[156:159], v9 offset:27584
  v_fmac_f32 v45, v27, v27
  v_mfma_f32_16x16x32_bf16 v[60:63], a[48:51], a[16:19], v[60:63]
  s_waitcnt vmcnt(8)
  ds_read_b128 a[160:163], v9 offset:28320
  v_lshlrev_b32 v8, 3, v4
  v_mfma_f32_16x16x32_bf16 v[64:67], a[52:55], a[16:19], v[64:67]
  s_waitcnt vmcnt(7)
  ds_read_b128 a[164:167], v9 offset:28352
  v_lshrrev_b32 v17, 1, v8
  v_mfma_f32_16x16x32_bf16 v[68:71], a[56:59], a[16:19], v[68:71]
  ds_read_b128 a[168:171], v9 offset:29056
  v_add_u32 v8, 159776, v8
  v_mfma_f32_16x16x32_bf16 v[72:75], a[36:39], a[20:23], v[72:75]
  ds_read_b128 a[172:175], v22 offset:27648
  v_lshlrev_b32 v9, 3, v4
  v_mfma_f32_16x16x32_bf16 v[76:79], a[40:43], a[20:23], v[76:79]
  ds_read_b128 a[16:19], v1 offset:576
  v_add_u32 v9, 512, v9
  v_mfma_f32_16x16x32_bf16 v[80:83], a[44:47], a[20:23], v[80:83]
  ds_read_b128 a[116:119], v10 offset:27584
  v_add_u32 v17, 162336, v17
  v_mfma_f32_16x16x32_bf16 v[84:87], a[48:51], a[20:23], v[84:87]
  ds_read_b128 a[120:123], v10 offset:28320
  v_lshrrev_b32 v5, 4, v4
  v_mfma_f32_16x16x32_bf16 v[88:91], a[52:55], a[20:23], v[88:91]
  ds_read_b128 a[124:127], v10 offset:28352
  v_lshlrev_b32 v5, 4, v5
  v_mfma_f32_16x16x32_bf16 v[92:95], a[56:59], a[20:23], v[92:95]
  ds_read_b128 a[128:131], v10 offset:29056
  v_add_u32 v5, 162336, v5
  v_mfma_f32_16x16x32_bf16 v[96:99], a[36:39], a[24:27], v[96:99]
  ds_read_b128 a[20:23], v1 offset:13376
  v_mfma_f32_16x16x32_bf16 v[100:103], a[40:43], a[24:27], v[100:103]
  v_mfma_f32_16x16x32_bf16 v[104:107], a[44:47], a[24:27], v[104:107]
  v_mfma_f32_16x16x32_bf16 v[108:111], a[48:51], a[24:27], v[108:111]
  v_mfma_f32_16x16x32_bf16 v[112:115], a[52:55], a[24:27], v[112:115]
  v_mfma_f32_16x16x32_bf16 v[116:119], a[56:59], a[24:27], v[116:119]
  s_waitcnt lgkmcnt(15)
  v_mfma_f32_16x16x32_bf16 v[120:123], a[36:39], a[28:31], v[120:123]
  buffer_load_dwordx4 a[32:35], v3, s[8:11], s26 offen offset:0
  v_mfma_f32_16x16x32_bf16 v[124:127], a[40:43], a[28:31], v[124:127]
  ds_read_b128 a[24:27], v1 offset:26176
  v_mfma_f32_16x16x32_bf16 v[128:131], a[44:47], a[28:31], v[128:131]
  v_mfma_f32_16x16x32_bf16 v[132:135], a[48:51], a[28:31], v[132:135]
  v_mfma_f32_16x16x32_bf16 v[136:139], a[52:55], a[28:31], v[136:139]
  v_mfma_f32_16x16x32_bf16 v[140:143], a[56:59], a[28:31], v[140:143]
  v_mfma_f32_16x16x32_bf16 v[28:31], a[188:191], a[136:139], 0
  s_waitcnt lgkmcnt(9)
  ds_read_b128 a[28:31], v1 offset:38976
  v_smfmac_f32_16x16x64_bf16 v[28:31], a[192:195], a[140:147], v15
  s_waitcnt vmcnt(7)
  ds_read_b128 a[136:139], v11 offset:27584
  v_smfmac_f32_16x16x64_bf16 v[28:31], a[196:199], a[148:155], v15
  ds_read_b128 a[140:143], v11 offset:28320
  v_mfma_f32_16x16x32_bf16 v[144:147], a[36:39], a[0:3], v[144:147]
  ds_read_b128 a[144:147], v11 offset:28352
  v_mfma_f32_16x16x32_bf16 v[148:151], a[40:43], a[0:3], v[148:151]
  ds_read_b128 a[148:151], v11 offset:29056
  v_add_f32 v36, v36, v28
  v_mfma_f32_16x16x32_bf16 v[152:155], a[44:47], a[0:3], v[152:155]
  v_add_f32 v36, v36, v29
  v_add_f32 v36, v36, v30
  v_mfma_f32_16x16x32_bf16 v[156:159], a[48:51], a[0:3], v[156:159]
  v_add_f32 v36, v36, v31
  v_mov_b32 v23, v36
  v_mfma_f32_16x16x32_bf16 v[160:163], a[52:55], a[0:3], v[160:163]
  s_nop 0
  v_permlane32_swap_b32 v36, v23
  v_mfma_f32_16x16x32_bf16 v[164:167], a[56:59], a[0:3], v[164:167]
  v_add_f32 v36, v36, v23
  v_mov_b32 v23, v36
  v_mfma_f32_16x16x32_bf16 v[24:27], a[188:191], a[156:159], 0
  v_fmac_f32 v37, v28, v28
  v_permlane16_swap_b32 v36, v23
  v_smfmac_f32_16x16x64_bf16 v[24:27], a[192:195], a[160:167], v15
  s_waitcnt lgkmcnt(6)
  v_fmac_f32 v37, v29, v29
  v_smfmac_f32_16x16x64_bf16 v[24:27], a[196:199], a[168:175], v15
  v_fmac_f32 v37, v30, v30
  v_mfma_f32_16x16x32_bf16 v[168:171], a[36:39], a[16:19], v[168:171]
  buffer_load_dwordx4 a[240:243], v3, s[8:11], s26 offen offset:1024
  v_mfma_f32_16x16x32_bf16 v[172:175], a[40:43], a[16:19], v[172:175]
  v_fmac_f32 v37, v31, v31
  v_add_f32 v36, v36, v23
  v_mfma_f32_16x16x32_bf16 v[176:179], a[44:47], a[16:19], v[176:179]
  v_mov_b32 v23, v37
  v_add_f32 v38, v38, v24
  v_mfma_f32_16x16x32_bf16 v[180:183], a[48:51], a[16:19], v[180:183]
  v_permlane32_swap_b32 v37, v23
  v_mfma_f32_16x16x32_bf16 v[184:187], a[52:55], a[16:19], v[184:187]
  v_add_f32 v37, v37, v23
  v_mov_b32 v23, v37
  v_mfma_f32_16x16x32_bf16 v[188:191], a[56:59], a[16:19], v[188:191]
  s_nop 0
  v_permlane16_swap_b32 v37, v23
  v_add_f32 v38, v38, v25
  v_add_f32 v37, v37, v23
  v_add_u32 v23, v10, v16
  ds_read_b128 a[132:135], v23 offset:27648
  v_cvt_pk_bf16_f32 v34, v28, v29
  v_cvt_pk_bf16_f32 v35, v30, v31
  v_mfma_f32_16x16x32_bf16 v[28:31], a[188:191], a[116:119], 0
  v_add_f32 v38, v38, v26
  v_add_f32 v38, v38, v27
  v_smfmac_f32_16x16x64_bf16 v[28:31], a[192:195], a[120:127], v15
  v_mov_b32 v22, v38
  v_fmac_f32 v39, v24, v24
  v_fmac_f32 v39, v25, v25
  v_permlane32_swap_b32 v38, v22
  v_fmac_f32 v39, v26, v26
  v_add_f32 v38, v38, v22
  v_mov_b32 v22, v38
  v_fmac_f32 v39, v27, v27
  ds_read_b128 a[156:159], v12 offset:27584
  v_permlane16_swap_b32 v38, v22
  ds_read_b128 a[160:163], v12 offset:28320
  v_add_f32 v38, v38, v22
  v_mov_b32 v22, v39
  ds_read_b128 a[164:167], v12 offset:28352
  v_cvt_pk_bf16_f32 v32, v24, v25
  v_permlane32_swap_b32 v39, v22
  v_cvt_pk_bf16_f32 v33, v26, v27
  v_add_f32 v39, v39, v22
  v_mov_b32 v22, v39
  ds_read_b128 a[168:171], v12 offset:29056
  s_nop 0
  v_permlane16_swap_b32 v39, v22
  ds_write_b64 v13, v[34:35] offset:704
  v_add_f32 v39, v39, v22
  v_add_u32 v22, v11, v16
  ds_read_b128 a[152:155], v22 offset:27648
  ds_read_b128 a[0:3], v2 offset:576
  s_waitcnt lgkmcnt(7)
  v_smfmac_f32_16x16x64_bf16 v[28:31], a[196:199], a[128:135], v15
  ds_read_b128 a[16:19], v0 offset:640
  v_mfma_f32_16x16x32_bf16 v[192:195], a[36:39], a[20:23], v[192:195]
  buffer_load_dwordx4 a[244:247], v3, s[8:11], s26 offen offset:2048
  v_mfma_f32_16x16x32_bf16 v[196:199], a[40:43], a[20:23], v[196:199]
  v_add_f32 v40, v40, v28
  v_add_f32 v40, v40, v29
  v_mfma_f32_16x16x32_bf16 v[200:203], a[44:47], a[20:23], v[200:203]
  v_add_f32 v40, v40, v30
  v_add_f32 v40, v40, v31
  v_mfma_f32_16x16x32_bf16 v[204:207], a[48:51], a[20:23], v[204:207]
  v_mov_b32 v23, v40
  v_fmac_f32 v41, v28, v28
  v_mfma_f32_16x16x32_bf16 v[208:211], a[52:55], a[20:23], v[208:211]
  v_permlane32_swap_b32 v40, v23
  v_mfma_f32_16x16x32_bf16 v[212:215], a[56:59], a[20:23], v[212:215]
  v_add_f32 v40, v40, v23
  v_mov_b32 v23, v40
  v_mfma_f32_16x16x32_bf16 v[24:27], a[188:191], a[136:139], 0
  s_nop 0
  v_permlane16_swap_b32 v40, v23
  v_smfmac_f32_16x16x64_bf16 v[24:27], a[192:195], a[140:147], v15
  v_fmac_f32 v41, v29, v29
  v_fmac_f32 v41, v30, v30
  v_fmac_f32 v41, v31, v31
  v_add_f32 v40, v40, v23
  v_mov_b32 v23, v41
  v_cvt_pk_bf16_f32 v34, v28, v29
  v_cvt_pk_bf16_f32 v35, v30, v31
  v_permlane32_swap_b32 v41, v23
  s_waitcnt lgkmcnt(2)
  v_smfmac_f32_16x16x64_bf16 v[24:27], a[196:199], a[148:155], v15
  v_add_f32 v41, v41, v23
  v_mfma_f32_16x16x32_bf16 v[216:219], a[36:39], a[24:27], v[216:219]
  buffer_load_dwordx4 a[248:251], v3, s[8:11], s26 offen offset:3072
  s_mov_b32 s26, 73728
  v_mfma_f32_16x16x32_bf16 v[220:223], a[40:43], a[24:27], v[220:223]
  v_mov_b32 v23, v41
  ds_read_b128 a[20:23], v0 offset:13440
  v_mfma_f32_16x16x32_bf16 v[224:227], a[44:47], a[24:27], v[224:227]
  v_permlane16_swap_b32 v41, v23
  v_mfma_f32_16x16x32_bf16 v[228:231], a[48:51], a[24:27], v[228:231]
  v_add_f32 v41, v41, v23
  v_add_u32 v23, v12, v16
  v_mfma_f32_16x16x32_bf16 v[232:235], a[52:55], a[24:27], v[232:235]
  ds_read_b128 a[172:175], v23 offset:27648
  v_add_f32 v42, v42, v24
  v_mfma_f32_16x16x32_bf16 v[236:239], a[56:59], a[24:27], v[236:239]
  v_add_f32 v42, v42, v25
  v_add_f32 v42, v42, v26
  v_mfma_f32_16x16x32_bf16 v[28:31], a[188:191], a[156:159], 0
  ds_read_b128 a[24:27], v0 offset:26240
  v_add_f32 v42, v42, v27
  v_smfmac_f32_16x16x64_bf16 v[28:31], a[192:195], a[160:167], v15
  v_mov_b32 v22, v42
  v_fmac_f32 v43, v24, v24
  v_fmac_f32 v43, v25, v25
  v_permlane32_swap_b32 v42, v22
  v_fmac_f32 v43, v26, v26
  v_add_f32 v42, v42, v22
  v_mov_b32 v22, v42
  v_fmac_f32 v43, v27, v27
  ds_write_b64 v13, v[32:33] offset:13504
  v_permlane16_swap_b32 v42, v22
  v_cvt_pk_bf16_f32 v32, v24, v25
  v_add_f32 v42, v42, v22
  v_mov_b32 v22, v43
  ds_write_b64 v13, v[34:35] offset:26304
  s_nop 0
  v_permlane32_swap_b32 v43, v22
  v_cvt_pk_bf16_f32 v33, v26, v27
  v_add_f32 v43, v43, v22
  v_mov_b32 v22, v43
  ds_write_b64 v21, v[36:37] offset:0
  s_nop 0
  v_permlane16_swap_b32 v43, v22
  v_add_f32 v43, v43, v22
  ds_write_b64 v21, v[38:39] offset:128
  s_waitcnt lgkmcnt(5)
  v_smfmac_f32_16x16x64_bf16 v[28:31], a[196:199], a[168:175], v15
  ds_write_b64 v21, v[40:41] offset:256
  v_mfma_f32_16x16x32_bf16 v[240:243], a[36:39], a[28:31], v[240:243]
  buffer_load_dwordx4 a[252:255], v3, s[8:11], s27 offen offset:0
  v_mfma_f32_16x16x32_bf16 v[244:247], a[40:43], a[28:31], v[244:247]
  v_accvgpr_read_b32 v6, a7
  v_add_f32 v44, v44, v28
  v_mfma_f32_16x16x32_bf16 v[248:251], a[44:47], a[28:31], v[248:251]
  buffer_store_dwordx4 a[236:239], v6, s[12:15], s19 offen offset:128 nt
  s_mov_b32 s19, s58
  v_mfma_f32_16x16x32_bf16 v[252:255], a[48:51], a[28:31], v[252:255]
  v_add_f32 v44, v44, v29
  v_add_f32 v44, v44, v30
  v_mfma_f32_16x16x32_bf16 a[84:87], a[52:55], a[28:31], a[84:87]
  v_add_f32 v44, v44, v31
  v_mov_b32 v23, v44
  v_mfma_f32_16x16x32_bf16 a[88:91], a[56:59], a[28:31], a[88:91]
  s_nop 0
  v_permlane32_swap_b32 v44, v23
  v_mfma_f32_16x16x32_bf16 a[92:95], a[36:39], a[0:3], a[92:95]
  buffer_load_dwordx4 a[200:203], v3, s[8:11], s27 offen offset:1024
  s_mov_b32 s27, 77824
  v_mfma_f32_16x16x32_bf16 a[96:99], a[40:43], a[0:3], a[96:99]
  buffer_load_dwordx4 a[36:39], v3, s[8:11], s26 offen offset:0
  v_mfma_f32_16x16x32_bf16 a[100:103], a[44:47], a[0:3], a[100:103]
  ds_read_b128 a[28:31], v0 offset:39040
  v_add_f32 v44, v44, v23
  v_mfma_f32_16x16x32_bf16 a[104:107], a[48:51], a[0:3], a[104:107]
  v_mov_b32 v23, v44
  v_fmac_f32 v45, v28, v28
  v_mfma_f32_16x16x32_bf16 a[108:111], a[52:55], a[0:3], a[108:111]
  buffer_load_dwordx4 a[40:43], v3, s[8:11], s26 offen offset:1024
  v_mfma_f32_16x16x32_bf16 a[112:115], a[56:59], a[0:3], a[112:115]
  s_waitcnt vmcnt(8)
  v_permlane16_swap_b32 v44, v23
  v_mfma_f32_16x16x32_bf16 v[48:51], a[60:63], a[16:19], v[48:51]
  ds_read_b128 a[0:3], v0 offset:51840
  v_fmac_f32 v45, v29, v29
  v_mfma_f32_16x16x32_bf16 v[52:55], a[64:67], a[16:19], v[52:55]
  buffer_load_dwordx4 a[44:47], v3, s[8:11], s26 offen offset:2048
  v_mfma_f32_16x16x32_bf16 v[56:59], a[68:71], a[16:19], v[56:59]
  v_fmac_f32 v45, v30, v30
  v_fmac_f32 v45, v31, v31
  v_mfma_f32_16x16x32_bf16 v[60:63], a[72:75], a[16:19], v[60:63]
  v_add_f32 v44, v44, v23
  v_mov_b32 v23, v45
  v_mfma_f32_16x16x32_bf16 v[64:67], a[76:79], a[16:19], v[64:67]
  s_nop 0
  v_permlane32_swap_b32 v45, v23
  v_mfma_f32_16x16x32_bf16 v[68:71], a[80:83], a[16:19], v[68:71]
  buffer_load_dwordx4 a[48:51], v3, s[8:11], s26 offen offset:3072
  s_addk_i32 s26, 6144
  v_mfma_f32_16x16x32_bf16 v[72:75], a[60:63], a[20:23], v[72:75]
  ds_read_b128 a[16:19], v1 offset:640
  v_add_f32 v45, v45, v23
  v_mfma_f32_16x16x32_bf16 v[76:79], a[64:67], a[20:23], v[76:79]
  v_mov_b32 v23, v45
  v_cvt_pk_bf16_f32 v34, v28, v29
  v_mfma_f32_16x16x32_bf16 v[80:83], a[68:71], a[20:23], v[80:83]
  v_permlane16_swap_b32 v45, v23
  v_mfma_f32_16x16x32_bf16 v[84:87], a[72:75], a[20:23], v[84:87]
  buffer_load_dwordx4 a[52:55], v3, s[8:11], s27 offen offset:0
  v_mfma_f32_16x16x32_bf16 v[88:91], a[76:79], a[20:23], v[88:91]
  v_cvt_pk_bf16_f32 v35, v30, v31
  v_add_f32 v45, v45, v23
  v_mfma_f32_16x16x32_bf16 v[92:95], a[80:83], a[20:23], v[92:95]
  s_waitcnt lgkmcnt(3)
  ds_write_b64 v13, v[32:33] offset:39104
  v_mfma_f32_16x16x32_bf16 v[96:99], a[60:63], a[24:27], v[96:99]
  buffer_load_dwordx4 a[56:59], v3, s[8:11], s27 offen offset:1024
  s_addk_i32 s27, 6144
  v_mfma_f32_16x16x32_bf16 v[100:103], a[64:67], a[24:27], v[100:103]
  ds_read_b128 a[20:23], v1 offset:13440
  v_lshrrev_b32 v23, 1, v9
  v_mfma_f32_16x16x32_bf16 v[104:107], a[68:71], a[24:27], v[104:107]
  ds_write_b64 v21, v[42:43] offset:384
  v_mfma_f32_16x16x32_bf16 v[108:111], a[72:75], a[24:27], v[108:111]
  v_add_u32 v9, 159776, v9
  ds_write_b64 v14, v[34:35] offset:704
  v_mfma_f32_16x16x32_bf16 v[112:115], a[76:79], a[24:27], v[112:115]
  v_add_u32 v23, 162336, v23
  v_and_b32 v6, 15, v4
  v_mfma_f32_16x16x32_bf16 v[116:119], a[80:83], a[24:27], v[116:119]
  s_waitcnt lgkmcnt(6)
  ds_write_b64 v21, v[44:45] offset:512
  v_mfma_f32_16x16x32_bf16 v[120:123], a[60:63], a[28:31], v[120:123]
  v_lshlrev_b32 v6, 2, v6
  v_add_u32 v6, 162336, v6
  v_mfma_f32_16x16x32_bf16 v[124:127], a[64:67], a[28:31], v[124:127]
  ds_read_b128 a[24:27], v1 offset:26240
  v_mfma_f32_16x16x32_bf16 v[128:131], a[68:71], a[28:31], v[128:131]
  v_mfma_f32_16x16x32_bf16 v[132:135], a[72:75], a[28:31], v[132:135]
  v_mfma_f32_16x16x32_bf16 v[136:139], a[76:79], a[28:31], v[136:139]
  s_waitcnt lgkmcnt(1)
  s_barrier
  ds_read_b64 v[12:13], v8
  v_mfma_f32_16x16x32_bf16 v[140:143], a[80:83], a[28:31], v[140:143]
  ds_read_b64 v[14:15], v8 offset:1280
  v_add_u32 v8, 128, v4
  v_mfma_f32_16x16x32_bf16 v[144:147], a[60:63], a[0:3], v[144:147]
  ds_read_b128 a[28:31], v1 offset:39040
  v_min_u32 v8, 159, v8
  v_mfma_f32_16x16x32_bf16 v[148:151], a[64:67], a[0:3], v[148:151]
  v_lshlrev_b32 v8, 3, v8
  v_lshrrev_b32 v29, 1, v8
  v_mfma_f32_16x16x32_bf16 v[152:155], a[68:71], a[0:3], v[152:155]
  ds_read_b64 v[18:19], v9
  ds_read_b64 v[20:21], v9 offset:1280
  v_mfma_f32_16x16x32_bf16 v[156:159], a[72:75], a[0:3], v[156:159]
  v_add_u32 v8, 159776, v8
  ds_read_b64 v[24:25], v8
  v_mfma_f32_16x16x32_bf16 v[160:163], a[76:79], a[0:3], v[160:163]
  ds_read_b64 v[26:27], v8 offset:1280
  v_add_u32 v29, 162336, v29
  v_mfma_f32_16x16x32_bf16 v[164:167], a[80:83], a[0:3], v[164:167]
  v_mfma_f32_16x16x32_bf16 v[168:171], a[60:63], a[16:19], v[168:171]
  ds_read_b128 a[0:3], v2 offset:640
  v_mfma_f32_16x16x32_bf16 v[172:175], a[64:67], a[16:19], v[172:175]
  v_mfma_f32_16x16x32_bf16 v[176:179], a[68:71], a[16:19], v[176:179]
  v_mfma_f32_16x16x32_bf16 v[180:183], a[72:75], a[16:19], v[180:183]
  v_mfma_f32_16x16x32_bf16 v[184:187], a[76:79], a[16:19], v[184:187]
  v_mfma_f32_16x16x32_bf16 v[188:191], a[80:83], a[16:19], v[188:191]
  v_mfma_f32_16x16x32_bf16 v[192:195], a[60:63], a[20:23], v[192:195]
  s_waitcnt lgkmcnt(6)
  ds_read_b128 a[16:19], v0 offset:704
  v_add_f32 v12, v12, v14
  v_mfma_f32_16x16x32_bf16 v[196:199], a[64:67], a[20:23], v[196:199]
  v_add_f32 v13, v13, v15
  v_mul_f32 v16, s47, v12
  v_mfma_f32_16x16x32_bf16 v[200:203], a[68:71], a[20:23], v[200:203]
  v_mul_f32 v13, s47, v13
  v_fma_f32 v13, -v16, v16, v13
  v_mfma_f32_16x16x32_bf16 v[204:207], a[72:75], a[20:23], v[204:207]
  s_waitcnt lgkmcnt(4)
  v_add_f32 v18, v18, v20
  v_add_f32 v19, v19, v21
  v_mfma_f32_16x16x32_bf16 v[208:211], a[76:79], a[20:23], v[208:211]
  v_mul_f32 v22, s47, v18
  v_mul_f32 v19, s47, v19
  v_mfma_f32_16x16x32_bf16 v[212:215], a[80:83], a[20:23], v[212:215]
  s_waitcnt lgkmcnt(2)
  v_add_f32 v24, v24, v26
  v_add_f32 v25, v25, v27
  v_mfma_f32_16x16x32_bf16 v[216:219], a[60:63], a[24:27], v[216:219]
  ds_read_b128 a[20:23], v0 offset:13504
  v_max_f32 v13, 0, v13
  v_mfma_f32_16x16x32_bf16 v[220:223], a[64:67], a[24:27], v[220:223]
  v_fma_f32 v19, -v22, v22, v19
  v_mul_f32 v28, s47, v24
  v_mfma_f32_16x16x32_bf16 v[224:227], a[68:71], a[24:27], v[224:227]
  v_mul_f32 v25, s47, v25
  v_add_f32 v13, s48, v13
  v_mfma_f32_16x16x32_bf16 v[228:231], a[72:75], a[24:27], v[228:231]
  v_max_f32 v19, 0, v19
  v_fma_f32 v25, -v28, v28, v25
  v_mfma_f32_16x16x32_bf16 v[232:235], a[76:79], a[24:27], v[232:235]
  v_rsq_f32 v13, v13
  v_mfma_f32_16x16x32_bf16 v[236:239], a[80:83], a[24:27], v[236:239]
  v_add_f32 v19, s48, v19
  v_max_f32 v25, 0, v25
  v_mfma_f32_16x16x32_bf16 v[240:243], a[60:63], a[28:31], v[240:243]
  ds_read_b128 a[24:27], v0 offset:26304
  v_add_f32 v25, s48, v25
  v_mfma_f32_16x16x32_bf16 v[244:247], a[64:67], a[28:31], v[244:247]
  v_rsq_f32 v19, v19
  v_mfma_f32_16x16x32_bf16 v[248:251], a[68:71], a[28:31], v[248:251]
  v_rsq_f32 v25, v25
  v_mfma_f32_16x16x32_bf16 v[252:255], a[72:75], a[28:31], v[252:255]
  ds_write_b32 v17, v13
  v_mfma_f32_16x16x32_bf16 a[84:87], a[76:79], a[28:31], a[84:87]
  ds_write_b32 v23, v19
  v_mfma_f32_16x16x32_bf16 a[88:91], a[80:83], a[28:31], a[88:91]
  s_waitcnt lgkmcnt(5)
  ds_write_b32 v29, v25
  v_mfma_f32_16x16x32_bf16 a[92:95], a[60:63], a[0:3], a[92:95]
  ds_read_b128 a[28:31], v0 offset:39104
  v_mfma_f32_16x16x32_bf16 a[96:99], a[64:67], a[0:3], a[96:99]
  buffer_load_dwordx4 a[60:63], v3, s[8:11], s26 offen offset:0
  v_mfma_f32_16x16x32_bf16 a[100:103], a[68:71], a[0:3], a[100:103]
  buffer_load_dwordx4 a[64:67], v3, s[8:11], s26 offen offset:1024
  v_mfma_f32_16x16x32_bf16 a[104:107], a[72:75], a[0:3], a[104:107]
  buffer_load_dwordx4 a[68:71], v3, s[8:11], s26 offen offset:2048
  v_mfma_f32_16x16x32_bf16 a[108:111], a[76:79], a[0:3], a[108:111]
  s_waitcnt lgkmcnt(1)
  ds_read_b128 v[8:11], v5 offset:0
  v_mfma_f32_16x16x32_bf16 a[112:115], a[80:83], a[0:3], a[112:115]
  s_waitcnt vmcnt(11)
  ds_read_b128 v[12:15], v5 offset:64
  v_mfma_f32_16x16x32_bf16 v[48:51], a[32:35], a[16:19], v[48:51]
  buffer_load_dwordx4 a[72:75], v3, s[8:11], s26 offen offset:3072
  s_addk_i32 s26, 6144
  v_mfma_f32_16x16x32_bf16 v[52:55], a[240:243], a[16:19], v[52:55]
  ds_read_b128 a[0:3], v0 offset:51904
  v_mfma_f32_16x16x32_bf16 v[56:59], a[244:247], a[16:19], v[56:59]
  v_cvt_pk_bf16_f32 v48, v48, v49
  v_cvt_pk_bf16_f32 v49, v50, v51
  v_mfma_f32_16x16x32_bf16 v[60:63], a[248:251], a[16:19], v[60:63]
  s_waitcnt vmcnt(11)
  v_accvgpr_write_b32 a116, v48
  v_cvt_pk_bf16_f32 v50, v52, v53
  v_mfma_f32_16x16x32_bf16 v[64:67], a[252:255], a[16:19], v[64:67]
  s_waitcnt vmcnt(10)
  buffer_load_dwordx4 a[76:79], v3, s[8:11], s27 offen offset:0
  v_mfma_f32_16x16x32_bf16 v[68:71], a[200:203], a[16:19], v[68:71]
  v_cvt_pk_bf16_f32 v51, v54, v55
  v_accvgpr_write_b32 a117, v49
  v_mfma_f32_16x16x32_bf16 v[72:75], a[32:35], a[20:23], v[72:75]
  ds_read_b128 a[16:19], v1 offset:704
  v_accvgpr_write_b32 a118, v50
  v_mfma_f32_16x16x32_bf16 v[76:79], a[240:243], a[20:23], v[76:79]
  v_accvgpr_write_b32 a119, v51
  v_cvt_pk_bf16_f32 v56, v56, v57
  v_mfma_f32_16x16x32_bf16 v[80:83], a[244:247], a[20:23], v[80:83]
  buffer_load_dwordx4 a[80:83], v3, s[8:11], s27 offen offset:1024
  s_addk_i32 s27, 6144
  s_max_i32 s30, s29, 0
  v_mfma_f32_16x16x32_bf16 v[84:87], a[248:251], a[20:23], v[84:87]
  s_cmp_ge_u32 s63, 972
  v_cvt_pk_bf16_f32 v57, v58, v59
  v_cvt_pk_bf16_f32 v58, v60, v61
  v_mfma_f32_16x16x32_bf16 v[88:91], a[252:255], a[20:23], v[88:91]
  s_cselect_b32 s30, s67, s30
  v_cvt_pk_bf16_f32 v59, v62, v63
  v_accvgpr_write_b32 a120, v56
  v_mfma_f32_16x16x32_bf16 v[92:95], a[200:203], a[20:23], v[92:95]
  s_cmp_eq_u32 s31, 0
  v_accvgpr_write_b32 a121, v57
  v_accvgpr_write_b32 a122, v58
  v_mfma_f32_16x16x32_bf16 v[96:99], a[32:35], a[24:27], v[96:99]
  s_cselect_b32 s69, s30, s67
  buffer_load_dwordx4 a[236:239], v3, s[8:11], s26 offen offset:1024
  v_mfma_f32_16x16x32_bf16 v[100:103], a[240:243], a[24:27], v[100:103]
  ds_read_b128 a[20:23], v1 offset:13504
  v_accvgpr_write_b32 a123, v59
  v_mfma_f32_16x16x32_bf16 v[104:107], a[244:247], a[24:27], v[104:107]
  v_cvt_pk_bf16_f32 v64, v64, v65
  v_cvt_pk_bf16_f32 v65, v66, v67
  v_mfma_f32_16x16x32_bf16 v[108:111], a[248:251], a[24:27], v[108:111]
  v_cvt_pk_bf16_f32 v66, v68, v69
  v_cvt_pk_bf16_f32 v67, v70, v71
  v_mfma_f32_16x16x32_bf16 v[112:115], a[252:255], a[24:27], v[112:115]
  v_accvgpr_write_b32 a124, v64
  v_accvgpr_write_b32 a125, v65
  v_mfma_f32_16x16x32_bf16 v[116:119], a[200:203], a[24:27], v[116:119]
  s_waitcnt lgkmcnt(5)
  v_accvgpr_write_b32 a126, v66
  v_accvgpr_write_b32 a127, v67
  v_mfma_f32_16x16x32_bf16 v[120:123], a[32:35], a[28:31], v[120:123]
  ds_read_b128 a[24:27], v1 offset:26304
  v_cvt_pk_bf16_f32 v72, v72, v73
  v_mfma_f32_16x16x32_bf16 v[124:127], a[240:243], a[28:31], v[124:127]
  v_cvt_pk_bf16_f32 v73, v74, v75
  v_cvt_pk_bf16_f32 v74, v76, v77
  v_mfma_f32_16x16x32_bf16 v[128:131], a[244:247], a[28:31], v[128:131]
  v_cvt_pk_bf16_f32 v75, v78, v79
  v_accvgpr_write_b32 a128, v72
  v_mfma_f32_16x16x32_bf16 v[132:135], a[248:251], a[28:31], v[132:135]
  v_accvgpr_write_b32 a129, v73
  v_accvgpr_write_b32 a130, v74
  v_mfma_f32_16x16x32_bf16 v[136:139], a[252:255], a[28:31], v[136:139]
  v_accvgpr_write_b32 a131, v75
  v_cvt_pk_bf16_f32 v80, v80, v81
  v_mfma_f32_16x16x32_bf16 v[140:143], a[200:203], a[28:31], v[140:143]
  s_waitcnt lgkmcnt(3)
  v_cvt_pk_bf16_f32 v81, v82, v83
  v_cvt_pk_bf16_f32 v82, v84, v85
  v_mfma_f32_16x16x32_bf16 v[144:147], a[32:35], a[0:3], v[144:147]
  ds_read_b128 a[28:31], v1 offset:39104
  v_cvt_pk_bf16_f32 v83, v86, v87
  v_mfma_f32_16x16x32_bf16 v[148:151], a[240:243], a[0:3], v[148:151]
  v_accvgpr_write_b32 a132, v80
  v_accvgpr_write_b32 a133, v81
  v_mfma_f32_16x16x32_bf16 v[152:155], a[244:247], a[0:3], v[152:155]
  v_accvgpr_write_b32 a134, v82
  v_accvgpr_write_b32 a135, v83
  v_mfma_f32_16x16x32_bf16 v[156:159], a[248:251], a[0:3], v[156:159]
  v_cvt_pk_bf16_f32 v88, v88, v89
  v_cvt_pk_bf16_f32 v89, v90, v91
  v_mfma_f32_16x16x32_bf16 v[160:163], a[252:255], a[0:3], v[160:163]
  v_cvt_pk_bf16_f32 v90, v92, v93
  v_cvt_pk_bf16_f32 v91, v94, v95
  v_mfma_f32_16x16x32_bf16 v[164:167], a[200:203], a[0:3], v[164:167]
  s_waitcnt lgkmcnt(3)
  v_accvgpr_write_b32 a136, v88
  v_accvgpr_write_b32 a137, v89
  v_mfma_f32_16x16x32_bf16 v[168:171], a[32:35], a[16:19], v[168:171]
  ds_read_b128 a[0:3], v2 offset:704
  v_accvgpr_write_b32 a138, v90
  v_mfma_f32_16x16x32_bf16 v[172:175], a[240:243], a[16:19], v[172:175]
  v_accvgpr_write_b32 a139, v91
  v_cvt_pk_bf16_f32 v96, v96, v97
  v_mfma_f32_16x16x32_bf16 v[176:179], a[244:247], a[16:19], v[176:179]
  v_cvt_pk_bf16_f32 v97, v98, v99
  v_cvt_pk_bf16_f32 v98, v100, v101
  v_mfma_f32_16x16x32_bf16 v[180:183], a[248:251], a[16:19], v[180:183]
  v_cvt_pk_bf16_f32 v99, v102, v103
  v_accvgpr_write_b32 a140, v96
  v_mfma_f32_16x16x32_bf16 v[184:187], a[252:255], a[16:19], v[184:187]
  v_accvgpr_write_b32 a141, v97
  v_accvgpr_write_b32 a142, v98
  v_mfma_f32_16x16x32_bf16 v[188:191], a[200:203], a[16:19], v[188:191]
  s_waitcnt lgkmcnt(3)
  v_accvgpr_write_b32 a143, v99
  v_cvt_pk_bf16_f32 v104, v104, v105
  v_mfma_f32_16x16x32_bf16 v[192:195], a[32:35], a[20:23], v[192:195]
  ds_read_b128 a[16:19], v0 offset:0
  v_cvt_pk_bf16_f32 v105, v106, v107
  v_mfma_f32_16x16x32_bf16 v[196:199], a[240:243], a[20:23], v[196:199]
  v_cvt_pk_bf16_f32 v106, v108, v109
  v_cvt_pk_bf16_f32 v107, v110, v111
  v_mfma_f32_16x16x32_bf16 v[200:203], a[244:247], a[20:23], v[200:203]
  v_accvgpr_write_b32 a144, v104
  v_accvgpr_write_b32 a145, v105
  v_mfma_f32_16x16x32_bf16 v[204:207], a[248:251], a[20:23], v[204:207]
  v_accvgpr_write_b32 a146, v106
  v_accvgpr_write_b32 a147, v107
  v_mfma_f32_16x16x32_bf16 v[208:211], a[252:255], a[20:23], v[208:211]
  v_cvt_pk_bf16_f32 v112, v112, v113
  v_cvt_pk_bf16_f32 v113, v114, v115
  v_mfma_f32_16x16x32_bf16 v[212:215], a[200:203], a[20:23], v[212:215]
  s_waitcnt lgkmcnt(3)
  v_cvt_pk_bf16_f32 v114, v116, v117
  v_cvt_pk_bf16_f32 v115, v118, v119
  v_mfma_f32_16x16x32_bf16 v[216:219], a[32:35], a[24:27], v[216:219]
  ds_read_b128 a[20:23], v0 offset:12800
  v_accvgpr_write_b32 a148, v112
  v_mfma_f32_16x16x32_bf16 v[220:223], a[240:243], a[24:27], v[220:223]
  v_accvgpr_write_b32 a149, v113
  v_accvgpr_write_b32 a150, v114
  v_mfma_f32_16x16x32_bf16 v[224:227], a[244:247], a[24:27], v[224:227]
  v_accvgpr_write_b32 a151, v115
  v_cvt_pk_bf16_f32 v120, v120, v121
  v_mfma_f32_16x16x32_bf16 v[228:231], a[248:251], a[24:27], v[228:231]
  v_cvt_pk_bf16_f32 v121, v122, v123
  v_cvt_pk_bf16_f32 v122, v124, v125
  v_mfma_f32_16x16x32_bf16 v[232:235], a[252:255], a[24:27], v[232:235]
  v_cvt_pk_bf16_f32 v123, v126, v127
  v_accvgpr_write_b32 a152, v120
  v_mfma_f32_16x16x32_bf16 v[236:239], a[200:203], a[24:27], v[236:239]
  s_waitcnt lgkmcnt(3)
  v_accvgpr_write_b32 a153, v121
  v_accvgpr_write_b32 a154, v122
  v_mfma_f32_16x16x32_bf16 v[240:243], a[32:35], a[28:31], v[240:243]
  ds_read_b128 a[24:27], v0 offset:25600
  v_accvgpr_write_b32 a155, v123
  v_mfma_f32_16x16x32_bf16 v[244:247], a[240:243], a[28:31], v[244:247]
  v_cvt_pk_bf16_f32 v128, v128, v129
  v_cvt_pk_bf16_f32 v129, v130, v131
  v_mfma_f32_16x16x32_bf16 v[248:251], a[244:247], a[28:31], v[248:251]
  v_cvt_pk_bf16_f32 v130, v132, v133
  v_cvt_pk_bf16_f32 v131, v134, v135
  v_mfma_f32_16x16x32_bf16 v[252:255], a[248:251], a[28:31], v[252:255]
  v_accvgpr_write_b32 a156, v128
  v_accvgpr_write_b32 a157, v129
  v_mfma_f32_16x16x32_bf16 a[84:87], a[252:255], a[28:31], a[84:87]
  v_accvgpr_write_b32 a158, v130
  v_accvgpr_write_b32 a159, v131
  v_mfma_f32_16x16x32_bf16 a[88:91], a[200:203], a[28:31], a[88:91]
  s_waitcnt lgkmcnt(3)
  v_cvt_pk_bf16_f32 v136, v136, v137
  v_cvt_pk_bf16_f32 v137, v138, v139
  v_mfma_f32_16x16x32_bf16 a[92:95], a[32:35], a[0:3], a[92:95]
  ds_read_b128 a[28:31], v0 offset:38400
  v_cvt_pk_bf16_f32 v138, v140, v141
  v_mfma_f32_16x16x32_bf16 a[96:99], a[240:243], a[0:3], a[96:99]
  buffer_load_dwordx4 a[32:35], v3, s[8:11], s26 offen offset:0
  v_mfma_f32_16x16x32_bf16 a[100:103], a[244:247], a[0:3], a[100:103]
  buffer_load_dwordx4 a[240:243], v3, s[8:11], s26 offen offset:2048
  v_mfma_f32_16x16x32_bf16 a[104:107], a[248:251], a[0:3], a[104:107]
  buffer_load_dwordx4 a[244:247], v3, s[8:11], s26 offen offset:3072
  s_addk_i32 s26, 6144
  v_mfma_f32_16x16x32_bf16 a[108:111], a[252:255], a[0:3], a[108:111]
  v_cvt_pk_bf16_f32 v139, v142, v143
  v_accvgpr_write_b32 a160, v136
  v_mfma_f32_16x16x32_bf16 a[112:115], a[200:203], a[0:3], a[112:115]
  s_waitcnt vmcnt(10) lgkmcnt(3)
  v_accvgpr_write_b32 a161, v137
  v_accvgpr_write_b32 a162, v138
  v_mfma_f32_16x16x32_bf16 v[48:51], a[36:39], a[16:19], 0
  buffer_load_dwordx4 a[248:251], v3, s[8:11], s27 offen offset:0
  v_mfma_f32_16x16x32_bf16 v[52:55], a[40:43], a[16:19], 0
  ds_read_b128 a[0:3], v0 offset:51200
  v_accvgpr_write_b32 a163, v139
  v_mfma_f32_16x16x32_bf16 v[56:59], a[44:47], a[16:19], 0
  v_cvt_pk_bf16_f32 v144, v144, v145
  v_cvt_pk_bf16_f32 v145, v146, v147
  v_mfma_f32_16x16x32_bf16 v[60:63], a[48:51], a[16:19], 0
  v_cvt_pk_bf16_f32 v146, v148, v149
  v_cvt_pk_bf16_f32 v147, v150, v151
  v_mfma_f32_16x16x32_bf16 v[64:67], a[52:55], a[16:19], 0
  buffer_load_dwordx4 a[252:255], v3, s[8:11], s27 offen offset:1024
  s_addk_i32 s27, 6144
  s_cmp_eq_u32 s31, 1
  v_mfma_f32_16x16x32_bf16 v[68:71], a[56:59], a[16:19], 0
  s_cselect_b32 s70, s30, s67
  v_accvgpr_write_b32 a164, v144
  v_accvgpr_write_b32 a165, v145
  s_waitcnt lgkmcnt(3)
  v_mfma_f32_16x16x32_bf16 v[72:75], a[36:39], a[20:23], 0
  ds_read_b128 a[16:19], v1 offset:0
  v_accvgpr_write_b32 a166, v146
  v_mfma_f32_16x16x32_bf16 v[76:79], a[40:43], a[20:23], 0
  v_accvgpr_write_b32 a167, v147
  v_cvt_pk_bf16_f32 v152, v152, v153
  v_mfma_f32_16x16x32_bf16 v[80:83], a[44:47], a[20:23], 0
  v_cvt_pk_bf16_f32 v153, v154, v155
  v_cvt_pk_bf16_f32 v154, v156, v157
  v_mfma_f32_16x16x32_bf16 v[84:87], a[48:51], a[20:23], 0
  v_cvt_pk_bf16_f32 v155, v158, v159
  v_accvgpr_write_b32 a168, v152
  v_mfma_f32_16x16x32_bf16 v[88:91], a[52:55], a[20:23], 0
  v_accvgpr_write_b32 a169, v153
  v_accvgpr_write_b32 a170, v154
  v_mfma_f32_16x16x32_bf16 v[92:95], a[56:59], a[20:23], 0
  s_waitcnt lgkmcnt(3)
  v_accvgpr_write_b32 a171, v155
  v_cvt_pk_bf16_f32 v160, v160, v161
  v_mfma_f32_16x16x32_bf16 v[96:99], a[36:39], a[24:27], 0
  ds_read_b128 a[20:23], v1 offset:12800
  v_cvt_pk_bf16_f32 v161, v162, v163
  v_mfma_f32_16x16x32_bf16 v[100:103], a[40:43], a[24:27], 0
  v_cvt_pk_bf16_f32 v162, v164, v165
  v_cvt_pk_bf16_f32 v163, v166, v167
  v_mfma_f32_16x16x32_bf16 v[104:107], a[44:47], a[24:27], 0
  v_accvgpr_write_b32 a172, v160
  v_accvgpr_write_b32 a173, v161
  v_mfma_f32_16x16x32_bf16 v[108:111], a[48:51], a[24:27], 0
  v_accvgpr_write_b32 a174, v162
  v_accvgpr_write_b32 a175, v163
  v_mfma_f32_16x16x32_bf16 v[112:115], a[52:55], a[24:27], 0
  v_cvt_pk_bf16_f32 v168, v168, v169
  v_cvt_pk_bf16_f32 v169, v170, v171
  v_mfma_f32_16x16x32_bf16 v[116:119], a[56:59], a[24:27], 0
  s_waitcnt lgkmcnt(3)
  v_cvt_pk_bf16_f32 v170, v172, v173
  v_cvt_pk_bf16_f32 v171, v174, v175
  v_mfma_f32_16x16x32_bf16 v[120:123], a[36:39], a[28:31], 0
  ds_read_b128 a[24:27], v1 offset:25600
  v_accvgpr_write_b32 a176, v168
  v_mfma_f32_16x16x32_bf16 v[124:127], a[40:43], a[28:31], 0
  v_accvgpr_write_b32 a177, v169
  v_accvgpr_write_b32 a178, v170
  v_mfma_f32_16x16x32_bf16 v[128:131], a[44:47], a[28:31], 0
  v_accvgpr_write_b32 a179, v171
  v_cvt_pk_bf16_f32 v176, v176, v177
  v_mfma_f32_16x16x32_bf16 v[132:135], a[48:51], a[28:31], 0
  v_cvt_pk_bf16_f32 v177, v178, v179
  v_cvt_pk_bf16_f32 v178, v180, v181
  v_mfma_f32_16x16x32_bf16 v[136:139], a[52:55], a[28:31], 0
  v_cvt_pk_bf16_f32 v179, v182, v183
  v_accvgpr_write_b32 a180, v176
  v_mfma_f32_16x16x32_bf16 v[140:143], a[56:59], a[28:31], 0
  s_waitcnt lgkmcnt(3)
  v_accvgpr_write_b32 a181, v177
  v_accvgpr_write_b32 a182, v178
  v_mfma_f32_16x16x32_bf16 v[144:147], a[36:39], a[0:3], 0
  v_accvgpr_write_b32 a183, v179
  v_cvt_pk_bf16_f32 v184, v184, v185
  v_mfma_f32_16x16x32_bf16 v[148:151], a[40:43], a[0:3], 0
  v_cvt_pk_bf16_f32 v185, v186, v187
  v_cvt_pk_bf16_f32 v186, v188, v189
  v_mfma_f32_16x16x32_bf16 v[152:155], a[44:47], a[0:3], 0
  v_cvt_pk_bf16_f32 v187, v190, v191
  v_accvgpr_write_b32 a184, v184
  v_mfma_f32_16x16x32_bf16 v[156:159], a[48:51], a[0:3], 0
  v_accvgpr_write_b32 a185, v185
  v_accvgpr_write_b32 a186, v186
  v_mfma_f32_16x16x32_bf16 v[160:163], a[52:55], a[0:3], 0
  v_accvgpr_write_b32 a187, v187
  v_cvt_pk_bf16_f32 v192, v192, v193
  v_mfma_f32_16x16x32_bf16 v[164:167], a[56:59], a[0:3], 0
  s_waitcnt lgkmcnt(2)
  v_cvt_pk_bf16_f32 v193, v194, v195
  v_cvt_pk_bf16_f32 v194, v196, v197
  v_mfma_f32_16x16x32_bf16 v[168:171], a[36:39], a[16:19], 0
  v_cvt_pk_bf16_f32 v195, v198, v199
  v_accvgpr_write_b32 a188, v192
  v_mfma_f32_16x16x32_bf16 v[172:175], a[40:43], a[16:19], 0
  v_accvgpr_write_b32 a189, v193
  v_accvgpr_write_b32 a190, v194
  v_mfma_f32_16x16x32_bf16 v[176:179], a[44:47], a[16:19], 0
  v_accvgpr_write_b32 a191, v195
  v_cvt_pk_bf16_f32 v200, v200, v201
  v_mfma_f32_16x16x32_bf16 v[180:183], a[48:51], a[16:19], 0
  ds_read_b128 a[28:31], v1 offset:38400
  v_cvt_pk_bf16_f32 v201, v202, v203
  v_mfma_f32_16x16x32_bf16 v[184:187], a[52:55], a[16:19], 0
  v_cvt_pk_bf16_f32 v202, v204, v205
  v_cvt_pk_bf16_f32 v203, v206, v207
  v_mfma_f32_16x16x32_bf16 v[188:191], a[56:59], a[16:19], 0
  s_waitcnt lgkmcnt(2)
  v_accvgpr_write_b32 a192, v200
  v_accvgpr_write_b32 a193, v201
  v_mfma_f32_16x16x32_bf16 v[192:195], a[36:39], a[20:23], 0
  v_accvgpr_write_b32 a194, v202
  v_accvgpr_write_b32 a195, v203
  v_mfma_f32_16x16x32_bf16 v[196:199], a[40:43], a[20:23], 0
  v_cvt_pk_bf16_f32 v208, v208, v209
  v_cvt_pk_bf16_f32 v209, v210, v211
  v_mfma_f32_16x16x32_bf16 v[200:203], a[44:47], a[20:23], 0
  v_cvt_pk_bf16_f32 v210, v212, v213
  v_cvt_pk_bf16_f32 v211, v214, v215
  v_mfma_f32_16x16x32_bf16 v[204:207], a[48:51], a[20:23], 0
  v_accvgpr_write_b32 a196, v208
  v_accvgpr_write_b32 a197, v209
  v_accvgpr_write_b32 a198, v210
  v_accvgpr_write_b32 a199, v211
  v_mfma_f32_16x16x32_bf16 v[208:211], a[52:55], a[20:23], 0
  v_cvt_pk_bf16_f32 v216, v216, v217
  v_cvt_pk_bf16_f32 v217, v218, v219
  v_mfma_f32_16x16x32_bf16 v[212:215], a[56:59], a[20:23], 0
  v_cvt_pk_bf16_f32 v218, v220, v221
  v_cvt_pk_bf16_f32 v219, v222, v223
  v_accvgpr_write_b32 a200, v216
  v_accvgpr_write_b32 a201, v217
  v_accvgpr_write_b32 a202, v218
  v_accvgpr_write_b32 a203, v219
  s_waitcnt lgkmcnt(1)
  v_mfma_f32_16x16x32_bf16 v[216:219], a[36:39], a[24:27], 0
  v_cvt_pk_bf16_f32 v224, v224, v225
  v_cvt_pk_bf16_f32 v225, v226, v227
  v_mfma_f32_16x16x32_bf16 v[220:223], a[40:43], a[24:27], 0
  v_cvt_pk_bf16_f32 v226, v228, v229
  v_cvt_pk_bf16_f32 v227, v230, v231
  v_accvgpr_write_b32 a204, v224
  v_accvgpr_write_b32 a205, v225
  v_accvgpr_write_b32 a206, v226
  v_accvgpr_write_b32 a207, v227
  v_mfma_f32_16x16x32_bf16 v[224:227], a[44:47], a[24:27], 0
  v_cvt_pk_bf16_f32 v232, v232, v233
  ds_read_b128 a[0:3], v2 offset:0
  v_mfma_f32_16x16x32_bf16 v[228:231], a[48:51], a[24:27], 0
  v_cvt_pk_bf16_f32 v233, v234, v235
  v_cvt_pk_bf16_f32 v234, v236, v237
  v_cvt_pk_bf16_f32 v235, v238, v239
  v_accvgpr_write_b32 a208, v232
  v_accvgpr_write_b32 a209, v233
  v_accvgpr_write_b32 a210, v234
  v_accvgpr_write_b32 a211, v235
  v_mfma_f32_16x16x32_bf16 v[232:235], a[52:55], a[24:27], 0
  v_cvt_pk_bf16_f32 v240, v240, v241
  v_cvt_pk_bf16_f32 v241, v242, v243
  v_mfma_f32_16x16x32_bf16 v[236:239], a[56:59], a[24:27], 0
  v_cvt_pk_bf16_f32 v242, v244, v245
  v_cvt_pk_bf16_f32 v243, v246, v247
  v_accvgpr_write_b32 a212, v240
  v_accvgpr_write_b32 a213, v241
  v_accvgpr_write_b32 a214, v242
  v_accvgpr_write_b32 a215, v243
  s_waitcnt lgkmcnt(1)
  v_mfma_f32_16x16x32_bf16 v[240:243], a[36:39], a[28:31], 0
  v_cvt_pk_bf16_f32 v248, v248, v249
  v_cvt_pk_bf16_f32 v249, v250, v251
  v_mfma_f32_16x16x32_bf16 v[244:247], a[40:43], a[28:31], 0
  v_cvt_pk_bf16_f32 v250, v252, v253
  v_cvt_pk_bf16_f32 v251, v254, v255
  v_accvgpr_write_b32 a216, v248
  v_accvgpr_write_b32 a217, v249
  v_accvgpr_write_b32 a218, v250
  v_accvgpr_write_b32 a219, v251
  v_mfma_f32_16x16x32_bf16 v[248:251], a[44:47], a[28:31], 0
  v_accvgpr_read_b32 v32, a84
  v_accvgpr_read_b32 v33, a85
  v_mfma_f32_16x16x32_bf16 v[252:255], a[48:51], a[28:31], 0
  v_accvgpr_read_b32 v34, a86
  v_accvgpr_read_b32 v35, a87
  v_mfma_f32_16x16x32_bf16 a[84:87], a[52:55], a[28:31], 0
  v_accvgpr_read_b32 v36, a88
  v_accvgpr_read_b32 v37, a89
  v_accvgpr_read_b32 v38, a90
  v_accvgpr_read_b32 v39, a91
  v_mfma_f32_16x16x32_bf16 a[88:91], a[56:59], a[28:31], 0
  v_accvgpr_read_b32 v40, a92
  v_accvgpr_read_b32 v41, a93
  v_accvgpr_read_b32 v42, a94
  v_accvgpr_read_b32 v43, a95
  s_waitcnt lgkmcnt(0)
  v_mfma_f32_16x16x32_bf16 a[92:95], a[36:39], a[0:3], 0
  ds_read_b128 a[16:19], v0 offset:64
  v_accvgpr_read_b32 v44, a96
  v_accvgpr_read_b32 v45, a97
  v_accvgpr_read_b32 v46, a98
  v_accvgpr_read_b32 v47, a99
  v_mfma_f32_16x16x32_bf16 a[96:99], a[40:43], a[0:3], 0
  buffer_load_dwordx4 a[36:39], v3, s[8:11], s26 offen offset:0
  v_cvt_pk_bf16_f32 v32, v32, v33
  v_cvt_pk_bf16_f32 v33, v34, v35
  v_cvt_pk_bf16_f32 v34, v36, v37
  v_cvt_pk_bf16_f32 v35, v38, v39
  v_accvgpr_write_b32 a220, v32
  v_accvgpr_write_b32 a221, v33
  v_accvgpr_write_b32 a222, v34
  v_accvgpr_write_b32 a223, v35
  v_accvgpr_read_b32 v32, a100
  v_accvgpr_read_b32 v33, a101
  v_accvgpr_read_b32 v34, a102
  v_accvgpr_read_b32 v35, a103
  v_mfma_f32_16x16x32_bf16 a[100:103], a[44:47], a[0:3], 0
  buffer_load_dwordx4 a[40:43], v3, s[8:11], s26 offen offset:1024
  v_accvgpr_read_b32 v36, a104
  v_accvgpr_read_b32 v37, a105
  v_accvgpr_read_b32 v38, a106
  v_accvgpr_read_b32 v39, a107
  v_mfma_f32_16x16x32_bf16 a[104:107], a[48:51], a[0:3], 0
  buffer_load_dwordx4 a[44:47], v3, s[8:11], s26 offen offset:2048
  v_cvt_pk_bf16_f32 v40, v40, v41
  v_cvt_pk_bf16_f32 v41, v42, v43
  v_cvt_pk_bf16_f32 v42, v44, v45
  v_cvt_pk_bf16_f32 v43, v46, v47
  ds_read_b128 a[20:23], v0 offset:12864
  v_accvgpr_write_b32 a224, v40
  v_accvgpr_write_b32 a225, v41
  v_accvgpr_write_b32 a226, v42
  v_accvgpr_write_b32 a227, v43
  v_accvgpr_read_b32 v40, a108
  v_accvgpr_read_b32 v41, a109
  v_accvgpr_read_b32 v42, a110
  v_accvgpr_read_b32 v43, a111
  v_mfma_f32_16x16x32_bf16 a[108:111], a[52:55], a[0:3], 0
  buffer_load_dwordx4 a[48:51], v3, s[8:11], s26 offen offset:3072
  s_addk_i32 s26, 6144
  v_accvgpr_read_b32 v44, a112
  v_accvgpr_read_b32 v45, a113
  v_accvgpr_read_b32 v46, a114
  v_accvgpr_read_b32 v47, a115
  v_mfma_f32_16x16x32_bf16 a[112:115], a[56:59], a[0:3], 0
  s_waitcnt vmcnt(9) lgkmcnt(1)
  buffer_load_dwordx4 a[52:55], v3, s[8:11], s27 offen offset:0
  v_mfma_f32_16x16x32_bf16 v[48:51], a[60:63], a[16:19], v[48:51]
  buffer_load_dwordx4 a[56:59], v3, s[8:11], s27 offen offset:1024
  s_addk_i32 s27, 6144
  s_cmp_eq_u32 s31, 2
  v_mfma_f32_16x16x32_bf16 v[52:55], a[64:67], a[16:19], v[52:55]
  ds_read_b128 a[24:27], v0 offset:25664
  v_cvt_pk_bf16_f32 v40, v40, v41
  v_mfma_f32_16x16x32_bf16 v[56:59], a[68:71], a[16:19], v[56:59]
  ds_read_b128 a[28:31], v0 offset:38464
  v_cvt_pk_bf16_f32 v41, v42, v43
  v_mfma_f32_16x16x32_bf16 v[60:63], a[72:75], a[16:19], v[60:63]
  ds_read_b128 a[0:3], v0 offset:51264
  v_cvt_pk_bf16_f32 v43, v46, v47
  v_mfma_f32_16x16x32_bf16 v[64:67], a[76:79], a[16:19], v[64:67]
  v_add_u32 v47, s56, v4
  v_min_u32 v46, 137, v47
  v_mfma_f32_16x16x32_bf16 v[68:71], a[80:83], a[16:19], v[68:71]
  s_mul_i32 s56, s16, 35
  v_lshlrev_b32 v47, 7, v46
  v_mov_b32 v46, 0x40000000
  v_cndmask_b32 v47, v46, v47, vcc
  ds_read_b128 a[16:19], v1 offset:64
  s_waitcnt lgkmcnt(4)
  v_mfma_f32_16x16x32_bf16 v[72:75], a[60:63], a[20:23], v[72:75]
  buffer_load_dword v47, s[4:7], s69 offen lds
  s_cselect_b32 s69, s30, s67
  s_mov_b32 m0, s68
  v_mfma_f32_16x16x32_bf16 v[76:79], a[64:67], a[20:23], v[76:79]
  v_cvt_pk_bf16_f32 v32, v32, v33
  v_cvt_pk_bf16_f32 v33, v34, v35
  v_mfma_f32_16x16x32_bf16 v[80:83], a[68:71], a[20:23], v[80:83]
  v_cvt_pk_bf16_f32 v34, v36, v37
  v_cvt_pk_bf16_f32 v35, v38, v39
  v_mfma_f32_16x16x32_bf16 v[84:87], a[72:75], a[20:23], v[84:87]
  buffer_load_dword v47, s[4:7], s70 offen lds
  s_mov_b32 m0, s68
  v_mfma_f32_16x16x32_bf16 v[88:91], a[76:79], a[20:23], v[88:91]
  v_accvgpr_write_b32 a228, v32
  v_accvgpr_write_b32 a229, v33
  v_mfma_f32_16x16x32_bf16 v[92:95], a[80:83], a[20:23], v[92:95]
  v_accvgpr_write_b32 a230, v34
  v_accvgpr_write_b32 a231, v35
  v_cvt_pk_bf16_f32 v42, v44, v45
  ds_read_b128 a[20:23], v1 offset:12864
  v_accvgpr_write_b32 a232, v40
  v_accvgpr_write_b32 a233, v41
  s_waitcnt lgkmcnt(4)
  v_mfma_f32_16x16x32_bf16 v[96:99], a[60:63], a[24:27], v[96:99]
  v_accvgpr_write_b32 a234, v42
  v_accvgpr_write_b32 a235, v43
  v_mfma_f32_16x16x32_bf16 v[100:103], a[64:67], a[24:27], v[100:103]
  v_cmp_gt_u32 vcc, 35, v4
  ds_read_b128 v[16:19], v5 offset:128
  v_mfma_f32_16x16x32_bf16 v[104:107], a[68:71], a[24:27], v[104:107]
  ds_read_b32 v30, v7 offset:576
  ds_read_b32 v31, v6 offset:0
  v_mfma_f32_16x16x32_bf16 v[108:111], a[72:75], a[24:27], v[108:111]
  v_mfma_f32_16x16x32_bf16 v[112:115], a[76:79], a[24:27], v[112:115]
  v_mfma_f32_16x16x32_bf16 v[116:119], a[80:83], a[24:27], v[116:119]
  s_waitcnt lgkmcnt(6)
  v_mfma_f32_16x16x32_bf16 v[120:123], a[60:63], a[28:31], v[120:123]
  ds_read_b128 a[24:27], v1 offset:25664
  v_mfma_f32_16x16x32_bf16 v[124:127], a[64:67], a[28:31], v[124:127]
  v_mfma_f32_16x16x32_bf16 v[128:131], a[68:71], a[28:31], v[128:131]
  v_mfma_f32_16x16x32_bf16 v[132:135], a[72:75], a[28:31], v[132:135]
  v_mfma_f32_16x16x32_bf16 v[136:139], a[76:79], a[28:31], v[136:139]
  v_mfma_f32_16x16x32_bf16 v[140:143], a[80:83], a[28:31], v[140:143]
  s_waitcnt lgkmcnt(6)
  v_mfma_f32_16x16x32_bf16 v[144:147], a[60:63], a[0:3], v[144:147]
  ds_read_b128 a[28:31], v1 offset:38464
  v_mfma_f32_16x16x32_bf16 v[148:151], a[64:67], a[0:3], v[148:151]
  v_mfma_f32_16x16x32_bf16 v[152:155], a[68:71], a[0:3], v[152:155]
  v_mfma_f32_16x16x32_bf16 v[156:159], a[72:75], a[0:3], v[156:159]
  s_waitcnt lgkmcnt(2)
  v_mul_f32 v31, s46, v31
  v_mfma_f32_16x16x32_bf16 v[160:163], a[76:79], a[0:3], v[160:163]
  v_mfma_f32_16x16x32_bf16 v[164:167], a[80:83], a[0:3], v[164:167]
  v_mfma_f32_16x16x32_bf16 v[168:171], a[60:63], a[16:19], v[168:171]
  ds_read_b128 a[0:3], v2 offset:64
  v_mfma_f32_16x16x32_bf16 v[172:175], a[64:67], a[16:19], v[172:175]
  v_mfma_f32_16x16x32_bf16 v[176:179], a[68:71], a[16:19], v[176:179]
  v_mfma_f32_16x16x32_bf16 v[180:183], a[72:75], a[16:19], v[180:183]
  v_mfma_f32_16x16x32_bf16 v[184:187], a[76:79], a[16:19], v[184:187]
  v_mfma_f32_16x16x32_bf16 v[188:191], a[80:83], a[16:19], v[188:191]
  v_mfma_f32_16x16x32_bf16 v[192:195], a[60:63], a[20:23], v[192:195]
  ds_read_b128 a[16:19], v0 offset:128
  v_mfma_f32_16x16x32_bf16 v[196:199], a[64:67], a[20:23], v[196:199]
  v_mfma_f32_16x16x32_bf16 v[200:203], a[68:71], a[20:23], v[200:203]
  v_mfma_f32_16x16x32_bf16 v[204:207], a[72:75], a[20:23], v[204:207]
  v_mfma_f32_16x16x32_bf16 v[208:211], a[76:79], a[20:23], v[208:211]
  v_mfma_f32_16x16x32_bf16 v[212:215], a[80:83], a[20:23], v[212:215]
  s_waitcnt lgkmcnt(3)
  v_mfma_f32_16x16x32_bf16 v[216:219], a[60:63], a[24:27], v[216:219]
  ds_read_b128 a[20:23], v0 offset:12928
  v_mfma_f32_16x16x32_bf16 v[220:223], a[64:67], a[24:27], v[220:223]
  v_mfma_f32_16x16x32_bf16 v[224:227], a[68:71], a[24:27], v[224:227]
  v_mfma_f32_16x16x32_bf16 v[228:231], a[72:75], a[24:27], v[228:231]
  v_mfma_f32_16x16x32_bf16 v[232:235], a[76:79], a[24:27], v[232:235]
  v_mfma_f32_16x16x32_bf16 v[236:239], a[80:83], a[24:27], v[236:239]
  s_waitcnt lgkmcnt(3)
  v_mfma_f32_16x16x32_bf16 v[240:243], a[60:63], a[28:31], v[240:243]
  ds_read_b128 a[24:27], v0 offset:25728
  v_mfma_f32_16x16x32_bf16 v[244:247], a[64:67], a[28:31], v[244:247]
  v_mfma_f32_16x16x32_bf16 v[248:251], a[68:71], a[28:31], v[248:251]
  v_mfma_f32_16x16x32_bf16 v[252:255], a[72:75], a[28:31], v[252:255]
  v_mfma_f32_16x16x32_bf16 a[84:87], a[76:79], a[28:31], a[84:87]
  v_mfma_f32_16x16x32_bf16 a[88:91], a[80:83], a[28:31], a[88:91]
  s_waitcnt lgkmcnt(3)
  v_mfma_f32_16x16x32_bf16 a[92:95], a[60:63], a[0:3], a[92:95]
  ds_read_b128 a[28:31], v0 offset:38528
  v_mfma_f32_16x16x32_bf16 a[96:99], a[64:67], a[0:3], a[96:99]
  buffer_load_dwordx4 a[60:63], v3, s[8:11], s26 offen offset:0
  v_mfma_f32_16x16x32_bf16 a[100:103], a[68:71], a[0:3], a[100:103]
  buffer_load_dwordx4 a[64:67], v3, s[8:11], s26 offen offset:1024
  v_mfma_f32_16x16x32_bf16 a[104:107], a[72:75], a[0:3], a[104:107]
  buffer_load_dwordx4 a[68:71], v3, s[8:11], s26 offen offset:2048
  v_mfma_f32_16x16x32_bf16 a[108:111], a[76:79], a[0:3], a[108:111]
  v_mfma_f32_16x16x32_bf16 a[112:115], a[80:83], a[0:3], a[112:115]
  s_waitcnt vmcnt(11) lgkmcnt(3)
  v_mfma_f32_16x16x32_bf16 v[48:51], a[32:35], a[16:19], v[48:51]
  buffer_load_dwordx4 a[72:75], v3, s[8:11], s26 offen offset:3072
  s_addk_i32 s26, 6144
  v_mfma_f32_16x16x32_bf16 v[52:55], a[236:239], a[16:19], v[52:55]
  ds_read_b128 a[0:3], v0 offset:51328
  v_mfma_f32_16x16x32_bf16 v[56:59], a[240:243], a[16:19], v[56:59]
  v_mfma_f32_16x16x32_bf16 v[60:63], a[244:247], a[16:19], v[60:63]
  v_mfma_f32_16x16x32_bf16 v[64:67], a[248:251], a[16:19], v[64:67]
  buffer_load_dwordx4 a[76:79], v3, s[8:11], s27 offen offset:0
  v_mfma_f32_16x16x32_bf16 v[68:71], a[252:255], a[16:19], v[68:71]
  s_waitcnt lgkmcnt(3)
  v_mfma_f32_16x16x32_bf16 v[72:75], a[32:35], a[20:23], v[72:75]
  ds_read_b128 a[16:19], v1 offset:128
  v_mfma_f32_16x16x32_bf16 v[76:79], a[236:239], a[20:23], v[76:79]
  v_mfma_f32_16x16x32_bf16 v[80:83], a[240:243], a[20:23], v[80:83]
  buffer_load_dwordx4 a[80:83], v3, s[8:11], s27 offen offset:1024
  s_addk_i32 s27, 6144
  s_add_u32 s29, s29, 290304
  v_mfma_f32_16x16x32_bf16 v[84:87], a[244:247], a[20:23], v[84:87]
  s_max_i32 s30, s29, 0
  s_cmp_ge_u32 s63, 972
  s_cselect_b32 s30, s67, s30
  v_mfma_f32_16x16x32_bf16 v[88:91], a[248:251], a[20:23], v[88:91]
  s_cmp_eq_u32 s31, 0
  s_cselect_b32 s70, s30, s67
  v_mfma_f32_16x16x32_bf16 v[92:95], a[252:255], a[20:23], v[92:95]
  buffer_load_dword v47, s[4:7], s69 offen lds
  s_mov_b32 m0, s68
  s_waitcnt lgkmcnt(3)
  v_mfma_f32_16x16x32_bf16 v[96:99], a[32:35], a[24:27], v[96:99]
  ds_read_b128 a[20:23], v1 offset:12928
  v_mfma_f32_16x16x32_bf16 v[100:103], a[236:239], a[24:27], v[100:103]
  v_mfma_f32_16x16x32_bf16 v[104:107], a[240:243], a[24:27], v[104:107]
  v_mfma_f32_16x16x32_bf16 v[108:111], a[244:247], a[24:27], v[108:111]
  v_mfma_f32_16x16x32_bf16 v[112:115], a[248:251], a[24:27], v[112:115]
  v_mfma_f32_16x16x32_bf16 v[116:119], a[252:255], a[24:27], v[116:119]
  s_waitcnt lgkmcnt(3)
  v_mfma_f32_16x16x32_bf16 v[120:123], a[32:35], a[28:31], v[120:123]
  ds_read_b128 a[24:27], v1 offset:25728
  v_mfma_f32_16x16x32_bf16 v[124:127], a[236:239], a[28:31], v[124:127]
  v_mfma_f32_16x16x32_bf16 v[128:131], a[240:243], a[28:31], v[128:131]
  v_mfma_f32_16x16x32_bf16 v[132:135], a[244:247], a[28:31], v[132:135]
  v_mfma_f32_16x16x32_bf16 v[136:139], a[248:251], a[28:31], v[136:139]
  v_mfma_f32_16x16x32_bf16 v[140:143], a[252:255], a[28:31], v[140:143]
  s_waitcnt lgkmcnt(3)
  v_mfma_f32_16x16x32_bf16 v[144:147], a[32:35], a[0:3], v[144:147]
  ds_read_b128 a[28:31], v1 offset:38528
  v_mfma_f32_16x16x32_bf16 v[148:151], a[236:239], a[0:3], v[148:151]
  v_mfma_f32_16x16x32_bf16 v[152:155], a[240:243], a[0:3], v[152:155]
  v_mfma_f32_16x16x32_bf16 v[156:159], a[244:247], a[0:3], v[156:159]
  v_mfma_f32_16x16x32_bf16 v[160:163], a[248:251], a[0:3], v[160:163]
  v_mfma_f32_16x16x32_bf16 v[164:167], a[252:255], a[0:3], v[164:167]
  s_waitcnt lgkmcnt(3)
  v_mfma_f32_16x16x32_bf16 v[168:171], a[32:35], a[16:19], v[168:171]
  ds_read_b128 a[0:3], v2 offset:128
  v_mfma_f32_16x16x32_bf16 v[172:175], a[236:239], a[16:19], v[172:175]
  v_mfma_f32_16x16x32_bf16 v[176:179], a[240:243], a[16:19], v[176:179]
  v_mfma_f32_16x16x32_bf16 v[180:183], a[244:247], a[16:19], v[180:183]
  v_mfma_f32_16x16x32_bf16 v[184:187], a[248:251], a[16:19], v[184:187]
  v_mfma_f32_16x16x32_bf16 v[188:191], a[252:255], a[16:19], v[188:191]
  s_waitcnt lgkmcnt(3)
  v_mfma_f32_16x16x32_bf16 v[192:195], a[32:35], a[20:23], v[192:195]
  ds_read_b128 a[16:19], v0 offset:192
  v_mfma_f32_16x16x32_bf16 v[196:199], a[236:239], a[20:23], v[196:199]
  v_mfma_f32_16x16x32_bf16 v[200:203], a[240:243], a[20:23], v[200:203]
  v_mfma_f32_16x16x32_bf16 v[204:207], a[244:247], a[20:23], v[204:207]
  v_mfma_f32_16x16x32_bf16 v[208:211], a[248:251], a[20:23], v[208:211]
  v_mfma_f32_16x16x32_bf16 v[212:215], a[252:255], a[20:23], v[212:215]
  s_waitcnt lgkmcnt(3)
  v_mfma_f32_16x16x32_bf16 v[216:219], a[32:35], a[24:27], v[216:219]
  ds_read_b128 a[20:23], v0 offset:12992
  v_mfma_f32_16x16x32_bf16 v[220:223], a[236:239], a[24:27], v[220:223]
  v_mfma_f32_16x16x32_bf16 v[224:227], a[240:243], a[24:27], v[224:227]
  v_mfma_f32_16x16x32_bf16 v[228:231], a[244:247], a[24:27], v[228:231]
  v_mfma_f32_16x16x32_bf16 v[232:235], a[248:251], a[24:27], v[232:235]
  v_mfma_f32_16x16x32_bf16 v[236:239], a[252:255], a[24:27], v[236:239]
  s_waitcnt lgkmcnt(3)
  v_mfma_f32_16x16x32_bf16 v[240:243], a[32:35], a[28:31], v[240:243]
  ds_read_b128 a[24:27], v0 offset:25792
  v_mfma_f32_16x16x32_bf16 v[244:247], a[236:239], a[28:31], v[244:247]
  v_mfma_f32_16x16x32_bf16 v[248:251], a[240:243], a[28:31], v[248:251]
  v_mfma_f32_16x16x32_bf16 v[252:255], a[244:247], a[28:31], v[252:255]
  v_mfma_f32_16x16x32_bf16 a[84:87], a[248:251], a[28:31], a[84:87]
  v_mfma_f32_16x16x32_bf16 a[88:91], a[252:255], a[28:31], a[88:91]
  s_waitcnt lgkmcnt(3)
  v_mfma_f32_16x16x32_bf16 a[92:95], a[32:35], a[0:3], a[92:95]
  ds_read_b128 a[28:31], v0 offset:38592
  v_mfma_f32_16x16x32_bf16 a[96:99], a[236:239], a[0:3], a[96:99]
  buffer_load_dwordx4 a[32:35], v3, s[8:11], s26 offen offset:0
  v_mfma_f32_16x16x32_bf16 a[100:103], a[240:243], a[0:3], a[100:103]
  buffer_load_dwordx4 a[236:239], v3, s[8:11], s26 offen offset:1024
  v_mfma_f32_16x16x32_bf16 a[104:107], a[244:247], a[0:3], a[104:107]
  buffer_load_dwordx4 a[240:243], v3, s[8:11], s26 offen offset:2048
  v_mfma_f32_16x16x32_bf16 a[108:111], a[248:251], a[0:3], a[108:111]
  v_mfma_f32_16x16x32_bf16 a[112:115], a[252:255], a[0:3], a[112:115]
  s_waitcnt vmcnt(12) lgkmcnt(3)
  v_mfma_f32_16x16x32_bf16 v[48:51], a[36:39], a[16:19], v[48:51]
  buffer_load_dwordx4 a[244:247], v3, s[8:11], s26 offen offset:3072
  s_addk_i32 s26, 6144
  v_mfma_f32_16x16x32_bf16 v[52:55], a[40:43], a[16:19], v[52:55]
  ds_read_b128 a[0:3], v0 offset:51392
  v_mfma_f32_16x16x32_bf16 v[56:59], a[44:47], a[16:19], v[56:59]
  v_mfma_f32_16x16x32_bf16 v[60:63], a[48:51], a[16:19], v[60:63]
  v_mfma_f32_16x16x32_bf16 v[64:67], a[52:55], a[16:19], v[64:67]
  buffer_load_dwordx4 a[248:251], v3, s[8:11], s27 offen offset:0
  v_mfma_f32_16x16x32_bf16 v[68:71], a[56:59], a[16:19], v[68:71]
  s_waitcnt lgkmcnt(3)
  v_mfma_f32_16x16x32_bf16 v[72:75], a[36:39], a[20:23], v[72:75]
  ds_read_b128 a[16:19], v1 offset:192
  v_mfma_f32_16x16x32_bf16 v[76:79], a[40:43], a[20:23], v[76:79]
  v_mfma_f32_16x16x32_bf16 v[80:83], a[44:47], a[20:23], v[80:83]
  buffer_load_dwordx4 a[252:255], v3, s[8:11], s27 offen offset:1024
  s_addk_i32 s27, 6144
  s_cmp_eq_u32 s31, 1
  v_mfma_f32_16x16x32_bf16 v[84:87], a[48:51], a[20:23], v[84:87]
  s_cselect_b32 s69, s30, s67
  v_mfma_f32_16x16x32_bf16 v[88:91], a[52:55], a[20:23], v[88:91]
  v_mfma_f32_16x16x32_bf16 v[92:95], a[56:59], a[20:23], v[92:95]
  buffer_load_dword v47, s[4:7], s70 offen lds
  s_mov_b32 m0, s68
  s_waitcnt lgkmcnt(3)
  v_mfma_f32_16x16x32_bf16 v[96:99], a[36:39], a[24:27], v[96:99]
  ds_read_b128 a[20:23], v1 offset:12992
  v_mfma_f32_16x16x32_bf16 v[100:103], a[40:43], a[24:27], v[100:103]
  v_mfma_f32_16x16x32_bf16 v[104:107], a[44:47], a[24:27], v[104:107]
  v_mfma_f32_16x16x32_bf16 v[108:111], a[48:51], a[24:27], v[108:111]
  v_mfma_f32_16x16x32_bf16 v[112:115], a[52:55], a[24:27], v[112:115]
  v_mfma_f32_16x16x32_bf16 v[116:119], a[56:59], a[24:27], v[116:119]
  s_waitcnt lgkmcnt(3)
  v_mfma_f32_16x16x32_bf16 v[120:123], a[36:39], a[28:31], v[120:123]
  ds_read_b128 a[24:27], v1 offset:25792
  v_mfma_f32_16x16x32_bf16 v[124:127], a[40:43], a[28:31], v[124:127]
  v_mfma_f32_16x16x32_bf16 v[128:131], a[44:47], a[28:31], v[128:131]
  v_mfma_f32_16x16x32_bf16 v[132:135], a[48:51], a[28:31], v[132:135]
  v_mfma_f32_16x16x32_bf16 v[136:139], a[52:55], a[28:31], v[136:139]
  v_mfma_f32_16x16x32_bf16 v[140:143], a[56:59], a[28:31], v[140:143]
  s_waitcnt lgkmcnt(3)
  v_mfma_f32_16x16x32_bf16 v[144:147], a[36:39], a[0:3], v[144:147]
  ds_read_b128 a[28:31], v1 offset:38592
  v_mfma_f32_16x16x32_bf16 v[148:151], a[40:43], a[0:3], v[148:151]
  v_mfma_f32_16x16x32_bf16 v[152:155], a[44:47], a[0:3], v[152:155]
  v_mfma_f32_16x16x32_bf16 v[156:159], a[48:51], a[0:3], v[156:159]
  v_mfma_f32_16x16x32_bf16 v[160:163], a[52:55], a[0:3], v[160:163]
  v_mfma_f32_16x16x32_bf16 v[164:167], a[56:59], a[0:3], v[164:167]
  s_waitcnt lgkmcnt(3)
  v_mfma_f32_16x16x32_bf16 v[168:171], a[36:39], a[16:19], v[168:171]
  ds_read_b128 a[0:3], v2 offset:192
  v_mfma_f32_16x16x32_bf16 v[172:175], a[40:43], a[16:19], v[172:175]
  v_mfma_f32_16x16x32_bf16 v[176:179], a[44:47], a[16:19], v[176:179]
  v_mfma_f32_16x16x32_bf16 v[180:183], a[48:51], a[16:19], v[180:183]
  v_mfma_f32_16x16x32_bf16 v[184:187], a[52:55], a[16:19], v[184:187]
  v_mfma_f32_16x16x32_bf16 v[188:191], a[56:59], a[16:19], v[188:191]
  s_waitcnt lgkmcnt(3)
  v_mfma_f32_16x16x32_bf16 v[192:195], a[36:39], a[20:23], v[192:195]
  ds_read_b128 a[16:19], v0 offset:256
  v_mfma_f32_16x16x32_bf16 v[196:199], a[40:43], a[20:23], v[196:199]
  v_mfma_f32_16x16x32_bf16 v[200:203], a[44:47], a[20:23], v[200:203]
  v_mfma_f32_16x16x32_bf16 v[204:207], a[48:51], a[20:23], v[204:207]
  v_mfma_f32_16x16x32_bf16 v[208:211], a[52:55], a[20:23], v[208:211]
  v_mfma_f32_16x16x32_bf16 v[212:215], a[56:59], a[20:23], v[212:215]
  s_waitcnt lgkmcnt(3)
  v_mfma_f32_16x16x32_bf16 v[216:219], a[36:39], a[24:27], v[216:219]
  ds_read_b128 a[20:23], v0 offset:13056
  v_mfma_f32_16x16x32_bf16 v[220:223], a[40:43], a[24:27], v[220:223]
  v_mfma_f32_16x16x32_bf16 v[224:227], a[44:47], a[24:27], v[224:227]
  v_mfma_f32_16x16x32_bf16 v[228:231], a[48:51], a[24:27], v[228:231]
  v_mfma_f32_16x16x32_bf16 v[232:235], a[52:55], a[24:27], v[232:235]
  v_mfma_f32_16x16x32_bf16 v[236:239], a[56:59], a[24:27], v[236:239]
  s_waitcnt lgkmcnt(3)
  v_mfma_f32_16x16x32_bf16 v[240:243], a[36:39], a[28:31], v[240:243]
  ds_read_b128 a[24:27], v0 offset:25856
  v_mfma_f32_16x16x32_bf16 v[244:247], a[40:43], a[28:31], v[244:247]
  v_mfma_f32_16x16x32_bf16 v[248:251], a[44:47], a[28:31], v[248:251]
  v_mfma_f32_16x16x32_bf16 v[252:255], a[48:51], a[28:31], v[252:255]
  v_mfma_f32_16x16x32_bf16 a[84:87], a[52:55], a[28:31], a[84:87]
  v_mfma_f32_16x16x32_bf16 a[88:91], a[56:59], a[28:31], a[88:91]
  s_waitcnt lgkmcnt(3)
  v_mfma_f32_16x16x32_bf16 a[92:95], a[36:39], a[0:3], a[92:95]
  ds_read_b128 a[28:31], v0 offset:38656
  v_mfma_f32_16x16x32_bf16 a[96:99], a[40:43], a[0:3], a[96:99]
  buffer_load_dwordx4 a[36:39], v3, s[8:11], s26 offen offset:0
  v_mfma_f32_16x16x32_bf16 a[100:103], a[44:47], a[0:3], a[100:103]
  buffer_load_dwordx4 a[40:43], v3, s[8:11], s26 offen offset:1024
  v_mfma_f32_16x16x32_bf16 a[104:107], a[48:51], a[0:3], a[104:107]
  buffer_load_dwordx4 a[44:47], v3, s[8:11], s26 offen offset:2048
  v_mfma_f32_16x16x32_bf16 a[108:111], a[52:55], a[0:3], a[108:111]
  v_mfma_f32_16x16x32_bf16 a[112:115], a[56:59], a[0:3], a[112:115]
  s_waitcnt vmcnt(11) lgkmcnt(3)
  v_mfma_f32_16x16x32_bf16 v[48:51], a[60:63], a[16:19], v[48:51]
  buffer_load_dwordx4 a[48:51], v3, s[8:11], s26 offen offset:3072
  s_addk_i32 s26, 6144
  v_mfma_f32_16x16x32_bf16 v[52:55], a[64:67], a[16:19], v[52:55]
  ds_read_b128 a[0:3], v0 offset:51456
  v_mfma_f32_16x16x32_bf16 v[56:59], a[68:71], a[16:19], v[56:59]
  v_mfma_f32_16x16x32_bf16 v[60:63], a[72:75], a[16:19], v[60:63]
  v_mfma_f32_16x16x32_bf16 v[64:67], a[76:79], a[16:19], v[64:67]
  buffer_load_dwordx4 a[52:55], v3, s[8:11], s27 offen offset:0
  v_mfma_f32_16x16x32_bf16 v[68:71], a[80:83], a[16:19], v[68:71]
  s_waitcnt lgkmcnt(3)
  v_mfma_f32_16x16x32_bf16 v[72:75], a[60:63], a[20:23], v[72:75]
  ds_read_b128 a[16:19], v1 offset:256
  v_mfma_f32_16x16x32_bf16 v[76:79], a[64:67], a[20:23], v[76:79]
  v_mfma_f32_16x16x32_bf16 v[80:83], a[68:71], a[20:23], v[80:83]
  buffer_load_dwordx4 a[56:59], v3, s[8:11], s27 offen offset:1024
  s_addk_i32 s27, 6144
  s_cmp_eq_u32 s31, 2
  v_mfma_f32_16x16x32_bf16 v[84:87], a[72:75], a[20:23], v[84:87]
  s_cselect_b32 s70, s30, s67
  v_mfma_f32_16x16x32_bf16 v[88:91], a[76:79], a[20:23], v[88:91]
  v_mfma_f32_16x16x32_bf16 v[92:95], a[80:83], a[20:23], v[92:95]
  buffer_load_dword v47, s[4:7], s69 offen lds
  s_mov_b32 m0, s68
  s_waitcnt lgkmcnt(3)
  v_mfma_f32_16x16x32_bf16 v[96:99], a[60:63], a[24:27], v[96:99]
  ds_read_b128 a[20:23], v1 offset:13056
  v_mfma_f32_16x16x32_bf16 v[100:103], a[64:67], a[24:27], v[100:103]
  v_mfma_f32_16x16x32_bf16 v[104:107], a[68:71], a[24:27], v[104:107]
  v_mfma_f32_16x16x32_bf16 v[108:111], a[72:75], a[24:27], v[108:111]
  v_mfma_f32_16x16x32_bf16 v[112:115], a[76:79], a[24:27], v[112:115]
  v_mfma_f32_16x16x32_bf16 v[116:119], a[80:83], a[24:27], v[116:119]
  s_waitcnt lgkmcnt(3)
  v_mfma_f32_16x16x32_bf16 v[120:123], a[60:63], a[28:31], v[120:123]
  ds_read_b128 a[24:27], v1 offset:25856
  v_mfma_f32_16x16x32_bf16 v[124:127], a[64:67], a[28:31], v[124:127]
  v_mfma_f32_16x16x32_bf16 v[128:131], a[68:71], a[28:31], v[128:131]
  v_mfma_f32_16x16x32_bf16 v[132:135], a[72:75], a[28:31], v[132:135]
  v_mfma_f32_16x16x32_bf16 v[136:139], a[76:79], a[28:31], v[136:139]
  v_mfma_f32_16x16x32_bf16 v[140:143], a[80:83], a[28:31], v[140:143]
  s_waitcnt lgkmcnt(3)
  v_mfma_f32_16x16x32_bf16 v[144:147], a[60:63], a[0:3], v[144:147]
  ds_read_b128 a[28:31], v1 offset:38656
  v_mfma_f32_16x16x32_bf16 v[148:151], a[64:67], a[0:3], v[148:151]
  v_mfma_f32_16x16x32_bf16 v[152:155], a[68:71], a[0:3], v[152:155]
  v_mfma_f32_16x16x32_bf16 v[156:159], a[72:75], a[0:3], v[156:159]
  v_mfma_f32_16x16x32_bf16 v[160:163], a[76:79], a[0:3], v[160:163]
  v_mfma_f32_16x16x32_bf16 v[164:167], a[80:83], a[0:3], v[164:167]
  s_waitcnt lgkmcnt(3)
  v_mfma_f32_16x16x32_bf16 v[168:171], a[60:63], a[16:19], v[168:171]
  ds_read_b128 a[0:3], v2 offset:256
  v_mfma_f32_16x16x32_bf16 v[172:175], a[64:67], a[16:19], v[172:175]
  v_mfma_f32_16x16x32_bf16 v[176:179], a[68:71], a[16:19], v[176:179]
  v_mfma_f32_16x16x32_bf16 v[180:183], a[72:75], a[16:19], v[180:183]
  v_mfma_f32_16x16x32_bf16 v[184:187], a[76:79], a[16:19], v[184:187]
  v_mfma_f32_16x16x32_bf16 v[188:191], a[80:83], a[16:19], v[188:191]
  s_waitcnt lgkmcnt(3)
  v_mfma_f32_16x16x32_bf16 v[192:195], a[60:63], a[20:23], v[192:195]
  ds_read_b128 a[16:19], v0 offset:320
  v_mfma_f32_16x16x32_bf16 v[196:199], a[64:67], a[20:23], v[196:199]
  v_mfma_f32_16x16x32_bf16 v[200:203], a[68:71], a[20:23], v[200:203]
  v_mfma_f32_16x16x32_bf16 v[204:207], a[72:75], a[20:23], v[204:207]
  v_mfma_f32_16x16x32_bf16 v[208:211], a[76:79], a[20:23], v[208:211]
  v_mfma_f32_16x16x32_bf16 v[212:215], a[80:83], a[20:23], v[212:215]
  s_waitcnt lgkmcnt(3)
  v_mfma_f32_16x16x32_bf16 v[216:219], a[60:63], a[24:27], v[216:219]
  ds_read_b128 a[20:23], v0 offset:13120
  v_mfma_f32_16x16x32_bf16 v[220:223], a[64:67], a[24:27], v[220:223]
  v_mfma_f32_16x16x32_bf16 v[224:227], a[68:71], a[24:27], v[224:227]
  v_mfma_f32_16x16x32_bf16 v[228:231], a[72:75], a[24:27], v[228:231]
  v_mfma_f32_16x16x32_bf16 v[232:235], a[76:79], a[24:27], v[232:235]
  v_mfma_f32_16x16x32_bf16 v[236:239], a[80:83], a[24:27], v[236:239]
  s_waitcnt lgkmcnt(3)
  v_mfma_f32_16x16x32_bf16 v[240:243], a[60:63], a[28:31], v[240:243]
  ds_read_b128 a[24:27], v0 offset:25920
  v_mfma_f32_16x16x32_bf16 v[244:247], a[64:67], a[28:31], v[244:247]
  v_mfma_f32_16x16x32_bf16 v[248:251], a[68:71], a[28:31], v[248:251]
  v_mfma_f32_16x16x32_bf16 v[252:255], a[72:75], a[28:31], v[252:255]
  v_mfma_f32_16x16x32_bf16 a[84:87], a[76:79], a[28:31], a[84:87]
  v_mfma_f32_16x16x32_bf16 a[88:91], a[80:83], a[28:31], a[88:91]
  s_waitcnt lgkmcnt(3)
  v_mfma_f32_16x16x32_bf16 a[92:95], a[60:63], a[0:3], a[92:95]
  ds_read_b128 a[28:31], v0 offset:38720
  v_mfma_f32_16x16x32_bf16 a[96:99], a[64:67], a[0:3], a[96:99]
  buffer_load_dwordx4 a[60:63], v3, s[8:11], s26 offen offset:0
  v_mfma_f32_16x16x32_bf16 a[100:103], a[68:71], a[0:3], a[100:103]
  buffer_load_dwordx4 a[64:67], v3, s[8:11], s26 offen offset:1024
  v_mfma_f32_16x16x32_bf16 a[104:107], a[72:75], a[0:3], a[104:107]
  buffer_load_dwordx4 a[68:71], v3, s[8:11], s26 offen offset:2048
  v_mfma_f32_16x16x32_bf16 a[108:111], a[76:79], a[0:3], a[108:111]
  v_mfma_f32_16x16x32_bf16 a[112:115], a[80:83], a[0:3], a[112:115]
  s_waitcnt vmcnt(11) lgkmcnt(3)
  v_mfma_f32_16x16x32_bf16 v[48:51], a[32:35], a[16:19], v[48:51]
  buffer_load_dwordx4 a[72:75], v3, s[8:11], s26 offen offset:3072
  s_addk_i32 s26, 6144
  v_mfma_f32_16x16x32_bf16 v[52:55], a[236:239], a[16:19], v[52:55]
  ds_read_b128 a[0:3], v0 offset:51520
  v_mfma_f32_16x16x32_bf16 v[56:59], a[240:243], a[16:19], v[56:59]
  v_mfma_f32_16x16x32_bf16 v[60:63], a[244:247], a[16:19], v[60:63]
  v_mfma_f32_16x16x32_bf16 v[64:67], a[248:251], a[16:19], v[64:67]
  buffer_load_dwordx4 a[76:79], v3, s[8:11], s27 offen offset:0
  v_mfma_f32_16x16x32_bf16 v[68:71], a[252:255], a[16:19], v[68:71]
  s_waitcnt lgkmcnt(3)
  v_mfma_f32_16x16x32_bf16 v[72:75], a[32:35], a[20:23], v[72:75]
  ds_read_b128 a[16:19], v1 offset:320
  v_mfma_f32_16x16x32_bf16 v[76:79], a[236:239], a[20:23], v[76:79]
  v_mfma_f32_16x16x32_bf16 v[80:83], a[240:243], a[20:23], v[80:83]
  buffer_load_dwordx4 a[80:83], v3, s[8:11], s27 offen offset:1024
  s_addk_i32 s27, 6144
  s_add_u32 s29, s29, 290304
  v_mfma_f32_16x16x32_bf16 v[84:87], a[244:247], a[20:23], v[84:87]
  s_max_i32 s30, s29, 0
  s_cmp_ge_u32 s63, 972
  s_cselect_b32 s30, s67, s30
  v_mfma_f32_16x16x32_bf16 v[88:91], a[248:251], a[20:23], v[88:91]
  s_cmp_eq_u32 s31, 0
  s_cselect_b32 s69, s30, s67
  v_mfma_f32_16x16x32_bf16 v[92:95], a[252:255], a[20:23], v[92:95]
  buffer_load_dword v47, s[4:7], s70 offen lds
  s_mov_b32 m0, s68
  s_waitcnt lgkmcnt(3)
  v_mfma_f32_16x16x32_bf16 v[96:99], a[32:35], a[24:27], v[96:99]
  ds_read_b128 a[20:23], v1 offset:13120
  v_mfma_f32_16x16x32_bf16 v[100:103], a[236:239], a[24:27], v[100:103]
  v_mfma_f32_16x16x32_bf16 v[104:107], a[240:243], a[24:27], v[104:107]
  v_mfma_f32_16x16x32_bf16 v[108:111], a[244:247], a[24:27], v[108:111]
  v_mfma_f32_16x16x32_bf16 v[112:115], a[248:251], a[24:27], v[112:115]
  v_mfma_f32_16x16x32_bf16 v[116:119], a[252:255], a[24:27], v[116:119]
  s_waitcnt lgkmcnt(3)
  v_mfma_f32_16x16x32_bf16 v[120:123], a[32:35], a[28:31], v[120:123]
  ds_read_b128 a[24:27], v1 offset:25920
  v_mfma_f32_16x16x32_bf16 v[124:127], a[236:239], a[28:31], v[124:127]
  v_mfma_f32_16x16x32_bf16 v[128:131], a[240:243], a[28:31], v[128:131]
  v_mfma_f32_16x16x32_bf16 v[132:135], a[244:247], a[28:31], v[132:135]
  v_mfma_f32_16x16x32_bf16 v[136:139], a[248:251], a[28:31], v[136:139]
  v_mfma_f32_16x16x32_bf16 v[140:143], a[252:255], a[28:31], v[140:143]
  s_waitcnt lgkmcnt(3)
  v_mfma_f32_16x16x32_bf16 v[144:147], a[32:35], a[0:3], v[144:147]
  ds_read_b128 a[28:31], v1 offset:38720
  v_mfma_f32_16x16x32_bf16 v[148:151], a[236:239], a[0:3], v[148:151]
  v_mfma_f32_16x16x32_bf16 v[152:155], a[240:243], a[0:3], v[152:155]
  v_mfma_f32_16x16x32_bf16 v[156:159], a[244:247], a[0:3], v[156:159]
  v_mfma_f32_16x16x32_bf16 v[160:163], a[248:251], a[0:3], v[160:163]
  v_mfma_f32_16x16x32_bf16 v[164:167], a[252:255], a[0:3], v[164:167]
  s_waitcnt lgkmcnt(3)
  v_mfma_f32_16x16x32_bf16 v[168:171], a[32:35], a[16:19], v[168:171]
  ds_read_b128 a[0:3], v2 offset:320
  v_mfma_f32_16x16x32_bf16 v[172:175], a[236:239], a[16:19], v[172:175]
  v_mfma_f32_16x16x32_bf16 v[176:179], a[240:243], a[16:19], v[176:179]
  v_mfma_f32_16x16x32_bf16 v[180:183], a[244:247], a[16:19], v[180:183]
  v_mfma_f32_16x16x32_bf16 v[184:187], a[248:251], a[16:19], v[184:187]
  v_mfma_f32_16x16x32_bf16 v[188:191], a[252:255], a[16:19], v[188:191]
  s_waitcnt lgkmcnt(3)
  v_mfma_f32_16x16x32_bf16 v[192:195], a[32:35], a[20:23], v[192:195]
  ds_read_b128 a[16:19], v0 offset:384
  v_mfma_f32_16x16x32_bf16 v[196:199], a[236:239], a[20:23], v[196:199]
  v_mfma_f32_16x16x32_bf16 v[200:203], a[240:243], a[20:23], v[200:203]
  v_mfma_f32_16x16x32_bf16 v[204:207], a[244:247], a[20:23], v[204:207]
  v_mfma_f32_16x16x32_bf16 v[208:211], a[248:251], a[20:23], v[208:211]
  v_mfma_f32_16x16x32_bf16 v[212:215], a[252:255], a[20:23], v[212:215]
  s_waitcnt lgkmcnt(3)
  v_mfma_f32_16x16x32_bf16 v[216:219], a[32:35], a[24:27], v[216:219]
  ds_read_b128 a[20:23], v0 offset:13184
  v_mfma_f32_16x16x32_bf16 v[220:223], a[236:239], a[24:27], v[220:223]
  v_mfma_f32_16x16x32_bf16 v[224:227], a[240:243], a[24:27], v[224:227]
  v_mfma_f32_16x16x32_bf16 v[228:231], a[244:247], a[24:27], v[228:231]
  v_mfma_f32_16x16x32_bf16 v[232:235], a[248:251], a[24:27], v[232:235]
  v_mfma_f32_16x16x32_bf16 v[236:239], a[252:255], a[24:27], v[236:239]
  s_waitcnt lgkmcnt(3)
  v_mfma_f32_16x16x32_bf16 v[240:243], a[32:35], a[28:31], v[240:243]
  ds_read_b128 a[24:27], v0 offset:25984
  v_mfma_f32_16x16x32_bf16 v[244:247], a[236:239], a[28:31], v[244:247]
  v_mfma_f32_16x16x32_bf16 v[248:251], a[240:243], a[28:31], v[248:251]
  v_mfma_f32_16x16x32_bf16 v[252:255], a[244:247], a[28:31], v[252:255]
  v_mfma_f32_16x16x32_bf16 a[84:87], a[248:251], a[28:31], a[84:87]
  v_mfma_f32_16x16x32_bf16 a[88:91], a[252:255], a[28:31], a[88:91]
  s_waitcnt lgkmcnt(3)
  v_mfma_f32_16x16x32_bf16 a[92:95], a[32:35], a[0:3], a[92:95]
  ds_read_b128 a[28:31], v0 offset:38784
  v_mfma_f32_16x16x32_bf16 a[96:99], a[236:239], a[0:3], a[96:99]
  buffer_load_dwordx4 a[32:35], v3, s[8:11], s26 offen offset:0
  v_mfma_f32_16x16x32_bf16 a[100:103], a[240:243], a[0:3], a[100:103]
  buffer_load_dwordx4 a[236:239], v3, s[8:11], s26 offen offset:1024
  v_mfma_f32_16x16x32_bf16 a[104:107], a[244:247], a[0:3], a[104:107]
  buffer_load_dwordx4 a[240:243], v3, s[8:11], s26 offen offset:2048
  v_mfma_f32_16x16x32_bf16 a[108:111], a[248:251], a[0:3], a[108:111]
  v_mfma_f32_16x16x32_bf16 a[112:115], a[252:255], a[0:3], a[112:115]
  s_waitcnt vmcnt(11) lgkmcnt(3)
  v_mfma_f32_16x16x32_bf16 v[48:51], a[36:39], a[16:19], v[48:51]
  buffer_load_dwordx4 a[244:247], v3, s[8:11], s26 offen offset:3072
  s_addk_i32 s26, 6144
  v_mfma_f32_16x16x32_bf16 v[52:55], a[40:43], a[16:19], v[52:55]
  ds_read_b128 a[0:3], v0 offset:51584
  v_mfma_f32_16x16x32_bf16 v[56:59], a[44:47], a[16:19], v[56:59]
  v_mfma_f32_16x16x32_bf16 v[60:63], a[48:51], a[16:19], v[60:63]
  v_mfma_f32_16x16x32_bf16 v[64:67], a[52:55], a[16:19], v[64:67]
  buffer_load_dwordx4 a[248:251], v3, s[8:11], s27 offen offset:0
  v_mfma_f32_16x16x32_bf16 v[68:71], a[56:59], a[16:19], v[68:71]
  s_waitcnt lgkmcnt(3)
  v_mfma_f32_16x16x32_bf16 v[72:75], a[36:39], a[20:23], v[72:75]
  ds_read_b128 a[16:19], v1 offset:384
  v_mfma_f32_16x16x32_bf16 v[76:79], a[40:43], a[20:23], v[76:79]
  v_mfma_f32_16x16x32_bf16 v[80:83], a[44:47], a[20:23], v[80:83]
  buffer_load_dwordx4 a[252:255], v3, s[8:11], s27 offen offset:1024
  s_addk_i32 s27, 6144
  s_cmp_eq_u32 s31, 1
  v_mfma_f32_16x16x32_bf16 v[84:87], a[48:51], a[20:23], v[84:87]
  s_cselect_b32 s70, s30, s67
  v_mfma_f32_16x16x32_bf16 v[88:91], a[52:55], a[20:23], v[88:91]
  v_mfma_f32_16x16x32_bf16 v[92:95], a[56:59], a[20:23], v[92:95]
  buffer_load_dword v47, s[4:7], s69 offen lds
  s_mov_b32 m0, s68
  s_waitcnt lgkmcnt(3)
  v_mfma_f32_16x16x32_bf16 v[96:99], a[36:39], a[24:27], v[96:99]
  ds_read_b128 a[20:23], v1 offset:13184
  v_mfma_f32_16x16x32_bf16 v[100:103], a[40:43], a[24:27], v[100:103]
  v_mfma_f32_16x16x32_bf16 v[104:107], a[44:47], a[24:27], v[104:107]
  v_mfma_f32_16x16x32_bf16 v[108:111], a[48:51], a[24:27], v[108:111]
  v_mfma_f32_16x16x32_bf16 v[112:115], a[52:55], a[24:27], v[112:115]
  v_mfma_f32_16x16x32_bf16 v[116:119], a[56:59], a[24:27], v[116:119]
  s_waitcnt lgkmcnt(3)
  v_mfma_f32_16x16x32_bf16 v[120:123], a[36:39], a[28:31], v[120:123]
  ds_read_b128 a[24:27], v1 offset:25984
  v_mfma_f32_16x16x32_bf16 v[124:127], a[40:43], a[28:31], v[124:127]
  v_mfma_f32_16x16x32_bf16 v[128:131], a[44:47], a[28:31], v[128:131]
  v_mfma_f32_16x16x32_bf16 v[132:135], a[48:51], a[28:31], v[132:135]
  v_mfma_f32_16x16x32_bf16 v[136:139], a[52:55], a[28:31], v[136:139]
  v_mfma_f32_16x16x32_bf16 v[140:143], a[56:59], a[28:31], v[140:143]
  s_waitcnt lgkmcnt(3)
  v_mfma_f32_16x16x32_bf16 v[144:147], a[36:39], a[0:3], v[144:147]
  ds_read_b128 a[28:31], v1 offset:38784
  v_mfma_f32_16x16x32_bf16 v[148:151], a[40:43], a[0:3], v[148:151]
  v_mfma_f32_16x16x32_bf16 v[152:155], a[44:47], a[0:3], v[152:155]
  v_mfma_f32_16x16x32_bf16 v[156:159], a[48:51], a[0:3], v[156:159]
  v_mfma_f32_16x16x32_bf16 v[160:163], a[52:55], a[0:3], v[160:163]
  v_mfma_f32_16x16x32_bf16 v[164:167], a[56:59], a[0:3], v[164:167]
  s_waitcnt lgkmcnt(3)
  v_mfma_f32_16x16x32_bf16 v[168:171], a[36:39], a[16:19], v[168:171]
  ds_read_b128 a[0:3], v2 offset:384
  v_mfma_f32_16x16x32_bf16 v[172:175], a[40:43], a[16:19], v[172:175]
  v_mfma_f32_16x16x32_bf16 v[176:179], a[44:47], a[16:19], v[176:179]
  v_mfma_f32_16x16x32_bf16 v[180:183], a[48:51], a[16:19], v[180:183]
  v_mfma_f32_16x16x32_bf16 v[184:187], a[52:55], a[16:19], v[184:187]
  v_mfma_f32_16x16x32_bf16 v[188:191], a[56:59], a[16:19], v[188:191]
  s_waitcnt lgkmcnt(3)
  v_mfma_f32_16x16x32_bf16 v[192:195], a[36:39], a[20:23], v[192:195]
  ds_read_b128 a[16:19], v0 offset:448
  v_mfma_f32_16x16x32_bf16 v[196:199], a[40:43], a[20:23], v[196:199]
  v_mfma_f32_16x16x32_bf16 v[200:203], a[44:47], a[20:23], v[200:203]
  v_mfma_f32_16x16x32_bf16 v[204:207], a[48:51], a[20:23], v[204:207]
  v_mfma_f32_16x16x32_bf16 v[208:211], a[52:55], a[20:23], v[208:211]
  v_mfma_f32_16x16x32_bf16 v[212:215], a[56:59], a[20:23], v[212:215]
  s_waitcnt lgkmcnt(3)
  v_mfma_f32_16x16x32_bf16 v[216:219], a[36:39], a[24:27], v[216:219]
  ds_read_b128 a[20:23], v0 offset:13248
  v_mfma_f32_16x16x32_bf16 v[220:223], a[40:43], a[24:27], v[220:223]
  v_mfma_f32_16x16x32_bf16 v[224:227], a[44:47], a[24:27], v[224:227]
  v_mfma_f32_16x16x32_bf16 v[228:231], a[48:51], a[24:27], v[228:231]
  v_mfma_f32_16x16x32_bf16 v[232:235], a[52:55], a[24:27], v[232:235]
  v_mfma_f32_16x16x32_bf16 v[236:239], a[56:59], a[24:27], v[236:239]
  s_waitcnt lgkmcnt(3)
  v_mfma_f32_16x16x32_bf16 v[240:243], a[36:39], a[28:31], v[240:243]
  ds_read_b128 a[24:27], v0 offset:26048
  v_mfma_f32_16x16x32_bf16 v[244:247], a[40:43], a[28:31], v[244:247]
  v_mfma_f32_16x16x32_bf16 v[248:251], a[44:47], a[28:31], v[248:251]
  v_mfma_f32_16x16x32_bf16 v[252:255], a[48:51], a[28:31], v[252:255]
  v_mfma_f32_16x16x32_bf16 a[84:87], a[52:55], a[28:31], a[84:87]
  v_mfma_f32_16x16x32_bf16 a[88:91], a[56:59], a[28:31], a[88:91]
  s_waitcnt lgkmcnt(3)
  v_mfma_f32_16x16x32_bf16 a[92:95], a[36:39], a[0:3], a[92:95]
  ds_read_b128 a[28:31], v0 offset:38848
  v_mfma_f32_16x16x32_bf16 a[96:99], a[40:43], a[0:3], a[96:99]
  buffer_load_dwordx4 a[36:39], v3, s[8:11], s26 offen offset:0
  v_mfma_f32_16x16x32_bf16 a[100:103], a[44:47], a[0:3], a[100:103]
  buffer_load_dwordx4 a[40:43], v3, s[8:11], s26 offen offset:1024
  v_mfma_f32_16x16x32_bf16 a[104:107], a[48:51], a[0:3], a[104:107]
  buffer_load_dwordx4 a[44:47], v3, s[8:11], s26 offen offset:2048
  v_mfma_f32_16x16x32_bf16 a[108:111], a[52:55], a[0:3], a[108:111]
  v_mfma_f32_16x16x32_bf16 a[112:115], a[56:59], a[0:3], a[112:115]
  s_waitcnt vmcnt(11) lgkmcnt(3)
  v_mfma_f32_16x16x32_bf16 v[48:51], a[60:63], a[16:19], v[48:51]
  buffer_load_dwordx4 a[48:51], v3, s[8:11], s26 offen offset:3072
  s_addk_i32 s26, 6144
  v_mfma_f32_16x16x32_bf16 v[52:55], a[64:67], a[16:19], v[52:55]
  ds_read_b128 a[0:3], v0 offset:51648
  v_mfma_f32_16x16x32_bf16 v[56:59], a[68:71], a[16:19], v[56:59]
  v_mfma_f32_16x16x32_bf16 v[60:63], a[72:75], a[16:19], v[60:63]
  v_mfma_f32_16x16x32_bf16 v[64:67], a[76:79], a[16:19], v[64:67]
  buffer_load_dwordx4 a[52:55], v3, s[8:11], s27 offen offset:0
  v_mfma_f32_16x16x32_bf16 v[68:71], a[80:83], a[16:19], v[68:71]
  s_waitcnt lgkmcnt(3)
  v_mfma_f32_16x16x32_bf16 v[72:75], a[60:63], a[20:23], v[72:75]
  ds_read_b128 a[16:19], v1 offset:448
  v_mfma_f32_16x16x32_bf16 v[76:79], a[64:67], a[20:23], v[76:79]
  v_mfma_f32_16x16x32_bf16 v[80:83], a[68:71], a[20:23], v[80:83]
  buffer_load_dwordx4 a[56:59], v3, s[8:11], s27 offen offset:1024
  s_addk_i32 s27, 6144
  s_cmp_eq_u32 s31, 2
  v_mfma_f32_16x16x32_bf16 v[84:87], a[72:75], a[20:23], v[84:87]
  s_cselect_b32 s69, s30, s67
  v_mfma_f32_16x16x32_bf16 v[88:91], a[76:79], a[20:23], v[88:91]
  v_mfma_f32_16x16x32_bf16 v[92:95], a[80:83], a[20:23], v[92:95]
  buffer_load_dword v47, s[4:7], s70 offen lds
  s_mov_b32 m0, s68
  s_waitcnt lgkmcnt(3)
  v_mfma_f32_16x16x32_bf16 v[96:99], a[60:63], a[24:27], v[96:99]
  ds_read_b128 a[20:23], v1 offset:13248
  v_mfma_f32_16x16x32_bf16 v[100:103], a[64:67], a[24:27], v[100:103]
  v_mfma_f32_16x16x32_bf16 v[104:107], a[68:71], a[24:27], v[104:107]
  v_mfma_f32_16x16x32_bf16 v[108:111], a[72:75], a[24:27], v[108:111]
  v_mfma_f32_16x16x32_bf16 v[112:115], a[76:79], a[24:27], v[112:115]
  v_mfma_f32_16x16x32_bf16 v[116:119], a[80:83], a[24:27], v[116:119]
  s_waitcnt lgkmcnt(3)
  v_mfma_f32_16x16x32_bf16 v[120:123], a[60:63], a[28:31], v[120:123]
  ds_read_b128 a[24:27], v1 offset:26048
  v_mfma_f32_16x16x32_bf16 v[124:127], a[64:67], a[28:31], v[124:127]
  v_mfma_f32_16x16x32_bf16 v[128:131], a[68:71], a[28:31], v[128:131]
  v_mfma_f32_16x16x32_bf16 v[132:135], a[72:75], a[28:31], v[132:135]
  v_mfma_f32_16x16x32_bf16 v[136:139], a[76:79], a[28:31], v[136:139]
  v_mfma_f32_16x16x32_bf16 v[140:143], a[80:83], a[28:31], v[140:143]
  s_waitcnt lgkmcnt(3)
  v_mfma_f32_16x16x32_bf16 v[144:147], a[60:63], a[0:3], v[144:147]
  ds_read_b128 a[28:31], v1 offset:38848
  v_mfma_f32_16x16x32_bf16 v[148:151], a[64:67], a[0:3], v[148:151]
  v_mfma_f32_16x16x32_bf16 v[152:155], a[68:71], a[0:3], v[152:155]
  v_mfma_f32_16x16x32_bf16 v[156:159], a[72:75], a[0:3], v[156:159]
  v_mfma_f32_16x16x32_bf16 v[160:163], a[76:79], a[0:3], v[160:163]
  v_mfma_f32_16x16x32_bf16 v[164:167], a[80:83], a[0:3], v[164:167]
  s_waitcnt lgkmcnt(3)
  v_mfma_f32_16x16x32_bf16 v[168:171], a[60:63], a[16:19], v[168:171]
  ds_read_b128 a[0:3], v2 offset:448
  v_mfma_f32_16x16x32_bf16 v[172:175], a[64:67], a[16:19], v[172:175]
  v_mfma_f32_16x16x32_bf16 v[176:179], a[68:71], a[16:19], v[176:179]
  v_mfma_f32_16x16x32_bf16 v[180:183], a[72:75], a[16:19], v[180:183]
  v_mfma_f32_16x16x32_bf16 v[184:187], a[76:79], a[16:19], v[184:187]
  v_mfma_f32_16x16x32_bf16 v[188:191], a[80:83], a[16:19], v[188:191]
  s_waitcnt lgkmcnt(3)
  v_mfma_f32_16x16x32_bf16 v[192:195], a[60:63], a[20:23], v[192:195]
  ds_read_b128 a[16:19], v0 offset:512
  v_mfma_f32_16x16x32_bf16 v[196:199], a[64:67], a[20:23], v[196:199]
  v_mfma_f32_16x16x32_bf16 v[200:203], a[68:71], a[20:23], v[200:203]
  v_mfma_f32_16x16x32_bf16 v[204:207], a[72:75], a[20:23], v[204:207]
  v_mfma_f32_16x16x32_bf16 v[208:211], a[76:79], a[20:23], v[208:211]
  v_mfma_f32_16x16x32_bf16 v[212:215], a[80:83], a[20:23], v[212:215]
  s_waitcnt lgkmcnt(3)
  v_mfma_f32_16x16x32_bf16 v[216:219], a[60:63], a[24:27], v[216:219]
  ds_read_b128 a[20:23], v0 offset:13312
  v_mfma_f32_16x16x32_bf16 v[220:223], a[64:67], a[24:27], v[220:223]
  v_mfma_f32_16x16x32_bf16 v[224:227], a[68:71], a[24:27], v[224:227]
  v_mfma_f32_16x16x32_bf16 v[228:231], a[72:75], a[24:27], v[228:231]
  v_mfma_f32_16x16x32_bf16 v[232:235], a[76:79], a[24:27], v[232:235]
  v_mfma_f32_16x16x32_bf16 v[236:239], a[80:83], a[24:27], v[236:239]
  s_waitcnt lgkmcnt(3)
  v_mfma_f32_16x16x32_bf16 v[240:243], a[60:63], a[28:31], v[240:243]
  ds_read_b128 a[24:27], v0 offset:26112
  v_mfma_f32_16x16x32_bf16 v[244:247], a[64:67], a[28:31], v[244:247]
  v_mfma_f32_16x16x32_bf16 v[248:251], a[68:71], a[28:31], v[248:251]
  v_mfma_f32_16x16x32_bf16 v[252:255], a[72:75], a[28:31], v[252:255]
  v_mfma_f32_16x16x32_bf16 a[84:87], a[76:79], a[28:31], a[84:87]
  v_mfma_f32_16x16x32_bf16 a[88:91], a[80:83], a[28:31], a[88:91]
  s_waitcnt lgkmcnt(3)
  v_mfma_f32_16x16x32_bf16 a[92:95], a[60:63], a[0:3], a[92:95]
  ds_read_b128 a[28:31], v0 offset:38912
  v_mfma_f32_16x16x32_bf16 a[96:99], a[64:67], a[0:3], a[96:99]
  buffer_load_dwordx4 a[60:63], v3, s[8:11], s26 offen offset:0
  v_mfma_f32_16x16x32_bf16 a[100:103], a[68:71], a[0:3], a[100:103]
  buffer_load_dwordx4 a[64:67], v3, s[8:11], s26 offen offset:1024
  v_mfma_f32_16x16x32_bf16 a[104:107], a[72:75], a[0:3], a[104:107]
  buffer_load_dwordx4 a[68:71], v3, s[8:11], s26 offen offset:2048
  v_mfma_f32_16x16x32_bf16 a[108:111], a[76:79], a[0:3], a[108:111]
  v_mfma_f32_16x16x32_bf16 a[112:115], a[80:83], a[0:3], a[112:115]
  s_waitcnt vmcnt(11) lgkmcnt(3)
  v_mfma_f32_16x16x32_bf16 v[48:51], a[32:35], a[16:19], v[48:51]
  buffer_load_dwordx4 a[72:75], v3, s[8:11], s26 offen offset:3072
  s_addk_i32 s26, 6144
  v_mfma_f32_16x16x32_bf16 v[52:55], a[236:239], a[16:19], v[52:55]
  ds_read_b128 a[0:3], v0 offset:51712
  v_mfma_f32_16x16x32_bf16 v[56:59], a[240:243], a[16:19], v[56:59]
  v_mfma_f32_16x16x32_bf16 v[60:63], a[244:247], a[16:19], v[60:63]
  v_mfma_f32_16x16x32_bf16 v[64:67], a[248:251], a[16:19], v[64:67]
  buffer_load_dwordx4 a[76:79], v3, s[8:11], s27 offen offset:0
  v_mfma_f32_16x16x32_bf16 v[68:71], a[252:255], a[16:19], v[68:71]
  s_waitcnt lgkmcnt(3)
  v_mfma_f32_16x16x32_bf16 v[72:75], a[32:35], a[20:23], v[72:75]
  ds_read_b128 a[16:19], v1 offset:512
  v_mfma_f32_16x16x32_bf16 v[76:79], a[236:239], a[20:23], v[76:79]
  v_mfma_f32_16x16x32_bf16 v[80:83], a[240:243], a[20:23], v[80:83]
  buffer_load_dwordx4 a[80:83], v3, s[8:11], s27 offen offset:1024
  s_addk_i32 s27, 6144
  s_add_u32 s29, s29, 290304
  v_mfma_f32_16x16x32_bf16 v[84:87], a[244:247], a[20:23], v[84:87]
  s_max_i32 s30, s29, 0
  s_cmp_ge_u32 s63, 972
  s_cselect_b32 s30, s67, s30
  v_mfma_f32_16x16x32_bf16 v[88:91], a[248:251], a[20:23], v[88:91]
  s_cmp_eq_u32 s31, 0
  s_cselect_b32 s70, s30, s67
  s_cmp_eq_u32 s31, 1
  v_mfma_f32_16x16x32_bf16 v[92:95], a[252:255], a[20:23], v[92:95]
  buffer_load_dword v47, s[4:7], s69 offen lds
  s_mov_b32 m0, s68
  s_cselect_b32 s69, s30, s67
  s_waitcnt lgkmcnt(3)
  v_mfma_f32_16x16x32_bf16 v[96:99], a[32:35], a[24:27], v[96:99]
  ds_read_b128 a[20:23], v1 offset:13312
  v_mfma_f32_16x16x32_bf16 v[100:103], a[236:239], a[24:27], v[100:103]
  v_mfma_f32_16x16x32_bf16 v[104:107], a[240:243], a[24:27], v[104:107]
  v_mfma_f32_16x16x32_bf16 v[108:111], a[244:247], a[24:27], v[108:111]
  v_mfma_f32_16x16x32_bf16 v[112:115], a[248:251], a[24:27], v[112:115]
  v_mfma_f32_16x16x32_bf16 v[116:119], a[252:255], a[24:27], v[116:119]
  s_waitcnt lgkmcnt(3)
  v_mfma_f32_16x16x32_bf16 v[120:123], a[32:35], a[28:31], v[120:123]
  ds_read_b128 a[24:27], v1 offset:26112
  v_mfma_f32_16x16x32_bf16 v[124:127], a[236:239], a[28:31], v[124:127]
  v_mfma_f32_16x16x32_bf16 v[128:131], a[240:243], a[28:31], v[128:131]
  v_mfma_f32_16x16x32_bf16 v[132:135], a[244:247], a[28:31], v[132:135]
  v_mfma_f32_16x16x32_bf16 v[136:139], a[248:251], a[28:31], v[136:139]
  v_mfma_f32_16x16x32_bf16 v[140:143], a[252:255], a[28:31], v[140:143]
  s_waitcnt lgkmcnt(3)
  v_mfma_f32_16x16x32_bf16 v[144:147], a[32:35], a[0:3], v[144:147]
  ds_read_b128 a[28:31], v1 offset:38912
  v_mfma_f32_16x16x32_bf16 v[148:151], a[236:239], a[0:3], v[148:151]
  v_mfma_f32_16x16x32_bf16 v[152:155], a[240:243], a[0:3], v[152:155]
  v_mfma_f32_16x16x32_bf16 v[156:159], a[244:247], a[0:3], v[156:159]
  v_mfma_f32_16x16x32_bf16 v[160:163], a[248:251], a[0:3], v[160:163]
  v_mfma_f32_16x16x32_bf16 v[164:167], a[252:255], a[0:3], v[164:167]
  s_waitcnt lgkmcnt(3)
  v_mfma_f32_16x16x32_bf16 v[168:171], a[32:35], a[16:19], v[168:171]
  ds_read_b128 a[0:3], v2 offset:512
  v_mfma_f32_16x16x32_bf16 v[172:175], a[236:239], a[16:19], v[172:175]
  v_mfma_f32_16x16x32_bf16 v[176:179], a[240:243], a[16:19], v[176:179]
  v_mfma_f32_16x16x32_bf16 v[180:183], a[244:247], a[16:19], v[180:183]
  v_mfma_f32_16x16x32_bf16 v[184:187], a[248:251], a[16:19], v[184:187]
  v_mfma_f32_16x16x32_bf16 v[188:191], a[252:255], a[16:19], v[188:191]
  s_waitcnt lgkmcnt(3)
  v_mfma_f32_16x16x32_bf16 v[192:195], a[32:35], a[20:23], v[192:195]
  ds_read_b128 a[16:19], v0 offset:576
  v_mfma_f32_16x16x32_bf16 v[196:199], a[236:239], a[20:23], v[196:199]
  v_mfma_f32_16x16x32_bf16 v[200:203], a[240:243], a[20:23], v[200:203]
  v_mfma_f32_16x16x32_bf16 v[204:207], a[244:247], a[20:23], v[204:207]
  v_mfma_f32_16x16x32_bf16 v[208:211], a[248:251], a[20:23], v[208:211]
  v_mfma_f32_16x16x32_bf16 v[212:215], a[252:255], a[20:23], v[212:215]
  s_waitcnt lgkmcnt(3)
  v_mfma_f32_16x16x32_bf16 v[216:219], a[32:35], a[24:27], v[216:219]
  ds_read_b128 a[20:23], v0 offset:13376
  v_mfma_f32_16x16x32_bf16 v[220:223], a[236:239], a[24:27], v[220:223]
  v_mfma_f32_16x16x32_bf16 v[224:227], a[240:243], a[24:27], v[224:227]
  v_mfma_f32_16x16x32_bf16 v[228:231], a[244:247], a[24:27], v[228:231]
  v_mfma_f32_16x16x32_bf16 v[232:235], a[248:251], a[24:27], v[232:235]
  v_mfma_f32_16x16x32_bf16 v[236:239], a[252:255], a[24:27], v[236:239]
  s_waitcnt lgkmcnt(3)
  v_mfma_f32_16x16x32_bf16 v[240:243], a[32:35], a[28:31], v[240:243]
  ds_read_b128 a[24:27], v0 offset:26176
  v_mfma_f32_16x16x32_bf16 v[244:247], a[236:239], a[28:31], v[244:247]
  v_mfma_f32_16x16x32_bf16 v[248:251], a[240:243], a[28:31], v[248:251]
  v_mfma_f32_16x16x32_bf16 v[252:255], a[244:247], a[28:31], v[252:255]
  v_mfma_f32_16x16x32_bf16 a[84:87], a[248:251], a[28:31], a[84:87]
  v_mfma_f32_16x16x32_bf16 a[88:91], a[252:255], a[28:31], a[88:91]
  s_waitcnt lgkmcnt(3)
  v_mfma_f32_16x16x32_bf16 a[92:95], a[32:35], a[0:3], a[92:95]
  ds_read_b128 a[28:31], v0 offset:38976
  v_mfma_f32_16x16x32_bf16 a[96:99], a[236:239], a[0:3], a[96:99]
  buffer_load_dwordx4 a[32:35], v3, s[8:11], s26 offen offset:0
  v_mfma_f32_16x16x32_bf16 a[100:103], a[240:243], a[0:3], a[100:103]
  buffer_load_dwordx4 a[236:239], v3, s[8:11], s26 offen offset:1024
  v_mfma_f32_16x16x32_bf16 a[104:107], a[244:247], a[0:3], a[104:107]
  buffer_load_dwordx4 a[240:243], v3, s[8:11], s26 offen offset:2048
  v_mfma_f32_16x16x32_bf16 a[108:111], a[248:251], a[0:3], a[108:111]
  v_mfma_f32_16x16x32_bf16 a[112:115], a[252:255], a[0:3], a[112:115]
  s_waitcnt vmcnt(11) lgkmcnt(3)
  v_mfma_f32_16x16x32_bf16 v[48:51], a[36:39], a[16:19], v[48:51]
  buffer_load_dwordx4 a[244:247], v3, s[8:11], s26 offen offset:3072
  s_mov_b32 s26, 147456
  v_mfma_f32_16x16x32_bf16 v[52:55], a[40:43], a[16:19], v[52:55]
  ds_read_b128 a[0:3], v0 offset:51776
  v_mfma_f32_16x16x32_bf16 v[56:59], a[44:47], a[16:19], v[56:59]
  v_mfma_f32_16x16x32_bf16 v[60:63], a[48:51], a[16:19], v[60:63]
  v_mfma_f32_16x16x32_bf16 v[64:67], a[52:55], a[16:19], v[64:67]
  buffer_load_dwordx4 a[248:251], v3, s[8:11], s27 offen offset:0
  v_mfma_f32_16x16x32_bf16 v[68:71], a[56:59], a[16:19], v[68:71]
  s_waitcnt lgkmcnt(3)
  v_mfma_f32_16x16x32_bf16 v[72:75], a[36:39], a[20:23], v[72:75]
  ds_read_b128 a[16:19], v1 offset:576
  v_mfma_f32_16x16x32_bf16 v[76:79], a[40:43], a[20:23], v[76:79]
  v_mfma_f32_16x16x32_bf16 v[80:83], a[44:47], a[20:23], v[80:83]
  buffer_load_dwordx4 a[252:255], v3, s[8:11], s27 offen offset:1024
  s_mov_b32 s27, 151552
  v_mfma_f32_16x16x32_bf16 v[84:87], a[48:51], a[20:23], v[84:87]
  v_mfma_f32_16x16x32_bf16 v[88:91], a[52:55], a[20:23], v[88:91]
  v_mfma_f32_16x16x32_bf16 v[92:95], a[56:59], a[20:23], v[92:95]
  buffer_load_dword v47, s[4:7], s70 offen lds
  s_mov_b32 m0, s68
  s_waitcnt lgkmcnt(3)
  v_mfma_f32_16x16x32_bf16 v[96:99], a[36:39], a[24:27], v[96:99]
  ds_read_b128 a[20:23], v1 offset:13376
  v_mfma_f32_16x16x32_bf16 v[100:103], a[40:43], a[24:27], v[100:103]
  v_mfma_f32_16x16x32_bf16 v[104:107], a[44:47], a[24:27], v[104:107]
  v_mfma_f32_16x16x32_bf16 v[108:111], a[48:51], a[24:27], v[108:111]
  v_mfma_f32_16x16x32_bf16 v[112:115], a[52:55], a[24:27], v[112:115]
  v_mfma_f32_16x16x32_bf16 v[116:119], a[56:59], a[24:27], v[116:119]
  s_waitcnt lgkmcnt(3)
  v_mfma_f32_16x16x32_bf16 v[120:123], a[36:39], a[28:31], v[120:123]
  ds_read_b128 a[24:27], v1 offset:26176
  v_mfma_f32_16x16x32_bf16 v[124:127], a[40:43], a[28:31], v[124:127]
  v_mfma_f32_16x16x32_bf16 v[128:131], a[44:47], a[28:31], v[128:131]
  v_mfma_f32_16x16x32_bf16 v[132:135], a[48:51], a[28:31], v[132:135]
  v_mfma_f32_16x16x32_bf16 v[136:139], a[52:55], a[28:31], v[136:139]
  v_mfma_f32_16x16x32_bf16 v[140:143], a[56:59], a[28:31], v[140:143]
  s_waitcnt lgkmcnt(3)
  v_mfma_f32_16x16x32_bf16 v[144:147], a[36:39], a[0:3], v[144:147]
  ds_read_b128 a[28:31], v1 offset:38976
  v_mfma_f32_16x16x32_bf16 v[148:151], a[40:43], a[0:3], v[148:151]
  v_mfma_f32_16x16x32_bf16 v[152:155], a[44:47], a[0:3], v[152:155]
  v_mfma_f32_16x16x32_bf16 v[156:159], a[48:51], a[0:3], v[156:159]
  v_mfma_f32_16x16x32_bf16 v[160:163], a[52:55], a[0:3], v[160:163]
  v_mfma_f32_16x16x32_bf16 v[164:167], a[56:59], a[0:3], v[164:167]
  s_waitcnt lgkmcnt(3)
  v_mfma_f32_16x16x32_bf16 v[168:171], a[36:39], a[16:19], v[168:171]
  ds_read_b128 a[0:3], v2 offset:576
  v_mfma_f32_16x16x32_bf16 v[172:175], a[40:43], a[16:19], v[172:175]
  v_mfma_f32_16x16x32_bf16 v[176:179], a[44:47], a[16:19], v[176:179]
  v_mfma_f32_16x16x32_bf16 v[180:183], a[48:51], a[16:19], v[180:183]
  v_mfma_f32_16x16x32_bf16 v[184:187], a[52:55], a[16:19], v[184:187]
  v_mfma_f32_16x16x32_bf16 v[188:191], a[56:59], a[16:19], v[188:191]
  s_waitcnt lgkmcnt(3)
  v_mfma_f32_16x16x32_bf16 v[192:195], a[36:39], a[20:23], v[192:195]
  ds_read_b128 a[16:19], v0 offset:640
  v_mfma_f32_16x16x32_bf16 v[196:199], a[40:43], a[20:23], v[196:199]
  v_mfma_f32_16x16x32_bf16 v[200:203], a[44:47], a[20:23], v[200:203]
  v_mfma_f32_16x16x32_bf16 v[204:207], a[48:51], a[20:23], v[204:207]
  v_mfma_f32_16x16x32_bf16 v[208:211], a[52:55], a[20:23], v[208:211]
  v_mfma_f32_16x16x32_bf16 v[212:215], a[56:59], a[20:23], v[212:215]
  s_waitcnt lgkmcnt(3)
  v_mfma_f32_16x16x32_bf16 v[216:219], a[36:39], a[24:27], v[216:219]
  ds_read_b128 a[20:23], v0 offset:13440
  v_mfma_f32_16x16x32_bf16 v[220:223], a[40:43], a[24:27], v[220:223]
  v_mfma_f32_16x16x32_bf16 v[224:227], a[44:47], a[24:27], v[224:227]
  v_mfma_f32_16x16x32_bf16 v[228:231], a[48:51], a[24:27], v[228:231]
  v_mfma_f32_16x16x32_bf16 v[232:235], a[52:55], a[24:27], v[232:235]
  v_mfma_f32_16x16x32_bf16 v[236:239], a[56:59], a[24:27], v[236:239]
  s_waitcnt lgkmcnt(3)
  v_mfma_f32_16x16x32_bf16 v[240:243], a[36:39], a[28:31], v[240:243]
  ds_read_b128 a[24:27], v0 offset:26240
  v_mfma_f32_16x16x32_bf16 v[244:247], a[40:43], a[28:31], v[244:247]
  v_mfma_f32_16x16x32_bf16 v[248:251], a[44:47], a[28:31], v[248:251]
  v_mfma_f32_16x16x32_bf16 v[252:255], a[48:51], a[28:31], v[252:255]
  v_mfma_f32_16x16x32_bf16 a[84:87], a[52:55], a[28:31], a[84:87]
  v_mfma_f32_16x16x32_bf16 a[88:91], a[56:59], a[28:31], a[88:91]
  s_waitcnt lgkmcnt(3)
  v_mfma_f32_16x16x32_bf16 a[92:95], a[36:39], a[0:3], a[92:95]
  ds_read_b128 a[28:31], v0 offset:39040
  v_mfma_f32_16x16x32_bf16 a[96:99], a[40:43], a[0:3], a[96:99]
  buffer_load_dwordx4 a[36:39], v3, s[8:11], s26 offen offset:0
  v_mfma_f32_16x16x32_bf16 a[100:103], a[44:47], a[0:3], a[100:103]
  buffer_load_dwordx4 a[40:43], v3, s[8:11], s26 offen offset:1024
  v_mfma_f32_16x16x32_bf16 a[104:107], a[48:51], a[0:3], a[104:107]
  buffer_load_dwordx4 a[44:47], v3, s[8:11], s26 offen offset:2048
  v_mfma_f32_16x16x32_bf16 a[108:111], a[52:55], a[0:3], a[108:111]
  v_mfma_f32_16x16x32_bf16 a[112:115], a[56:59], a[0:3], a[112:115]
  s_waitcnt vmcnt(11) lgkmcnt(3)
  v_mfma_f32_16x16x32_bf16 v[48:51], a[60:63], a[16:19], v[48:51]
  buffer_load_dwordx4 a[48:51], v3, s[8:11], s26 offen offset:3072
  s_addk_i32 s26, 6144
  v_mfma_f32_16x16x32_bf16 v[52:55], a[64:67], a[16:19], v[52:55]
  ds_read_b128 a[0:3], v0 offset:51840
  v_mfma_f32_16x16x32_bf16 v[56:59], a[68:71], a[16:19], v[56:59]
  v_mfma_f32_16x16x32_bf16 v[60:63], a[72:75], a[16:19], v[60:63]
  v_mfma_f32_16x16x32_bf16 v[64:67], a[76:79], a[16:19], v[64:67]
  buffer_load_dwordx4 a[52:55], v3, s[8:11], s27 offen offset:0
  v_mfma_f32_16x16x32_bf16 v[68:71], a[80:83], a[16:19], v[68:71]
  s_waitcnt lgkmcnt(3)
  v_mfma_f32_16x16x32_bf16 v[72:75], a[60:63], a[20:23], v[72:75]
  ds_read_b128 a[16:19], v1 offset:640
  v_mfma_f32_16x16x32_bf16 v[76:79], a[64:67], a[20:23], v[76:79]
  v_mfma_f32_16x16x32_bf16 v[80:83], a[68:71], a[20:23], v[80:83]
  buffer_load_dwordx4 a[56:59], v3, s[8:11], s27 offen offset:1024
  s_addk_i32 s27, 6144
  s_cmp_eq_u32 s31, 2
  v_mfma_f32_16x16x32_bf16 v[84:87], a[72:75], a[20:23], v[84:87]
  s_cselect_b32 s70, s30, s67
  v_mfma_f32_16x16x32_bf16 v[88:91], a[76:79], a[20:23], v[88:91]
  v_mfma_f32_16x16x32_bf16 v[92:95], a[80:83], a[20:23], v[92:95]
  buffer_load_dword v47, s[4:7], s69 offen lds
  s_mov_b32 m0, s68
  s_waitcnt lgkmcnt(3)
  v_mfma_f32_16x16x32_bf16 v[96:99], a[60:63], a[24:27], v[96:99]
  ds_read_b128 a[20:23], v1 offset:13440
  v_mfma_f32_16x16x32_bf16 v[100:103], a[64:67], a[24:27], v[100:103]
  v_mfma_f32_16x16x32_bf16 v[104:107], a[68:71], a[24:27], v[104:107]
  v_mfma_f32_16x16x32_bf16 v[108:111], a[72:75], a[24:27], v[108:111]
  v_mfma_f32_16x16x32_bf16 v[112:115], a[76:79], a[24:27], v[112:115]
  v_mfma_f32_16x16x32_bf16 v[116:119], a[80:83], a[24:27], v[116:119]
  s_waitcnt lgkmcnt(3)
  v_mfma_f32_16x16x32_bf16 v[120:123], a[60:63], a[28:31], v[120:123]
  ds_read_b128 a[24:27], v1 offset:26240
  v_mfma_f32_16x16x32_bf16 v[124:127], a[64:67], a[28:31], v[124:127]
  v_mfma_f32_16x16x32_bf16 v[128:131], a[68:71], a[28:31], v[128:131]
  v_mfma_f32_16x16x32_bf16 v[132:135], a[72:75], a[28:31], v[132:135]
  v_mfma_f32_16x16x32_bf16 v[136:139], a[76:79], a[28:31], v[136:139]
  v_mfma_f32_16x16x32_bf16 v[140:143], a[80:83], a[28:31], v[140:143]
  s_waitcnt lgkmcnt(3)
  v_mfma_f32_16x16x32_bf16 v[144:147], a[60:63], a[0:3], v[144:147]
  ds_read_b128 a[28:31], v1 offset:39040
  v_mfma_f32_16x16x32_bf16 v[148:151], a[64:67], a[0:3], v[148:151]
  v_mfma_f32_16x16x32_bf16 v[152:155], a[68:71], a[0:3], v[152:155]
  v_mfma_f32_16x16x32_bf16 v[156:159], a[72:75], a[0:3], v[156:159]
  v_mfma_f32_16x16x32_bf16 v[160:163], a[76:79], a[0:3], v[160:163]
  v_mfma_f32_16x16x32_bf16 v[164:167], a[80:83], a[0:3], v[164:167]
  s_waitcnt lgkmcnt(3)
  v_mfma_f32_16x16x32_bf16 v[168:171], a[60:63], a[16:19], v[168:171]
  ds_read_b128 a[0:3], v2 offset:640
  v_mfma_f32_16x16x32_bf16 v[172:175], a[64:67], a[16:19], v[172:175]
  v_mfma_f32_16x16x32_bf16 v[176:179], a[68:71], a[16:19], v[176:179]
  v_mfma_f32_16x16x32_bf16 v[180:183], a[72:75], a[16:19], v[180:183]
  v_mfma_f32_16x16x32_bf16 v[184:187], a[76:79], a[16:19], v[184:187]
  v_mfma_f32_16x16x32_bf16 v[188:191], a[80:83], a[16:19], v[188:191]
  s_waitcnt lgkmcnt(3)
  v_mfma_f32_16x16x32_bf16 v[192:195], a[60:63], a[20:23], v[192:195]
  ds_read_b128 a[16:19], v2 offset:704
  v_mfma_f32_16x16x32_bf16 v[196:199], a[64:67], a[20:23], v[196:199]
  v_mfma_f32_16x16x32_bf16 v[200:203], a[68:71], a[20:23], v[200:203]
  v_mfma_f32_16x16x32_bf16 v[204:207], a[72:75], a[20:23], v[204:207]
  v_mfma_f32_16x16x32_bf16 v[208:211], a[76:79], a[20:23], v[208:211]
  v_mfma_f32_16x16x32_bf16 v[212:215], a[80:83], a[20:23], v[212:215]
  s_waitcnt lgkmcnt(3)
  v_mfma_f32_16x16x32_bf16 v[216:219], a[60:63], a[24:27], v[216:219]
  ds_read_b128 a[20:23], v0 offset:704
  v_mfma_f32_16x16x32_bf16 v[220:223], a[64:67], a[24:27], v[220:223]
  v_mfma_f32_16x16x32_bf16 v[224:227], a[68:71], a[24:27], v[224:227]
  v_mfma_f32_16x16x32_bf16 v[228:231], a[72:75], a[24:27], v[228:231]
  v_mfma_f32_16x16x32_bf16 v[232:235], a[76:79], a[24:27], v[232:235]
  v_mfma_f32_16x16x32_bf16 v[236:239], a[80:83], a[24:27], v[236:239]
  s_waitcnt lgkmcnt(3)
  v_mfma_f32_16x16x32_bf16 v[240:243], a[60:63], a[28:31], v[240:243]
  ds_read_b128 a[24:27], v0 offset:13504
  v_mfma_f32_16x16x32_bf16 v[244:247], a[64:67], a[28:31], v[244:247]
  v_mfma_f32_16x16x32_bf16 v[248:251], a[68:71], a[28:31], v[248:251]
  v_mfma_f32_16x16x32_bf16 v[252:255], a[72:75], a[28:31], v[252:255]
  v_mfma_f32_16x16x32_bf16 a[84:87], a[76:79], a[28:31], a[84:87]
  v_mfma_f32_16x16x32_bf16 a[88:91], a[80:83], a[28:31], a[88:91]
  s_waitcnt lgkmcnt(3)
  v_mfma_f32_16x16x32_bf16 a[92:95], a[60:63], a[0:3], a[92:95]
  ds_read_b128 a[28:31], v0 offset:26304
  v_mfma_f32_16x16x32_bf16 a[96:99], a[64:67], a[0:3], a[96:99]
  buffer_load_dwordx4 a[60:63], v3, s[8:11], s26 offen offset:0
  v_mfma_f32_16x16x32_bf16 a[100:103], a[68:71], a[0:3], a[100:103]
  buffer_load_dwordx4 a[64:67], v3, s[8:11], s26 offen offset:1024
  v_mfma_f32_16x16x32_bf16 a[104:107], a[72:75], a[0:3], a[104:107]
  buffer_load_dwordx4 a[68:71], v3, s[8:11], s26 offen offset:2048
  v_mfma_f32_16x16x32_bf16 a[108:111], a[76:79], a[0:3], a[108:111]
  v_mfma_f32_16x16x32_bf16 a[112:115], a[80:83], a[0:3], a[112:115]
  s_waitcnt vmcnt(11) lgkmcnt(3)
  v_mfma_f32_16x16x32_bf16 a[92:95], a[32:35], a[16:19], a[92:95]
  buffer_load_dwordx4 a[72:75], v3, s[8:11], s26 offen offset:3072
  s_addk_i32 s26, 6144
  v_mfma_f32_16x16x32_bf16 a[96:99], a[236:239], a[16:19], a[96:99]
  ds_read_b128 a[0:3], v0 offset:39104
  v_mfma_f32_16x16x32_bf16 a[100:103], a[240:243], a[16:19], a[100:103]
  v_accvgpr_read_b32 v32, a92
  v_accvgpr_read_b32 v33, a93
  v_mfma_f32_16x16x32_bf16 a[104:107], a[244:247], a[16:19], a[104:107]
  v_accvgpr_read_b32 v34, a94
  v_accvgpr_read_b32 v35, a95
  v_mfma_f32_16x16x32_bf16 a[108:111], a[248:251], a[16:19], a[108:111]
  buffer_load_dwordx4 a[76:79], v3, s[8:11], s27 offen offset:0
  v_mfma_f32_16x16x32_bf16 a[112:115], a[252:255], a[16:19], a[112:115]
  s_waitcnt lgkmcnt(3)
  v_cvt_pk_bf16_f32 v32, v32, v33
  v_accvgpr_read_b32 v36, a96
  v_mfma_f32_16x16x32_bf16 v[48:51], a[32:35], a[20:23], v[48:51]
  ds_read_b128 a[16:19], v0 offset:51904
  v_accvgpr_read_b32 v37, a97
  v_mfma_f32_16x16x32_bf16 v[52:55], a[236:239], a[20:23], v[52:55]
  v_accvgpr_read_b32 v38, a98
  v_accvgpr_read_b32 v39, a99
  v_mfma_f32_16x16x32_bf16 v[56:59], a[240:243], a[20:23], v[56:59]
  buffer_load_dwordx4 a[80:83], v3, s[8:11], s27 offen offset:1024
  s_addk_i32 s27, 6144
  s_add_u32 s29, s29, 290304
  v_mfma_f32_16x16x32_bf16 v[60:63], a[244:247], a[20:23], v[60:63]
  s_max_i32 s30, s29, 0
  v_cvt_pk_bf16_f32 v33, v34, v35
  v_cvt_pk_bf16_f32 v34, v36, v37
  v_mfma_f32_16x16x32_bf16 v[64:67], a[248:251], a[20:23], v[64:67]
  s_cmp_ge_u32 s63, 972
  v_cvt_pk_bf16_f32 v35, v38, v39
  v_accvgpr_write_b32 a92, v32
  v_mfma_f32_16x16x32_bf16 v[68:71], a[252:255], a[20:23], v[68:71]
  s_cselect_b32 s30, s67, s30
  v_accvgpr_write_b32 a93, v33
  v_accvgpr_write_b32 a94, v34
  s_waitcnt lgkmcnt(3)
  v_mfma_f32_16x16x32_bf16 v[72:75], a[32:35], a[24:27], v[72:75]
  s_cmp_eq_u32 s31, 0
  buffer_load_dword v47, s[4:7], s70 offen lds
  s_cselect_b32 s69, s30, s67
  s_mov_b32 m0, s68
  v_mfma_f32_16x16x32_bf16 v[76:79], a[236:239], a[24:27], v[76:79]
  ds_read_b128 a[20:23], v1 offset:704
  v_accvgpr_write_b32 a95, v35
  v_mfma_f32_16x16x32_bf16 v[80:83], a[240:243], a[24:27], v[80:83]
  v_accvgpr_read_b32 v32, a108
  v_accvgpr_read_b32 v33, a109
  v_mfma_f32_16x16x32_bf16 v[84:87], a[244:247], a[24:27], v[84:87]
  v_accvgpr_read_b32 v34, a110
  v_accvgpr_read_b32 v35, a111
  v_mfma_f32_16x16x32_bf16 v[88:91], a[248:251], a[24:27], v[88:91]
  v_cvt_pk_bf16_f32 v32, v32, v33
  v_accvgpr_read_b32 v40, a100
  v_mfma_f32_16x16x32_bf16 v[92:95], a[252:255], a[24:27], v[92:95]
  s_waitcnt lgkmcnt(3)
  v_accvgpr_read_b32 v41, a101
  v_accvgpr_read_b32 v36, a112
  v_mfma_f32_16x16x32_bf16 v[96:99], a[32:35], a[28:31], v[96:99]
  ds_read_b128 a[24:27], v1 offset:13504
  v_accvgpr_read_b32 v37, a113
  v_mfma_f32_16x16x32_bf16 v[100:103], a[236:239], a[28:31], v[100:103]
  v_accvgpr_read_b32 v38, a114
  v_accvgpr_read_b32 v39, a115
  v_mfma_f32_16x16x32_bf16 v[104:107], a[240:243], a[28:31], v[104:107]
  v_cvt_pk_bf16_f32 v33, v34, v35
  v_accvgpr_read_b32 v42, a102
  v_mfma_f32_16x16x32_bf16 v[108:111], a[244:247], a[28:31], v[108:111]
  v_accvgpr_read_b32 v43, a103
  v_cvt_pk_bf16_f32 v40, v40, v41
  v_mfma_f32_16x16x32_bf16 v[112:115], a[248:251], a[28:31], v[112:115]
  v_cvt_pk_bf16_f32 v34, v36, v37
  v_cvt_pk_bf16_f32 v35, v38, v39
  v_mfma_f32_16x16x32_bf16 v[116:119], a[252:255], a[28:31], v[116:119]
  s_waitcnt lgkmcnt(3)
  v_accvgpr_read_b32 v44, a104
  v_accvgpr_read_b32 v45, a105
  v_mfma_f32_16x16x32_bf16 v[120:123], a[32:35], a[0:3], v[120:123]
  ds_read_b128 a[28:31], v1 offset:26304
  v_accvgpr_read_b32 v46, a106
  v_mfma_f32_16x16x32_bf16 v[124:127], a[236:239], a[0:3], v[124:127]
  v_accvgpr_read_b32 v47, a107
  v_cvt_pk_bf16_f32 v41, v42, v43
  v_mfma_f32_16x16x32_bf16 v[128:131], a[240:243], a[0:3], v[128:131]
  v_accvgpr_write_b32 a108, v32
  v_accvgpr_write_b32 a109, v33
  v_mfma_f32_16x16x32_bf16 v[132:135], a[244:247], a[0:3], v[132:135]
  v_accvgpr_write_b32 a110, v34
  v_accvgpr_write_b32 a111, v35
  v_mfma_f32_16x16x32_bf16 v[136:139], a[248:251], a[0:3], v[136:139]
  v_cvt_pk_bf16_f32 v42, v44, v45
  v_cvt_pk_bf16_f32 v43, v46, v47
  v_mfma_f32_16x16x32_bf16 v[140:143], a[252:255], a[0:3], v[140:143]
  s_waitcnt lgkmcnt(3)
  v_accvgpr_write_b32 a100, v40
  v_accvgpr_write_b32 a101, v41
  v_mfma_f32_16x16x32_bf16 v[144:147], a[32:35], a[16:19], v[144:147]
  ds_read_b128 a[0:3], v1 offset:39104
  v_accvgpr_write_b32 a102, v42
  v_mfma_f32_16x16x32_bf16 v[148:151], a[236:239], a[16:19], v[148:151]
  v_accvgpr_write_b32 a103, v43
  v_cvt_pk_bf16_f32 v48, v48, v49
  v_mfma_f32_16x16x32_bf16 v[152:155], a[240:243], a[16:19], v[152:155]
  v_cvt_pk_bf16_f32 v49, v50, v51
  v_cvt_pk_bf16_f32 v50, v52, v53
  v_mfma_f32_16x16x32_bf16 v[156:159], a[244:247], a[16:19], v[156:159]
  v_cvt_pk_bf16_f32 v51, v54, v55
  v_cvt_pk_bf16_f32 v56, v56, v57
  v_mfma_f32_16x16x32_bf16 v[160:163], a[248:251], a[16:19], v[160:163]
  v_cvt_pk_bf16_f32 v57, v58, v59
  v_cvt_pk_bf16_f32 v58, v60, v61
  v_mfma_f32_16x16x32_bf16 v[164:167], a[252:255], a[16:19], v[164:167]
  s_waitcnt lgkmcnt(3)
  v_cvt_pk_bf16_f32 v59, v62, v63
  v_cvt_pk_bf16_f32 v64, v64, v65
  v_mfma_f32_16x16x32_bf16 v[168:171], a[32:35], a[20:23], v[168:171]
  v_cvt_pk_bf16_f32 v65, v66, v67
  v_cvt_pk_bf16_f32 v66, v68, v69
  v_mfma_f32_16x16x32_bf16 v[172:175], a[236:239], a[20:23], v[172:175]
  v_cvt_pk_bf16_f32 v67, v70, v71
  v_cvt_pk_bf16_f32 v72, v72, v73
  v_mfma_f32_16x16x32_bf16 v[176:179], a[240:243], a[20:23], v[176:179]
  v_cvt_pk_bf16_f32 v73, v74, v75
  v_cvt_pk_bf16_f32 v74, v76, v77
  v_mfma_f32_16x16x32_bf16 v[180:183], a[244:247], a[20:23], v[180:183]
  v_cvt_pk_bf16_f32 v75, v78, v79
  v_cvt_pk_bf16_f32 v80, v80, v81
  v_mfma_f32_16x16x32_bf16 v[184:187], a[248:251], a[20:23], v[184:187]
  v_cvt_pk_bf16_f32 v81, v82, v83
  v_cvt_pk_bf16_f32 v82, v84, v85
  v_mfma_f32_16x16x32_bf16 v[188:191], a[252:255], a[20:23], v[188:191]
  s_waitcnt lgkmcnt(2)
  v_cvt_pk_bf16_f32 v83, v86, v87
  v_cvt_pk_bf16_f32 v88, v88, v89
  v_mfma_f32_16x16x32_bf16 v[192:195], a[32:35], a[24:27], v[192:195]
  v_cvt_pk_bf16_f32 v89, v90, v91
  v_cvt_pk_bf16_f32 v90, v92, v93
  v_mfma_f32_16x16x32_bf16 v[196:199], a[236:239], a[24:27], v[196:199]
  v_cvt_pk_bf16_f32 v91, v94, v95
  v_cvt_pk_bf16_f32 v96, v96, v97
  v_mfma_f32_16x16x32_bf16 v[200:203], a[240:243], a[24:27], v[200:203]
  v_cvt_pk_bf16_f32 v97, v98, v99
  v_cvt_pk_bf16_f32 v98, v100, v101
  v_mfma_f32_16x16x32_bf16 v[204:207], a[244:247], a[24:27], v[204:207]
  v_cvt_pk_bf16_f32 v99, v102, v103
  v_cvt_pk_bf16_f32 v104, v104, v105
  v_mfma_f32_16x16x32_bf16 v[208:211], a[248:251], a[24:27], v[208:211]
  v_cvt_pk_bf16_f32 v105, v106, v107
  v_cvt_pk_bf16_f32 v106, v108, v109
  v_mfma_f32_16x16x32_bf16 v[212:215], a[252:255], a[24:27], v[212:215]
  s_waitcnt lgkmcnt(1)
  v_cvt_pk_bf16_f32 v107, v110, v111
  v_cvt_pk_bf16_f32 v112, v112, v113
  v_mfma_f32_16x16x32_bf16 v[216:219], a[32:35], a[28:31], v[216:219]
  v_cvt_pk_bf16_f32 v113, v114, v115
  v_cvt_pk_bf16_f32 v114, v116, v117
  v_mfma_f32_16x16x32_bf16 v[220:223], a[236:239], a[28:31], v[220:223]
  v_cvt_pk_bf16_f32 v115, v118, v119
  v_cvt_pk_bf16_f32 v120, v120, v121
  v_mfma_f32_16x16x32_bf16 v[224:227], a[240:243], a[28:31], v[224:227]
  v_cvt_pk_bf16_f32 v121, v122, v123
  v_cvt_pk_bf16_f32 v122, v124, v125
  v_mfma_f32_16x16x32_bf16 v[228:231], a[244:247], a[28:31], v[228:231]
  v_cvt_pk_bf16_f32 v123, v126, v127
  v_cvt_pk_bf16_f32 v128, v128, v129
  v_mfma_f32_16x16x32_bf16 v[232:235], a[248:251], a[28:31], v[232:235]
  v_cvt_pk_bf16_f32 v129, v130, v131
  v_cvt_pk_bf16_f32 v224, v224, v225
  v_mfma_f32_16x16x32_bf16 v[236:239], a[252:255], a[28:31], v[236:239]
  s_waitcnt lgkmcnt(0)
  v_cvt_pk_bf16_f32 v225, v226, v227
  v_cvt_pk_bf16_f32 v226, v228, v229
  v_mfma_f32_16x16x32_bf16 v[240:243], a[32:35], a[0:3], v[240:243]
  v_cvt_pk_bf16_f32 v227, v230, v231
  v_cvt_pk_bf16_f32 v232, v232, v233
  v_mfma_f32_16x16x32_bf16 v[244:247], a[236:239], a[0:3], v[244:247]
  buffer_load_dwordx4 a[32:35], v3, s[8:11], s26 offen offset:0
  v_mfma_f32_16x16x32_bf16 v[248:251], a[240:243], a[0:3], v[248:251]
  v_cvt_pk_bf16_f32 v233, v234, v235
  v_cvt_pk_bf16_f32 v234, v236, v237
  v_mfma_f32_16x16x32_bf16 v[252:255], a[244:247], a[0:3], v[252:255]
  v_accvgpr_write_b32 a240, v224
  v_accvgpr_write_b32 a241, v225
  v_mfma_f32_16x16x32_bf16 a[84:87], a[248:251], a[0:3], a[84:87]
  v_accvgpr_write_b32 a242, v226
  v_accvgpr_write_b32 a243, v227
  v_mfma_f32_16x16x32_bf16 a[88:91], a[252:255], a[0:3], a[88:91]
  v_cvt_pk_bf16_f32 v235, v238, v239
  v_accvgpr_write_b32 a244, v232
  v_mfma_f32_16x16x32_bf16 v[32:35], a[92:95], a[224:227], 0
  v_accvgpr_write_b32 a245, v233
  v_accvgpr_read_b32 v40, a84
  v_mfma_f32_16x16x32_bf16 v[32:35], a[100:103], a[228:231], v[32:35]
  v_accvgpr_read_b32 v41, a85
  v_accvgpr_read_b32 v42, a86
  v_mfma_f32_16x16x32_bf16 v[32:35], a[108:111], a[232:235], v[32:35]
  v_accvgpr_read_b32 v43, a87
  v_cvt_pk_bf16_f32 v40, v40, v41
  v_mfma_f32_16x16x32_bf16 v[36:39], a[92:95], a[116:119], 0
  v_accvgpr_read_b32 v44, a88
  v_accvgpr_read_b32 v45, a89
  v_mfma_f32_16x16x32_bf16 v[36:39], a[100:103], a[120:123], v[36:39]
  v_accvgpr_read_b32 v46, a90
  v_accvgpr_read_b32 v47, a91
  v_mfma_f32_16x16x32_bf16 v[36:39], a[108:111], a[124:127], v[36:39]
  v_cvt_pk_bf16_f32 v41, v42, v43
  v_cvt_pk_bf16_f32 v42, v44, v45
  v_mfma_f32_16x16x32_bf16 v[52:55], v[48:51], a[116:119], 0
  v_cvt_pk_bf16_f32 v43, v46, v47
  v_accvgpr_write_b32 a84, v40
  v_mfma_f32_16x16x32_bf16 v[52:55], v[56:59], a[120:123], v[52:55]
  v_accvgpr_write_b32 a85, v41
  v_accvgpr_write_b32 a86, v42
  v_mfma_f32_16x16x32_bf16 v[52:55], v[64:67], a[124:127], v[52:55]
  v_accvgpr_write_b32 a87, v43
  v_accvgpr_write_b32 a246, v234
  v_mfma_f32_16x16x32_bf16 v[60:63], v[72:75], a[116:119], 0
  v_accvgpr_write_b32 a247, v235
  v_cvt_pk_bf16_f32 v240, v240, v241
  v_mfma_f32_16x16x32_bf16 v[60:63], v[80:83], a[120:123], v[60:63]
  v_cvt_pk_bf16_f32 v241, v242, v243
  v_cvt_pk_bf16_f32 v242, v244, v245
  v_mfma_f32_16x16x32_bf16 v[60:63], v[88:91], a[124:127], v[60:63]
  v_cvt_pk_bf16_f32 v243, v246, v247
  v_accvgpr_write_b32 a248, v240
  v_mfma_f32_16x16x32_bf16 v[68:71], v[96:99], a[116:119], 0
  v_accvgpr_write_b32 a249, v241
  v_accvgpr_write_b32 a250, v242
  v_mfma_f32_16x16x32_bf16 v[68:71], v[104:107], a[120:123], v[68:71]
  v_accvgpr_write_b32 a251, v243
  v_cndmask_b32 v29, v32, v33, s[42:43]
  v_mfma_f32_16x16x32_bf16 v[68:71], v[112:115], a[124:127], v[68:71]
  v_cndmask_b32 v29, v29, v34, s[44:45]
  v_cvt_pk_bf16_f32 v130, v132, v133
  v_mfma_f32_16x16x32_bf16 v[40:43], a[92:95], a[128:131], 0
  v_cvt_pk_bf16_f32 v131, v134, v135
  v_cvt_pk_bf16_f32 v136, v136, v137
  v_mfma_f32_16x16x32_bf16 v[40:43], a[100:103], a[132:135], v[40:43]
  v_cvt_pk_bf16_f32 v137, v138, v139
  v_cvt_pk_bf16_f32 v138, v140, v141
  v_mfma_f32_16x16x32_bf16 v[40:43], a[108:111], a[136:139], v[40:43]
  v_cvt_pk_bf16_f32 v139, v142, v143
  v_cvt_pk_bf16_f32 v144, v144, v145
  v_mfma_f32_16x16x32_bf16 v[76:79], v[48:51], a[128:131], 0
  v_cvt_pk_bf16_f32 v145, v146, v147
  v_cvt_pk_bf16_f32 v146, v148, v149
  v_mfma_f32_16x16x32_bf16 v[76:79], v[56:59], a[132:135], v[76:79]
  v_cvt_pk_bf16_f32 v147, v150, v151
  v_cvt_pk_bf16_f32 v152, v152, v153
  v_mfma_f32_16x16x32_bf16 v[76:79], v[64:67], a[136:139], v[76:79]
  v_cvt_pk_bf16_f32 v153, v154, v155
  v_cvt_pk_bf16_f32 v154, v156, v157
  v_mfma_f32_16x16x32_bf16 v[84:87], v[72:75], a[128:131], 0
  v_cvt_pk_bf16_f32 v155, v158, v159
  v_cvt_pk_bf16_f32 v160, v160, v161
  v_mfma_f32_16x16x32_bf16 v[84:87], v[80:83], a[132:135], v[84:87]
  v_cvt_pk_bf16_f32 v161, v162, v163
  v_cvt_pk_bf16_f32 v162, v164, v165
  v_mfma_f32_16x16x32_bf16 v[84:87], v[88:91], a[136:139], v[84:87]
  v_cvt_pk_bf16_f32 v163, v166, v167
  v_cvt_pk_bf16_f32 v168, v168, v169
  v_mfma_f32_16x16x32_bf16 v[92:95], v[96:99], a[128:131], 0
  v_cvt_pk_bf16_f32 v169, v170, v171
  v_cvt_pk_bf16_f32 v170, v172, v173
  v_mfma_f32_16x16x32_bf16 v[92:95], v[104:107], a[132:135], v[92:95]
  v_cvt_pk_bf16_f32 v171, v174, v175
  v_cvt_pk_bf16_f32 v176, v176, v177
  v_mfma_f32_16x16x32_bf16 v[92:95], v[112:115], a[136:139], v[92:95]
  v_cvt_pk_bf16_f32 v177, v178, v179
  v_cvt_pk_bf16_f32 v178, v180, v181
  v_mfma_f32_16x16x32_bf16 v[44:47], a[92:95], a[140:143], 0
  v_cvt_pk_bf16_f32 v179, v182, v183
  v_cvt_pk_bf16_f32 v184, v184, v185
  v_mfma_f32_16x16x32_bf16 v[44:47], a[100:103], a[144:147], v[44:47]
  v_cvt_pk_bf16_f32 v185, v186, v187
  v_cvt_pk_bf16_f32 v186, v188, v189
  v_mfma_f32_16x16x32_bf16 v[44:47], a[108:111], a[148:151], v[44:47]
  v_cvt_pk_bf16_f32 v187, v190, v191
  v_mov_b32 v20, v36
  v_mfma_f32_16x16x32_bf16 v[100:103], v[48:51], a[140:143], 0
  v_mov_b32 v21, v40
  v_cvt_pk_bf16_f32 v192, v192, v193
  v_mfma_f32_16x16x32_bf16 v[100:103], v[56:59], a[144:147], v[100:103]
  v_cvt_pk_bf16_f32 v193, v194, v195
  v_mov_b32 v22, v44
  v_mfma_f32_16x16x32_bf16 v[100:103], v[64:67], a[148:151], v[100:103]
  v_cvt_pk_bf16_f32 v194, v196, v197
  v_cvt_pk_bf16_f32 v195, v198, v199
  v_mfma_f32_16x16x32_bf16 v[108:111], v[72:75], a[140:143], 0
  v_cvt_pk_bf16_f32 v200, v200, v201
  v_cvt_pk_bf16_f32 v201, v202, v203
  v_mfma_f32_16x16x32_bf16 v[108:111], v[80:83], a[144:147], v[108:111]
  v_cvt_pk_bf16_f32 v202, v204, v205
  v_cvt_pk_bf16_f32 v203, v206, v207
  v_mfma_f32_16x16x32_bf16 v[108:111], v[88:91], a[148:151], v[108:111]
  v_cvt_pk_bf16_f32 v208, v208, v209
  v_cvt_pk_bf16_f32 v209, v210, v211
  v_mfma_f32_16x16x32_bf16 v[116:119], v[96:99], a[140:143], 0
  v_cvt_pk_bf16_f32 v210, v212, v213
  v_cvt_pk_bf16_f32 v211, v214, v215
  v_mfma_f32_16x16x32_bf16 v[116:119], v[104:107], a[144:147], v[116:119]
  v_cvt_pk_bf16_f32 v216, v216, v217
  v_cvt_pk_bf16_f32 v217, v218, v219
  v_mfma_f32_16x16x32_bf16 v[116:119], v[112:115], a[148:151], v[116:119]
  v_cvt_pk_bf16_f32 v218, v220, v221
  v_cvt_pk_bf16_f32 v219, v222, v223
  v_mfma_f32_16x16x32_bf16 v[224:227], v[48:51], a[224:227], 0
  v_accvgpr_write_b32 a236, v216
  v_accvgpr_write_b32 a237, v217
  v_mfma_f32_16x16x32_bf16 v[224:227], v[56:59], a[228:231], v[224:227]
  v_accvgpr_write_b32 a238, v218
  v_accvgpr_write_b32 a239, v219
  v_mfma_f32_16x16x32_bf16 v[224:227], v[64:67], a[232:235], v[224:227]
  v_cvt_pk_bf16_f32 v248, v248, v249
  v_cvt_pk_bf16_f32 v249, v250, v251
  v_mfma_f32_16x16x32_bf16 v[232:235], v[72:75], a[224:227], 0
  v_cvt_pk_bf16_f32 v250, v252, v253
  v_cvt_pk_bf16_f32 v251, v254, v255
  v_mfma_f32_16x16x32_bf16 v[232:235], v[80:83], a[228:231], v[232:235]
  v_accvgpr_write_b32 a252, v248
  v_accvgpr_write_b32 a253, v249
  v_mfma_f32_16x16x32_bf16 v[232:235], v[88:91], a[232:235], v[232:235]
  v_accvgpr_write_b32 a254, v250
  v_accvgpr_write_b32 a255, v251
  v_mfma_f32_16x16x32_bf16 v[240:243], v[96:99], a[224:227], 0
  ds_read_b128 a[16:19], v0 offset:0
  v_mul_f32 v52, v52, v8
  v_mfma_f32_16x16x32_bf16 v[240:243], v[104:107], a[228:231], v[240:243]
  ds_read_b128 a[20:23], v0 offset:12800
  v_mul_f32 v53, v53, v9
  v_mfma_f32_16x16x32_bf16 v[240:243], v[112:115], a[232:235], v[240:243]
  ds_read_b128 a[24:27], v0 offset:25600
  v_mul_f32 v54, v54, v10
  v_mfma_f32_16x16x32_bf16 v[32:35], a[92:95], a[152:155], 0
  ds_read_b128 a[28:31], v0 offset:38400
  v_mul_f32 v55, v55, v11
  v_mfma_f32_16x16x32_bf16 v[32:35], a[100:103], a[156:159], v[32:35]
  ds_read_b128 a[0:3], v0 offset:51200
  v_mul_f32 v60, v60, v12
  v_mfma_f32_16x16x32_bf16 v[32:35], a[108:111], a[160:163], v[32:35]
  v_mul_f32 v61, v61, v13
  v_mul_f32 v62, v62, v14
  v_mfma_f32_16x16x32_bf16 v[124:127], v[120:123], a[152:155], 0
  v_mul_f32 v63, v63, v15
  v_mul_f32 v68, v68, v16
  v_mfma_f32_16x16x32_bf16 v[124:127], v[128:131], a[156:159], v[124:127]
  v_mul_f32 v69, v69, v17
  v_mov_b32 v23, v33
  v_mfma_f32_16x16x32_bf16 v[124:127], v[136:139], a[160:163], v[124:127]
  v_mul_f32 v70, v70, v18
  v_mul_f32 v20, v20, v30
  v_mfma_f32_16x16x32_bf16 v[132:135], v[144:147], a[152:155], 0
  v_mul_f32 v71, v71, v19
  v_mul_f32 v76, v76, v8
  v_mfma_f32_16x16x32_bf16 v[132:135], v[152:155], a[156:159], v[132:135]
  v_mul_f32 v77, v77, v9
  v_mul_f32 v78, v78, v10
  v_mfma_f32_16x16x32_bf16 v[132:135], v[160:163], a[160:163], v[132:135]
  v_mul_f32 v100, v100, v8
  v_mul_f32 v101, v101, v9
  v_mfma_f32_16x16x32_bf16 v[140:143], v[168:171], a[152:155], 0
  v_mul_f32 v102, v102, v10
  v_mul_f32 v79, v79, v11
  v_mfma_f32_16x16x32_bf16 v[140:143], v[176:179], a[156:159], v[140:143]
  v_mul_f32 v84, v84, v12
  v_mul_f32 v103, v103, v11
  v_mfma_f32_16x16x32_bf16 v[140:143], v[184:187], a[160:163], v[140:143]
  v_mul_f32 v108, v108, v12
  v_mul_f32 v85, v85, v13
  v_mfma_f32_16x16x32_bf16 v[36:39], a[92:95], a[164:167], 0
  v_mul_f32 v86, v86, v14
  v_mul_f32 v109, v109, v13
  v_mfma_f32_16x16x32_bf16 v[36:39], a[100:103], a[168:171], v[36:39]
  v_mul_f32 v110, v110, v14
  v_mul_f32 v87, v87, v15
  v_mfma_f32_16x16x32_bf16 v[36:39], a[108:111], a[172:175], v[36:39]
  v_mul_f32 v92, v92, v16
  v_mul_f32 v111, v111, v15
  v_mfma_f32_16x16x32_bf16 v[148:151], v[120:123], a[164:167], 0
  v_mul_f32 v116, v116, v16
  v_mul_f32 v93, v93, v17
  v_mfma_f32_16x16x32_bf16 v[148:151], v[128:131], a[168:171], v[148:151]
  v_mul_f32 v94, v94, v18
  v_mov_b32 v24, v37
  v_mfma_f32_16x16x32_bf16 v[148:151], v[136:139], a[172:175], v[148:151]
  v_mul_f32 v21, v21, v30
  v_mul_f32 v117, v117, v17
  v_mfma_f32_16x16x32_bf16 v[156:159], v[144:147], a[164:167], 0
  v_mul_f32 v118, v118, v18
  v_mul_f32 v22, v22, v30
  v_mfma_f32_16x16x32_bf16 v[156:159], v[152:155], a[168:171], v[156:159]
  v_mul_f32 v95, v95, v19
  v_mul_f32 v119, v119, v19
  v_mfma_f32_16x16x32_bf16 v[156:159], v[160:163], a[172:175], v[156:159]
  v_mfma_f32_16x16x32_bf16 v[164:167], v[168:171], a[164:167], 0
  v_mfma_f32_16x16x32_bf16 v[164:167], v[176:179], a[168:171], v[164:167]
  v_mfma_f32_16x16x32_bf16 v[164:167], v[184:187], a[172:175], v[164:167]
  v_mfma_f32_16x16x32_bf16 v[40:43], a[92:95], a[176:179], 0
  v_mfma_f32_16x16x32_bf16 v[40:43], a[100:103], a[180:183], v[40:43]
  v_mfma_f32_16x16x32_bf16 v[40:43], a[108:111], a[184:187], v[40:43]
  v_mfma_f32_16x16x32_bf16 v[172:175], v[120:123], a[176:179], 0
  v_mfma_f32_16x16x32_bf16 v[172:175], v[128:131], a[180:183], v[172:175]
  v_mov_b32 v25, v41
  v_mfma_f32_16x16x32_bf16 v[172:175], v[136:139], a[184:187], v[172:175]
  v_mfma_f32_16x16x32_bf16 v[180:183], v[144:147], a[176:179], 0
  v_mfma_f32_16x16x32_bf16 v[180:183], v[152:155], a[180:183], v[180:183]
  v_mfma_f32_16x16x32_bf16 v[180:183], v[160:163], a[184:187], v[180:183]
  v_mfma_f32_16x16x32_bf16 v[188:191], v[168:171], a[176:179], 0
  v_mfma_f32_16x16x32_bf16 v[188:191], v[176:179], a[180:183], v[188:191]
  v_mfma_f32_16x16x32_bf16 v[188:191], v[184:187], a[184:187], v[188:191]
  v_mfma_f32_16x16x32_bf16 v[44:47], v[120:123], a[224:227], 0
  v_mfma_f32_16x16x32_bf16 v[44:47], v[128:131], a[228:231], v[44:47]
  v_mfma_f32_16x16x32_bf16 v[44:47], v[136:139], a[232:235], v[44:47]
  v_mfma_f32_16x16x32_bf16 v[32:35], v[144:147], a[224:227], 0
  v_mfma_f32_16x16x32_bf16 v[32:35], v[152:155], a[228:231], v[32:35]
  v_cndmask_b32 v224, v224, v44, s[42:43]
  v_mfma_f32_16x16x32_bf16 v[32:35], v[160:163], a[232:235], v[32:35]
  v_cndmask_b32 v225, v225, v45, s[42:43]
  v_cndmask_b32 v226, v226, v46, s[42:43]
  v_mfma_f32_16x16x32_bf16 v[36:39], v[168:171], a[224:227], 0
  v_cndmask_b32 v227, v227, v47, s[42:43]
  v_mfma_f32_16x16x32_bf16 v[36:39], v[176:179], a[228:231], v[36:39]
  v_cndmask_b32 v232, v232, v32, s[42:43]
  v_mfma_f32_16x16x32_bf16 v[36:39], v[184:187], a[232:235], v[36:39]
  v_cndmask_b32 v233, v233, v33, s[42:43]
  v_cndmask_b32 v234, v234, v34, s[42:43]
  v_mfma_f32_16x16x32_bf16 v[40:43], a[92:95], a[188:191], 0
  v_cndmask_b32 v235, v235, v35, s[42:43]
  v_mfma_f32_16x16x32_bf16 v[40:43], a[100:103], a[192:195], v[40:43]
  v_cndmask_b32 v240, v240, v36, s[42:43]
  v_mfma_f32_16x16x32_bf16 v[40:43], a[108:111], a[196:199], v[40:43]
  v_cndmask_b32 v241, v241, v37, s[42:43]
  v_cndmask_b32 v242, v242, v38, s[42:43]
  v_mfma_f32_16x16x32_bf16 v[196:199], v[192:195], a[188:191], 0
  v_cndmask_b32 v243, v243, v39, s[42:43]
  v_mfma_f32_16x16x32_bf16 v[196:199], v[200:203], a[192:195], v[196:199]
  v_mov_b32 v26, v42
  v_mfma_f32_16x16x32_bf16 v[196:199], v[208:211], a[196:199], v[196:199]
  v_mfma_f32_16x16x32_bf16 v[204:207], a[236:239], a[188:191], 0
  v_mfma_f32_16x16x32_bf16 v[204:207], a[240:243], a[192:195], v[204:207]
  v_mfma_f32_16x16x32_bf16 v[204:207], a[244:247], a[196:199], v[204:207]
  v_mfma_f32_16x16x32_bf16 v[212:215], a[248:251], a[188:191], 0
  v_mfma_f32_16x16x32_bf16 v[212:215], a[252:255], a[192:195], v[212:215]
  v_mfma_f32_16x16x32_bf16 v[212:215], a[84:87], a[196:199], v[212:215]
  v_mfma_f32_16x16x32_bf16 v[44:47], a[92:95], a[200:203], 0
  v_mfma_f32_16x16x32_bf16 v[44:47], a[100:103], a[204:207], v[44:47]
  v_mfma_f32_16x16x32_bf16 v[44:47], a[108:111], a[208:211], v[44:47]
  v_mfma_f32_16x16x32_bf16 v[220:223], v[192:195], a[200:203], 0
  v_mfma_f32_16x16x32_bf16 v[220:223], v[200:203], a[204:207], v[220:223]
  v_mov_b32 v27, v46
  v_mfma_f32_16x16x32_bf16 v[220:223], v[208:211], a[208:211], v[220:223]
  v_mfma_f32_16x16x32_bf16 v[228:231], a[236:239], a[200:203], 0
  v_mfma_f32_16x16x32_bf16 v[228:231], a[240:243], a[204:207], v[228:231]
  v_mfma_f32_16x16x32_bf16 v[228:231], a[244:247], a[208:211], v[228:231]
  v_mfma_f32_16x16x32_bf16 v[236:239], a[248:251], a[200:203], 0
  v_mfma_f32_16x16x32_bf16 v[236:239], a[252:255], a[204:207], v[236:239]
  v_mfma_f32_16x16x32_bf16 v[236:239], a[84:87], a[208:211], v[236:239]
  v_mfma_f32_16x16x32_bf16 v[32:35], a[92:95], a[212:215], 0
  v_mfma_f32_16x16x32_bf16 v[32:35], a[100:103], a[216:219], v[32:35]
  v_mfma_f32_16x16x32_bf16 v[32:35], a[108:111], a[220:223], v[32:35]
  v_mfma_f32_16x16x32_bf16 v[244:247], v[192:195], a[212:215], 0
  v_mfma_f32_16x16x32_bf16 v[244:247], v[200:203], a[216:219], v[244:247]
  v_max3_f32 v33, v52, v53, v54
  v_mfma_f32_16x16x32_bf16 v[244:247], v[208:211], a[220:223], v[244:247]
  v_max3_f32 v33, v33, v55, v60
  v_mov_b32 v28, v34
  v_mfma_f32_16x16x32_bf16 v[252:255], a[236:239], a[212:215], 0
  v_max3_f32 v33, v33, v61, v62
  v_mov_b32 v34, s64
  v_mfma_f32_16x16x32_bf16 v[252:255], a[240:243], a[216:219], v[252:255]
  v_max3_f32 v33, v33, v63, v68
  v_cndmask_b32 v20, v34, v20, s[38:39]
  v_mfma_f32_16x16x32_bf16 v[252:255], a[244:247], a[220:223], v[252:255]
  v_max3_f32 v33, v33, v69, v70
  v_max3_f32 v33, v33, v71, v20
  v_mfma_f32_16x16x32_bf16 v[216:219], a[248:251], a[212:215], 0
  v_mov_b32 v34, v33
  ds_read_b32 v32, v6 offset:64
  v_mfma_f32_16x16x32_bf16 v[216:219], a[252:255], a[216:219], v[216:219]
  v_permlane32_swap_b32 v33, v34
  v_mfma_f32_16x16x32_bf16 v[216:219], a[84:87], a[220:223], v[216:219]
  v_max_f32 v33, v33, v34
  v_mov_b32 v34, v33
  v_mfma_f32_16x16x32_bf16 v[36:39], v[192:195], a[224:227], 0
  s_nop 0
  v_permlane16_swap_b32 v33, v34
  v_mfma_f32_16x16x32_bf16 v[36:39], v[200:203], a[228:231], v[36:39]
  v_max_f32 v33, v33, v34
  v_mul_f32 v33, v33, v31
  v_mfma_f32_16x16x32_bf16 v[36:39], v[208:211], a[232:235], v[36:39]
  v_fma_f32 v52, v52, v31, -v33
  v_fma_f32 v53, v53, v31, -v33
  v_mfma_f32_16x16x32_bf16 v[40:43], a[236:239], a[224:227], 0
  v_fma_f32 v54, v54, v31, -v33
  v_fma_f32 v55, v55, v31, -v33
  v_mfma_f32_16x16x32_bf16 v[40:43], a[240:243], a[228:231], v[40:43]
  buffer_load_dwordx4 a[236:239], v3, s[8:11], s26 offen offset:1024
  v_mfma_f32_16x16x32_bf16 v[40:43], a[244:247], a[232:235], v[40:43]
  buffer_load_dwordx4 a[240:243], v3, s[8:11], s26 offen offset:2048
  v_mfma_f32_16x16x32_bf16 v[44:47], a[248:251], a[224:227], 0
  buffer_load_dwordx4 a[244:247], v3, s[8:11], s26 offen offset:3072
  s_addk_i32 s26, 6144
  v_mfma_f32_16x16x32_bf16 v[44:47], a[252:255], a[228:231], v[44:47]
  v_fma_f32 v60, v60, v31, -v33
  v_fma_f32 v61, v61, v31, -v33
  v_mfma_f32_16x16x32_bf16 v[44:47], a[84:87], a[232:235], v[44:47]
  s_waitcnt vmcnt(12) lgkmcnt(1)
  v_fma_f32 v62, v62, v31, -v33
  v_fma_f32 v63, v63, v31, -v33
  v_mfma_f32_16x16x32_bf16 v[96:99], a[16:19], a[36:39], 0
  buffer_load_dwordx4 a[248:251], v3, s[8:11], s27 offen offset:0
  v_mfma_f32_16x16x32_bf16 v[104:107], a[16:19], a[40:43], 0
  v_cndmask_b32 v243, v243, v47, s[44:45]
  v_cndmask_b32 v242, v242, v46, s[44:45]
  v_mfma_f32_16x16x32_bf16 v[112:115], a[16:19], a[44:47], 0
  v_add_u32 v47, s56, v4
  v_min_u32 v46, 137, v47
  v_mfma_f32_16x16x32_bf16 v[120:123], a[16:19], a[48:51], 0
  v_lshlrev_b32 v47, 7, v46
  v_mov_b32 v46, 0x40000000
  v_mfma_f32_16x16x32_bf16 v[128:131], a[16:19], a[52:55], 0
  buffer_load_dwordx4 a[252:255], v3, s[8:11], s27 offen offset:1024
  s_addk_i32 s27, 6144
  s_cmp_eq_u32 s31, 1
  v_mfma_f32_16x16x32_bf16 v[136:139], a[16:19], a[56:59], 0
  s_cselect_b32 s70, s30, s67
  v_cndmask_b32 v47, v46, v47, vcc
  v_fma_f32 v68, v68, v31, -v33
  v_mfma_f32_16x16x32_bf16 v[144:147], a[20:23], a[36:39], 0
  ds_read_b128 a[16:19], v1 offset:0
  v_fma_f32 v69, v69, v31, -v33
  v_mfma_f32_16x16x32_bf16 v[152:155], a[20:23], a[40:43], 0
  v_fma_f32 v70, v70, v31, -v33
  v_fma_f32 v71, v71, v31, -v33
  v_mfma_f32_16x16x32_bf16 v[160:163], a[20:23], a[44:47], 0
  buffer_load_dword v47, s[4:7], s69 offen lds
  s_mov_b32 m0, s68
  v_mfma_f32_16x16x32_bf16 v[168:171], a[20:23], a[48:51], 0
  v_fma_f32 v20, v20, v31, -v33
  ds_read_b32 v31, v6 offset:128
  v_mfma_f32_16x16x32_bf16 v[176:179], a[20:23], a[52:55], 0
  v_exp_f32 v52, v52
  v_mfma_f32_16x16x32_bf16 v[184:187], a[20:23], a[56:59], 0
  v_exp_f32 v53, v53
  v_mfma_f32_16x16x32_bf16 v[192:195], a[24:27], a[36:39], 0
  ds_read_b128 a[20:23], v1 offset:12800
  v_add_f32 v35, v52, v53
  v_mfma_f32_16x16x32_bf16 v[200:203], a[24:27], a[40:43], 0
  v_exp_f32 v54, v54
  v_mfma_f32_16x16x32_bf16 v[208:211], a[24:27], a[44:47], 0
  v_exp_f32 v55, v55
  v_mfma_f32_16x16x32_bf16 v[248:251], a[24:27], a[48:51], 0
  v_exp_f32 v60, v60
  v_mfma_f32_16x16x32_bf16 a[156:159], a[24:27], a[52:55], 0
  v_exp_f32 v61, v61
  v_mfma_f32_16x16x32_bf16 a[160:163], a[24:27], a[56:59], 0
  v_add_f32 v35, v35, v54
  v_add_f32 v35, v35, v55
  v_mfma_f32_16x16x32_bf16 a[84:87], a[28:31], a[36:39], 0
  ds_read_b128 a[24:27], v1 offset:25600
  v_add_f32 v35, v35, v60
  v_mfma_f32_16x16x32_bf16 a[88:91], a[28:31], a[40:43], 0
  v_exp_f32 v62, v62
  v_mfma_f32_16x16x32_bf16 a[92:95], a[28:31], a[44:47], 0
  v_exp_f32 v63, v63
  v_mfma_f32_16x16x32_bf16 a[96:99], a[28:31], a[48:51], 0
  v_exp_f32 v68, v68
  v_mfma_f32_16x16x32_bf16 a[100:103], a[28:31], a[52:55], 0
  v_add_f32 v35, v35, v61
  v_add_f32 v35, v35, v62
  v_mfma_f32_16x16x32_bf16 a[104:107], a[28:31], a[56:59], 0
  v_exp_f32 v69, v69
  v_mfma_f32_16x16x32_bf16 a[108:111], a[0:3], a[36:39], 0
  ds_read_b128 a[28:31], v1 offset:38400
  v_add_f32 v35, v35, v63
  v_mfma_f32_16x16x32_bf16 a[112:115], a[0:3], a[40:43], 0
  v_exp_f32 v70, v70
  v_mfma_f32_16x16x32_bf16 a[116:119], a[0:3], a[44:47], 0
  v_exp_f32 v71, v71
  v_mfma_f32_16x16x32_bf16 a[120:123], a[0:3], a[48:51], 0
  v_add_f32 v35, v35, v68
  v_add_f32 v35, v35, v69
  v_mfma_f32_16x16x32_bf16 a[124:127], a[0:3], a[52:55], 0
  v_exp_f32 v20, v20
  v_mfma_f32_16x16x32_bf16 a[128:131], a[0:3], a[56:59], 0
  s_waitcnt lgkmcnt(4)
  v_add_f32 v35, v35, v70
  v_add_f32 v35, v35, v71
  v_mfma_f32_16x16x32_bf16 a[132:135], a[16:19], a[36:39], 0
  ds_read_b128 a[0:3], v2 offset:0
  v_add_f32 v35, v35, v20
  v_mfma_f32_16x16x32_bf16 a[136:139], a[16:19], a[40:43], 0
  v_mov_b32 v34, v35
  v_cndmask_b32 v224, v224, v36, s[44:45]
  v_mfma_f32_16x16x32_bf16 a[140:143], a[16:19], a[44:47], 0
  v_permlane32_swap_b32 v35, v34
  v_mfma_f32_16x16x32_bf16 a[144:147], a[16:19], a[48:51], 0
  v_add_f32 v35, v35, v34
  v_mov_b32 v34, v35
  v_mfma_f32_16x16x32_bf16 a[148:151], a[16:19], a[52:55], 0
  s_nop 0
  v_permlane16_swap_b32 v35, v34
  v_mfma_f32_16x16x32_bf16 a[152:155], a[16:19], a[56:59], 0
  s_waitcnt lgkmcnt(3)
  v_max3_f32 v36, v76, v77, v78
  v_max3_f32 v33, v100, v101, v102
  v_mfma_f32_16x16x32_bf16 a[164:167], a[20:23], a[36:39], 0
  ds_read_b128 a[16:19], v0 offset:64
  v_max3_f32 v36, v36, v79, v84
  v_mfma_f32_16x16x32_bf16 a[168:171], a[20:23], a[40:43], 0
  v_max3_f32 v33, v33, v103, v108
  v_cndmask_b32 v225, v225, v37, s[44:45]
  v_mfma_f32_16x16x32_bf16 a[172:175], a[20:23], a[44:47], 0
  v_add_f32 v35, v35, v34
  v_max3_f32 v36, v36, v85, v86
  v_mfma_f32_16x16x32_bf16 a[176:179], a[20:23], a[48:51], 0
  v_max3_f32 v33, v33, v109, v110
  v_mov_b32 v37, s64
  v_mfma_f32_16x16x32_bf16 a[180:183], a[20:23], a[52:55], 0
  v_max3_f32 v36, v36, v87, v92
  v_mov_b32 v34, s64
  v_mfma_f32_16x16x32_bf16 a[184:187], a[20:23], a[56:59], 0
  s_waitcnt lgkmcnt(3)
  v_max3_f32 v33, v33, v111, v116
  v_cndmask_b32 v21, v37, v21, s[38:39]
  v_mfma_f32_16x16x32_bf16 a[188:191], a[24:27], a[36:39], 0
  ds_read_b128 a[20:23], v0 offset:12864
  v_max3_f32 v36, v36, v93, v94
  v_mfma_f32_16x16x32_bf16 a[192:195], a[24:27], a[40:43], 0
  v_cndmask_b32 v22, v34, v22, s[38:39]
  v_max3_f32 v33, v33, v117, v118
  v_mfma_f32_16x16x32_bf16 a[196:199], a[24:27], a[44:47], 0
  v_max3_f32 v36, v36, v95, v21
  v_max3_f32 v33, v33, v119, v22
  v_mfma_f32_16x16x32_bf16 a[200:203], a[24:27], a[48:51], 0
  v_mov_b32 v37, v36
  v_mov_b32 v34, v33
  v_mfma_f32_16x16x32_bf16 a[204:207], a[24:27], a[52:55], 0
  v_permlane32_swap_b32 v36, v37
  v_mfma_f32_16x16x32_bf16 a[208:211], a[24:27], a[56:59], 0
  s_waitcnt lgkmcnt(3)
  v_permlane32_swap_b32 v33, v34
  v_mfma_f32_16x16x32_bf16 a[212:215], a[28:31], a[36:39], 0
  ds_read_b128 a[24:27], v0 offset:25664
  v_max_f32 v36, v36, v37
  v_mfma_f32_16x16x32_bf16 a[216:219], a[28:31], a[40:43], 0
  v_max_f32 v33, v33, v34
  v_mov_b32 v37, v36
  v_mfma_f32_16x16x32_bf16 a[220:223], a[28:31], a[44:47], 0
  v_mov_b32 v34, v33
  v_mul_f32 v32, s46, v32
  v_mfma_f32_16x16x32_bf16 a[224:227], a[28:31], a[48:51], 0
  v_permlane16_swap_b32 v36, v37
  v_mfma_f32_16x16x32_bf16 a[228:231], a[28:31], a[52:55], 0
  v_permlane16_swap_b32 v33, v34
  v_mfma_f32_16x16x32_bf16 a[232:235], a[28:31], a[56:59], 0
  s_waitcnt lgkmcnt(3)
  v_max_f32 v36, v36, v37
  v_mul_f32 v31, s46, v31
  v_mfma_f32_16x16x32_bf16 v[48:51], a[0:3], a[36:39], 0
  ds_read_b128 a[28:31], v0 offset:38464
  v_max_f32 v33, v33, v34
  v_mfma_f32_16x16x32_bf16 v[56:59], a[0:3], a[40:43], 0
  buffer_load_dwordx4 a[36:39], v3, s[8:11], s26 offen offset:0
  v_mfma_f32_16x16x32_bf16 v[64:67], a[0:3], a[44:47], 0
  buffer_load_dwordx4 a[40:43], v3, s[8:11], s26 offen offset:1024
  v_mfma_f32_16x16x32_bf16 v[72:75], a[0:3], a[48:51], 0
  buffer_load_dwordx4 a[44:47], v3, s[8:11], s26 offen offset:2048
  v_mfma_f32_16x16x32_bf16 v[80:83], a[0:3], a[52:55], 0
  v_mul_f32 v36, v36, v32
  v_mul_f32 v33, v33, v31
  v_mfma_f32_16x16x32_bf16 v[88:91], a[0:3], a[56:59], 0
  s_waitcnt vmcnt(11) lgkmcnt(3)
  v_rcp_f32 v35, v35
  v_mfma_f32_16x16x32_bf16 v[96:99], a[16:19], a[60:63], v[96:99]
  buffer_load_dwordx4 a[48:51], v3, s[8:11], s26 offen offset:3072
  s_addk_i32 s26, 6144
  v_mfma_f32_16x16x32_bf16 v[104:107], a[16:19], a[64:67], v[104:107]
  ds_read_b128 a[0:3], v0 offset:51264
  v_fma_f32 v76, v76, v32, -v36
  v_mfma_f32_16x16x32_bf16 v[112:115], a[16:19], a[68:71], v[112:115]
  v_fma_f32 v77, v77, v32, -v36
  v_fma_f32 v100, v100, v31, -v33
  v_mfma_f32_16x16x32_bf16 v[120:123], a[16:19], a[72:75], v[120:123]
  v_fma_f32 v101, v101, v31, -v33
  v_fma_f32 v78, v78, v32, -v36
  v_mfma_f32_16x16x32_bf16 v[128:131], a[16:19], a[76:79], v[128:131]
  buffer_load_dwordx4 a[52:55], v3, s[8:11], s27 offen offset:0
  v_mfma_f32_16x16x32_bf16 v[136:139], a[16:19], a[80:83], v[136:139]
  s_waitcnt lgkmcnt(3)
  v_exp_f32 v76, v76
  v_mfma_f32_16x16x32_bf16 v[144:147], a[20:23], a[60:63], v[144:147]
  ds_read_b128 a[16:19], v1 offset:64
  v_fma_f32 v102, v102, v31, -v33
  v_mfma_f32_16x16x32_bf16 v[152:155], a[20:23], a[64:67], v[152:155]
  v_exp_f32 v77, v77
  v_mfma_f32_16x16x32_bf16 v[160:163], a[20:23], a[68:71], v[160:163]
  buffer_load_dwordx4 a[56:59], v3, s[8:11], s27 offen offset:1024
  s_addk_i32 s27, 6144
  s_cmp_eq_u32 s31, 2
  v_mfma_f32_16x16x32_bf16 v[168:171], a[20:23], a[72:75], v[168:171]
  s_cselect_b32 s69, s30, s67
  s_add_u32 s29, s29, 290304
  v_mul_f32 v52, v52, v8
  v_mfma_f32_16x16x32_bf16 v[176:179], a[20:23], a[76:79], v[176:179]
  s_max_i32 s30, s29, 0
  s_cmp_ge_u32 s63, 972
  v_mul_f32 v53, v53, v9
  v_mfma_f32_16x16x32_bf16 v[184:187], a[20:23], a[80:83], v[184:187]
  s_cselect_b32 s30, s67, s30
  s_cmp_eq_u32 s31, 0
  buffer_load_dword v47, s[4:7], s70 offen lds
  s_cselect_b32 s70, s30, s67
  s_mov_b32 m0, s68
  s_waitcnt lgkmcnt(3)
  v_mfma_f32_16x16x32_bf16 v[192:195], a[24:27], a[60:63], v[192:195]
  ds_read_b128 a[20:23], v1 offset:12864
  v_mul_f32 v54, v54, v10
  v_mfma_f32_16x16x32_bf16 v[200:203], a[24:27], a[64:67], v[200:203]
  v_exp_f32 v100, v100
  v_mfma_f32_16x16x32_bf16 v[208:211], a[24:27], a[68:71], v[208:211]
  v_exp_f32 v101, v101
  v_mfma_f32_16x16x32_bf16 v[248:251], a[24:27], a[72:75], v[248:251]
  v_mul_f32 v55, v55, v11
  v_mul_f32 v60, v60, v12
  v_mfma_f32_16x16x32_bf16 a[156:159], a[24:27], a[76:79], a[156:159]
  v_mul_f32 v61, v61, v13
  v_mul_f32 v62, v62, v14
  v_mfma_f32_16x16x32_bf16 a[160:163], a[24:27], a[80:83], a[160:163]
  s_waitcnt lgkmcnt(3)
  v_mul_f32 v63, v63, v15
  v_mul_f32 v68, v68, v16
  v_mfma_f32_16x16x32_bf16 a[84:87], a[28:31], a[60:63], a[84:87]
  ds_read_b128 a[24:27], v1 offset:25664
  v_mul_f32 v69, v69, v17
  v_mfma_f32_16x16x32_bf16 a[88:91], a[28:31], a[64:67], a[88:91]
  v_mul_f32 v70, v70, v18
  v_mul_f32 v71, v71, v19
  v_mfma_f32_16x16x32_bf16 a[92:95], a[28:31], a[68:71], a[92:95]
  v_mul_f32 v20, v20, v30
  v_fma_f32 v79, v79, v32, -v36
  v_mfma_f32_16x16x32_bf16 a[96:99], a[28:31], a[72:75], a[96:99]
  v_exp_f32 v78, v78
  v_mfma_f32_16x16x32_bf16 a[100:103], a[28:31], a[76:79], a[100:103]
  v_fma_f32 v103, v103, v31, -v33
  v_cndmask_b32 v226, v226, v38, s[44:45]
  v_mfma_f32_16x16x32_bf16 a[104:107], a[28:31], a[80:83], a[104:107]
  s_waitcnt lgkmcnt(3)
  v_exp_f32 v102, v102
  v_mfma_f32_16x16x32_bf16 a[108:111], a[0:3], a[60:63], a[108:111]
  ds_read_b128 a[28:31], v1 offset:38464
  v_mul_f32 v52, v52, v35
  v_mfma_f32_16x16x32_bf16 a[112:115], a[0:3], a[64:67], a[112:115]
  v_mul_f32 v53, v53, v35
  v_mul_f32 v54, v54, v35
  v_mfma_f32_16x16x32_bf16 a[116:119], a[0:3], a[68:71], a[116:119]
  v_mul_f32 v55, v55, v35
  v_mul_f32 v60, v60, v35
  v_mfma_f32_16x16x32_bf16 a[120:123], a[0:3], a[72:75], a[120:123]
  v_mul_f32 v61, v61, v35
  v_mul_f32 v62, v62, v35
  v_mfma_f32_16x16x32_bf16 a[124:127], a[0:3], a[76:79], a[124:127]
  v_mul_f32 v63, v63, v35
  v_mul_f32 v68, v68, v35
  v_mfma_f32_16x16x32_bf16 a[128:131], a[0:3], a[80:83], a[128:131]
  s_waitcnt lgkmcnt(3)
  v_mul_f32 v69, v69, v35
  v_mul_f32 v70, v70, v35
  v_mfma_f32_16x16x32_bf16 a[132:135], a[16:19], a[60:63], a[132:135]
  ds_read_b128 a[0:3], v2 offset:64
  v_mul_f32 v71, v71, v35
  v_mfma_f32_16x16x32_bf16 a[136:139], a[16:19], a[64:67], a[136:139]
  v_mul_f32 v20, v20, v35
  v_fma_f32 v84, v84, v32, -v36
  v_mfma_f32_16x16x32_bf16 a[140:143], a[16:19], a[68:71], a[140:143]
  v_exp_f32 v79, v79
  v_mfma_f32_16x16x32_bf16 a[144:147], a[16:19], a[72:75], a[144:147]
  v_fma_f32 v108, v108, v31, -v33
  v_fma_f32 v85, v85, v32, -v36
  v_mfma_f32_16x16x32_bf16 a[148:151], a[16:19], a[76:79], a[148:151]
  v_exp_f32 v103, v103
  v_mfma_f32_16x16x32_bf16 a[152:155], a[16:19], a[80:83], a[152:155]
  s_waitcnt lgkmcnt(3)
  v_exp_f32 v84, v84
  v_mfma_f32_16x16x32_bf16 a[164:167], a[20:23], a[60:63], a[164:167]
  ds_read_b128 a[16:19], v0 offset:128
  v_add_f32 v38, v76, v77
  v_mfma_f32_16x16x32_bf16 a[168:171], a[20:23], a[64:67], a[168:171]
  v_fma_f32 v109, v109, v31, -v33
  v_add_f32 v35, v100, v101
  v_mfma_f32_16x16x32_bf16 a[172:175], a[20:23], a[68:71], a[172:175]
  v_exp_f32 v108, v108
  v_mfma_f32_16x16x32_bf16 a[176:179], a[20:23], a[72:75], a[176:179]
  v_fma_f32 v86, v86, v32, -v36
  v_add_f32 v38, v38, v78
  v_mfma_f32_16x16x32_bf16 a[180:183], a[20:23], a[76:79], a[180:183]
  v_exp_f32 v85, v85
  v_mfma_f32_16x16x32_bf16 a[184:187], a[20:23], a[80:83], a[184:187]
  s_waitcnt lgkmcnt(3)
  v_fma_f32 v110, v110, v31, -v33
  v_add_f32 v35, v35, v102
  v_mfma_f32_16x16x32_bf16 a[188:191], a[24:27], a[60:63], a[188:191]
  ds_read_b128 a[20:23], v0 offset:12928
  v_fma_f32 v87, v87, v32, -v36
  v_mfma_f32_16x16x32_bf16 a[192:195], a[24:27], a[64:67], a[192:195]
  v_exp_f32 v109, v109
  v_mfma_f32_16x16x32_bf16 a[196:199], a[24:27], a[68:71], a[196:199]
  v_exp_f32 v86, v86
  v_mfma_f32_16x16x32_bf16 a[200:203], a[24:27], a[72:75], a[200:203]
  v_add_f32 v38, v38, v79
  v_fma_f32 v111, v111, v31, -v33
  v_mfma_f32_16x16x32_bf16 a[204:207], a[24:27], a[76:79], a[204:207]
  v_exp_f32 v110, v110
  v_mfma_f32_16x16x32_bf16 a[208:211], a[24:27], a[80:83], a[208:211]
  s_waitcnt lgkmcnt(3)
  v_add_f32 v35, v35, v103
  v_fma_f32 v92, v92, v32, -v36
  v_mfma_f32_16x16x32_bf16 a[212:215], a[28:31], a[60:63], a[212:215]
  ds_read_b128 a[24:27], v0 offset:25728
  v_add_f32 v38, v38, v84
  v_mfma_f32_16x16x32_bf16 a[216:219], a[28:31], a[64:67], a[216:219]
  v_exp_f32 v87, v87
  v_mfma_f32_16x16x32_bf16 a[220:223], a[28:31], a[68:71], a[220:223]
  v_fma_f32 v116, v116, v31, -v33
  v_add_f32 v35, v35, v108
  v_mfma_f32_16x16x32_bf16 a[224:227], a[28:31], a[72:75], a[224:227]
  v_exp_f32 v111, v111
  v_mfma_f32_16x16x32_bf16 a[228:231], a[28:31], a[76:79], a[228:231]
  v_fma_f32 v93, v93, v32, -v36
  v_add_f32 v38, v38, v85
  v_mfma_f32_16x16x32_bf16 a[232:235], a[28:31], a[80:83], a[232:235]
  s_waitcnt lgkmcnt(3)
  v_exp_f32 v92, v92
  v_mfma_f32_16x16x32_bf16 v[48:51], a[0:3], a[60:63], v[48:51]
  ds_read_b128 a[28:31], v0 offset:38528
  v_fma_f32 v117, v117, v31, -v33
  v_mfma_f32_16x16x32_bf16 v[56:59], a[0:3], a[64:67], v[56:59]
  buffer_load_dwordx4 a[60:63], v3, s[8:11], s26 offen offset:0
  v_mfma_f32_16x16x32_bf16 v[64:67], a[0:3], a[68:71], v[64:67]
  buffer_load_dwordx4 a[64:67], v3, s[8:11], s26 offen offset:1024
  v_mfma_f32_16x16x32_bf16 v[72:75], a[0:3], a[72:75], v[72:75]
  buffer_load_dwordx4 a[68:71], v3, s[8:11], s26 offen offset:2048
  v_mfma_f32_16x16x32_bf16 v[80:83], a[0:3], a[76:79], v[80:83]
  v_exp_f32 v116, v116
  v_mfma_f32_16x16x32_bf16 v[88:91], a[0:3], a[80:83], v[88:91]
  s_waitcnt vmcnt(11) lgkmcnt(3)
  v_add_f32 v35, v35, v109
  v_fma_f32 v94, v94, v32, -v36
  v_mfma_f32_16x16x32_bf16 v[96:99], a[16:19], a[32:35], v[96:99]
  buffer_load_dwordx4 a[72:75], v3, s[8:11], s26 offen offset:3072
  s_addk_i32 s26, 6144
  v_mfma_f32_16x16x32_bf16 v[104:107], a[16:19], a[236:239], v[104:107]
  ds_read_b128 a[0:3], v0 offset:51328
  v_add_f32 v38, v38, v86
  v_mfma_f32_16x16x32_bf16 v[112:115], a[16:19], a[240:243], v[112:115]
  v_exp_f32 v93, v93
  v_mfma_f32_16x16x32_bf16 v[120:123], a[16:19], a[244:247], v[120:123]
  v_fma_f32 v118, v118, v31, -v33
  v_add_f32 v35, v35, v110
  v_mfma_f32_16x16x32_bf16 v[128:131], a[16:19], a[248:251], v[128:131]
  buffer_load_dwordx4 a[76:79], v3, s[8:11], s27 offen offset:0
  v_mfma_f32_16x16x32_bf16 v[136:139], a[16:19], a[252:255], v[136:139]
  s_waitcnt lgkmcnt(3)
  v_exp_f32 v117, v117
  v_mfma_f32_16x16x32_bf16 v[144:147], a[20:23], a[32:35], v[144:147]
  ds_read_b128 a[16:19], v1 offset:128
  v_fma_f32 v95, v95, v32, -v36
  v_mfma_f32_16x16x32_bf16 v[152:155], a[20:23], a[236:239], v[152:155]
  v_exp_f32 v94, v94
  v_mfma_f32_16x16x32_bf16 v[160:163], a[20:23], a[240:243], v[160:163]
  buffer_load_dwordx4 a[80:83], v3, s[8:11], s27 offen offset:1024
  s_addk_i32 s27, 6144
  s_cmp_eq_u32 s31, 1
  v_mfma_f32_16x16x32_bf16 v[168:171], a[20:23], a[244:247], v[168:171]
  v_add_f32 v38, v38, v87
  v_fma_f32 v119, v119, v31, -v33
  v_mfma_f32_16x16x32_bf16 v[176:179], a[20:23], a[248:251], v[176:179]
  v_exp_f32 v118, v118
  v_mfma_f32_16x16x32_bf16 v[184:187], a[20:23], a[252:255], v[184:187]
  s_waitcnt lgkmcnt(3)
  v_add_f32 v35, v35, v111
  v_fma_f32 v21, v21, v32, -v36
  v_mfma_f32_16x16x32_bf16 v[192:195], a[24:27], a[32:35], v[192:195]
  buffer_load_dword v47, s[4:7], s69 offen lds
  s_cselect_b32 s69, s30, s67
  s_mov_b32 m0, s68
  v_mfma_f32_16x16x32_bf16 v[200:203], a[24:27], a[236:239], v[200:203]
  ds_read_b128 a[20:23], v1 offset:12928
  v_add_f32 v38, v38, v92
  v_mfma_f32_16x16x32_bf16 v[208:211], a[24:27], a[240:243], v[208:211]
  v_exp_f32 v95, v95
  v_mfma_f32_16x16x32_bf16 v[248:251], a[24:27], a[244:247], v[248:251]
  v_fma_f32 v22, v22, v31, -v33
  v_add_f32 v35, v35, v116
  v_mfma_f32_16x16x32_bf16 a[156:159], a[24:27], a[248:251], a[156:159]
  v_exp_f32 v119, v119
  v_mfma_f32_16x16x32_bf16 a[160:163], a[24:27], a[252:255], a[160:163]
  buffer_load_dword v47, s[4:7], s70 offen lds
  s_mov_b32 m0, s68
  s_waitcnt lgkmcnt(3)
  v_mfma_f32_16x16x32_bf16 a[84:87], a[28:31], a[32:35], a[84:87]
  ds_read_b128 a[24:27], v1 offset:25728
  v_add_f32 v38, v38, v93
  v_mfma_f32_16x16x32_bf16 a[88:91], a[28:31], a[236:239], a[88:91]
  v_exp_f32 v21, v21
  v_mfma_f32_16x16x32_bf16 a[92:95], a[28:31], a[240:243], a[92:95]
  v_mul_f32 v76, v76, v8
  v_mul_f32 v77, v77, v9
  v_mfma_f32_16x16x32_bf16 a[96:99], a[28:31], a[244:247], a[96:99]
  v_mul_f32 v78, v78, v10
  v_mul_f32 v79, v79, v11
  v_mfma_f32_16x16x32_bf16 a[100:103], a[28:31], a[248:251], a[100:103]
  v_exp_f32 v22, v22
  v_mfma_f32_16x16x32_bf16 a[104:107], a[28:31], a[252:255], a[104:107]
  s_waitcnt lgkmcnt(3)
  v_add_f32 v35, v35, v117
  v_mul_f32 v100, v100, v8
  v_mfma_f32_16x16x32_bf16 a[108:111], a[0:3], a[32:35], a[108:111]
  ds_read_b128 a[28:31], v1 offset:38528
  v_mul_f32 v101, v101, v9
  v_mfma_f32_16x16x32_bf16 a[112:115], a[0:3], a[236:239], a[112:115]
  v_mul_f32 v102, v102, v10
  v_mul_f32 v103, v103, v11
  v_mfma_f32_16x16x32_bf16 a[116:119], a[0:3], a[240:243], a[116:119]
  v_add_f32 v38, v38, v94
  v_mul_f32 v84, v84, v12
  v_mfma_f32_16x16x32_bf16 a[120:123], a[0:3], a[244:247], a[120:123]
  v_mul_f32 v85, v85, v13
  v_mul_f32 v86, v86, v14
  v_mfma_f32_16x16x32_bf16 a[124:127], a[0:3], a[248:251], a[124:127]
  v_mul_f32 v87, v87, v15
  v_add_f32 v35, v35, v118
  v_mfma_f32_16x16x32_bf16 a[128:131], a[0:3], a[252:255], a[128:131]
  s_waitcnt lgkmcnt(3)
  v_mul_f32 v108, v108, v12
  v_mul_f32 v109, v109, v13
  v_mfma_f32_16x16x32_bf16 a[132:135], a[16:19], a[32:35], a[132:135]
  ds_read_b128 a[0:3], v2 offset:128
  v_mul_f32 v110, v110, v14
  v_mfma_f32_16x16x32_bf16 a[136:139], a[16:19], a[236:239], a[136:139]
  v_mul_f32 v111, v111, v15
  ds_read_b128 v[8:11], v5 offset:192
  v_mfma_f32_16x16x32_bf16 a[140:143], a[16:19], a[240:243], a[140:143]
  v_add_f32 v38, v38, v95
  v_add_f32 v35, v35, v119
  v_mfma_f32_16x16x32_bf16 a[144:147], a[16:19], a[244:247], a[144:147]
  ds_read_b128 v[12:15], v5 offset:256
  v_add_f32 v38, v38, v21
  v_mfma_f32_16x16x32_bf16 a[148:151], a[16:19], a[248:251], a[148:151]
  v_mul_f32 v92, v92, v16
  v_mul_f32 v93, v93, v17
  v_mfma_f32_16x16x32_bf16 a[152:155], a[16:19], a[252:255], a[152:155]
  s_waitcnt lgkmcnt(5)
  v_mul_f32 v94, v94, v18
  v_mul_f32 v95, v95, v19
  v_mfma_f32_16x16x32_bf16 a[164:167], a[20:23], a[32:35], a[164:167]
  ds_read_b128 a[16:19], v0 offset:192
  v_add_f32 v35, v35, v22
  v_mfma_f32_16x16x32_bf16 a[168:171], a[20:23], a[236:239], a[168:171]
  v_mul_f32 v116, v116, v16
  v_mul_f32 v117, v117, v17
  v_mfma_f32_16x16x32_bf16 a[172:175], a[20:23], a[240:243], a[172:175]
  v_mul_f32 v118, v118, v18
  v_mul_f32 v119, v119, v19
  v_mfma_f32_16x16x32_bf16 a[176:179], a[20:23], a[244:247], a[176:179]
  v_mul_f32 v21, v21, v30
  v_mul_f32 v22, v22, v30
  v_mfma_f32_16x16x32_bf16 a[180:183], a[20:23], a[248:251], a[180:183]
  ds_read_b128 v[16:19], v5 offset:320
  v_mov_b32 v37, v38
  v_mfma_f32_16x16x32_bf16 a[184:187], a[20:23], a[252:255], a[184:187]
  s_waitcnt lgkmcnt(6)
  ds_read_b32 v30, v7 offset:580
  ds_read_b32 v32, v6 offset:192
  v_mfma_f32_16x16x32_bf16 a[188:191], a[24:27], a[32:35], a[188:191]
  ds_read_b128 a[20:23], v0 offset:12992
  v_mov_b32 v34, v35
  v_mfma_f32_16x16x32_bf16 a[192:195], a[24:27], a[236:239], a[192:195]
  v_permlane32_swap_b32 v38, v37
  v_mfma_f32_16x16x32_bf16 a[196:199], a[24:27], a[240:243], a[196:199]
  v_add_f32 v38, v38, v37
  v_mov_b32 v37, v38
  v_mfma_f32_16x16x32_bf16 a[200:203], a[24:27], a[244:247], a[200:203]
  s_nop 0
  v_permlane16_swap_b32 v38, v37
  v_mfma_f32_16x16x32_bf16 a[204:207], a[24:27], a[248:251], a[204:207]
  s_waitcnt lgkmcnt(6)
  v_mul_f32 v124, v124, v8
  v_mul_f32 v125, v125, v9
  v_mfma_f32_16x16x32_bf16 a[208:211], a[24:27], a[252:255], a[208:211]
  v_mul_f32 v126, v126, v10
  v_mul_f32 v127, v127, v11
  v_mfma_f32_16x16x32_bf16 a[212:215], a[28:31], a[32:35], a[212:215]
  s_waitcnt lgkmcnt(5)
  ds_read_b128 a[24:27], v0 offset:25792
  v_mul_f32 v132, v132, v12
  v_mfma_f32_16x16x32_bf16 a[216:219], a[28:31], a[236:239], a[216:219]
  v_max3_f32 v36, v124, v125, v126
  v_mul_f32 v133, v133, v13
  v_mfma_f32_16x16x32_bf16 a[220:223], a[28:31], a[240:243], a[220:223]
  v_mul_f32 v134, v134, v14
  v_max3_f32 v36, v36, v127, v132
  v_mfma_f32_16x16x32_bf16 a[224:227], a[28:31], a[244:247], a[224:227]
  v_add_f32 v38, v38, v37
  v_mul_f32 v135, v135, v15
  v_mfma_f32_16x16x32_bf16 a[228:231], a[28:31], a[248:251], a[228:231]
  v_max3_f32 v36, v36, v133, v134
  v_mov_b32 v37, s64
  v_mfma_f32_16x16x32_bf16 a[232:235], a[28:31], a[252:255], a[232:235]
  s_waitcnt lgkmcnt(4)
  v_mul_f32 v140, v140, v16
  v_mul_f32 v141, v141, v17
  v_mfma_f32_16x16x32_bf16 v[48:51], a[0:3], a[32:35], v[48:51]
  ds_read_b128 a[28:31], v0 offset:38592
  v_mul_f32 v142, v142, v18
  v_mfma_f32_16x16x32_bf16 v[56:59], a[0:3], a[236:239], v[56:59]
  buffer_load_dwordx4 a[32:35], v3, s[8:11], s26 offen offset:0
  v_mfma_f32_16x16x32_bf16 v[64:67], a[0:3], a[240:243], v[64:67]
  buffer_load_dwordx4 a[236:239], v3, s[8:11], s26 offen offset:1024
  v_mfma_f32_16x16x32_bf16 v[72:75], a[0:3], a[244:247], v[72:75]
  buffer_load_dwordx4 a[240:243], v3, s[8:11], s26 offen offset:2048
  v_mfma_f32_16x16x32_bf16 v[80:83], a[0:3], a[248:251], v[80:83]
  s_waitcnt lgkmcnt(4)
  v_mul_f32 v23, v23, v30
  v_max3_f32 v36, v36, v135, v140
  v_mfma_f32_16x16x32_bf16 v[88:91], a[0:3], a[252:255], v[88:91]
  s_waitcnt vmcnt(12)
  v_mul_f32 v143, v143, v19
  v_cndmask_b32 v23, v37, v23, s[38:39]
  v_mfma_f32_16x16x32_bf16 v[96:99], a[16:19], a[36:39], v[96:99]
  buffer_load_dwordx4 a[244:247], v3, s[8:11], s26 offen offset:3072
  s_addk_i32 s26, 6144
  v_mfma_f32_16x16x32_bf16 v[104:107], a[16:19], a[40:43], v[104:107]
  ds_read_b128 a[0:3], v0 offset:51392
  v_max3_f32 v36, v36, v141, v142
  v_mfma_f32_16x16x32_bf16 v[112:115], a[16:19], a[44:47], v[112:115]
  v_max3_f32 v36, v36, v143, v23
  v_mov_b32 v37, v36
  v_mfma_f32_16x16x32_bf16 v[120:123], a[16:19], a[48:51], v[120:123]
  s_nop 0
  v_permlane32_swap_b32 v36, v37
  v_mfma_f32_16x16x32_bf16 v[128:131], a[16:19], a[52:55], v[128:131]
  buffer_load_dwordx4 a[248:251], v3, s[8:11], s27 offen offset:0
  v_mfma_f32_16x16x32_bf16 v[136:139], a[16:19], a[56:59], v[136:139]
  s_waitcnt lgkmcnt(3)
  v_max_f32 v36, v36, v37
  v_mov_b32 v37, v36
  v_mfma_f32_16x16x32_bf16 v[144:147], a[20:23], a[36:39], v[144:147]
  ds_read_b128 a[16:19], v1 offset:192
  v_mul_f32 v32, s46, v32
  v_mfma_f32_16x16x32_bf16 v[152:155], a[20:23], a[40:43], v[152:155]
  v_permlane16_swap_b32 v36, v37
  v_mfma_f32_16x16x32_bf16 v[160:163], a[20:23], a[44:47], v[160:163]
  buffer_load_dwordx4 a[252:255], v3, s[8:11], s27 offen offset:1024
  s_addk_i32 s27, 6144
  s_cmp_eq_u32 s31, 2
  v_mfma_f32_16x16x32_bf16 v[168:171], a[20:23], a[48:51], v[168:171]
  s_cselect_b32 s70, s30, s67
  v_max_f32 v36, v36, v37
  v_mul_f32 v36, v36, v32
  v_mfma_f32_16x16x32_bf16 v[176:179], a[20:23], a[52:55], v[176:179]
  v_fma_f32 v124, v124, v32, -v36
  v_fma_f32 v125, v125, v32, -v36
  v_mfma_f32_16x16x32_bf16 v[184:187], a[20:23], a[56:59], v[184:187]
  s_waitcnt lgkmcnt(3)
  v_fma_f32 v126, v126, v32, -v36
  v_fma_f32 v127, v127, v32, -v36
  v_mfma_f32_16x16x32_bf16 v[192:195], a[24:27], a[36:39], v[192:195]
  buffer_load_dword v47, s[4:7], s69 offen lds
  s_mov_b32 m0, s68
  v_mfma_f32_16x16x32_bf16 v[200:203], a[24:27], a[40:43], v[200:203]
  ds_read_b128 a[20:23], v1 offset:12992
  v_fma_f32 v132, v132, v32, -v36
  v_mfma_f32_16x16x32_bf16 v[208:211], a[24:27], a[44:47], v[208:211]
  v_fma_f32 v133, v133, v32, -v36
  v_fma_f32 v134, v134, v32, -v36
  v_mfma_f32_16x16x32_bf16 v[248:251], a[24:27], a[48:51], v[248:251]
  v_fma_f32 v135, v135, v32, -v36
  v_fma_f32 v140, v140, v32, -v36
  v_mfma_f32_16x16x32_bf16 a[156:159], a[24:27], a[52:55], a[156:159]
  v_fma_f32 v141, v141, v32, -v36
  v_fma_f32 v142, v142, v32, -v36
  v_mfma_f32_16x16x32_bf16 a[160:163], a[24:27], a[56:59], a[160:163]
  s_waitcnt lgkmcnt(3)
  v_fma_f32 v143, v143, v32, -v36
  v_fma_f32 v23, v23, v32, -v36
  v_mfma_f32_16x16x32_bf16 a[84:87], a[28:31], a[36:39], a[84:87]
  ds_read_b128 a[24:27], v1 offset:25792
  v_mfma_f32_16x16x32_bf16 a[88:91], a[28:31], a[40:43], a[88:91]
  ds_read_b32 v31, v6 offset:256
  ds_read_b32 v32, v6 offset:320
  v_mfma_f32_16x16x32_bf16 a[92:95], a[28:31], a[44:47], a[92:95]
  v_rcp_f32 v38, v38
  v_mfma_f32_16x16x32_bf16 a[96:99], a[28:31], a[48:51], a[96:99]
  v_exp_f32 v124, v124
  v_mfma_f32_16x16x32_bf16 a[100:103], a[28:31], a[52:55], a[100:103]
  v_exp_f32 v125, v125
  v_mfma_f32_16x16x32_bf16 a[104:107], a[28:31], a[56:59], a[104:107]
  s_waitcnt lgkmcnt(5)
  v_exp_f32 v126, v126
  v_mfma_f32_16x16x32_bf16 a[108:111], a[0:3], a[36:39], a[108:111]
  ds_read_b128 a[28:31], v1 offset:38592
  v_mul_f32 v76, v76, v38
  v_mfma_f32_16x16x32_bf16 a[112:115], a[0:3], a[40:43], a[112:115]
  v_mul_f32 v77, v77, v38
  v_mul_f32 v78, v78, v38
  v_mfma_f32_16x16x32_bf16 a[116:119], a[0:3], a[44:47], a[116:119]
  v_mul_f32 v79, v79, v38
  v_mul_f32 v84, v84, v38
  v_mfma_f32_16x16x32_bf16 a[120:123], a[0:3], a[48:51], a[120:123]
  v_mul_f32 v85, v85, v38
  v_mul_f32 v86, v86, v38
  v_mfma_f32_16x16x32_bf16 a[124:127], a[0:3], a[52:55], a[124:127]
  v_mul_f32 v87, v87, v38
  v_mul_f32 v92, v92, v38
  v_mfma_f32_16x16x32_bf16 a[128:131], a[0:3], a[56:59], a[128:131]
  s_waitcnt lgkmcnt(5)
  v_mul_f32 v93, v93, v38
  v_mul_f32 v94, v94, v38
  v_mfma_f32_16x16x32_bf16 a[132:135], a[16:19], a[36:39], a[132:135]
  ds_read_b128 a[0:3], v2 offset:192
  v_mul_f32 v95, v95, v38
  v_mfma_f32_16x16x32_bf16 a[136:139], a[16:19], a[40:43], a[136:139]
  v_mul_f32 v21, v21, v38
  v_add_f32 v38, v124, v125
  v_mfma_f32_16x16x32_bf16 a[140:143], a[16:19], a[44:47], a[140:143]
  v_exp_f32 v127, v127
  v_mfma_f32_16x16x32_bf16 a[144:147], a[16:19], a[48:51], a[144:147]
  v_exp_f32 v132, v132
  v_mfma_f32_16x16x32_bf16 a[148:151], a[16:19], a[52:55], a[148:151]
  v_exp_f32 v133, v133
  v_mfma_f32_16x16x32_bf16 a[152:155], a[16:19], a[56:59], a[152:155]
  s_waitcnt lgkmcnt(5)
  v_add_f32 v38, v38, v126
  v_add_f32 v38, v38, v127
  v_mfma_f32_16x16x32_bf16 a[164:167], a[20:23], a[36:39], a[164:167]
  ds_read_b128 a[16:19], v0 offset:256
  v_add_f32 v38, v38, v132
  v_mfma_f32_16x16x32_bf16 a[168:171], a[20:23], a[40:43], a[168:171]
  v_exp_f32 v134, v134
  v_mfma_f32_16x16x32_bf16 a[172:175], a[20:23], a[44:47], a[172:175]
  v_exp_f32 v135, v135
  v_mfma_f32_16x16x32_bf16 a[176:179], a[20:23], a[48:51], a[176:179]
  v_exp_f32 v140, v140
  v_mfma_f32_16x16x32_bf16 a[180:183], a[20:23], a[52:55], a[180:183]
  v_add_f32 v38, v38, v133
  v_add_f32 v38, v38, v134
  v_mfma_f32_16x16x32_bf16 a[184:187], a[20:23], a[56:59], a[184:187]
  s_waitcnt lgkmcnt(3)
  v_exp_f32 v141, v141
  v_mfma_f32_16x16x32_bf16 a[188:191], a[24:27], a[36:39], a[188:191]
  ds_read_b128 a[20:23], v0 offset:13056
  v_add_f32 v38, v38, v135
  v_mfma_f32_16x16x32_bf16 a[192:195], a[24:27], a[40:43], a[192:195]
  v_exp_f32 v142, v142
  v_mfma_f32_16x16x32_bf16 a[196:199], a[24:27], a[44:47], a[196:199]
  v_exp_f32 v143, v143
  v_mfma_f32_16x16x32_bf16 a[200:203], a[24:27], a[48:51], a[200:203]
  v_add_f32 v38, v38, v140
  v_add_f32 v38, v38, v141
  v_mfma_f32_16x16x32_bf16 a[204:207], a[24:27], a[52:55], a[204:207]
  v_exp_f32 v23, v23
  v_mfma_f32_16x16x32_bf16 a[208:211], a[24:27], a[56:59], a[208:211]
  s_waitcnt lgkmcnt(3)
  v_add_f32 v38, v38, v142
  v_add_f32 v38, v38, v143
  v_mfma_f32_16x16x32_bf16 a[212:215], a[28:31], a[36:39], a[212:215]
  ds_read_b128 a[24:27], v0 offset:25856
  v_add_f32 v38, v38, v23
  v_mfma_f32_16x16x32_bf16 a[216:219], a[28:31], a[40:43], a[216:219]
  v_mov_b32 v37, v38
  v_mul_f32 v148, v148, v8
  v_mfma_f32_16x16x32_bf16 a[220:223], a[28:31], a[44:47], a[220:223]
  v_permlane32_swap_b32 v35, v34
  v_mfma_f32_16x16x32_bf16 a[224:227], a[28:31], a[48:51], a[224:227]
  v_permlane32_swap_b32 v38, v37
  v_mfma_f32_16x16x32_bf16 a[228:231], a[28:31], a[52:55], a[228:231]
  v_add_f32 v35, v35, v34
  v_add_f32 v38, v38, v37
  v_mfma_f32_16x16x32_bf16 a[232:235], a[28:31], a[56:59], a[232:235]
  s_waitcnt lgkmcnt(3)
  v_mov_b32 v34, v35
  v_mov_b32 v37, v38
  v_mfma_f32_16x16x32_bf16 v[48:51], a[0:3], a[36:39], v[48:51]
  ds_read_b128 a[28:31], v0 offset:38656
  v_mul_f32 v149, v149, v9
  v_mfma_f32_16x16x32_bf16 v[56:59], a[0:3], a[40:43], v[56:59]
  buffer_load_dwordx4 a[36:39], v3, s[8:11], s26 offen offset:0
  v_mfma_f32_16x16x32_bf16 v[64:67], a[0:3], a[44:47], v[64:67]
  buffer_load_dwordx4 a[40:43], v3, s[8:11], s26 offen offset:1024
  v_mfma_f32_16x16x32_bf16 v[72:75], a[0:3], a[48:51], v[72:75]
  buffer_load_dwordx4 a[44:47], v3, s[8:11], s26 offen offset:2048
  v_mfma_f32_16x16x32_bf16 v[80:83], a[0:3], a[52:55], v[80:83]
  v_permlane16_swap_b32 v35, v34
  v_mfma_f32_16x16x32_bf16 v[88:91], a[0:3], a[56:59], v[88:91]
  s_waitcnt vmcnt(12) lgkmcnt(3)
  v_permlane16_swap_b32 v38, v37
  v_mfma_f32_16x16x32_bf16 v[96:99], a[16:19], a[60:63], v[96:99]
  buffer_load_dwordx4 a[48:51], v3, s[8:11], s26 offen offset:3072
  s_addk_i32 s26, 6144
  v_mfma_f32_16x16x32_bf16 v[104:107], a[16:19], a[64:67], v[104:107]
  ds_read_b128 a[0:3], v0 offset:51456
  v_mul_f32 v150, v150, v10
  v_mfma_f32_16x16x32_bf16 v[112:115], a[16:19], a[68:71], v[112:115]
  v_mul_f32 v172, v172, v8
  v_mul_f32 v173, v173, v9
  v_mfma_f32_16x16x32_bf16 v[120:123], a[16:19], a[72:75], v[120:123]
  v_mul_f32 v174, v174, v10
  v_mul_f32 v151, v151, v11
  v_mfma_f32_16x16x32_bf16 v[128:131], a[16:19], a[76:79], v[128:131]
  buffer_load_dwordx4 a[52:55], v3, s[8:11], s27 offen offset:0
  v_mfma_f32_16x16x32_bf16 v[136:139], a[16:19], a[80:83], v[136:139]
  s_waitcnt lgkmcnt(3)
  v_mul_f32 v156, v156, v12
  v_max3_f32 v33, v148, v149, v150
  v_mfma_f32_16x16x32_bf16 v[144:147], a[20:23], a[60:63], v[144:147]
  ds_read_b128 a[16:19], v1 offset:256
  v_mul_f32 v175, v175, v11
  v_mfma_f32_16x16x32_bf16 v[152:155], a[20:23], a[64:67], v[152:155]
  v_mul_f32 v180, v180, v12
  v_max3_f32 v36, v172, v173, v174
  v_mfma_f32_16x16x32_bf16 v[160:163], a[20:23], a[68:71], v[160:163]
  buffer_load_dwordx4 a[56:59], v3, s[8:11], s27 offen offset:1024
  s_addk_i32 s27, 6144
  s_add_u32 s29, s29, 290304
  v_mfma_f32_16x16x32_bf16 v[168:171], a[20:23], a[72:75], v[168:171]
  s_max_i32 s30, s29, 0
  s_cmp_ge_u32 s63, 972
  v_mul_f32 v157, v157, v13
  v_mfma_f32_16x16x32_bf16 v[176:179], a[20:23], a[76:79], v[176:179]
  s_cselect_b32 s30, s67, s30
  s_cmp_eq_u32 s31, 0
  v_mul_f32 v158, v158, v14
  v_mfma_f32_16x16x32_bf16 v[184:187], a[20:23], a[80:83], v[184:187]
  s_cselect_b32 s69, s30, s67
  v_max3_f32 v33, v33, v151, v156
  v_mul_f32 v181, v181, v13
  s_waitcnt lgkmcnt(3)
  v_mfma_f32_16x16x32_bf16 v[192:195], a[24:27], a[60:63], v[192:195]
  buffer_load_dword v47, s[4:7], s70 offen lds
  s_mov_b32 m0, s68
  v_mfma_f32_16x16x32_bf16 v[200:203], a[24:27], a[64:67], v[200:203]
  ds_read_b128 a[20:23], v1 offset:13056
  v_mul_f32 v182, v182, v14
  v_mfma_f32_16x16x32_bf16 v[208:211], a[24:27], a[68:71], v[208:211]
  v_max3_f32 v36, v36, v175, v180
  v_add_f32 v35, v35, v34
  v_mfma_f32_16x16x32_bf16 v[248:251], a[24:27], a[72:75], v[248:251]
  v_add_f32 v38, v38, v37
  v_mul_f32 v159, v159, v15
  v_mfma_f32_16x16x32_bf16 a[156:159], a[24:27], a[76:79], a[156:159]
  v_mul_f32 v164, v164, v16
  v_max3_f32 v33, v33, v157, v158
  v_mfma_f32_16x16x32_bf16 a[160:163], a[24:27], a[80:83], a[160:163]
  s_waitcnt lgkmcnt(3)
  v_mul_f32 v183, v183, v15
  v_mul_f32 v188, v188, v16
  v_mfma_f32_16x16x32_bf16 a[84:87], a[28:31], a[60:63], a[84:87]
  ds_read_b128 a[24:27], v1 offset:25856
  v_max3_f32 v36, v36, v181, v182
  v_mfma_f32_16x16x32_bf16 a[88:91], a[28:31], a[64:67], a[88:91]
  v_mul_f32 v165, v165, v17
  v_mul_f32 v166, v166, v18
  v_mfma_f32_16x16x32_bf16 a[92:95], a[28:31], a[68:71], a[92:95]
  v_mul_f32 v24, v24, v30
  v_mov_b32 v34, s64
  v_mfma_f32_16x16x32_bf16 a[96:99], a[28:31], a[72:75], a[96:99]
  v_max3_f32 v33, v33, v159, v164
  v_mul_f32 v189, v189, v17
  v_mfma_f32_16x16x32_bf16 a[100:103], a[28:31], a[76:79], a[100:103]
  v_mul_f32 v190, v190, v18
  v_mul_f32 v25, v25, v30
  v_mfma_f32_16x16x32_bf16 a[104:107], a[28:31], a[80:83], a[104:107]
  s_waitcnt lgkmcnt(3)
  v_mov_b32 v37, s64
  v_max3_f32 v36, v36, v183, v188
  v_mfma_f32_16x16x32_bf16 a[108:111], a[0:3], a[60:63], a[108:111]
  ds_read_b128 a[28:31], v1 offset:38656
  v_mul_f32 v167, v167, v19
  v_mfma_f32_16x16x32_bf16 a[112:115], a[0:3], a[64:67], a[112:115]
  v_cndmask_b32 v24, v34, v24, s[38:39]
  v_max3_f32 v33, v33, v165, v166
  v_mfma_f32_16x16x32_bf16 a[116:119], a[0:3], a[68:71], a[116:119]
  v_mul_f32 v191, v191, v19
  v_cndmask_b32 v25, v37, v25, s[38:39]
  v_mfma_f32_16x16x32_bf16 a[120:123], a[0:3], a[72:75], a[120:123]
  v_max3_f32 v36, v36, v189, v190
  v_max3_f32 v33, v33, v167, v24
  v_mfma_f32_16x16x32_bf16 a[124:127], a[0:3], a[76:79], a[124:127]
  v_max3_f32 v36, v36, v191, v25
  v_mov_b32 v34, v33
  v_mfma_f32_16x16x32_bf16 a[128:131], a[0:3], a[80:83], a[128:131]
  s_waitcnt lgkmcnt(3)
  v_mov_b32 v37, v36
  v_mul_f32 v31, s46, v31
  v_mfma_f32_16x16x32_bf16 a[132:135], a[16:19], a[60:63], a[132:135]
  ds_read_b128 a[0:3], v2 offset:256
  v_mul_f32 v32, s46, v32
  v_mfma_f32_16x16x32_bf16 a[136:139], a[16:19], a[64:67], a[136:139]
  v_permlane32_swap_b32 v33, v34
  v_mfma_f32_16x16x32_bf16 a[140:143], a[16:19], a[68:71], a[140:143]
  v_permlane32_swap_b32 v36, v37
  v_mfma_f32_16x16x32_bf16 a[144:147], a[16:19], a[72:75], a[144:147]
  v_max_f32 v33, v33, v34
  v_max_f32 v36, v36, v37
  v_mfma_f32_16x16x32_bf16 a[148:151], a[16:19], a[76:79], a[148:151]
  v_mov_b32 v34, v33
  v_mov_b32 v37, v36
  v_mfma_f32_16x16x32_bf16 a[152:155], a[16:19], a[80:83], a[152:155]
  s_waitcnt lgkmcnt(3)
  v_permlane16_swap_b32 v33, v34
  v_mfma_f32_16x16x32_bf16 a[164:167], a[20:23], a[60:63], a[164:167]
  ds_read_b128 a[16:19], v0 offset:320
  v_max_f32 v33, v33, v34
  v_mfma_f32_16x16x32_bf16 a[168:171], a[20:23], a[64:67], a[168:171]
  v_permlane16_swap_b32 v36, v37
  v_mfma_f32_16x16x32_bf16 a[172:175], a[20:23], a[68:71], a[172:175]
  v_max_f32 v36, v36, v37
  v_mul_f32 v33, v33, v31
  v_mfma_f32_16x16x32_bf16 a[176:179], a[20:23], a[72:75], a[176:179]
  v_mul_f32 v36, v36, v32
  v_fma_f32 v148, v148, v31, -v33
  v_mfma_f32_16x16x32_bf16 a[180:183], a[20:23], a[76:79], a[180:183]
  v_rcp_f32 v35, v35
  v_mfma_f32_16x16x32_bf16 a[184:187], a[20:23], a[80:83], a[184:187]
  s_waitcnt lgkmcnt(3)
  v_rcp_f32 v38, v38
  v_mfma_f32_16x16x32_bf16 a[188:191], a[24:27], a[60:63], a[188:191]
  ds_read_b128 a[20:23], v0 offset:13120
  v_fma_f32 v149, v149, v31, -v33
  v_mfma_f32_16x16x32_bf16 a[192:195], a[24:27], a[64:67], a[192:195]
  v_fma_f32 v172, v172, v32, -v36
  v_fma_f32 v173, v173, v32, -v36
  v_mfma_f32_16x16x32_bf16 a[196:199], a[24:27], a[68:71], a[196:199]
  v_fma_f32 v150, v150, v31, -v33
  v_fma_f32 v174, v174, v32, -v36
  v_mfma_f32_16x16x32_bf16 a[200:203], a[24:27], a[72:75], a[200:203]
  v_exp_f32 v148, v148
  v_mfma_f32_16x16x32_bf16 a[204:207], a[24:27], a[76:79], a[204:207]
  v_exp_f32 v149, v149
  v_mfma_f32_16x16x32_bf16 a[208:211], a[24:27], a[80:83], a[208:211]
  s_waitcnt lgkmcnt(3)
  v_exp_f32 v172, v172
  v_mfma_f32_16x16x32_bf16 a[212:215], a[28:31], a[60:63], a[212:215]
  ds_read_b128 a[24:27], v0 offset:25920
  v_mul_f32 v124, v124, v8
  v_mfma_f32_16x16x32_bf16 a[216:219], a[28:31], a[64:67], a[216:219]
  v_exp_f32 v173, v173
  v_mfma_f32_16x16x32_bf16 a[220:223], a[28:31], a[68:71], a[220:223]
  v_mul_f32 v125, v125, v9
  v_mul_f32 v126, v126, v10
  v_mfma_f32_16x16x32_bf16 a[224:227], a[28:31], a[72:75], a[224:227]
  v_mul_f32 v127, v127, v11
  v_mul_f32 v132, v132, v12
  v_mfma_f32_16x16x32_bf16 a[228:231], a[28:31], a[76:79], a[228:231]
  v_mul_f32 v133, v133, v13
  v_mul_f32 v134, v134, v14
  v_mfma_f32_16x16x32_bf16 a[232:235], a[28:31], a[80:83], a[232:235]
  s_waitcnt lgkmcnt(3)
  v_mul_f32 v135, v135, v15
  v_mul_f32 v140, v140, v16
  v_mfma_f32_16x16x32_bf16 v[48:51], a[0:3], a[60:63], v[48:51]
  ds_read_b128 a[28:31], v0 offset:38720
  v_mul_f32 v141, v141, v17
  v_mfma_f32_16x16x32_bf16 v[56:59], a[0:3], a[64:67], v[56:59]
  buffer_load_dwordx4 a[60:63], v3, s[8:11], s26 offen offset:0
  v_mfma_f32_16x16x32_bf16 v[64:67], a[0:3], a[68:71], v[64:67]
  buffer_load_dwordx4 a[64:67], v3, s[8:11], s26 offen offset:1024
  v_mfma_f32_16x16x32_bf16 v[72:75], a[0:3], a[72:75], v[72:75]
  buffer_load_dwordx4 a[68:71], v3, s[8:11], s26 offen offset:2048
  v_mfma_f32_16x16x32_bf16 v[80:83], a[0:3], a[76:79], v[80:83]
  v_mul_f32 v142, v142, v18
  v_mul_f32 v143, v143, v19
  v_mfma_f32_16x16x32_bf16 v[88:91], a[0:3], a[80:83], v[88:91]
  s_waitcnt vmcnt(11) lgkmcnt(3)
  v_mul_f32 v23, v23, v30
  v_fma_f32 v151, v151, v31, -v33
  v_mfma_f32_16x16x32_bf16 v[96:99], a[16:19], a[32:35], v[96:99]
  buffer_load_dwordx4 a[72:75], v3, s[8:11], s26 offen offset:3072
  s_addk_i32 s26, 6144
  v_mfma_f32_16x16x32_bf16 v[104:107], a[16:19], a[236:239], v[104:107]
  ds_read_b128 a[0:3], v0 offset:51520
  v_fma_f32 v175, v175, v32, -v36
  v_mfma_f32_16x16x32_bf16 v[112:115], a[16:19], a[240:243], v[112:115]
  v_exp_f32 v150, v150
  v_mfma_f32_16x16x32_bf16 v[120:123], a[16:19], a[244:247], v[120:123]
  v_exp_f32 v174, v174
  v_mfma_f32_16x16x32_bf16 v[128:131], a[16:19], a[248:251], v[128:131]
  buffer_load_dwordx4 a[76:79], v3, s[8:11], s27 offen offset:0
  v_mfma_f32_16x16x32_bf16 v[136:139], a[16:19], a[252:255], v[136:139]
  s_waitcnt lgkmcnt(3)
  v_mul_f32 v100, v100, v35
  v_mul_f32 v101, v101, v35
  v_mfma_f32_16x16x32_bf16 v[144:147], a[20:23], a[32:35], v[144:147]
  ds_read_b128 a[16:19], v1 offset:320
  v_mul_f32 v102, v102, v35
  v_mfma_f32_16x16x32_bf16 v[152:155], a[20:23], a[236:239], v[152:155]
  v_mul_f32 v103, v103, v35
  v_mul_f32 v108, v108, v35
  v_mfma_f32_16x16x32_bf16 v[160:163], a[20:23], a[240:243], v[160:163]
  buffer_load_dwordx4 a[80:83], v3, s[8:11], s27 offen offset:1024
  s_addk_i32 s27, 6144
  s_cmp_eq_u32 s31, 1
  v_mfma_f32_16x16x32_bf16 v[168:171], a[20:23], a[244:247], v[168:171]
  s_cselect_b32 s70, s30, s67
  s_cmp_eq_u32 s31, 2
  v_mul_f32 v109, v109, v35
  v_mfma_f32_16x16x32_bf16 v[176:179], a[20:23], a[248:251], v[176:179]
  v_mul_f32 v110, v110, v35
  v_mul_f32 v111, v111, v35
  v_mfma_f32_16x16x32_bf16 v[184:187], a[20:23], a[252:255], v[184:187]
  s_waitcnt lgkmcnt(3)
  v_mul_f32 v116, v116, v35
  v_mul_f32 v117, v117, v35
  v_mfma_f32_16x16x32_bf16 v[192:195], a[24:27], a[32:35], v[192:195]
  buffer_load_dword v47, s[4:7], s69 offen lds
  s_cselect_b32 s69, s30, s67
  s_mov_b32 m0, s68
  v_mfma_f32_16x16x32_bf16 v[200:203], a[24:27], a[236:239], v[200:203]
  ds_read_b128 a[20:23], v1 offset:13120
  v_mul_f32 v118, v118, v35
  v_mfma_f32_16x16x32_bf16 v[208:211], a[24:27], a[240:243], v[208:211]
  v_mul_f32 v119, v119, v35
  v_mul_f32 v22, v22, v35
  v_mfma_f32_16x16x32_bf16 v[248:251], a[24:27], a[244:247], v[248:251]
  v_mul_f32 v124, v124, v38
  v_mul_f32 v125, v125, v38
  v_mfma_f32_16x16x32_bf16 a[156:159], a[24:27], a[248:251], a[156:159]
  v_mul_f32 v126, v126, v38
  v_mul_f32 v127, v127, v38
  v_mfma_f32_16x16x32_bf16 a[160:163], a[24:27], a[252:255], a[160:163]
  s_waitcnt lgkmcnt(3)
  v_mul_f32 v132, v132, v38
  v_mul_f32 v133, v133, v38
  v_mfma_f32_16x16x32_bf16 a[84:87], a[28:31], a[32:35], a[84:87]
  ds_read_b128 a[24:27], v1 offset:25920
  v_mul_f32 v134, v134, v38
  v_mfma_f32_16x16x32_bf16 a[88:91], a[28:31], a[236:239], a[88:91]
  v_mul_f32 v135, v135, v38
  v_mul_f32 v140, v140, v38
  v_mfma_f32_16x16x32_bf16 a[92:95], a[28:31], a[240:243], a[92:95]
  v_mul_f32 v141, v141, v38
  v_mul_f32 v142, v142, v38
  v_mfma_f32_16x16x32_bf16 a[96:99], a[28:31], a[244:247], a[96:99]
  v_mul_f32 v143, v143, v38
  v_mul_f32 v23, v23, v38
  v_mfma_f32_16x16x32_bf16 a[100:103], a[28:31], a[248:251], a[100:103]
  v_fma_f32 v156, v156, v31, -v33
  v_fma_f32 v180, v180, v32, -v36
  v_mfma_f32_16x16x32_bf16 a[104:107], a[28:31], a[252:255], a[104:107]
  s_waitcnt lgkmcnt(3)
  v_exp_f32 v151, v151
  v_mfma_f32_16x16x32_bf16 a[108:111], a[0:3], a[32:35], a[108:111]
  ds_read_b128 a[28:31], v1 offset:38720
  v_fma_f32 v157, v157, v31, -v33
  v_mfma_f32_16x16x32_bf16 a[112:115], a[0:3], a[236:239], a[112:115]
  v_exp_f32 v175, v175
  v_mfma_f32_16x16x32_bf16 a[116:119], a[0:3], a[240:243], a[116:119]
  v_exp_f32 v156, v156
  v_mfma_f32_16x16x32_bf16 a[120:123], a[0:3], a[244:247], a[120:123]
  v_add_f32 v35, v148, v149
  v_fma_f32 v181, v181, v32, -v36
  v_mfma_f32_16x16x32_bf16 a[124:127], a[0:3], a[248:251], a[124:127]
  v_exp_f32 v180, v180
  v_mfma_f32_16x16x32_bf16 a[128:131], a[0:3], a[252:255], a[128:131]
  s_waitcnt lgkmcnt(3)
  v_add_f32 v38, v172, v173
  v_fma_f32 v158, v158, v31, -v33
  v_mfma_f32_16x16x32_bf16 a[132:135], a[16:19], a[32:35], a[132:135]
  ds_read_b128 a[0:3], v2 offset:320
  v_add_f32 v35, v35, v150
  v_mfma_f32_16x16x32_bf16 a[136:139], a[16:19], a[236:239], a[136:139]
  v_exp_f32 v157, v157
  v_mfma_f32_16x16x32_bf16 a[140:143], a[16:19], a[240:243], a[140:143]
  v_fma_f32 v182, v182, v32, -v36
  v_add_f32 v38, v38, v174
  v_mfma_f32_16x16x32_bf16 a[144:147], a[16:19], a[244:247], a[144:147]
  v_exp_f32 v181, v181
  v_mfma_f32_16x16x32_bf16 a[148:151], a[16:19], a[248:251], a[148:151]
  v_fma_f32 v159, v159, v31, -v33
  v_add_f32 v35, v35, v151
  v_mfma_f32_16x16x32_bf16 a[152:155], a[16:19], a[252:255], a[152:155]
  s_waitcnt lgkmcnt(3)
  v_exp_f32 v158, v158
  v_mfma_f32_16x16x32_bf16 a[164:167], a[20:23], a[32:35], a[164:167]
  ds_read_b128 a[16:19], v0 offset:384
  v_fma_f32 v183, v183, v32, -v36
  v_mfma_f32_16x16x32_bf16 a[168:171], a[20:23], a[236:239], a[168:171]
  v_exp_f32 v182, v182
  v_mfma_f32_16x16x32_bf16 a[172:175], a[20:23], a[240:243], a[172:175]
  v_add_f32 v38, v38, v175
  v_fma_f32 v164, v164, v31, -v33
  v_mfma_f32_16x16x32_bf16 a[176:179], a[20:23], a[244:247], a[176:179]
  v_exp_f32 v159, v159
  v_mfma_f32_16x16x32_bf16 a[180:183], a[20:23], a[248:251], a[180:183]
  v_add_f32 v35, v35, v156
  v_fma_f32 v188, v188, v32, -v36
  v_mfma_f32_16x16x32_bf16 a[184:187], a[20:23], a[252:255], a[184:187]
  s_waitcnt lgkmcnt(3)
  v_exp_f32 v183, v183
  v_mfma_f32_16x16x32_bf16 a[188:191], a[24:27], a[32:35], a[188:191]
  ds_read_b128 a[20:23], v0 offset:13184
  v_add_f32 v38, v38, v180
  v_mfma_f32_16x16x32_bf16 a[192:195], a[24:27], a[236:239], a[192:195]
  v_fma_f32 v165, v165, v31, -v33
  v_add_f32 v35, v35, v157
  v_mfma_f32_16x16x32_bf16 a[196:199], a[24:27], a[240:243], a[196:199]
  v_exp_f32 v164, v164
  v_mfma_f32_16x16x32_bf16 a[200:203], a[24:27], a[244:247], a[200:203]
  v_fma_f32 v189, v189, v32, -v36
  v_add_f32 v38, v38, v181
  v_mfma_f32_16x16x32_bf16 a[204:207], a[24:27], a[248:251], a[204:207]
  v_exp_f32 v188, v188
  v_mfma_f32_16x16x32_bf16 a[208:211], a[24:27], a[252:255], a[208:211]
  s_waitcnt lgkmcnt(3)
  v_fma_f32 v166, v166, v31, -v33
  v_add_f32 v35, v35, v158
  v_mfma_f32_16x16x32_bf16 a[212:215], a[28:31], a[32:35], a[212:215]
  ds_read_b128 a[24:27], v0 offset:25984
  v_fma_f32 v190, v190, v32, -v36
  v_mfma_f32_16x16x32_bf16 a[216:219], a[28:31], a[236:239], a[216:219]
  v_exp_f32 v165, v165
  v_mfma_f32_16x16x32_bf16 a[220:223], a[28:31], a[240:243], a[220:223]
  v_exp_f32 v189, v189
  v_mfma_f32_16x16x32_bf16 a[224:227], a[28:31], a[244:247], a[224:227]
  v_add_f32 v38, v38, v182
  v_fma_f32 v167, v167, v31, -v33
  v_mfma_f32_16x16x32_bf16 a[228:231], a[28:31], a[248:251], a[228:231]
  v_exp_f32 v166, v166
  v_mfma_f32_16x16x32_bf16 a[232:235], a[28:31], a[252:255], a[232:235]
  s_waitcnt lgkmcnt(3)
  v_add_f32 v35, v35, v159
  v_fma_f32 v191, v191, v32, -v36
  v_mfma_f32_16x16x32_bf16 v[48:51], a[0:3], a[32:35], v[48:51]
  ds_read_b128 a[28:31], v0 offset:38784
  v_add_f32 v38, v38, v183
  v_mfma_f32_16x16x32_bf16 v[56:59], a[0:3], a[236:239], v[56:59]
  buffer_load_dwordx4 a[32:35], v3, s[8:11], s26 offen offset:0
  v_mfma_f32_16x16x32_bf16 v[64:67], a[0:3], a[240:243], v[64:67]
  buffer_load_dwordx4 a[236:239], v3, s[8:11], s26 offen offset:1024
  v_mfma_f32_16x16x32_bf16 v[72:75], a[0:3], a[244:247], v[72:75]
  buffer_load_dwordx4 a[240:243], v3, s[8:11], s26 offen offset:2048
  v_mfma_f32_16x16x32_bf16 v[80:83], a[0:3], a[248:251], v[80:83]
  v_exp_f32 v190, v190
  v_mfma_f32_16x16x32_bf16 v[88:91], a[0:3], a[252:255], v[88:91]
  s_waitcnt vmcnt(11) lgkmcnt(3)
  v_fma_f32 v24, v24, v31, -v33
  v_add_f32 v35, v35, v164
  v_mfma_f32_16x16x32_bf16 v[96:99], a[16:19], a[36:39], v[96:99]
  buffer_load_dwordx4 a[244:247], v3, s[8:11], s26 offen offset:3072
  s_addk_i32 s26, 6144
  v_mfma_f32_16x16x32_bf16 v[104:107], a[16:19], a[40:43], v[104:107]
  ds_read_b128 a[0:3], v0 offset:51584
  v_fma_f32 v25, v25, v32, -v36
  v_mfma_f32_16x16x32_bf16 v[112:115], a[16:19], a[44:47], v[112:115]
  v_exp_f32 v167, v167
  v_mfma_f32_16x16x32_bf16 v[120:123], a[16:19], a[48:51], v[120:123]
  v_exp_f32 v191, v191
  v_mfma_f32_16x16x32_bf16 v[128:131], a[16:19], a[52:55], v[128:131]
  buffer_load_dwordx4 a[248:251], v3, s[8:11], s27 offen offset:0
  v_mfma_f32_16x16x32_bf16 v[136:139], a[16:19], a[56:59], v[136:139]
  s_waitcnt lgkmcnt(3)
  v_add_f32 v38, v38, v188
  v_add_f32 v35, v35, v165
  v_mfma_f32_16x16x32_bf16 v[144:147], a[20:23], a[36:39], v[144:147]
  ds_read_b128 a[16:19], v1 offset:384
  v_mul_f32 v148, v148, v8
  v_mfma_f32_16x16x32_bf16 v[152:155], a[20:23], a[40:43], v[152:155]
  v_exp_f32 v24, v24
  v_mfma_f32_16x16x32_bf16 v[160:163], a[20:23], a[44:47], v[160:163]
  buffer_load_dwordx4 a[252:255], v3, s[8:11], s27 offen offset:1024
  s_addk_i32 s27, 6144
  s_add_u32 s29, s29, 290304
  v_mfma_f32_16x16x32_bf16 v[168:171], a[20:23], a[48:51], v[168:171]
  s_max_i32 s30, s29, 0
  s_cmp_ge_u32 s63, 972
  v_mul_f32 v149, v149, v9
  v_mfma_f32_16x16x32_bf16 v[176:179], a[20:23], a[52:55], v[176:179]
  s_cselect_b32 s30, s67, s30
  s_cmp_eq_u32 s31, 0
  v_mul_f32 v150, v150, v10
  v_mfma_f32_16x16x32_bf16 v[184:187], a[20:23], a[56:59], v[184:187]
  s_waitcnt lgkmcnt(3)
  v_mul_f32 v151, v151, v11
  v_add_f32 v38, v38, v189
  v_mfma_f32_16x16x32_bf16 v[192:195], a[24:27], a[36:39], v[192:195]
  buffer_load_dword v47, s[4:7], s70 offen lds
  s_cselect_b32 s70, s30, s67
  s_mov_b32 m0, s68
  v_mfma_f32_16x16x32_bf16 v[200:203], a[24:27], a[40:43], v[200:203]
  ds_read_b128 a[20:23], v1 offset:13184
  v_mul_f32 v172, v172, v8
  v_mfma_f32_16x16x32_bf16 v[208:211], a[24:27], a[44:47], v[208:211]
  v_exp_f32 v25, v25
  v_mfma_f32_16x16x32_bf16 v[248:251], a[24:27], a[48:51], v[248:251]
  v_mul_f32 v173, v173, v9
  v_mul_f32 v174, v174, v10
  v_mfma_f32_16x16x32_bf16 a[156:159], a[24:27], a[52:55], a[156:159]
  v_mul_f32 v175, v175, v11
  v_add_f32 v35, v35, v166
  v_mfma_f32_16x16x32_bf16 a[160:163], a[24:27], a[56:59], a[160:163]
  buffer_load_dword v47, s[4:7], s69 offen lds
  s_mov_b32 m0, s68
  s_waitcnt lgkmcnt(3)
  v_mfma_f32_16x16x32_bf16 a[84:87], a[28:31], a[36:39], a[84:87]
  ds_read_b128 a[24:27], v1 offset:25984
  v_mul_f32 v156, v156, v12
  v_mfma_f32_16x16x32_bf16 a[88:91], a[28:31], a[40:43], a[88:91]
  v_mul_f32 v157, v157, v13
  v_mul_f32 v158, v158, v14
  v_mfma_f32_16x16x32_bf16 a[92:95], a[28:31], a[44:47], a[92:95]
  v_mul_f32 v159, v159, v15
  v_add_f32 v38, v38, v190
  v_mfma_f32_16x16x32_bf16 a[96:99], a[28:31], a[48:51], a[96:99]
  v_mul_f32 v180, v180, v12
  v_mul_f32 v181, v181, v13
  v_mfma_f32_16x16x32_bf16 a[100:103], a[28:31], a[52:55], a[100:103]
  v_mul_f32 v182, v182, v14
  v_mul_f32 v183, v183, v15
  v_mfma_f32_16x16x32_bf16 a[104:107], a[28:31], a[56:59], a[104:107]
  s_waitcnt lgkmcnt(3)
  ds_read_b128 v[8:11], v5 offset:384
  v_add_f32 v35, v35, v167
  v_mfma_f32_16x16x32_bf16 a[108:111], a[0:3], a[36:39], a[108:111]
  ds_read_b128 a[28:31], v1 offset:38784
  v_add_f32 v38, v38, v191
  v_mfma_f32_16x16x32_bf16 a[112:115], a[0:3], a[40:43], a[112:115]
  ds_read_b128 v[12:15], v5 offset:448
  v_add_f32 v35, v35, v24
  v_mfma_f32_16x16x32_bf16 a[116:119], a[0:3], a[44:47], a[116:119]
  v_mul_f32 v164, v164, v16
  v_mul_f32 v165, v165, v17
  v_mfma_f32_16x16x32_bf16 a[120:123], a[0:3], a[48:51], a[120:123]
  v_mul_f32 v166, v166, v18
  v_mul_f32 v167, v167, v19
  v_mfma_f32_16x16x32_bf16 a[124:127], a[0:3], a[52:55], a[124:127]
  v_add_f32 v38, v38, v25
  v_mul_f32 v188, v188, v16
  v_mfma_f32_16x16x32_bf16 a[128:131], a[0:3], a[56:59], a[128:131]
  s_waitcnt lgkmcnt(5)
  v_mul_f32 v189, v189, v17
  v_mul_f32 v190, v190, v18
  v_mfma_f32_16x16x32_bf16 a[132:135], a[16:19], a[36:39], a[132:135]
  ds_read_b128 a[0:3], v2 offset:384
  v_mul_f32 v191, v191, v19
  v_mfma_f32_16x16x32_bf16 a[136:139], a[16:19], a[40:43], a[136:139]
  v_mul_f32 v24, v24, v30
  v_mul_f32 v25, v25, v30
  v_mfma_f32_16x16x32_bf16 a[140:143], a[16:19], a[44:47], a[140:143]
  ds_read_b128 v[16:19], v5 offset:512
  v_mov_b32 v34, v35
  v_mfma_f32_16x16x32_bf16 a[144:147], a[16:19], a[48:51], a[144:147]
  ds_read_b32 v30, v7 offset:584
  ds_read_b32 v31, v6 offset:384
  v_mfma_f32_16x16x32_bf16 a[148:151], a[16:19], a[52:55], a[148:151]
  v_permlane32_swap_b32 v35, v34
  v_mfma_f32_16x16x32_bf16 a[152:155], a[16:19], a[56:59], a[152:155]
  s_waitcnt lgkmcnt(8)
  v_add_f32 v35, v35, v34
  v_mov_b32 v34, v35
  v_mfma_f32_16x16x32_bf16 a[164:167], a[20:23], a[36:39], a[164:167]
  s_waitcnt lgkmcnt(6)
  ds_read_b128 a[16:19], v0 offset:448
  v_mul_f32 v196, v196, v8
  v_mfma_f32_16x16x32_bf16 a[168:171], a[20:23], a[40:43], a[168:171]
  v_permlane16_swap_b32 v35, v34
  v_mfma_f32_16x16x32_bf16 a[172:175], a[20:23], a[44:47], a[172:175]
  v_mul_f32 v197, v197, v9
  v_mul_f32 v198, v198, v10
  v_mfma_f32_16x16x32_bf16 a[176:179], a[20:23], a[48:51], a[176:179]
  s_waitcnt lgkmcnt(5)
  v_mul_f32 v199, v199, v11
  v_mul_f32 v204, v204, v12
  v_mfma_f32_16x16x32_bf16 a[180:183], a[20:23], a[52:55], a[180:183]
  v_max3_f32 v33, v196, v197, v198
  v_mul_f32 v205, v205, v13
  v_mfma_f32_16x16x32_bf16 a[184:187], a[20:23], a[56:59], a[184:187]
  v_mul_f32 v206, v206, v14
  v_max3_f32 v33, v33, v199, v204
  v_mfma_f32_16x16x32_bf16 a[188:191], a[24:27], a[36:39], a[188:191]
  ds_read_b128 a[20:23], v0 offset:13248
  v_add_f32 v35, v35, v34
  v_mfma_f32_16x16x32_bf16 a[192:195], a[24:27], a[40:43], a[192:195]
  v_mul_f32 v207, v207, v15
  v_max3_f32 v33, v33, v205, v206
  v_mfma_f32_16x16x32_bf16 a[196:199], a[24:27], a[44:47], a[196:199]
  v_mov_b32 v34, s64
  ds_read_b32 v32, v6 offset:448
  v_mfma_f32_16x16x32_bf16 a[200:203], a[24:27], a[48:51], a[200:203]
  s_waitcnt lgkmcnt(5)
  v_mul_f32 v212, v212, v16
  v_mul_f32 v213, v213, v17
  v_mfma_f32_16x16x32_bf16 a[204:207], a[24:27], a[52:55], a[204:207]
  s_waitcnt lgkmcnt(4)
  v_mul_f32 v214, v214, v18
  v_mul_f32 v26, v26, v30
  v_mfma_f32_16x16x32_bf16 a[208:211], a[24:27], a[56:59], a[208:211]
  v_max3_f32 v33, v33, v207, v212
  v_mul_f32 v215, v215, v19
  v_mfma_f32_16x16x32_bf16 a[212:215], a[28:31], a[36:39], a[212:215]
  ds_read_b128 a[24:27], v0 offset:26048
  v_cndmask_b32 v26, v34, v26, s[38:39]
  v_mfma_f32_16x16x32_bf16 a[216:219], a[28:31], a[40:43], a[216:219]
  v_max3_f32 v33, v33, v213, v214
  v_max3_f32 v33, v33, v215, v26
  v_mfma_f32_16x16x32_bf16 a[220:223], a[28:31], a[44:47], a[220:223]
  s_waitcnt lgkmcnt(4)
  v_mov_b32 v34, v33
  v_mul_f32 v31, s46, v31
  v_mfma_f32_16x16x32_bf16 a[224:227], a[28:31], a[48:51], a[224:227]
  v_permlane32_swap_b32 v33, v34
  v_mfma_f32_16x16x32_bf16 a[228:231], a[28:31], a[52:55], a[228:231]
  v_max_f32 v33, v33, v34
  v_mov_b32 v34, v33
  v_mfma_f32_16x16x32_bf16 a[232:235], a[28:31], a[56:59], a[232:235]
  s_nop 0
  v_permlane16_swap_b32 v33, v34
  v_mfma_f32_16x16x32_bf16 v[48:51], a[0:3], a[36:39], v[48:51]
  ds_read_b128 a[28:31], v0 offset:38848
  v_max_f32 v33, v33, v34
  v_mfma_f32_16x16x32_bf16 v[56:59], a[0:3], a[40:43], v[56:59]
  buffer_load_dwordx4 a[36:39], v3, s[8:11], s26 offen offset:0
  v_mfma_f32_16x16x32_bf16 v[64:67], a[0:3], a[44:47], v[64:67]
  buffer_load_dwordx4 a[40:43], v3, s[8:11], s26 offen offset:1024
  v_mfma_f32_16x16x32_bf16 v[72:75], a[0:3], a[48:51], v[72:75]
  buffer_load_dwordx4 a[44:47], v3, s[8:11], s26 offen offset:2048
  v_mfma_f32_16x16x32_bf16 v[80:83], a[0:3], a[52:55], v[80:83]
  v_mul_f32 v33, v33, v31
  v_fma_f32 v196, v196, v31, -v33
  v_mfma_f32_16x16x32_bf16 v[88:91], a[0:3], a[56:59], v[88:91]
  s_waitcnt vmcnt(12) lgkmcnt(4)
  v_fma_f32 v197, v197, v31, -v33
  v_fma_f32 v198, v198, v31, -v33
  v_mfma_f32_16x16x32_bf16 v[96:99], a[16:19], a[60:63], v[96:99]
  buffer_load_dwordx4 a[48:51], v3, s[8:11], s26 offen offset:3072
  s_addk_i32 s26, 6144
  v_mfma_f32_16x16x32_bf16 v[104:107], a[16:19], a[64:67], v[104:107]
  ds_read_b128 a[0:3], v0 offset:51648
  v_fma_f32 v199, v199, v31, -v33
  v_mfma_f32_16x16x32_bf16 v[112:115], a[16:19], a[68:71], v[112:115]
  v_fma_f32 v204, v204, v31, -v33
  v_fma_f32 v205, v205, v31, -v33
  v_mfma_f32_16x16x32_bf16 v[120:123], a[16:19], a[72:75], v[120:123]
  v_fma_f32 v206, v206, v31, -v33
  v_fma_f32 v207, v207, v31, -v33
  v_mfma_f32_16x16x32_bf16 v[128:131], a[16:19], a[76:79], v[128:131]
  buffer_load_dwordx4 a[52:55], v3, s[8:11], s27 offen offset:0
  v_mfma_f32_16x16x32_bf16 v[136:139], a[16:19], a[80:83], v[136:139]
  s_waitcnt lgkmcnt(3)
  v_fma_f32 v212, v212, v31, -v33
  v_fma_f32 v213, v213, v31, -v33
  v_mfma_f32_16x16x32_bf16 v[144:147], a[20:23], a[60:63], v[144:147]
  ds_read_b128 a[16:19], v1 offset:448
  v_fma_f32 v214, v214, v31, -v33
  v_mfma_f32_16x16x32_bf16 v[152:155], a[20:23], a[64:67], v[152:155]
  v_fma_f32 v215, v215, v31, -v33
  v_fma_f32 v26, v26, v31, -v33
  v_mfma_f32_16x16x32_bf16 v[160:163], a[20:23], a[68:71], v[160:163]
  buffer_load_dwordx4 a[56:59], v3, s[8:11], s27 offen offset:1024
  s_addk_i32 s27, 6144
  s_cmp_eq_u32 s31, 1
  v_mfma_f32_16x16x32_bf16 v[168:171], a[20:23], a[72:75], v[168:171]
  s_cselect_b32 s69, s30, s67
  ds_read_b32 v31, v6 offset:512
  v_mfma_f32_16x16x32_bf16 v[176:179], a[20:23], a[76:79], v[176:179]
  v_rcp_f32 v35, v35
  v_mfma_f32_16x16x32_bf16 v[184:187], a[20:23], a[80:83], v[184:187]
  s_waitcnt lgkmcnt(4)
  v_exp_f32 v196, v196
  v_mfma_f32_16x16x32_bf16 v[192:195], a[24:27], a[60:63], v[192:195]
  buffer_load_dword v47, s[4:7], s70 offen lds
  s_mov_b32 m0, s68
  v_mfma_f32_16x16x32_bf16 v[200:203], a[24:27], a[64:67], v[200:203]
  ds_read_b128 a[20:23], v1 offset:13248
  v_mul_f32 v148, v148, v35
  v_mfma_f32_16x16x32_bf16 v[208:211], a[24:27], a[68:71], v[208:211]
  v_exp_f32 v197, v197
  v_mfma_f32_16x16x32_bf16 v[248:251], a[24:27], a[72:75], v[248:251]
  v_exp_f32 v198, v198
  v_mfma_f32_16x16x32_bf16 a[156:159], a[24:27], a[76:79], a[156:159]
  v_mul_f32 v149, v149, v35
  v_mul_f32 v150, v150, v35
  v_mfma_f32_16x16x32_bf16 a[160:163], a[24:27], a[80:83], a[160:163]
  s_waitcnt lgkmcnt(4)
  v_mul_f32 v151, v151, v35
  v_mul_f32 v156, v156, v35
  v_mfma_f32_16x16x32_bf16 a[84:87], a[28:31], a[60:63], a[84:87]
  ds_read_b128 a[24:27], v1 offset:26048
  v_mul_f32 v157, v157, v35
  v_mfma_f32_16x16x32_bf16 a[88:91], a[28:31], a[64:67], a[88:91]
  v_mul_f32 v158, v158, v35
  v_mul_f32 v159, v159, v35
  v_mfma_f32_16x16x32_bf16 a[92:95], a[28:31], a[68:71], a[92:95]
  v_mul_f32 v164, v164, v35
  v_mul_f32 v165, v165, v35
  v_mfma_f32_16x16x32_bf16 a[96:99], a[28:31], a[72:75], a[96:99]
  v_mul_f32 v166, v166, v35
  v_mul_f32 v167, v167, v35
  v_mfma_f32_16x16x32_bf16 a[100:103], a[28:31], a[76:79], a[100:103]
  v_mul_f32 v24, v24, v35
  v_add_f32 v35, v196, v197
  v_mfma_f32_16x16x32_bf16 a[104:107], a[28:31], a[80:83], a[104:107]
  s_waitcnt lgkmcnt(4)
  v_exp_f32 v199, v199
  v_mfma_f32_16x16x32_bf16 a[108:111], a[0:3], a[60:63], a[108:111]
  ds_read_b128 a[28:31], v1 offset:38848
  v_add_f32 v35, v35, v198
  v_mfma_f32_16x16x32_bf16 a[112:115], a[0:3], a[64:67], a[112:115]
  v_exp_f32 v204, v204
  v_mfma_f32_16x16x32_bf16 a[116:119], a[0:3], a[68:71], a[116:119]
  v_exp_f32 v205, v205
  v_mfma_f32_16x16x32_bf16 a[120:123], a[0:3], a[72:75], a[120:123]
  v_exp_f32 v206, v206
  v_mfma_f32_16x16x32_bf16 a[124:127], a[0:3], a[76:79], a[124:127]
  v_add_f32 v35, v35, v199
  v_add_f32 v35, v35, v204
  v_mfma_f32_16x16x32_bf16 a[128:131], a[0:3], a[80:83], a[128:131]
  s_waitcnt lgkmcnt(3)
  v_exp_f32 v207, v207
  v_mfma_f32_16x16x32_bf16 a[132:135], a[16:19], a[60:63], a[132:135]
  ds_read_b128 a[0:3], v2 offset:448
  v_add_f32 v35, v35, v205
  v_mfma_f32_16x16x32_bf16 a[136:139], a[16:19], a[64:67], a[136:139]
  v_exp_f32 v212, v212
  v_mfma_f32_16x16x32_bf16 a[140:143], a[16:19], a[68:71], a[140:143]
  v_exp_f32 v213, v213
  v_mfma_f32_16x16x32_bf16 a[144:147], a[16:19], a[72:75], a[144:147]
  v_add_f32 v35, v35, v206
  v_add_f32 v35, v35, v207
  v_mfma_f32_16x16x32_bf16 a[148:151], a[16:19], a[76:79], a[148:151]
  v_exp_f32 v214, v214
  v_mfma_f32_16x16x32_bf16 a[152:155], a[16:19], a[80:83], a[152:155]
  s_waitcnt lgkmcnt(3)
  v_exp_f32 v215, v215
  v_mfma_f32_16x16x32_bf16 a[164:167], a[20:23], a[60:63], a[164:167]
  ds_read_b128 a[16:19], v0 offset:512
  v_add_f32 v35, v35, v212
  v_mfma_f32_16x16x32_bf16 a[168:171], a[20:23], a[64:67], a[168:171]
  v_exp_f32 v26, v26
  v_mfma_f32_16x16x32_bf16 a[172:175], a[20:23], a[68:71], a[172:175]
  v_add_f32 v35, v35, v213
  v_add_f32 v35, v35, v214
  v_mfma_f32_16x16x32_bf16 a[176:179], a[20:23], a[72:75], a[176:179]
  v_add_f32 v35, v35, v215
  v_add_f32 v35, v35, v26
  v_mfma_f32_16x16x32_bf16 a[180:183], a[20:23], a[76:79], a[180:183]
  v_mov_b32 v37, v38
  v_mov_b32 v34, v35
  v_mfma_f32_16x16x32_bf16 a[184:187], a[20:23], a[80:83], a[184:187]
  s_waitcnt lgkmcnt(3)
  v_permlane32_swap_b32 v38, v37
  v_mfma_f32_16x16x32_bf16 a[188:191], a[24:27], a[60:63], a[188:191]
  ds_read_b128 a[20:23], v0 offset:13312
  v_add_f32 v38, v38, v37
  v_mfma_f32_16x16x32_bf16 a[192:195], a[24:27], a[64:67], a[192:195]
  v_permlane32_swap_b32 v35, v34
  v_mfma_f32_16x16x32_bf16 a[196:199], a[24:27], a[68:71], a[196:199]
  v_add_f32 v35, v35, v34
  v_mov_b32 v37, v38
  v_mfma_f32_16x16x32_bf16 a[200:203], a[24:27], a[72:75], a[200:203]
  v_mov_b32 v34, v35
  v_mul_f32 v220, v220, v8
  v_mfma_f32_16x16x32_bf16 a[204:207], a[24:27], a[76:79], a[204:207]
  v_permlane16_swap_b32 v38, v37
  v_mfma_f32_16x16x32_bf16 a[208:211], a[24:27], a[80:83], a[208:211]
  s_waitcnt lgkmcnt(3)
  v_permlane16_swap_b32 v35, v34
  v_mfma_f32_16x16x32_bf16 a[212:215], a[28:31], a[60:63], a[212:215]
  ds_read_b128 a[24:27], v0 offset:26112
  v_mul_f32 v221, v221, v9
  v_mfma_f32_16x16x32_bf16 a[216:219], a[28:31], a[64:67], a[216:219]
  v_mul_f32 v222, v222, v10
  v_mul_f32 v244, v244, v8
  v_mfma_f32_16x16x32_bf16 a[220:223], a[28:31], a[68:71], a[220:223]
  v_mul_f32 v245, v245, v9
  v_mul_f32 v246, v246, v10
  v_mfma_f32_16x16x32_bf16 a[224:227], a[28:31], a[72:75], a[224:227]
  v_mul_f32 v223, v223, v11
  v_mul_f32 v228, v228, v12
  v_mfma_f32_16x16x32_bf16 a[228:231], a[28:31], a[76:79], a[228:231]
  v_max3_f32 v36, v220, v221, v222
  v_mul_f32 v247, v247, v11
  v_mfma_f32_16x16x32_bf16 a[232:235], a[28:31], a[80:83], a[232:235]
  s_waitcnt lgkmcnt(3)
  v_mul_f32 v252, v252, v12
  v_max3_f32 v33, v244, v245, v246
  v_mfma_f32_16x16x32_bf16 v[48:51], a[0:3], a[60:63], v[48:51]
  ds_read_b128 a[28:31], v0 offset:38912
  v_mul_f32 v229, v229, v13
  v_mfma_f32_16x16x32_bf16 v[56:59], a[0:3], a[64:67], v[56:59]
  buffer_load_dwordx4 a[60:63], v3, s[8:11], s26 offen offset:0
  v_mfma_f32_16x16x32_bf16 v[64:67], a[0:3], a[68:71], v[64:67]
  buffer_load_dwordx4 a[64:67], v3, s[8:11], s26 offen offset:1024
  v_mfma_f32_16x16x32_bf16 v[72:75], a[0:3], a[72:75], v[72:75]
  buffer_load_dwordx4 a[68:71], v3, s[8:11], s26 offen offset:2048
  v_mfma_f32_16x16x32_bf16 v[80:83], a[0:3], a[76:79], v[80:83]
  v_mul_f32 v230, v230, v14
  v_max3_f32 v36, v36, v223, v228
  v_mfma_f32_16x16x32_bf16 v[88:91], a[0:3], a[80:83], v[88:91]
  s_waitcnt vmcnt(12) lgkmcnt(3)
  v_mul_f32 v253, v253, v13
  v_mul_f32 v254, v254, v14
  v_mfma_f32_16x16x32_bf16 v[96:99], a[16:19], a[32:35], v[96:99]
  buffer_load_dwordx4 a[72:75], v3, s[8:11], s26 offen offset:3072
  s_addk_i32 s26, 6144
  v_mfma_f32_16x16x32_bf16 v[104:107], a[16:19], a[236:239], v[104:107]
  ds_read_b128 a[0:3], v0 offset:51712
  v_max3_f32 v33, v33, v247, v252
  v_mfma_f32_16x16x32_bf16 v[112:115], a[16:19], a[240:243], v[112:115]
  v_add_f32 v38, v38, v37
  v_add_f32 v35, v35, v34
  v_mfma_f32_16x16x32_bf16 v[120:123], a[16:19], a[244:247], v[120:123]
  v_mul_f32 v231, v231, v15
  v_mul_f32 v236, v236, v16
  v_mfma_f32_16x16x32_bf16 v[128:131], a[16:19], a[248:251], v[128:131]
  buffer_load_dwordx4 a[76:79], v3, s[8:11], s27 offen offset:0
  v_mfma_f32_16x16x32_bf16 v[136:139], a[16:19], a[252:255], v[136:139]
  s_waitcnt lgkmcnt(3)
  v_max3_f32 v36, v36, v229, v230
  v_mul_f32 v255, v255, v15
  v_mfma_f32_16x16x32_bf16 v[144:147], a[20:23], a[32:35], v[144:147]
  ds_read_b128 a[16:19], v1 offset:512
  v_mul_f32 v216, v216, v16
  v_mfma_f32_16x16x32_bf16 v[152:155], a[20:23], a[236:239], v[152:155]
  v_max3_f32 v33, v33, v253, v254
  v_mul_f32 v237, v237, v17
  v_mfma_f32_16x16x32_bf16 v[160:163], a[20:23], a[240:243], v[160:163]
  buffer_load_dwordx4 a[80:83], v3, s[8:11], s27 offen offset:1024
  s_addk_i32 s27, 6144
  s_cmp_eq_u32 s31, 2
  v_mfma_f32_16x16x32_bf16 v[168:171], a[20:23], a[244:247], v[168:171]
  s_cselect_b32 s70, s30, s67
  v_mul_f32 v238, v238, v18
  v_mul_f32 v27, v27, v30
  v_mfma_f32_16x16x32_bf16 v[176:179], a[20:23], a[248:251], v[176:179]
  s_add_u32 s29, s29, 290304
  v_mov_b32 v37, s64
  v_max3_f32 v36, v36, v231, v236
  v_mfma_f32_16x16x32_bf16 v[184:187], a[20:23], a[252:255], v[184:187]
  s_max_i32 s30, s29, 0
  v_mul_f32 v217, v217, v17
  v_mul_f32 v218, v218, v18
  s_waitcnt lgkmcnt(3)
  v_mfma_f32_16x16x32_bf16 v[192:195], a[24:27], a[32:35], v[192:195]
  s_cmp_ge_u32 s63, 972
  buffer_load_dword v47, s[4:7], s69 offen lds
  s_mov_b32 m0, s68
  s_cselect_b32 s30, s67, s30
  v_mfma_f32_16x16x32_bf16 v[200:203], a[24:27], a[236:239], v[200:203]
  s_cmp_eq_u32 s31, 0
  ds_read_b128 a[20:23], v1 offset:13312
  v_mul_f32 v28, v28, v30
  v_mfma_f32_16x16x32_bf16 v[208:211], a[24:27], a[240:243], v[208:211]
  s_cselect_b32 s69, s30, s67
  v_mov_b32 v34, s64
  v_max3_f32 v33, v33, v255, v216
  v_mfma_f32_16x16x32_bf16 v[248:251], a[24:27], a[244:247], v[248:251]
  s_cmp_eq_u32 s31, 1
  v_mul_f32 v239, v239, v19
  v_cndmask_b32 v27, v37, v27, s[38:39]
  v_mfma_f32_16x16x32_bf16 a[156:159], a[24:27], a[248:251], a[156:159]
  v_max3_f32 v36, v36, v237, v238
  v_mul_f32 v219, v219, v19
  v_mfma_f32_16x16x32_bf16 a[160:163], a[24:27], a[252:255], a[160:163]
  s_waitcnt lgkmcnt(3)
  v_cndmask_b32 v28, v34, v28, s[38:39]
  v_max3_f32 v33, v33, v217, v218
  v_mfma_f32_16x16x32_bf16 a[84:87], a[28:31], a[32:35], a[84:87]
  ds_read_b128 a[24:27], v1 offset:26112
  v_max3_f32 v36, v36, v239, v27
  v_mfma_f32_16x16x32_bf16 a[88:91], a[28:31], a[236:239], a[88:91]
  v_max3_f32 v33, v33, v219, v28
  v_mov_b32 v37, v36
  v_mfma_f32_16x16x32_bf16 a[92:95], a[28:31], a[240:243], a[92:95]
  v_mov_b32 v34, v33
  v_mul_f32 v32, s46, v32
  v_mfma_f32_16x16x32_bf16 a[96:99], a[28:31], a[244:247], a[96:99]
  v_permlane32_swap_b32 v36, v37
  v_mfma_f32_16x16x32_bf16 a[100:103], a[28:31], a[248:251], a[100:103]
  v_permlane32_swap_b32 v33, v34
  v_mfma_f32_16x16x32_bf16 a[104:107], a[28:31], a[252:255], a[104:107]
  s_waitcnt lgkmcnt(3)
  v_max_f32 v36, v36, v37
  v_max_f32 v33, v33, v34
  v_mfma_f32_16x16x32_bf16 a[108:111], a[0:3], a[32:35], a[108:111]
  ds_read_b128 a[28:31], v1 offset:38912
  v_mov_b32 v37, v36
  v_mfma_f32_16x16x32_bf16 a[112:115], a[0:3], a[236:239], a[112:115]
  v_mov_b32 v34, v33
  v_mul_f32 v31, s46, v31
  v_mfma_f32_16x16x32_bf16 a[116:119], a[0:3], a[240:243], a[116:119]
  v_permlane16_swap_b32 v36, v37
  v_mfma_f32_16x16x32_bf16 a[120:123], a[0:3], a[244:247], a[120:123]
  v_permlane16_swap_b32 v33, v34
  v_mfma_f32_16x16x32_bf16 a[124:127], a[0:3], a[248:251], a[124:127]
  v_max_f32 v36, v36, v37
  v_max_f32 v33, v33, v34
  v_mfma_f32_16x16x32_bf16 a[128:131], a[0:3], a[252:255], a[128:131]
  s_waitcnt lgkmcnt(3)
  v_mul_f32 v36, v36, v32
  v_mul_f32 v33, v33, v31
  v_mfma_f32_16x16x32_bf16 a[132:135], a[16:19], a[32:35], a[132:135]
  ds_read_b128 a[0:3], v2 offset:512
  v_fma_f32 v220, v220, v32, -v36
  v_mfma_f32_16x16x32_bf16 a[136:139], a[16:19], a[236:239], a[136:139]
  v_rcp_f32 v38, v38
  v_mfma_f32_16x16x32_bf16 a[140:143], a[16:19], a[240:243], a[140:143]
  v_rcp_f32 v35, v35
  v_mfma_f32_16x16x32_bf16 a[144:147], a[16:19], a[244:247], a[144:147]
  v_fma_f32 v221, v221, v32, -v36
  v_fma_f32 v244, v244, v31, -v33
  v_mfma_f32_16x16x32_bf16 a[148:151], a[16:19], a[248:251], a[148:151]
  v_fma_f32 v245, v245, v31, -v33
  v_fma_f32 v222, v222, v32, -v36
  v_mfma_f32_16x16x32_bf16 a[152:155], a[16:19], a[252:255], a[152:155]
  s_waitcnt lgkmcnt(3)
  v_exp_f32 v220, v220
  v_mfma_f32_16x16x32_bf16 a[164:167], a[20:23], a[32:35], a[164:167]
  ds_read_b128 a[16:19], v0 offset:576
  v_fma_f32 v246, v246, v31, -v33
  v_mfma_f32_16x16x32_bf16 a[168:171], a[20:23], a[236:239], a[168:171]
  v_exp_f32 v221, v221
  v_mfma_f32_16x16x32_bf16 a[172:175], a[20:23], a[240:243], a[172:175]
  v_exp_f32 v244, v244
  v_mfma_f32_16x16x32_bf16 a[176:179], a[20:23], a[244:247], a[176:179]
  v_exp_f32 v245, v245
  v_mfma_f32_16x16x32_bf16 a[180:183], a[20:23], a[248:251], a[180:183]
  v_mul_f32 v196, v196, v8
  v_mul_f32 v197, v197, v9
  v_mfma_f32_16x16x32_bf16 a[184:187], a[20:23], a[252:255], a[184:187]
  s_waitcnt lgkmcnt(3)
  v_mul_f32 v198, v198, v10
  v_mul_f32 v199, v199, v11
  v_mfma_f32_16x16x32_bf16 a[188:191], a[24:27], a[32:35], a[188:191]
  ds_read_b128 a[20:23], v0 offset:13376
  v_mul_f32 v204, v204, v12
  v_mfma_f32_16x16x32_bf16 a[192:195], a[24:27], a[236:239], a[192:195]
  v_mul_f32 v205, v205, v13
  v_mul_f32 v206, v206, v14
  v_mfma_f32_16x16x32_bf16 a[196:199], a[24:27], a[240:243], a[196:199]
  v_mul_f32 v207, v207, v15
  v_mul_f32 v212, v212, v16
  v_mfma_f32_16x16x32_bf16 a[200:203], a[24:27], a[244:247], a[200:203]
  v_mul_f32 v213, v213, v17
  v_mul_f32 v214, v214, v18
  v_mfma_f32_16x16x32_bf16 a[204:207], a[24:27], a[248:251], a[204:207]
  v_mul_f32 v215, v215, v19
  v_mul_f32 v26, v26, v30
  v_mfma_f32_16x16x32_bf16 a[208:211], a[24:27], a[252:255], a[208:211]
  s_waitcnt lgkmcnt(3)
  v_fma_f32 v223, v223, v32, -v36
  v_fma_f32 v247, v247, v31, -v33
  v_mfma_f32_16x16x32_bf16 a[212:215], a[28:31], a[32:35], a[212:215]
  ds_read_b128 a[24:27], v0 offset:26176
  v_mul_f32 v172, v172, v38
  v_mfma_f32_16x16x32_bf16 a[216:219], a[28:31], a[236:239], a[216:219]
  v_exp_f32 v222, v222
  v_mfma_f32_16x16x32_bf16 a[220:223], a[28:31], a[240:243], a[220:223]
  v_exp_f32 v246, v246
  v_mfma_f32_16x16x32_bf16 a[224:227], a[28:31], a[244:247], a[224:227]
  v_mul_f32 v173, v173, v38
  v_mul_f32 v174, v174, v38
  v_mfma_f32_16x16x32_bf16 a[228:231], a[28:31], a[248:251], a[228:231]
  v_mul_f32 v175, v175, v38
  v_mul_f32 v180, v180, v38
  v_mfma_f32_16x16x32_bf16 a[232:235], a[28:31], a[252:255], a[232:235]
  s_waitcnt lgkmcnt(3)
  v_mul_f32 v181, v181, v38
  v_mul_f32 v182, v182, v38
  v_mfma_f32_16x16x32_bf16 v[48:51], a[0:3], a[32:35], v[48:51]
  ds_read_b128 a[28:31], v0 offset:38976
  v_mul_f32 v183, v183, v38
  v_mfma_f32_16x16x32_bf16 v[56:59], a[0:3], a[236:239], v[56:59]
  buffer_load_dwordx4 a[32:35], v3, s[8:11], s26 offen offset:0
  v_mfma_f32_16x16x32_bf16 v[64:67], a[0:3], a[240:243], v[64:67]
  buffer_load_dwordx4 a[236:239], v3, s[8:11], s26 offen offset:1024
  v_mfma_f32_16x16x32_bf16 v[72:75], a[0:3], a[244:247], v[72:75]
  buffer_load_dwordx4 a[240:243], v3, s[8:11], s26 offen offset:2048
  v_mfma_f32_16x16x32_bf16 v[80:83], a[0:3], a[248:251], v[80:83]
  v_mul_f32 v188, v188, v38
  v_mul_f32 v189, v189, v38
  v_mfma_f32_16x16x32_bf16 v[88:91], a[0:3], a[252:255], v[88:91]
  s_waitcnt vmcnt(11) lgkmcnt(3)
  v_mul_f32 v190, v190, v38
  v_mul_f32 v191, v191, v38
  v_mfma_f32_16x16x32_bf16 v[96:99], a[16:19], a[36:39], v[96:99]
  buffer_load_dwordx4 a[244:247], v3, s[8:11], s26 offen offset:3072
  s_mov_b32 s26, 0
  v_mfma_f32_16x16x32_bf16 v[104:107], a[16:19], a[40:43], v[104:107]
  ds_read_b128 a[0:3], v0 offset:51776
  v_mul_f32 v25, v25, v38
  v_mfma_f32_16x16x32_bf16 v[112:115], a[16:19], a[44:47], v[112:115]
  v_mul_f32 v196, v196, v35
  v_mul_f32 v197, v197, v35
  v_mfma_f32_16x16x32_bf16 v[120:123], a[16:19], a[48:51], v[120:123]
  v_mul_f32 v198, v198, v35
  v_mul_f32 v199, v199, v35
  v_mfma_f32_16x16x32_bf16 v[128:131], a[16:19], a[52:55], v[128:131]
  buffer_load_dwordx4 a[248:251], v3, s[8:11], s27 offen offset:0
  v_mfma_f32_16x16x32_bf16 v[136:139], a[16:19], a[56:59], v[136:139]
  s_waitcnt lgkmcnt(3)
  v_mul_f32 v204, v204, v35
  v_mul_f32 v205, v205, v35
  v_mfma_f32_16x16x32_bf16 v[144:147], a[20:23], a[36:39], v[144:147]
  ds_read_b128 a[16:19], v1 offset:576
  v_mul_f32 v206, v206, v35
  v_mfma_f32_16x16x32_bf16 v[152:155], a[20:23], a[40:43], v[152:155]
  v_mul_f32 v207, v207, v35
  v_mul_f32 v212, v212, v35
  v_mfma_f32_16x16x32_bf16 v[160:163], a[20:23], a[44:47], v[160:163]
  buffer_load_dwordx4 a[252:255], v3, s[8:11], s27 offen offset:1024
  s_mov_b32 s27, 4096
  v_mfma_f32_16x16x32_bf16 v[168:171], a[20:23], a[48:51], v[168:171]
  v_mul_f32 v213, v213, v35
  v_mul_f32 v214, v214, v35
  v_mfma_f32_16x16x32_bf16 v[176:179], a[20:23], a[52:55], v[176:179]
  v_mul_f32 v215, v215, v35
  v_mul_f32 v26, v26, v35
  v_mfma_f32_16x16x32_bf16 v[184:187], a[20:23], a[56:59], v[184:187]
  s_waitcnt lgkmcnt(3)
  v_fma_f32 v228, v228, v32, -v36
  v_fma_f32 v252, v252, v31, -v33
  v_mfma_f32_16x16x32_bf16 v[192:195], a[24:27], a[36:39], v[192:195]
  buffer_load_dword v47, s[4:7], s70 offen lds
  s_mov_b32 m0, s68
  s_cselect_b32 s70, s30, s67
  v_mfma_f32_16x16x32_bf16 v[200:203], a[24:27], a[40:43], v[200:203]
  s_cmp_eq_u32 s31, 2
  ds_read_b128 a[20:23], v1 offset:13376
  v_fma_f32 v229, v229, v32, -v36
  v_mfma_f32_16x16x32_bf16 v[208:211], a[24:27], a[44:47], v[208:211]
  v_exp_f32 v223, v223
  v_mfma_f32_16x16x32_bf16 v[248:251], a[24:27], a[48:51], v[248:251]
  v_exp_f32 v247, v247
  v_mfma_f32_16x16x32_bf16 a[156:159], a[24:27], a[52:55], a[156:159]
  v_exp_f32 v228, v228
  v_mfma_f32_16x16x32_bf16 a[160:163], a[24:27], a[56:59], a[160:163]
  buffer_load_dword v47, s[4:7], s69 offen lds
  s_mov_b32 m0, s68
  s_cselect_b32 s69, s30, s67
  s_waitcnt lgkmcnt(3)
  v_mfma_f32_16x16x32_bf16 a[84:87], a[28:31], a[36:39], a[84:87]
  ds_read_b128 a[24:27], v1 offset:26176
  v_add_f32 v38, v220, v221
  v_mfma_f32_16x16x32_bf16 a[88:91], a[28:31], a[40:43], a[88:91]
  v_fma_f32 v253, v253, v31, -v33
  v_add_f32 v35, v244, v245
  v_mfma_f32_16x16x32_bf16 a[92:95], a[28:31], a[44:47], a[92:95]
  v_exp_f32 v252, v252
  v_mfma_f32_16x16x32_bf16 a[96:99], a[28:31], a[48:51], a[96:99]
  v_fma_f32 v230, v230, v32, -v36
  v_add_f32 v38, v38, v222
  v_mfma_f32_16x16x32_bf16 a[100:103], a[28:31], a[52:55], a[100:103]
  v_exp_f32 v229, v229
  v_mfma_f32_16x16x32_bf16 a[104:107], a[28:31], a[56:59], a[104:107]
  buffer_load_dword v47, s[4:7], s70 offen lds
  s_mov_b32 m0, s68
  s_waitcnt lgkmcnt(3)
  v_mfma_f32_16x16x32_bf16 a[108:111], a[0:3], a[36:39], a[108:111]
  ds_read_b128 a[28:31], v1 offset:38976
  v_fma_f32 v254, v254, v31, -v33
  v_mfma_f32_16x16x32_bf16 a[112:115], a[0:3], a[40:43], a[112:115]
  v_exp_f32 v253, v253
  v_mfma_f32_16x16x32_bf16 a[116:119], a[0:3], a[44:47], a[116:119]
  v_add_f32 v35, v35, v246
  v_fma_f32 v231, v231, v32, -v36
  v_mfma_f32_16x16x32_bf16 a[120:123], a[0:3], a[48:51], a[120:123]
  v_exp_f32 v230, v230
  v_mfma_f32_16x16x32_bf16 a[124:127], a[0:3], a[52:55], a[124:127]
  v_add_f32 v38, v38, v223
  v_fma_f32 v255, v255, v31, -v33
  v_mfma_f32_16x16x32_bf16 a[128:131], a[0:3], a[56:59], a[128:131]
  s_waitcnt lgkmcnt(3)
  buffer_load_dword v47, s[4:7], s69 offen lds
  v_mfma_f32_16x16x32_bf16 a[132:135], a[16:19], a[36:39], a[132:135]
  ds_read_b128 a[0:3], v2 offset:576
  v_add_f32 v35, v35, v247
  v_mfma_f32_16x16x32_bf16 a[136:139], a[16:19], a[40:43], a[136:139]
  v_exp_f32 v254, v254
  v_mfma_f32_16x16x32_bf16 a[140:143], a[16:19], a[44:47], a[140:143]
  v_fma_f32 v236, v236, v32, -v36
  v_add_f32 v38, v38, v228
  v_mfma_f32_16x16x32_bf16 a[144:147], a[16:19], a[48:51], a[144:147]
  v_exp_f32 v231, v231
  v_mfma_f32_16x16x32_bf16 a[148:151], a[16:19], a[52:55], a[148:151]
  v_fma_f32 v216, v216, v31, -v33
  v_add_f32 v35, v35, v252
  v_mfma_f32_16x16x32_bf16 a[152:155], a[16:19], a[56:59], a[152:155]
  s_waitcnt lgkmcnt(3)
  v_exp_f32 v255, v255
  v_mfma_f32_16x16x32_bf16 a[164:167], a[20:23], a[36:39], a[164:167]
  ds_read_b128 a[16:19], v0 offset:640
  v_fma_f32 v237, v237, v32, -v36
  v_mfma_f32_16x16x32_bf16 a[168:171], a[20:23], a[40:43], a[168:171]
  v_exp_f32 v236, v236
  v_mfma_f32_16x16x32_bf16 a[172:175], a[20:23], a[44:47], a[172:175]
  v_add_f32 v38, v38, v229
  v_fma_f32 v217, v217, v31, -v33
  v_mfma_f32_16x16x32_bf16 a[176:179], a[20:23], a[48:51], a[176:179]
  v_exp_f32 v216, v216
  v_mfma_f32_16x16x32_bf16 a[180:183], a[20:23], a[52:55], a[180:183]
  v_add_f32 v35, v35, v253
  v_fma_f32 v238, v238, v32, -v36
  v_mfma_f32_16x16x32_bf16 a[184:187], a[20:23], a[56:59], a[184:187]
  s_waitcnt lgkmcnt(3)
  v_exp_f32 v237, v237
  v_mfma_f32_16x16x32_bf16 a[188:191], a[24:27], a[36:39], a[188:191]
  ds_read_b128 a[20:23], v0 offset:13440
  v_add_f32 v38, v38, v230
  v_mfma_f32_16x16x32_bf16 a[192:195], a[24:27], a[40:43], a[192:195]
  v_fma_f32 v218, v218, v31, -v33
  v_add_f32 v35, v35, v254
  v_mfma_f32_16x16x32_bf16 a[196:199], a[24:27], a[44:47], a[196:199]
  v_exp_f32 v217, v217
  v_mfma_f32_16x16x32_bf16 a[200:203], a[24:27], a[48:51], a[200:203]
  v_fma_f32 v239, v239, v32, -v36
  v_add_f32 v38, v38, v231
  v_mfma_f32_16x16x32_bf16 a[204:207], a[24:27], a[52:55], a[204:207]
  v_exp_f32 v238, v238
  v_mfma_f32_16x16x32_bf16 a[208:211], a[24:27], a[56:59], a[208:211]
  s_waitcnt lgkmcnt(3)
  v_fma_f32 v219, v219, v31, -v33
  v_add_f32 v35, v35, v255
  v_mfma_f32_16x16x32_bf16 a[212:215], a[28:31], a[36:39], a[212:215]
  ds_read_b128 a[24:27], v0 offset:26240
  v_fma_f32 v27, v27, v32, -v36
  v_mfma_f32_16x16x32_bf16 a[216:219], a[28:31], a[40:43], a[216:219]
  v_exp_f32 v218, v218
  v_mfma_f32_16x16x32_bf16 a[220:223], a[28:31], a[44:47], a[220:223]
  v_exp_f32 v239, v239
  v_mfma_f32_16x16x32_bf16 a[224:227], a[28:31], a[48:51], a[224:227]
  v_add_f32 v38, v38, v236
  v_fma_f32 v28, v28, v31, -v33
  v_mfma_f32_16x16x32_bf16 a[228:231], a[28:31], a[52:55], a[228:231]
  v_exp_f32 v219, v219
  v_mfma_f32_16x16x32_bf16 a[232:235], a[28:31], a[56:59], a[232:235]
  s_waitcnt lgkmcnt(3)
  v_add_f32 v35, v35, v216
  v_add_f32 v38, v38, v237
  v_mfma_f32_16x16x32_bf16 v[48:51], a[0:3], a[36:39], v[48:51]
  ds_read_b128 a[28:31], v0 offset:39040
  v_add_f32 v35, v35, v217
  v_mfma_f32_16x16x32_bf16 v[56:59], a[0:3], a[40:43], v[56:59]
  v_exp_f32 v27, v27
  v_mfma_f32_16x16x32_bf16 v[64:67], a[0:3], a[44:47], v[64:67]
  v_exp_f32 v28, v28
  v_mfma_f32_16x16x32_bf16 v[72:75], a[0:3], a[48:51], v[72:75]
  v_add_f32 v38, v38, v238
  v_add_f32 v35, v35, v218
  v_mfma_f32_16x16x32_bf16 v[80:83], a[0:3], a[52:55], v[80:83]
  v_add_f32 v38, v38, v239
  v_add_f32 v35, v35, v219
  v_mfma_f32_16x16x32_bf16 v[88:91], a[0:3], a[56:59], v[88:91]
  s_waitcnt vmcnt(11) lgkmcnt(3)
  v_add_f32 v38, v38, v27
  v_add_f32 v35, v35, v28
  v_mfma_f32_16x16x32_bf16 v[96:99], a[16:19], a[60:63], v[96:99]
  ds_read_b128 a[0:3], v0 offset:51840
  v_and_b32 v7, 15, v4
  v_mfma_f32_16x16x32_bf16 v[104:107], a[16:19], a[64:67], v[104:107]
  v_mul_f32 v27, v27, v30
  v_mul_f32 v28, v28, v30
  v_mfma_f32_16x16x32_bf16 v[112:115], a[16:19], a[68:71], v[112:115]
  v_min_u32 v7, 2, v7
  v_lshlrev_b32 v30, 2, v7
  v_mfma_f32_16x16x32_bf16 v[120:123], a[16:19], a[72:75], v[120:123]
  v_mul_u32_u24 v7, 192, v7
  v_mul_f32 v220, v220, v8
  v_mfma_f32_16x16x32_bf16 v[128:131], a[16:19], a[76:79], v[128:131]
  v_mul_f32 v221, v221, v9
  v_mul_f32 v222, v222, v10
  v_mfma_f32_16x16x32_bf16 v[136:139], a[16:19], a[80:83], v[136:139]
  s_waitcnt lgkmcnt(3)
  v_mul_f32 v223, v223, v11
  v_mul_f32 v244, v244, v8
  v_mfma_f32_16x16x32_bf16 v[144:147], a[20:23], a[60:63], v[144:147]
  ds_read_b128 a[16:19], v1 offset:640
  v_mul_f32 v245, v245, v9
  v_mfma_f32_16x16x32_bf16 v[152:155], a[20:23], a[64:67], v[152:155]
  v_mul_f32 v246, v246, v10
  v_mul_f32 v247, v247, v11
  v_mfma_f32_16x16x32_bf16 v[160:163], a[20:23], a[68:71], v[160:163]
  v_add_u32 v7, v7, v5
  v_mul_f32 v228, v228, v12
  v_mfma_f32_16x16x32_bf16 v[168:171], a[20:23], a[72:75], v[168:171]
  v_mul_f32 v229, v229, v13
  v_mul_f32 v230, v230, v14
  v_mfma_f32_16x16x32_bf16 v[176:179], a[20:23], a[76:79], v[176:179]
  v_mul_f32 v231, v231, v15
  v_mul_f32 v252, v252, v12
  v_mfma_f32_16x16x32_bf16 v[184:187], a[20:23], a[80:83], v[184:187]
  s_waitcnt lgkmcnt(3)
  v_mul_f32 v253, v253, v13
  v_mul_f32 v254, v254, v14
  v_mfma_f32_16x16x32_bf16 v[192:195], a[24:27], a[60:63], v[192:195]
  ds_read_b128 a[20:23], v1 offset:13440
  v_mul_f32 v255, v255, v15
  v_mfma_f32_16x16x32_bf16 v[200:203], a[24:27], a[64:67], v[200:203]
  ds_read_b128 v[8:11], v7 offset:0
  v_mul_f32 v236, v236, v16
  v_mfma_f32_16x16x32_bf16 v[208:211], a[24:27], a[68:71], v[208:211]
  ds_read_b128 v[12:15], v7 offset:64
  v_mul_f32 v237, v237, v17
  v_mfma_f32_16x16x32_bf16 v[248:251], a[24:27], a[72:75], v[248:251]
  v_mul_f32 v238, v238, v18
  v_mul_f32 v239, v239, v19
  v_mfma_f32_16x16x32_bf16 a[156:159], a[24:27], a[76:79], a[156:159]
  v_mul_f32 v216, v216, v16
  v_mul_f32 v217, v217, v17
  v_mfma_f32_16x16x32_bf16 a[160:163], a[24:27], a[80:83], a[160:163]
  s_waitcnt lgkmcnt(5)
  v_mul_f32 v218, v218, v18
  v_mul_f32 v219, v219, v19
  v_mfma_f32_16x16x32_bf16 a[84:87], a[28:31], a[60:63], a[84:87]
  ds_read_b128 a[24:27], v1 offset:26240
  v_add_u32 v30, 162912, v30
  v_mfma_f32_16x16x32_bf16 a[88:91], a[28:31], a[64:67], a[88:91]
  ds_read_b128 v[16:19], v7 offset:128
  v_mov_b32 v37, v38
  v_mfma_f32_16x16x32_bf16 a[92:95], a[28:31], a[68:71], a[92:95]
  ds_read_b32 v30, v30
  v_cndmask_b32 v227, v227, v39, s[44:45]
  v_mfma_f32_16x16x32_bf16 a[96:99], a[28:31], a[72:75], a[96:99]
  v_permlane32_swap_b32 v38, v37
  v_mfma_f32_16x16x32_bf16 a[100:103], a[28:31], a[76:79], a[100:103]
  v_add_f32 v38, v38, v37
  v_mov_b32 v37, v38
  v_mfma_f32_16x16x32_bf16 a[104:107], a[28:31], a[80:83], a[104:107]
  s_waitcnt lgkmcnt(7)
  v_cndmask_b32 v232, v232, v40, s[44:45]
  v_cndmask_b32 v233, v233, v41, s[44:45]
  v_mfma_f32_16x16x32_bf16 a[108:111], a[0:3], a[60:63], a[108:111]
  ds_read_b128 a[28:31], v1 offset:39040
  v_cndmask_b32 v234, v234, v42, s[44:45]
  v_mfma_f32_16x16x32_bf16 a[112:115], a[0:3], a[64:67], a[112:115]
  v_permlane16_swap_b32 v38, v37
  v_mfma_f32_16x16x32_bf16 a[116:119], a[0:3], a[68:71], a[116:119]
  s_waitcnt lgkmcnt(5)
  v_mul_f32 v224, v224, v8
  v_mul_f32 v225, v225, v9
  v_mfma_f32_16x16x32_bf16 a[120:123], a[0:3], a[72:75], a[120:123]
  v_mul_f32 v226, v226, v10
  v_mul_f32 v227, v227, v11
  v_mfma_f32_16x16x32_bf16 a[124:127], a[0:3], a[76:79], a[124:127]
  s_waitcnt lgkmcnt(4)
  v_mul_f32 v232, v232, v12
  v_max3_f32 v36, v224, v225, v226
  v_mfma_f32_16x16x32_bf16 a[128:131], a[0:3], a[80:83], a[128:131]
  v_cndmask_b32 v235, v235, v43, s[44:45]
  v_cndmask_b32 v240, v240, v44, s[44:45]
  v_mfma_f32_16x16x32_bf16 a[132:135], a[16:19], a[60:63], a[132:135]
  ds_read_b128 a[0:3], v2 offset:640
  v_mul_f32 v233, v233, v13
  v_mfma_f32_16x16x32_bf16 a[136:139], a[16:19], a[64:67], a[136:139]
  v_mul_f32 v234, v234, v14
  v_max3_f32 v36, v36, v227, v232
  v_mfma_f32_16x16x32_bf16 a[140:143], a[16:19], a[68:71], a[140:143]
  v_cndmask_b32 v241, v241, v45, s[44:45]
  v_add_f32 v38, v38, v37
  v_mfma_f32_16x16x32_bf16 a[144:147], a[16:19], a[72:75], a[144:147]
  s_waitcnt lgkmcnt(3)
  v_mul_f32 v235, v235, v15
  v_mul_f32 v240, v240, v16
  v_mfma_f32_16x16x32_bf16 a[148:151], a[16:19], a[76:79], a[148:151]
  v_max3_f32 v36, v36, v233, v234
  v_mul_f32 v241, v241, v17
  v_mfma_f32_16x16x32_bf16 a[152:155], a[16:19], a[80:83], a[152:155]
  s_waitcnt lgkmcnt(2)
  v_mul_f32 v242, v242, v18
  v_mul_f32 v29, v29, v30
  v_mfma_f32_16x16x32_bf16 a[164:167], a[20:23], a[60:63], a[164:167]
  ds_read_b128 a[16:19], v2 offset:704
  v_mov_b32 v37, s64
  v_mfma_f32_16x16x32_bf16 a[168:171], a[20:23], a[64:67], a[168:171]
  v_max3_f32 v36, v36, v235, v240
  v_mul_f32 v243, v243, v19
  v_mfma_f32_16x16x32_bf16 a[172:175], a[20:23], a[68:71], a[172:175]
  v_cndmask_b32 v29, v37, v29, s[38:39]
  v_max3_f32 v36, v36, v241, v242
  v_mfma_f32_16x16x32_bf16 a[176:179], a[20:23], a[72:75], a[176:179]
  v_max3_f32 v36, v36, v243, v29
  v_mov_b32 v37, v36
  v_mfma_f32_16x16x32_bf16 a[180:183], a[20:23], a[76:79], a[180:183]
  s_nop 0
  v_permlane32_swap_b32 v36, v37
  v_mfma_f32_16x16x32_bf16 a[184:187], a[20:23], a[80:83], a[184:187]
  v_max_f32 v36, v36, v37
  v_mov_b32 v37, v36
  v_mfma_f32_16x16x32_bf16 a[188:191], a[24:27], a[60:63], a[188:191]
  ds_read_b128 a[20:23], v0 offset:704
  v_mul_f32 v32, s46, v30
  v_mfma_f32_16x16x32_bf16 a[192:195], a[24:27], a[64:67], a[192:195]
  v_permlane16_swap_b32 v36, v37
  v_mfma_f32_16x16x32_bf16 a[196:199], a[24:27], a[68:71], a[196:199]
  v_max_f32 v36, v36, v37
  v_mul_f32 v36, v36, v32
  v_mfma_f32_16x16x32_bf16 a[200:203], a[24:27], a[72:75], a[200:203]
  v_rcp_f32 v38, v38
  v_mfma_f32_16x16x32_bf16 a[204:207], a[24:27], a[76:79], a[204:207]
  v_fma_f32 v224, v224, v32, -v36
  v_fma_f32 v225, v225, v32, -v36
  v_mfma_f32_16x16x32_bf16 a[208:211], a[24:27], a[80:83], a[208:211]
  s_waitcnt lgkmcnt(3)
  v_fma_f32 v226, v226, v32, -v36
  v_fma_f32 v227, v227, v32, -v36
  v_mfma_f32_16x16x32_bf16 a[212:215], a[28:31], a[60:63], a[212:215]
  ds_read_b128 a[24:27], v0 offset:13504
  v_mul_f32 v220, v220, v38
  v_mfma_f32_16x16x32_bf16 a[216:219], a[28:31], a[64:67], a[216:219]
  v_exp_f32 v224, v224
  v_mfma_f32_16x16x32_bf16 a[220:223], a[28:31], a[68:71], a[220:223]
  v_exp_f32 v225, v225
  v_mfma_f32_16x16x32_bf16 a[224:227], a[28:31], a[72:75], a[224:227]
  v_exp_f32 v226, v226
  v_mfma_f32_16x16x32_bf16 a[228:231], a[28:31], a[76:79], a[228:231]
  v_mul_f32 v221, v221, v38
  v_mul_f32 v222, v222, v38
  v_mfma_f32_16x16x32_bf16 a[232:235], a[28:31], a[80:83], a[232:235]
  s_waitcnt lgkmcnt(3)
  v_mul_f32 v223, v223, v38
  v_mul_f32 v228, v228, v38
  v_mfma_f32_16x16x32_bf16 v[48:51], a[0:3], a[60:63], v[48:51]
  ds_read_b128 a[28:31], v0 offset:26304
  v_mul_f32 v229, v229, v38
  v_mfma_f32_16x16x32_bf16 v[56:59], a[0:3], a[64:67], v[56:59]
  v_mul_f32 v230, v230, v38
  v_mul_f32 v231, v231, v38
  v_mfma_f32_16x16x32_bf16 v[64:67], a[0:3], a[68:71], v[64:67]
  v_mul_f32 v236, v236, v38
  v_mul_f32 v237, v237, v38
  v_mfma_f32_16x16x32_bf16 v[72:75], a[0:3], a[72:75], v[72:75]
  buffer_load_dwordx4 a[68:71], v3, s[8:11], s28 offen offset:0
  v_mfma_f32_16x16x32_bf16 v[80:83], a[0:3], a[76:79], v[80:83]
  buffer_load_dwordx4 a[72:75], v3, s[8:11], s28 offen offset:1024
  v_mfma_f32_16x16x32_bf16 v[88:91], a[0:3], a[80:83], v[88:91]
  s_waitcnt vmcnt(6) lgkmcnt(3)
  buffer_load_dwordx4 a[76:79], v3, s[8:11], s28 offen offset:2048
  v_mfma_f32_16x16x32_bf16 v[48:51], a[16:19], a[32:35], v[48:51]
  ds_read_b128 a[0:3], v0 offset:39104
  v_mul_f32 v238, v238, v38
  v_mfma_f32_16x16x32_bf16 v[56:59], a[16:19], a[236:239], v[56:59]
  v_mul_f32 v239, v239, v38
  v_mul_f32 v27, v27, v38
  v_mfma_f32_16x16x32_bf16 v[64:67], a[16:19], a[240:243], v[64:67]
  buffer_load_dwordx4 a[80:83], v3, s[8:11], s28 offen offset:3072
  s_addk_i32 s28, 4096
  v_mfma_f32_16x16x32_bf16 v[72:75], a[16:19], a[244:247], v[72:75]
  v_fma_f32 v232, v232, v32, -v36
  v_fma_f32 v233, v233, v32, -v36
  v_mfma_f32_16x16x32_bf16 v[80:83], a[16:19], a[248:251], v[80:83]
  v_exp_f32 v227, v227
  v_mfma_f32_16x16x32_bf16 v[88:91], a[16:19], a[252:255], v[88:91]
  s_waitcnt lgkmcnt(3)
  v_exp_f32 v232, v232
  v_mfma_f32_16x16x32_bf16 v[96:99], a[20:23], a[32:35], v[96:99]
  ds_read_b128 a[16:19], v0 offset:51904
  v_add_f32 v38, v224, v225
  v_mfma_f32_16x16x32_bf16 v[104:107], a[20:23], a[236:239], v[104:107]
  v_cvt_pk_bf16_f32 v52, v52, v53
  v_fma_f32 v234, v234, v32, -v36
  v_mfma_f32_16x16x32_bf16 v[112:115], a[20:23], a[240:243], v[112:115]
  v_exp_f32 v233, v233
  v_mfma_f32_16x16x32_bf16 v[120:123], a[20:23], a[244:247], v[120:123]
  v_add_f32 v38, v38, v226
  v_cvt_pk_bf16_f32 v96, v96, v97
  v_mfma_f32_16x16x32_bf16 v[128:131], a[20:23], a[248:251], v[128:131]
  v_cvt_pk_bf16_f32 v53, v54, v55
  v_fma_f32 v235, v235, v32, -v36
  v_mfma_f32_16x16x32_bf16 v[136:139], a[20:23], a[252:255], v[136:139]
  s_waitcnt lgkmcnt(3)
  v_exp_f32 v234, v234
  v_mfma_f32_16x16x32_bf16 v[144:147], a[24:27], a[32:35], v[144:147]
  ds_read_b128 a[20:23], v1 offset:704
  v_add_f32 v38, v38, v227
  v_mfma_f32_16x16x32_bf16 v[152:155], a[24:27], a[236:239], v[152:155]
  v_cvt_pk_bf16_f32 v97, v98, v99
  v_cvt_pk_bf16_f32 v54, v60, v61
  v_mfma_f32_16x16x32_bf16 v[160:163], a[24:27], a[240:243], v[160:163]
  v_cvt_pk_bf16_f32 v55, v62, v63
  v_fma_f32 v240, v240, v32, -v36
  v_mfma_f32_16x16x32_bf16 v[168:171], a[24:27], a[244:247], v[168:171]
  v_exp_f32 v235, v235
  v_mfma_f32_16x16x32_bf16 v[176:179], a[24:27], a[248:251], v[176:179]
  v_add_f32 v38, v38, v232
  v_cvt_pk_bf16_f32 v98, v144, v145
  v_mfma_f32_16x16x32_bf16 v[184:187], a[24:27], a[252:255], v[184:187]
  s_waitcnt lgkmcnt(3)
  v_cvt_pk_bf16_f32 v99, v146, v147
  v_fma_f32 v241, v241, v32, -v36
  v_mfma_f32_16x16x32_bf16 v[192:195], a[28:31], a[32:35], v[192:195]
  ds_read_b128 a[24:27], v1 offset:13504
  v_add_f32 v38, v38, v233
  v_mfma_f32_16x16x32_bf16 v[200:203], a[28:31], a[236:239], v[200:203]
  v_exp_f32 v240, v240
  v_mfma_f32_16x16x32_bf16 v[208:211], a[28:31], a[240:243], v[208:211]
  v_cvt_pk_bf16_f32 v60, v68, v69
  v_cvt_pk_bf16_f32 v61, v70, v71
  v_mfma_f32_16x16x32_bf16 v[248:251], a[28:31], a[244:247], v[248:251]
  v_exp_f32 v241, v241
  v_mfma_f32_16x16x32_bf16 a[156:159], a[28:31], a[248:251], a[156:159]
  v_add_f32 v38, v38, v234
  v_cvt_pk_bf16_f32 v104, v104, v105
  v_mfma_f32_16x16x32_bf16 a[160:163], a[28:31], a[252:255], a[160:163]
  s_waitcnt lgkmcnt(3)
  v_cvt_pk_bf16_f32 v76, v76, v77
  v_add_f32 v38, v38, v235
  v_mfma_f32_16x16x32_bf16 a[84:87], a[0:3], a[32:35], a[84:87]
  ds_read_b128 a[28:31], v1 offset:26304
  v_cvt_pk_bf16_f32 v105, v106, v107
  v_mfma_f32_16x16x32_bf16 a[88:91], a[0:3], a[236:239], a[88:91]
  v_cvt_pk_bf16_f32 v77, v78, v79
  v_fma_f32 v242, v242, v32, -v36
  v_mfma_f32_16x16x32_bf16 a[92:95], a[0:3], a[240:243], a[92:95]
  v_add_f32 v38, v38, v240
  v_cvt_pk_bf16_f32 v106, v152, v153
  v_mfma_f32_16x16x32_bf16 a[96:99], a[0:3], a[244:247], a[96:99]
  v_cvt_pk_bf16_f32 v107, v154, v155
  v_cvt_pk_bf16_f32 v78, v84, v85
  v_mfma_f32_16x16x32_bf16 a[100:103], a[0:3], a[248:251], a[100:103]
  v_fma_f32 v243, v243, v32, -v36
  v_add_f32 v38, v38, v241
  v_mfma_f32_16x16x32_bf16 a[104:107], a[0:3], a[252:255], a[104:107]
  s_waitcnt lgkmcnt(3)
  v_exp_f32 v242, v242
  v_mfma_f32_16x16x32_bf16 a[108:111], a[16:19], a[32:35], a[108:111]
  ds_read_b128 a[0:3], v1 offset:39104
  v_cvt_pk_bf16_f32 v84, v92, v93
  v_mfma_f32_16x16x32_bf16 a[112:115], a[16:19], a[236:239], a[112:115]
  v_cvt_pk_bf16_f32 v85, v94, v95
  v_mul_f32 v240, v240, v16
  v_mfma_f32_16x16x32_bf16 a[116:119], a[16:19], a[240:243], a[116:119]
  v_exp_f32 v243, v243
  v_mfma_f32_16x16x32_bf16 a[120:123], a[16:19], a[244:247], a[120:123]
  v_mul_f32 v241, v241, v17
  v_cvt_pk_bf16_f32 v16, v48, v49
  v_mfma_f32_16x16x32_bf16 a[124:127], a[16:19], a[248:251], a[124:127]
  v_cvt_pk_bf16_f32 v17, v50, v51
  v_cvt_pk_bf16_f32 v62, v20, 0
  v_mfma_f32_16x16x32_bf16 a[128:131], a[16:19], a[252:255], a[128:131]
  s_waitcnt lgkmcnt(3)
  v_mov_b32 v63, 0
  v_add_f32 v38, v38, v242
  v_mfma_f32_16x16x32_bf16 a[132:135], a[20:23], a[32:35], a[132:135]
  v_cvt_pk_bf16_f32 v144, v192, v193
  v_cvt_pk_bf16_f32 v145, v194, v195
  v_mfma_f32_16x16x32_bf16 a[136:139], a[20:23], a[236:239], a[136:139]
  v_mov_b32 v146, v16
  v_mov_b32 v147, v17
  v_mfma_f32_16x16x32_bf16 a[140:143], a[20:23], a[240:243], a[140:143]
  v_add_f32 v38, v38, v243
  v_mul_f32 v242, v242, v18
  v_mfma_f32_16x16x32_bf16 a[144:147], a[20:23], a[244:247], a[144:147]
  v_mul_f32 v243, v243, v19
  v_cvt_pk_bf16_f32 v18, v56, v57
  v_mfma_f32_16x16x32_bf16 a[148:151], a[20:23], a[248:251], a[148:151]
  v_cvt_pk_bf16_f32 v19, v58, v59
  v_cvt_pk_bf16_f32 v152, v200, v201
  v_mfma_f32_16x16x32_bf16 a[152:155], a[20:23], a[252:255], a[152:155]
  s_waitcnt lgkmcnt(0)
  s_barrier
  v_cvt_pk_bf16_f32 v153, v202, v203
  v_mov_b32 v154, v18
  v_mfma_f32_16x16x32_bf16 a[164:167], a[24:27], a[32:35], a[164:167]
  v_mov_b32 v155, v19
  v_cvt_pk_bf16_f32 v100, v100, v101
  v_mfma_f32_16x16x32_bf16 a[168:171], a[24:27], a[236:239], a[168:171]
  v_cvt_pk_bf16_f32 v79, v86, v87
  v_cvt_pk_bf16_f32 v101, v102, v103
  v_mfma_f32_16x16x32_bf16 a[172:175], a[24:27], a[240:243], a[172:175]
  v_cvt_pk_bf16_f32 v102, v108, v109
  v_cvt_pk_bf16_f32 v108, v116, v117
  v_mfma_f32_16x16x32_bf16 a[176:179], a[24:27], a[244:247], a[176:179]
  v_cvt_pk_bf16_f32 v109, v118, v119
  v_cvt_pk_bf16_f32 v124, v124, v125
  v_mfma_f32_16x16x32_bf16 a[180:183], a[24:27], a[248:251], a[180:183]
  v_cvt_pk_bf16_f32 v125, v126, v127
  v_cvt_pk_bf16_f32 v126, v132, v133
  v_mfma_f32_16x16x32_bf16 a[184:187], a[24:27], a[252:255], a[184:187]
  v_cvt_pk_bf16_f32 v132, v140, v141
  v_cvt_pk_bf16_f32 v133, v142, v143
  v_mfma_f32_16x16x32_bf16 a[188:191], a[28:31], a[32:35], a[188:191]
  v_fma_f32 v29, v29, v32, -v36
  v_cvt_pk_bf16_f32 v86, v21, 0
  v_mfma_f32_16x16x32_bf16 a[192:195], a[28:31], a[236:239], a[192:195]
  v_exp_f32 v29, v29
  v_mfma_f32_16x16x32_bf16 a[196:199], a[28:31], a[240:243], a[196:199]
  v_mov_b32 v87, 0
  v_add_f32 v38, v38, v29
  v_mfma_f32_16x16x32_bf16 a[200:203], a[28:31], a[244:247], a[200:203]
  v_mov_b32 v37, v38
  v_cvt_pk_bf16_f32 v148, v148, v149
  v_mfma_f32_16x16x32_bf16 a[204:207], a[28:31], a[248:251], a[204:207]
  v_permlane32_swap_b32 v38, v37
  v_mfma_f32_16x16x32_bf16 a[208:211], a[28:31], a[252:255], a[208:211]
  v_cvt_pk_bf16_f32 v103, v110, v111
  v_cvt_pk_bf16_f32 v149, v150, v151
  v_mfma_f32_16x16x32_bf16 a[212:215], a[0:3], a[32:35], a[212:215]
  v_cvt_pk_bf16_f32 v150, v156, v157
  v_add_f32 v38, v38, v37
  v_mfma_f32_16x16x32_bf16 a[216:219], a[0:3], a[236:239], a[216:219]
  v_cvt_pk_bf16_f32 v156, v164, v165
  v_cvt_pk_bf16_f32 v157, v166, v167
  v_mfma_f32_16x16x32_bf16 a[220:223], a[0:3], a[240:243], a[220:223]
  v_mov_b32 v37, v38
  v_cvt_pk_bf16_f32 v172, v172, v173
  v_mfma_f32_16x16x32_bf16 a[224:227], a[0:3], a[244:247], a[224:227]
  buffer_load_dwordx4 a[240:243], v3, s[8:11], s28 offen offset:0
  v_mfma_f32_16x16x32_bf16 a[228:231], a[0:3], a[248:251], a[228:231]
  buffer_load_dwordx4 a[244:247], v3, s[8:11], s28 offen offset:1024
  v_mfma_f32_16x16x32_bf16 a[232:235], a[0:3], a[252:255], a[232:235]
  buffer_load_dwordx4 a[248:251], v3, s[8:11], s28 offen offset:2048
  v_mfma_f32_16x16x32_bf16 v[68:71], v[96:99], v[52:55], 0
  v_cvt_pk_bf16_f32 v173, v174, v175
  v_cvt_pk_bf16_f32 v174, v180, v181
  v_mfma_f32_16x16x32_bf16 v[92:95], v[104:107], v[52:55], 0
  v_permlane16_swap_b32 v38, v37
  v_mfma_f32_16x16x32_bf16 v[68:71], v[144:147], v[60:63], v[68:71]
  v_cvt_pk_bf16_f32 v180, v188, v189
  v_cvt_pk_bf16_f32 v181, v190, v191
  v_mfma_f32_16x16x32_bf16 v[92:95], v[152:155], v[60:63], v[92:95]
  v_cvt_pk_bf16_f32 v110, v22, 0
  v_mov_b32 v111, 0
  v_mfma_f32_16x16x32_bf16 v[116:119], v[96:99], v[76:79], 0
  v_add_f32 v38, v38, v37
  v_mul_f32 v224, v224, v8
  v_mfma_f32_16x16x32_bf16 v[140:143], v[104:107], v[76:79], 0
  v_rcp_f32 v38, v38
  v_mfma_f32_16x16x32_bf16 v[116:119], v[144:147], v[84:87], v[116:119]
  v_mul_f32 v225, v225, v9
  v_mul_f32 v226, v226, v10
  v_mfma_f32_16x16x32_bf16 v[140:143], v[152:155], v[84:87], v[140:143]
  v_mul_f32 v227, v227, v11
  v_mul_f32 v224, v224, v38
  v_mfma_f32_16x16x32_bf16 v[164:167], v[96:99], v[100:103], 0
  v_mul_f32 v225, v225, v38
  v_mul_f32 v232, v232, v12
  v_mfma_f32_16x16x32_bf16 v[188:191], v[104:107], v[100:103], 0
  v_mul_f32 v233, v233, v13
  v_mul_f32 v234, v234, v14
  v_mfma_f32_16x16x32_bf16 v[164:167], v[144:147], v[108:111], v[164:167]
  v_mul_f32 v235, v235, v15
  v_mul_f32 v226, v226, v38
  v_mfma_f32_16x16x32_bf16 v[188:191], v[152:155], v[108:111], v[188:191]
  v_mul_f32 v227, v227, v38
  v_cvt_pk_bf16_f32 v224, v224, v225
  v_mul_f32 v232, v232, v38
  v_mul_f32 v233, v233, v38
  v_mul_f32 v234, v234, v38
  v_mul_f32 v235, v235, v38
  v_cvt_pk_bf16_f32 v225, v226, v227
  v_cvt_pk_bf16_f32 v226, v232, v233
  v_cvt_pk_bf16_f32 v227, v234, v235
  v_cndmask_b32 v44, 0, v224, s[40:41]
  v_cndmask_b32 v45, 0, v225, s[40:41]
  v_cndmask_b32 v46, 0, v226, s[40:41]
  v_cndmask_b32 v47, 0, v227, s[40:41]
  v_mul_f32 v29, v29, v30
  v_mul_f32 v240, v240, v38
  v_mul_f32 v241, v241, v38
  v_mul_f32 v242, v242, v38
  v_mul_f32 v243, v243, v38
  v_mul_f32 v29, v29, v38
  v_mfma_f32_16x16x32_bf16 v[36:39], v[96:99], v[44:47], 0
  v_cvt_pk_bf16_f32 v175, v182, v183
  v_cvt_pk_bf16_f32 v151, v158, v159
  v_mfma_f32_16x16x32_bf16 v[40:43], v[104:107], v[44:47], 0
  v_cvt_pk_bf16_f32 v182, 0, v25
  v_cvt_pk_bf16_f32 v158, 0, v24
  v_mov_b32 v234, v29
  v_cvt_pk_bf16_f32 v25, v82, v83
  v_cvt_pk_bf16_f32 v232, v240, v241
  v_cvt_pk_bf16_f32 v233, v242, v243
  v_cvt_pk_bf16_f32 v24, v80, v81
  v_cndmask_b32 v82, 0, v234, s[40:41]
  v_cndmask_b32 v80, 0, v232, s[40:41]
  v_cndmask_b32 v81, 0, v233, s[40:41]
  v_cvt_pk_bf16_f32 v82, v82, 0
  v_mov_b32 v83, 0
  v_cvt_pk_bf16_f32 v112, v112, v113
  v_cvt_pk_bf16_f32 v196, v196, v197
  v_mfma_f32_16x16x32_bf16 v[36:39], v[144:147], v[80:83], v[36:39]
  v_cvt_pk_bf16_f32 v113, v114, v115
  v_cvt_pk_bf16_f32 v197, v198, v199
  v_mfma_f32_16x16x32_bf16 v[40:43], v[152:155], v[80:83], v[40:43]
  v_cvt_pk_bf16_f32 v114, v160, v161
  v_cvt_pk_bf16_f32 v115, v162, v163
  v_cvt_pk_bf16_f32 v198, v204, v205
  v_cvt_pk_bf16_f32 v204, v212, v213
  v_cvt_pk_bf16_f32 v205, v214, v215
  v_mfma_f32_16x16x32_bf16 v[212:215], v[112:115], v[52:55], 0
  v_cvt_pk_bf16_f32 v120, v120, v121
  v_cvt_pk_bf16_f32 v220, v220, v221
  v_cvt_pk_bf16_f32 v121, v122, v123
  v_cvt_pk_bf16_f32 v221, v222, v223
  v_cvt_pk_bf16_f32 v122, v168, v169
  v_cvt_pk_bf16_f32 v123, v170, v171
  v_cvt_pk_bf16_f32 v222, v228, v229
  v_cvt_pk_bf16_f32 v228, v236, v237
  v_cvt_pk_bf16_f32 v229, v238, v239
  v_mfma_f32_16x16x32_bf16 v[236:239], v[120:123], v[52:55], 0
  v_cvt_pk_bf16_f32 v20, v64, v65
  v_cvt_pk_bf16_f32 v21, v66, v67
  v_cvt_pk_bf16_f32 v160, v208, v209
  v_cvt_pk_bf16_f32 v161, v210, v211
  v_mov_b32 v162, v20
  v_mov_b32 v163, v21
  v_mov_b32 v34, v35
  v_cvt_pk_bf16_f32 v127, v134, v135
  v_mfma_f32_16x16x32_bf16 v[212:215], v[160:163], v[60:63], v[212:215]
  v_cvt_pk_bf16_f32 v134, 0, v23
  v_permlane32_swap_b32 v35, v34
  v_cvt_pk_bf16_f32 v22, v72, v73
  v_cvt_pk_bf16_f32 v23, v74, v75
  v_cvt_pk_bf16_f32 v168, v248, v249
  v_cvt_pk_bf16_f32 v169, v250, v251
  v_mov_b32 v170, v22
  v_mov_b32 v171, v23
  v_add_f32 v35, v35, v34
  v_mov_b32 v34, v35
  v_mfma_f32_16x16x32_bf16 v[236:239], v[168:171], v[60:63], v[236:239]
  s_nop 0
  v_permlane16_swap_b32 v35, v34
  v_add_u32 v5, s37, v0
  v_add_f32 v35, v35, v34
  v_rcp_f32 v35, v35
  ds_read_b128 a[36:39], v5 offset:0
  v_mul_f32 v244, v244, v35
  v_mul_f32 v245, v245, v35
  v_mul_f32 v246, v246, v35
  v_mul_f32 v247, v247, v35
  v_cvt_pk_bf16_f32 v244, v244, v245
  v_mul_f32 v252, v252, v35
  v_mul_f32 v253, v253, v35
  v_cvt_pk_bf16_f32 v245, v246, v247
  v_mul_f32 v216, v216, v35
  v_mul_f32 v217, v217, v35
  v_mul_f32 v218, v218, v35
  v_mul_f32 v219, v219, v35
  v_cvt_pk_bf16_f32 v246, v252, v253
  v_cvt_pk_bf16_f32 v252, v216, v217
  v_cvt_pk_bf16_f32 v253, v218, v219
  v_mfma_f32_16x16x32_bf16 v[216:219], v[112:115], v[76:79], 0
  v_mul_f32 v254, v254, v35
  v_mul_f32 v255, v255, v35
  v_mfma_f32_16x16x32_bf16 v[240:243], v[120:123], v[76:79], 0
  v_mul_f32 v28, v28, v35
  v_cvt_pk_bf16_f32 v247, v254, v255
  v_mfma_f32_16x16x32_bf16 v[216:219], v[160:163], v[84:87], v[216:219]
  v_cvt_pk_bf16_f32 v255, v28, 0
  v_cvt_pk_bf16_f32 v128, v128, v129
  v_mfma_f32_16x16x32_bf16 v[240:243], v[168:171], v[84:87], v[240:243]
  v_cvt_pk_bf16_f32 v68, v68, v69
  ds_read_b128 a[40:43], v5 offset:12800
  v_mfma_f32_16x16x32_bf16 v[28:31], v[112:115], v[100:103], 0
  v_cvt_pk_bf16_f32 v129, v130, v131
  v_cvt_pk_bf16_f32 v69, v70, v71
  v_mfma_f32_16x16x32_bf16 v[32:35], v[120:123], v[100:103], 0
  v_cvt_pk_bf16_f32 v130, v176, v177
  v_cvt_pk_bf16_f32 v131, v178, v179
  v_mfma_f32_16x16x32_bf16 v[28:31], v[160:163], v[108:111], v[28:31]
  v_cvt_pk_bf16_f32 v70, v92, v93
  v_cvt_pk_bf16_f32 v71, v94, v95
  v_mfma_f32_16x16x32_bf16 v[32:35], v[168:171], v[108:111], v[32:35]
  v_cvt_pk_bf16_f32 v136, v136, v137
  v_cvt_pk_bf16_f32 v137, v138, v139
  v_mfma_f32_16x16x32_bf16 v[48:51], v[112:115], v[44:47], 0
  v_cvt_pk_bf16_f32 v138, v184, v185
  v_cvt_pk_bf16_f32 v139, v186, v187
  v_mfma_f32_16x16x32_bf16 v[56:59], v[120:123], v[44:47], 0
  v_accvgpr_read_b32 v8, a156
  v_accvgpr_read_b32 v9, a157
  v_mfma_f32_16x16x32_bf16 v[48:51], v[160:163], v[80:83], v[48:51]
  v_accvgpr_read_b32 v10, a158
  v_accvgpr_read_b32 v11, a159
  v_mfma_f32_16x16x32_bf16 v[56:59], v[168:171], v[80:83], v[56:59]
  ds_write_b128 v5, v[68:71] offset:0
  v_mfma_f32_16x16x32_bf16 v[68:71], v[128:131], v[52:55], 0
  v_cvt_pk_bf16_f32 v176, v8, v9
  v_cvt_pk_bf16_f32 v177, v10, v11
  v_mfma_f32_16x16x32_bf16 v[92:95], v[136:139], v[52:55], 0
  v_mov_b32 v178, v24
  v_mov_b32 v179, v25
  ds_read_b128 a[44:47], v5 offset:25600
  v_cvt_pk_bf16_f32 v199, v206, v207
  v_mfma_f32_16x16x32_bf16 v[68:71], v[176:179], v[60:63], v[68:71]
  v_cvt_pk_bf16_f32 v223, v230, v231
  v_cvt_pk_bf16_f32 v207, v26, 0
  v_cvt_pk_bf16_f32 v231, v27, 0
  v_cvt_pk_bf16_f32 v26, v88, v89
  v_cvt_pk_bf16_f32 v27, v90, v91
  v_accvgpr_read_b32 v12, a160
  v_accvgpr_read_b32 v13, a161
  v_accvgpr_read_b32 v14, a162
  v_accvgpr_read_b32 v15, a163
  v_cvt_pk_bf16_f32 v184, v12, v13
  v_cvt_pk_bf16_f32 v185, v14, v15
  v_mov_b32 v186, v26
  v_mov_b32 v187, v27
  v_cvt_pk_bf16_f32 v116, v116, v117
  v_cvt_pk_bf16_f32 v117, v118, v119
  v_mfma_f32_16x16x32_bf16 v[92:95], v[184:187], v[60:63], v[92:95]
  v_cvt_pk_bf16_f32 v118, v140, v141
  v_cvt_pk_bf16_f32 v119, v142, v143
  ds_write_b128 v5, v[116:119] offset:12800
  v_mfma_f32_16x16x32_bf16 v[116:119], v[128:131], v[76:79], 0
  v_cvt_pk_bf16_f32 v164, v164, v165
  v_cvt_pk_bf16_f32 v165, v166, v167
  v_mfma_f32_16x16x32_bf16 v[140:143], v[136:139], v[76:79], 0
  v_cvt_pk_bf16_f32 v166, v188, v189
  v_cvt_pk_bf16_f32 v167, v190, v191
  v_mfma_f32_16x16x32_bf16 v[116:119], v[176:179], v[84:87], v[116:119]
  ds_read_b128 a[16:19], v5 offset:64
  v_cvt_pk_bf16_f32 v212, v212, v213
  v_mfma_f32_16x16x32_bf16 v[140:143], v[184:187], v[84:87], v[140:143]
  ds_write_b128 v5, v[164:167] offset:25600
  v_mfma_f32_16x16x32_bf16 v[164:167], v[128:131], v[100:103], 0
  v_accvgpr_read_b32 v8, a84
  v_accvgpr_read_b32 v9, a85
  v_mfma_f32_16x16x32_bf16 v[188:191], v[136:139], v[100:103], 0
  v_accvgpr_read_b32 v10, a86
  v_accvgpr_read_b32 v11, a87
  v_mfma_f32_16x16x32_bf16 v[164:167], v[176:179], v[108:111], v[164:167]
  v_accvgpr_read_b32 v12, a108
  v_accvgpr_read_b32 v13, a109
  v_mfma_f32_16x16x32_bf16 v[188:191], v[184:187], v[108:111], v[188:191]
  v_accvgpr_read_b32 v14, a110
  v_accvgpr_read_b32 v15, a111
  v_mfma_f32_16x16x32_bf16 v[64:67], v[128:131], v[44:47], 0
  v_cvt_pk_bf16_f32 v213, v214, v215
  v_cvt_pk_bf16_f32 v192, v8, v9
  v_mfma_f32_16x16x32_bf16 v[72:75], v[136:139], v[44:47], 0
  v_cvt_pk_bf16_f32 v193, v10, v11
  v_cvt_pk_bf16_f32 v194, v12, v13
  v_mfma_f32_16x16x32_bf16 v[64:67], v[176:179], v[80:83], v[64:67]
  v_cvt_pk_bf16_f32 v195, v14, v15
  v_cvt_pk_bf16_f32 v214, v236, v237
  v_mfma_f32_16x16x32_bf16 v[72:75], v[184:187], v[80:83], v[72:75]
  v_cvt_pk_bf16_f32 v215, v238, v239
  ds_write_b128 v5, v[212:215] offset:64
  v_mfma_f32_16x16x32_bf16 v[212:215], v[192:195], v[124:127], 0
  v_accvgpr_read_b32 v8, a132
  v_accvgpr_read_b32 v9, a133
  v_accvgpr_read_b32 v10, a134
  v_accvgpr_read_b32 v11, a135
  ds_read_b128 a[24:27], v5 offset:12864
  v_cvt_pk_bf16_f32 v200, v8, v9
  v_cvt_pk_bf16_f32 v201, v10, v11
  v_accvgpr_read_b32 v12, a88
  v_accvgpr_read_b32 v13, a89
  v_accvgpr_read_b32 v14, a90
  v_accvgpr_read_b32 v15, a91
  v_accvgpr_read_b32 v8, a112
  v_accvgpr_read_b32 v9, a113
  v_accvgpr_read_b32 v10, a114
  v_accvgpr_read_b32 v11, a115
  v_cvt_pk_bf16_f32 v208, v12, v13
  v_cvt_pk_bf16_f32 v209, v14, v15
  v_cvt_pk_bf16_f32 v210, v8, v9
  v_cvt_pk_bf16_f32 v211, v10, v11
  v_mov_b32 v135, 0
  ds_read_b128 a[32:35], v5 offset:25664
  v_mfma_f32_16x16x32_bf16 v[236:239], v[208:211], v[124:127], 0
  v_mov_b32 v202, v16
  v_mov_b32 v203, v17
  v_accvgpr_read_b32 v12, a136
  v_accvgpr_read_b32 v13, a137
  v_mfma_f32_16x16x32_bf16 v[212:215], v[200:203], v[132:135], v[212:215]
  v_accvgpr_read_b32 v14, a138
  v_accvgpr_read_b32 v15, a139
  v_cvt_pk_bf16_f32 v248, v12, v13
  v_cvt_pk_bf16_f32 v249, v14, v15
  v_mov_b32 v250, v18
  v_mov_b32 v251, v19
  v_cvt_pk_bf16_f32 v216, v216, v217
  v_cvt_pk_bf16_f32 v217, v218, v219
  v_mfma_f32_16x16x32_bf16 v[236:239], v[248:251], v[132:135], v[236:239]
  v_cvt_pk_bf16_f32 v218, v240, v241
  v_cvt_pk_bf16_f32 v219, v242, v243
  v_mov_b32 v159, 0
  v_cvt_pk_bf16_f32 v28, v28, v29
  v_cvt_pk_bf16_f32 v29, v30, v31
  v_cvt_pk_bf16_f32 v30, v32, v33
  v_cvt_pk_bf16_f32 v31, v34, v35
  ds_write_b128 v5, v[216:219] offset:12864
  v_mfma_f32_16x16x32_bf16 v[216:219], v[192:195], v[148:151], 0
  v_mov_b32 v183, 0
  v_cndmask_b32 v44, 0, v224, s[42:43]
  v_mfma_f32_16x16x32_bf16 v[240:243], v[208:211], v[148:151], 0
  ds_read_b128 a[20:23], v5 offset:128
  v_cndmask_b32 v45, 0, v225, s[42:43]
  v_mfma_f32_16x16x32_bf16 v[216:219], v[200:203], v[156:159], v[216:219]
  v_cndmask_b32 v46, 0, v226, s[42:43]
  v_cndmask_b32 v47, 0, v227, s[42:43]
  v_mfma_f32_16x16x32_bf16 v[240:243], v[248:251], v[156:159], v[240:243]
  ds_write_b128 v5, v[28:31] offset:25664
  v_mfma_f32_16x16x32_bf16 v[28:31], v[192:195], v[172:175], 0
  v_cndmask_b32 v82, 0, v234, s[42:43]
  v_cndmask_b32 v80, 0, v232, s[42:43]
  v_mfma_f32_16x16x32_bf16 v[32:35], v[208:211], v[172:175], 0
  v_cndmask_b32 v81, 0, v233, s[42:43]
  v_cvt_pk_bf16_f32 v82, 0, v82
  v_mfma_f32_16x16x32_bf16 v[28:31], v[200:203], v[180:183], v[28:31]
  v_mov_b32 v83, 0
  v_cvt_pk_bf16_f32 v68, v68, v69
  v_mfma_f32_16x16x32_bf16 v[32:35], v[248:251], v[180:183], v[32:35]
  v_accvgpr_read_b32 v8, a92
  v_accvgpr_read_b32 v9, a93
  v_mfma_f32_16x16x32_bf16 v[36:39], v[192:195], v[44:47], v[36:39]
  v_accvgpr_read_b32 v10, a94
  v_accvgpr_read_b32 v11, a95
  v_mfma_f32_16x16x32_bf16 v[40:43], v[208:211], v[44:47], v[40:43]
  v_accvgpr_read_b32 v12, a116
  v_accvgpr_read_b32 v13, a117
  v_mfma_f32_16x16x32_bf16 v[36:39], v[200:203], v[80:83], v[36:39]
  v_accvgpr_read_b32 v14, a118
  v_accvgpr_read_b32 v15, a119
  v_mfma_f32_16x16x32_bf16 v[40:43], v[248:251], v[80:83], v[40:43]
  v_cvt_pk_bf16_f32 v69, v70, v71
  v_cvt_pk_bf16_f32 v96, v8, v9
  v_cvt_pk_bf16_f32 v97, v10, v11
  v_cvt_pk_bf16_f32 v98, v12, v13
  v_cvt_pk_bf16_f32 v99, v14, v15
  v_cvt_pk_bf16_f32 v70, v92, v93
  v_cvt_pk_bf16_f32 v71, v94, v95
  ds_write_b128 v5, v[68:71] offset:128
  v_mfma_f32_16x16x32_bf16 v[68:71], v[96:99], v[124:127], 0
  v_accvgpr_read_b32 v8, a140
  v_accvgpr_read_b32 v9, a141
  v_accvgpr_read_b32 v10, a142
  v_accvgpr_read_b32 v11, a143
  ds_read_b128 a[28:31], v5 offset:12928
  v_cvt_pk_bf16_f32 v144, v8, v9
  v_cvt_pk_bf16_f32 v145, v10, v11
  v_accvgpr_read_b32 v12, a96
  v_accvgpr_read_b32 v13, a97
  v_accvgpr_read_b32 v14, a98
  v_accvgpr_read_b32 v15, a99
  v_accvgpr_read_b32 v8, a120
  v_accvgpr_read_b32 v9, a121
  v_accvgpr_read_b32 v10, a122
  v_accvgpr_read_b32 v11, a123
  v_cvt_pk_bf16_f32 v104, v12, v13
  v_cvt_pk_bf16_f32 v105, v14, v15
  v_cvt_pk_bf16_f32 v106, v8, v9
  v_cvt_pk_bf16_f32 v107, v10, v11
  v_mov_b32 v146, v20
  v_mov_b32 v147, v21
  v_mfma_f32_16x16x32_bf16 v[92:95], v[104:107], v[124:127], 0
  ds_read_b128 a[156:159], v5 offset:25728
  v_accvgpr_read_b32 v12, a144
  v_mfma_f32_16x16x32_bf16 v[68:71], v[144:147], v[132:135], v[68:71]
  v_accvgpr_read_b32 v13, a145
  v_accvgpr_read_b32 v14, a146
  v_accvgpr_read_b32 v15, a147
  v_cvt_pk_bf16_f32 v152, v12, v13
  v_cvt_pk_bf16_f32 v153, v14, v15
  v_mov_b32 v154, v22
  v_mov_b32 v155, v23
  v_cvt_pk_bf16_f32 v116, v116, v117
  v_cvt_pk_bf16_f32 v117, v118, v119
  v_mfma_f32_16x16x32_bf16 v[92:95], v[152:155], v[132:135], v[92:95]
  v_cvt_pk_bf16_f32 v118, v140, v141
  v_cvt_pk_bf16_f32 v119, v142, v143
  v_cvt_pk_bf16_f32 v164, v164, v165
  v_cvt_pk_bf16_f32 v165, v166, v167
  v_cvt_pk_bf16_f32 v166, v188, v189
  v_cvt_pk_bf16_f32 v167, v190, v191
  ds_read_b128 a[48:51], v5 offset:38400
  v_cvt_pk_bf16_f32 v212, v212, v213
  ds_write_b128 v5, v[116:119] offset:12928
  v_mfma_f32_16x16x32_bf16 v[116:119], v[96:99], v[148:151], 0
  v_accvgpr_read_b32 v8, a100
  v_accvgpr_read_b32 v9, a101
  v_mfma_f32_16x16x32_bf16 v[140:143], v[104:107], v[148:151], 0
  v_accvgpr_read_b32 v10, a102
  v_accvgpr_read_b32 v11, a103
  v_mfma_f32_16x16x32_bf16 v[116:119], v[144:147], v[156:159], v[116:119]
  v_accvgpr_read_b32 v12, a124
  v_accvgpr_read_b32 v13, a125
  v_mfma_f32_16x16x32_bf16 v[140:143], v[152:155], v[156:159], v[140:143]
  ds_write_b128 v5, v[164:167] offset:25728
  v_mfma_f32_16x16x32_bf16 v[164:167], v[96:99], v[172:175], 0
  v_accvgpr_read_b32 v14, a126
  v_accvgpr_read_b32 v15, a127
  v_mfma_f32_16x16x32_bf16 v[188:191], v[104:107], v[172:175], 0
  v_cvt_pk_bf16_f32 v213, v214, v215
  v_cvt_pk_bf16_f32 v112, v8, v9
  v_mfma_f32_16x16x32_bf16 v[164:167], v[144:147], v[180:183], v[164:167]
  v_cvt_pk_bf16_f32 v113, v10, v11
  v_cvt_pk_bf16_f32 v114, v12, v13
  v_mfma_f32_16x16x32_bf16 v[188:191], v[152:155], v[180:183], v[188:191]
  v_cvt_pk_bf16_f32 v115, v14, v15
  v_cvt_pk_bf16_f32 v214, v236, v237
  v_mfma_f32_16x16x32_bf16 v[48:51], v[96:99], v[44:47], v[48:51]
  v_cvt_pk_bf16_f32 v215, v238, v239
  v_accvgpr_read_b32 v8, a148
  v_mfma_f32_16x16x32_bf16 v[56:59], v[104:107], v[44:47], v[56:59]
  v_accvgpr_read_b32 v9, a149
  v_accvgpr_read_b32 v10, a150
  v_mfma_f32_16x16x32_bf16 v[48:51], v[144:147], v[80:83], v[48:51]
  v_accvgpr_read_b32 v11, a151
  v_cvt_pk_bf16_f32 v160, v8, v9
  v_mfma_f32_16x16x32_bf16 v[56:59], v[152:155], v[80:83], v[56:59]
  ds_write_b128 v5, v[212:215] offset:38400
  v_mfma_f32_16x16x32_bf16 v[212:215], v[112:115], v[124:127], 0
  v_cvt_pk_bf16_f32 v161, v10, v11
  v_accvgpr_read_b32 v12, a104
  v_accvgpr_read_b32 v13, a105
  v_accvgpr_read_b32 v14, a106
  ds_read_b128 a[52:55], v5 offset:51200
  v_accvgpr_read_b32 v15, a107
  v_accvgpr_read_b32 v8, a128
  v_accvgpr_read_b32 v9, a129
  v_accvgpr_read_b32 v10, a130
  v_accvgpr_read_b32 v11, a131
  v_cvt_pk_bf16_f32 v120, v12, v13
  v_cvt_pk_bf16_f32 v121, v14, v15
  v_cvt_pk_bf16_f32 v122, v8, v9
  v_cvt_pk_bf16_f32 v123, v10, v11
  v_add_u32 v6, s37, v1
  v_mov_b32 v162, v24
  v_mfma_f32_16x16x32_bf16 v[236:239], v[120:123], v[124:127], 0
  v_mov_b32 v163, v25
  ds_read_b128 a[56:59], v6 offset:0
  v_accvgpr_read_b32 v12, a152
  v_mfma_f32_16x16x32_bf16 v[212:215], v[160:163], v[132:135], v[212:215]
  v_accvgpr_read_b32 v13, a153
  v_accvgpr_read_b32 v14, a154
  v_accvgpr_read_b32 v15, a155
  v_cvt_pk_bf16_f32 v168, v12, v13
  v_cvt_pk_bf16_f32 v169, v14, v15
  v_mov_b32 v170, v26
  v_mov_b32 v171, v27
  v_cvt_pk_bf16_f32 v216, v216, v217
  v_cvt_pk_bf16_f32 v217, v218, v219
  v_mfma_f32_16x16x32_bf16 v[236:239], v[168:171], v[132:135], v[236:239]
  v_cvt_pk_bf16_f32 v218, v240, v241
  v_cvt_pk_bf16_f32 v219, v242, v243
  v_cvt_pk_bf16_f32 v28, v28, v29
  v_cvt_pk_bf16_f32 v29, v30, v31
  v_cvt_pk_bf16_f32 v30, v32, v33
  v_cvt_pk_bf16_f32 v31, v34, v35
  ds_read_b128 a[92:95], v5 offset:38464
  v_cvt_pk_bf16_f32 v68, v68, v69
  v_accvgpr_read_b32 v8, a164
  v_accvgpr_read_b32 v9, a165
  v_accvgpr_read_b32 v10, a166
  v_accvgpr_read_b32 v11, a167
  ds_write_b128 v5, v[216:219] offset:51200
  v_mfma_f32_16x16x32_bf16 v[216:219], v[112:115], v[148:151], 0
  v_accvgpr_read_b32 v12, a188
  v_accvgpr_read_b32 v13, a189
  v_mfma_f32_16x16x32_bf16 v[240:243], v[120:123], v[148:151], 0
  v_accvgpr_read_b32 v14, a190
  v_accvgpr_read_b32 v15, a191
  v_mfma_f32_16x16x32_bf16 v[216:219], v[160:163], v[156:159], v[216:219]
  v_cvt_pk_bf16_f32 v69, v70, v71
  v_cvt_pk_bf16_f32 v128, v8, v9
  v_mfma_f32_16x16x32_bf16 v[240:243], v[168:171], v[156:159], v[240:243]
  ds_write_b128 v6, v[28:31] offset:0
  v_mfma_f32_16x16x32_bf16 v[28:31], v[112:115], v[172:175], 0
  v_cvt_pk_bf16_f32 v129, v10, v11
  v_cvt_pk_bf16_f32 v130, v12, v13
  v_mfma_f32_16x16x32_bf16 v[32:35], v[120:123], v[172:175], 0
  v_cvt_pk_bf16_f32 v131, v14, v15
  v_cvt_pk_bf16_f32 v70, v92, v93
  v_mfma_f32_16x16x32_bf16 v[28:31], v[160:163], v[180:183], v[28:31]
  v_cvt_pk_bf16_f32 v71, v94, v95
  v_accvgpr_read_b32 v8, a212
  v_mfma_f32_16x16x32_bf16 v[32:35], v[168:171], v[180:183], v[32:35]
  v_accvgpr_read_b32 v9, a213
  v_accvgpr_read_b32 v10, a214
  v_mfma_f32_16x16x32_bf16 v[64:67], v[112:115], v[44:47], v[64:67]
  v_accvgpr_read_b32 v11, a215
  v_cvt_pk_bf16_f32 v176, v8, v9
  v_mfma_f32_16x16x32_bf16 v[72:75], v[120:123], v[44:47], v[72:75]
  v_cvt_pk_bf16_f32 v177, v10, v11
  v_accvgpr_read_b32 v12, a168
  v_mfma_f32_16x16x32_bf16 v[64:67], v[160:163], v[80:83], v[64:67]
  v_accvgpr_read_b32 v13, a169
  v_accvgpr_read_b32 v14, a170
  v_mfma_f32_16x16x32_bf16 v[72:75], v[168:171], v[80:83], v[72:75]
  ds_write_b128 v5, v[68:71] offset:38464
  v_mfma_f32_16x16x32_bf16 v[68:71], v[128:131], v[196:199], 0
  v_accvgpr_read_b32 v15, a171
  v_accvgpr_read_b32 v8, a192
  v_accvgpr_read_b32 v9, a193
  v_accvgpr_read_b32 v10, a194
  ds_read_b128 a[116:119], v5 offset:51264
  v_accvgpr_read_b32 v11, a195
  v_cvt_pk_bf16_f32 v136, v12, v13
  v_cvt_pk_bf16_f32 v137, v14, v15
  v_cvt_pk_bf16_f32 v138, v8, v9
  v_cvt_pk_bf16_f32 v139, v10, v11
  v_mov_b32 v206, 0
  ds_read_b128 a[140:143], v6 offset:64
  v_mfma_f32_16x16x32_bf16 v[92:95], v[136:139], v[196:199], 0
  v_mov_b32 v178, v16
  v_mov_b32 v179, v17
  v_accvgpr_read_b32 v12, a216
  v_accvgpr_read_b32 v13, a217
  v_mfma_f32_16x16x32_bf16 v[68:71], v[176:179], v[204:207], v[68:71]
  v_accvgpr_read_b32 v14, a218
  v_accvgpr_read_b32 v15, a219
  v_cvt_pk_bf16_f32 v184, v12, v13
  v_cvt_pk_bf16_f32 v185, v14, v15
  v_mov_b32 v186, v18
  v_mov_b32 v187, v19
  v_cvt_pk_bf16_f32 v116, v116, v117
  v_cvt_pk_bf16_f32 v117, v118, v119
  v_mfma_f32_16x16x32_bf16 v[92:95], v[184:187], v[204:207], v[92:95]
  v_cvt_pk_bf16_f32 v118, v140, v141
  v_cvt_pk_bf16_f32 v119, v142, v143
  v_mov_b32 v230, 0
  v_cvt_pk_bf16_f32 v164, v164, v165
  v_cvt_pk_bf16_f32 v165, v166, v167
  v_cvt_pk_bf16_f32 v166, v188, v189
  v_cvt_pk_bf16_f32 v167, v190, v191
  v_mov_b32 v254, 0
  ds_read_b128 a[100:103], v5 offset:38528
  v_cndmask_b32 v44, 0, v224, s[44:45]
  v_cndmask_b32 v45, 0, v225, s[44:45]
  v_cndmask_b32 v46, 0, v226, s[44:45]
  v_cndmask_b32 v47, 0, v227, s[44:45]
  v_cndmask_b32 v83, 0, v234, s[44:45]
  v_cndmask_b32 v80, 0, v232, s[44:45]
  v_cndmask_b32 v81, 0, v233, s[44:45]
  ds_write_b128 v5, v[116:119] offset:51264
  v_mfma_f32_16x16x32_bf16 v[116:119], v[128:131], v[220:223], 0
  v_cvt_pk_bf16_f32 v83, v83, 0
  v_mov_b32 v82, 0
  v_mfma_f32_16x16x32_bf16 v[140:143], v[136:139], v[220:223], 0
  v_cvt_pk_bf16_f32 v212, v212, v213
  v_accvgpr_read_b32 v8, a172
  v_mfma_f32_16x16x32_bf16 v[116:119], v[176:179], v[228:231], v[116:119]
  v_accvgpr_read_b32 v9, a173
  v_accvgpr_read_b32 v10, a174
  v_mfma_f32_16x16x32_bf16 v[140:143], v[184:187], v[228:231], v[140:143]
  ds_write_b128 v6, v[164:167] offset:64
  v_mfma_f32_16x16x32_bf16 v[164:167], v[128:131], v[244:247], 0
  v_accvgpr_read_b32 v11, a175
  v_accvgpr_read_b32 v12, a196
  v_mfma_f32_16x16x32_bf16 v[188:191], v[136:139], v[244:247], 0
  v_accvgpr_read_b32 v13, a197
  v_accvgpr_read_b32 v14, a198
  v_mfma_f32_16x16x32_bf16 v[164:167], v[176:179], v[252:255], v[164:167]
  v_accvgpr_read_b32 v15, a199
  v_cvt_pk_bf16_f32 v213, v214, v215
  v_mfma_f32_16x16x32_bf16 v[188:191], v[184:187], v[252:255], v[188:191]
  v_cvt_pk_bf16_f32 v192, v8, v9
  v_cvt_pk_bf16_f32 v193, v10, v11
  v_mfma_f32_16x16x32_bf16 v[36:39], v[128:131], v[44:47], v[36:39]
  v_cvt_pk_bf16_f32 v194, v12, v13
  v_cvt_pk_bf16_f32 v195, v14, v15
  v_mfma_f32_16x16x32_bf16 v[40:43], v[136:139], v[44:47], v[40:43]
  v_cvt_pk_bf16_f32 v214, v236, v237
  v_cvt_pk_bf16_f32 v215, v238, v239
  v_mfma_f32_16x16x32_bf16 v[36:39], v[176:179], v[80:83], v[36:39]
  v_accvgpr_read_b32 v8, a220
  v_accvgpr_read_b32 v9, a221
  v_mfma_f32_16x16x32_bf16 v[40:43], v[184:187], v[80:83], v[40:43]
  ds_write_b128 v5, v[212:215] offset:38528
  v_mfma_f32_16x16x32_bf16 v[212:215], v[192:195], v[196:199], 0
  v_accvgpr_read_b32 v10, a222
  v_accvgpr_read_b32 v11, a223
  v_cvt_pk_bf16_f32 v200, v8, v9
  v_cvt_pk_bf16_f32 v201, v10, v11
  ds_read_b128 a[124:127], v5 offset:51328
  v_accvgpr_read_b32 v12, a176
  v_accvgpr_read_b32 v13, a177
  v_accvgpr_read_b32 v14, a178
  v_accvgpr_read_b32 v15, a179
  v_accvgpr_read_b32 v8, a200
  v_accvgpr_read_b32 v9, a201
  v_accvgpr_read_b32 v10, a202
  v_accvgpr_read_b32 v11, a203
  v_cvt_pk_bf16_f32 v208, v12, v13
  v_cvt_pk_bf16_f32 v209, v14, v15
  v_cvt_pk_bf16_f32 v210, v8, v9
  v_cvt_pk_bf16_f32 v211, v10, v11
  v_mov_b32 v202, v20
  v_mov_b32 v203, v21
  v_mfma_f32_16x16x32_bf16 v[236:239], v[208:211], v[196:199], 0
  ds_read_b128 a[148:151], v6 offset:128
  v_accvgpr_read_b32 v12, a224
  v_mfma_f32_16x16x32_bf16 v[212:215], v[200:203], v[204:207], v[212:215]
  v_accvgpr_read_b32 v13, a225
  v_accvgpr_read_b32 v14, a226
  v_accvgpr_read_b32 v15, a227
  v_cvt_pk_bf16_f32 v248, v12, v13
  v_cvt_pk_bf16_f32 v249, v14, v15
  v_mov_b32 v250, v22
  v_mov_b32 v251, v23
  v_cvt_pk_bf16_f32 v216, v216, v217
  v_cvt_pk_bf16_f32 v217, v218, v219
  v_mfma_f32_16x16x32_bf16 v[236:239], v[248:251], v[204:207], v[236:239]
  v_cvt_pk_bf16_f32 v218, v240, v241
  v_cvt_pk_bf16_f32 v219, v242, v243
  v_cvt_pk_bf16_f32 v28, v28, v29
  v_cvt_pk_bf16_f32 v29, v30, v31
  v_cvt_pk_bf16_f32 v30, v32, v33
  v_cvt_pk_bf16_f32 v31, v34, v35
  ds_read_b128 a[60:63], v6 offset:12800
  v_cvt_pk_bf16_f32 v68, v68, v69
  v_accvgpr_read_b32 v8, a180
  v_accvgpr_read_b32 v9, a181
  ds_write_b128 v5, v[216:219] offset:51328
  v_mfma_f32_16x16x32_bf16 v[216:219], v[192:195], v[220:223], 0
  v_accvgpr_read_b32 v10, a182
  v_accvgpr_read_b32 v11, a183
  v_mfma_f32_16x16x32_bf16 v[240:243], v[208:211], v[220:223], 0
  v_accvgpr_read_b32 v12, a204
  v_accvgpr_read_b32 v13, a205
  v_mfma_f32_16x16x32_bf16 v[216:219], v[200:203], v[228:231], v[216:219]
  v_accvgpr_read_b32 v14, a206
  v_accvgpr_read_b32 v15, a207
  v_mfma_f32_16x16x32_bf16 v[240:243], v[248:251], v[228:231], v[240:243]
  ds_write_b128 v6, v[28:31] offset:128
  v_mfma_f32_16x16x32_bf16 v[28:31], v[192:195], v[244:247], 0
  v_cvt_pk_bf16_f32 v69, v70, v71
  v_cvt_pk_bf16_f32 v96, v8, v9
  v_mfma_f32_16x16x32_bf16 v[32:35], v[208:211], v[244:247], 0
  v_cvt_pk_bf16_f32 v97, v10, v11
  v_cvt_pk_bf16_f32 v98, v12, v13
  v_mfma_f32_16x16x32_bf16 v[28:31], v[200:203], v[252:255], v[28:31]
  v_cvt_pk_bf16_f32 v99, v14, v15
  v_cvt_pk_bf16_f32 v70, v92, v93
  v_mfma_f32_16x16x32_bf16 v[32:35], v[248:251], v[252:255], v[32:35]
  v_cvt_pk_bf16_f32 v71, v94, v95
  v_accvgpr_read_b32 v8, a228
  v_mfma_f32_16x16x32_bf16 v[48:51], v[192:195], v[44:47], v[48:51]
  v_accvgpr_read_b32 v9, a229
  v_accvgpr_read_b32 v10, a230
  v_mfma_f32_16x16x32_bf16 v[56:59], v[208:211], v[44:47], v[56:59]
  v_accvgpr_read_b32 v11, a231
  v_cvt_pk_bf16_f32 v144, v8, v9
  v_mfma_f32_16x16x32_bf16 v[48:51], v[200:203], v[80:83], v[48:51]
  v_cvt_pk_bf16_f32 v145, v10, v11
  v_accvgpr_read_b32 v12, a184
  v_mfma_f32_16x16x32_bf16 v[56:59], v[248:251], v[80:83], v[56:59]
  ds_write_b128 v6, v[68:71] offset:12800
  v_mfma_f32_16x16x32_bf16 v[68:71], v[96:99], v[196:199], 0
  v_accvgpr_read_b32 v13, a185
  v_accvgpr_read_b32 v14, a186
  v_accvgpr_read_b32 v15, a187
  v_accvgpr_read_b32 v8, a208
  ds_read_b128 a[64:67], v6 offset:25600
  v_accvgpr_read_b32 v9, a209
  v_accvgpr_read_b32 v10, a210
  v_accvgpr_read_b32 v11, a211
  v_cvt_pk_bf16_f32 v104, v12, v13
  v_cvt_pk_bf16_f32 v105, v14, v15
  v_cvt_pk_bf16_f32 v106, v8, v9
  v_cvt_pk_bf16_f32 v107, v10, v11
  v_mov_b32 v146, v24
  v_mov_b32 v147, v25
  v_mfma_f32_16x16x32_bf16 v[92:95], v[104:107], v[196:199], 0
  ds_read_b128 a[236:239], v6 offset:38400
  v_accvgpr_read_b32 v12, a232
  v_mfma_f32_16x16x32_bf16 v[68:71], v[144:147], v[204:207], v[68:71]
  v_accvgpr_read_b32 v13, a233
  v_accvgpr_read_b32 v14, a234
  v_accvgpr_read_b32 v15, a235
  v_cvt_pk_bf16_f32 v152, v12, v13
  v_cvt_pk_bf16_f32 v153, v14, v15
  v_mov_b32 v154, v26
  v_mov_b32 v155, v27
  v_cvt_pk_bf16_f32 v116, v116, v117
  v_cvt_pk_bf16_f32 v117, v118, v119
  v_mfma_f32_16x16x32_bf16 v[92:95], v[152:155], v[204:207], v[92:95]
  v_cvt_pk_bf16_f32 v118, v140, v141
  v_cvt_pk_bf16_f32 v119, v142, v143
  v_cvt_pk_bf16_f32 v164, v164, v165
  v_cvt_pk_bf16_f32 v165, v166, v167
  v_cvt_pk_bf16_f32 v166, v188, v189
  v_cvt_pk_bf16_f32 v167, v190, v191
  v_add_u32 v7, s37, v2
  ds_read_b128 a[252:255], v7 offset:0
  v_cvt_pk_bf16_f32 v68, v68, v69
  ds_read_b128 a[96:99], v6 offset:12864
  v_cvt_pk_bf16_f32 v69, v70, v71
  v_cvt_pk_bf16_f32 v70, v92, v93
  v_cvt_pk_bf16_f32 v71, v94, v95
  ds_read_b128 a[120:123], v6 offset:25664
  v_cvt_pk_bf16_f32 v36, v36, v37
  v_cvt_pk_bf16_f32 v212, v212, v213
  v_cvt_pk_bf16_f32 v216, v216, v217
  ds_write_b128 v6, v[116:119] offset:25600
  v_mfma_f32_16x16x32_bf16 v[116:119], v[96:99], v[220:223], 0
  v_cvt_pk_bf16_f32 v28, v28, v29
  v_cvt_pk_bf16_f32 v48, v48, v49
  v_mfma_f32_16x16x32_bf16 v[140:143], v[104:107], v[220:223], 0
  v_cvt_pk_bf16_f32 v37, v38, v39
  v_cvt_pk_bf16_f32 v213, v214, v215
  v_mfma_f32_16x16x32_bf16 v[116:119], v[144:147], v[228:231], v[116:119]
  v_cvt_pk_bf16_f32 v217, v218, v219
  v_cvt_pk_bf16_f32 v29, v30, v31
  v_mfma_f32_16x16x32_bf16 v[140:143], v[152:155], v[228:231], v[140:143]
  ds_write_b128 v6, v[164:167] offset:38400
  v_mfma_f32_16x16x32_bf16 v[164:167], v[96:99], v[244:247], 0
  v_cvt_pk_bf16_f32 v116, v116, v117
  v_cvt_pk_bf16_f32 v49, v50, v51
  v_mfma_f32_16x16x32_bf16 v[188:191], v[104:107], v[244:247], 0
  ds_read_b128 a[104:107], v6 offset:12928
  v_cvt_pk_bf16_f32 v117, v118, v119
  v_mfma_f32_16x16x32_bf16 v[164:167], v[144:147], v[252:255], v[164:167]
  ds_read_b128 a[144:147], v6 offset:38464
  v_cvt_pk_bf16_f32 v38, v40, v41
  v_mfma_f32_16x16x32_bf16 v[188:191], v[152:155], v[252:255], v[188:191]
  ds_read_b128 a[84:87], v7 offset:64
  v_cvt_pk_bf16_f32 v39, v42, v43
  v_mfma_f32_16x16x32_bf16 v[64:67], v[96:99], v[44:47], v[64:67]
  ds_read_b128 a[128:131], v6 offset:25728
  v_cvt_pk_bf16_f32 v164, v164, v165
  v_mfma_f32_16x16x32_bf16 v[72:75], v[104:107], v[44:47], v[72:75]
  ds_read_b128 a[152:155], v6 offset:38528
  v_cvt_pk_bf16_f32 v165, v166, v167
  v_mfma_f32_16x16x32_bf16 v[64:67], v[144:147], v[80:83], v[64:67]
  ds_read_b128 a[88:91], v7 offset:128
  v_cvt_pk_bf16_f32 v214, v236, v237
  v_mfma_f32_16x16x32_bf16 v[72:75], v[152:155], v[80:83], v[72:75]
  s_waitcnt lgkmcnt(11)
  v_cvt_pk_bf16_f32 v215, v238, v239
  v_cvt_pk_bf16_f32 v218, v240, v241
  v_mfma_f32_16x16x32_bf16 v[52:55], a[8:11], a[36:39], 0
  v_cvt_pk_bf16_f32 v219, v242, v243
  v_cvt_pk_bf16_f32 v64, v64, v65
  v_mfma_f32_16x16x32_bf16 v[60:63], a[12:15], a[36:39], 0
  v_cvt_pk_bf16_f32 v65, v66, v67
  v_cvt_pk_bf16_f32 v30, v32, v33
  v_mfma_f32_16x16x32_bf16 v[76:79], a[8:11], a[40:43], 0
  v_cvt_pk_bf16_f32 v31, v34, v35
  v_cvt_pk_bf16_f32 v50, v56, v57
  v_mfma_f32_16x16x32_bf16 v[84:87], a[12:15], a[40:43], 0
  v_cvt_pk_bf16_f32 v51, v58, v59
  v_cvt_pk_bf16_f32 v118, v140, v141
  v_mfma_f32_16x16x32_bf16 v[100:103], a[8:11], a[44:47], 0
  v_cvt_pk_bf16_f32 v119, v142, v143
  v_cvt_pk_bf16_f32 v166, v188, v189
  v_mfma_f32_16x16x32_bf16 v[108:111], a[12:15], a[44:47], 0
  v_cvt_pk_bf16_f32 v167, v190, v191
  v_cvt_pk_bf16_f32 v66, v72, v73
  v_mfma_f32_16x16x32_bf16 v[124:127], a[8:11], a[48:51], 0
  v_cvt_pk_bf16_f32 v67, v74, v75
  v_and_b32 v17, 1, v4
  v_mfma_f32_16x16x32_bf16 v[132:135], a[12:15], a[48:51], 0
  v_mov_b32 v22, 0xc0000000
  v_and_b32 v18, 1, v4
  v_mfma_f32_16x16x32_bf16 v[148:151], a[8:11], a[52:55], 0
  v_mfma_f32_16x16x32_bf16 v[156:159], a[12:15], a[52:55], 0
  v_mfma_f32_16x16x32_bf16 v[172:175], a[8:11], a[56:59], 0
  v_mfma_f32_16x16x32_bf16 v[180:183], a[12:15], a[56:59], 0
  v_mfma_f32_16x16x32_bf16 v[112:115], a[8:11], a[60:63], 0
  v_mfma_f32_16x16x32_bf16 v[160:163], a[12:15], a[60:63], 0
  v_mfma_f32_16x16x32_bf16 v[120:123], a[8:11], a[64:67], 0
  v_mfma_f32_16x16x32_bf16 v[168:171], a[12:15], a[64:67], 0
  v_mfma_f32_16x16x32_bf16 v[128:131], a[8:11], a[236:239], 0
  v_mfma_f32_16x16x32_bf16 v[176:179], a[12:15], a[236:239], 0
  s_waitcnt lgkmcnt(2)
  v_mfma_f32_16x16x32_bf16 v[136:139], a[8:11], a[252:255], 0
  v_mfma_f32_16x16x32_bf16 v[184:187], a[12:15], a[252:255], 0
  v_mfma_f32_16x16x32_bf16 v[196:199], a[8:11], a[16:19], 0
  buffer_load_dwordx4 a[252:255], v3, s[8:11], s28 offen offset:3072
  s_addk_i32 s28, 4096
  v_mfma_f32_16x16x32_bf16 v[204:207], a[12:15], a[16:19], 0
  buffer_load_dwordx4 a[36:39], v3, s[8:11], s28 offen offset:0
  v_mfma_f32_16x16x32_bf16 v[220:223], a[8:11], a[24:27], 0
  buffer_load_dwordx4 a[40:43], v3, s[8:11], s28 offen offset:1024
  v_mfma_f32_16x16x32_bf16 v[228:231], a[12:15], a[24:27], 0
  v_mfma_f32_16x16x32_bf16 v[244:247], a[8:11], a[32:35], 0
  v_mfma_f32_16x16x32_bf16 v[252:255], a[12:15], a[32:35], 0
  buffer_load_dwordx4 a[44:47], v3, s[8:11], s28 offen offset:2048
  v_mfma_f32_16x16x32_bf16 v[192:195], a[8:11], a[92:95], 0
  v_mfma_f32_16x16x32_bf16 v[200:203], a[12:15], a[92:95], 0
  v_mfma_f32_16x16x32_bf16 v[208:211], a[8:11], a[116:119], 0
  v_mfma_f32_16x16x32_bf16 v[248:251], a[12:15], a[116:119], 0
  buffer_load_dwordx4 a[48:51], v3, s[8:11], s28 offen offset:3072
  s_addk_i32 s28, 4096
  v_mfma_f32_16x16x32_bf16 v[96:99], a[8:11], a[140:143], 0
  v_mfma_f32_16x16x32_bf16 v[144:147], a[12:15], a[140:143], 0
  v_mfma_f32_16x16x32_bf16 v[104:107], a[8:11], a[96:99], 0
  v_mfma_f32_16x16x32_bf16 v[152:155], a[12:15], a[96:99], 0
  buffer_load_dwordx4 a[52:55], v3, s[8:11], s28 offen offset:0
  ds_write_b128 v6, v[68:71] offset:12928
  v_mfma_f32_16x16x32_bf16 v[68:71], a[8:11], a[120:123], 0
  v_mfma_f32_16x16x32_bf16 v[92:95], a[12:15], a[120:123], 0
  buffer_load_dwordx4 a[56:59], v3, s[8:11], s28 offen offset:1024
  ds_write_b128 v7, v[36:39] offset:0
  v_lshrrev_b32 v36, 1, v4
  v_add_u32 v36, s49, v36
  v_mul_u32_u24 v37, 2850, v36
  v_lshrrev_b32 v37, 16, v37
  v_mul_u32_u24 v38, 23, v37
  v_sub_u32 v38, v36, v38
  ds_write_b128 v6, v[212:215] offset:12864
  v_mul_u32_u24 v39, 378, v37
  v_add_u32 v39, v39, v38
  v_mul_u32_u24 v39, 768, v39
  v_lshl_add_u32 v39, v17, 4, v39
  v_cmp_le_u32 vcc, 207, v36
  v_lshrrev_b32 v36, 1, v4
  v_add_u32 v36, s71, v36
  ds_write_b128 v6, v[216:219] offset:25664
  ds_write_b128 v6, v[28:31] offset:38464
  ds_write_b128 v7, v[48:51] offset:64
  ds_write_b128 v6, v[116:119] offset:25728
  v_mfma_f32_16x16x32_bf16 v[116:119], a[8:11], a[144:147], 0
  buffer_load_dwordx4 a[60:63], v3, s[8:11], s28 offen offset:2048
  v_mfma_f32_16x16x32_bf16 v[140:143], a[12:15], a[144:147], 0
  buffer_load_dwordx4 a[64:67], v3, s[8:11], s28 offen offset:3072
  s_addk_i32 s28, 4096
  ds_write_b128 v6, v[164:167] offset:38528
  v_mfma_f32_16x16x32_bf16 v[164:167], a[8:11], a[84:87], 0
  v_mfma_f32_16x16x32_bf16 v[188:191], a[12:15], a[84:87], 0
  ds_write_b128 v7, v[64:67] offset:128
  s_waitcnt lgkmcnt(0)
  s_barrier
  ds_read_b128 a[200:203], v0 offset:0
  ds_read_b128 a[204:207], v0 offset:12800
  ds_read_b128 a[208:211], v0 offset:25600
  ds_read_b128 a[212:215], v0 offset:38400
  ds_read_b128 a[216:219], v0 offset:51200
  ds_read_b128 a[220:223], v1 offset:0
  ds_read_b128 a[224:227], v1 offset:12800
  ds_read_b128 a[228:231], v1 offset:25600
  ds_read_b128 a[232:235], v1 offset:38400
  ds_read_b128 a[236:239], v2 offset:0
  ds_read_b128 a[160:163], v0 offset:64
  ds_read_b128 a[164:167], v0 offset:12864
  ds_read_b128 a[168:171], v0 offset:25664
  s_waitcnt vmcnt(9) lgkmcnt(12)
  v_mfma_f32_16x16x32_bf16 v[52:55], a[68:71], a[200:203], v[52:55]
  ds_read_b128 a[172:175], v0 offset:38464
  v_mfma_f32_16x16x32_bf16 v[60:63], a[72:75], a[200:203], v[60:63]
  s_waitcnt lgkmcnt(12)
  v_mfma_f32_16x16x32_bf16 v[76:79], a[68:71], a[204:207], v[76:79]
  ds_read_b128 a[200:203], v0 offset:51264
  v_mfma_f32_16x16x32_bf16 v[84:87], a[72:75], a[204:207], v[84:87]
  s_waitcnt lgkmcnt(12)
  v_mfma_f32_16x16x32_bf16 v[100:103], a[68:71], a[208:211], v[100:103]
  ds_read_b128 a[204:207], v1 offset:64
  v_mfma_f32_16x16x32_bf16 v[108:111], a[72:75], a[208:211], v[108:111]
  s_waitcnt lgkmcnt(12)
  v_mfma_f32_16x16x32_bf16 v[124:127], a[68:71], a[212:215], v[124:127]
  ds_read_b128 a[208:211], v1 offset:12864
  v_mfma_f32_16x16x32_bf16 v[132:135], a[72:75], a[212:215], v[132:135]
  s_waitcnt lgkmcnt(12)
  v_mfma_f32_16x16x32_bf16 v[148:151], a[68:71], a[216:219], v[148:151]
  ds_read_b128 a[212:215], v1 offset:25664
  v_mfma_f32_16x16x32_bf16 v[156:159], a[72:75], a[216:219], v[156:159]
  s_waitcnt lgkmcnt(12)
  v_mfma_f32_16x16x32_bf16 v[172:175], a[68:71], a[220:223], v[172:175]
  ds_read_b128 a[216:219], v1 offset:38464
  v_mfma_f32_16x16x32_bf16 v[180:183], a[72:75], a[220:223], v[180:183]
  s_waitcnt lgkmcnt(12)
  v_mfma_f32_16x16x32_bf16 v[112:115], a[68:71], a[224:227], v[112:115]
  ds_read_b128 a[220:223], v2 offset:64
  v_mfma_f32_16x16x32_bf16 v[160:163], a[72:75], a[224:227], v[160:163]
  s_waitcnt lgkmcnt(12)
  v_mfma_f32_16x16x32_bf16 v[120:123], a[68:71], a[228:231], v[120:123]
  ds_read_b128 a[224:227], v0 offset:128
  v_mfma_f32_16x16x32_bf16 v[168:171], a[72:75], a[228:231], v[168:171]
  s_waitcnt lgkmcnt(12)
  v_mfma_f32_16x16x32_bf16 v[128:131], a[68:71], a[232:235], v[128:131]
  ds_read_b128 a[228:231], v0 offset:12928
  v_mfma_f32_16x16x32_bf16 v[176:179], a[72:75], a[232:235], v[176:179]
  s_waitcnt lgkmcnt(11)
  v_mfma_f32_16x16x32_bf16 v[136:139], a[68:71], a[236:239], v[136:139]
  ds_read_b128 a[232:235], v0 offset:25728
  v_mfma_f32_16x16x32_bf16 v[184:187], a[72:75], a[236:239], v[184:187]
  buffer_load_dwordx4 a[68:71], v3, s[8:11], s28 offen offset:0
  v_mfma_f32_16x16x32_bf16 v[52:55], a[76:79], a[160:163], v[52:55]
  buffer_load_dwordx4 a[72:75], v3, s[8:11], s28 offen offset:1024
  v_mfma_f32_16x16x32_bf16 v[60:63], a[80:83], a[160:163], v[60:63]
  s_waitcnt lgkmcnt(9)
  ds_read_b128 a[236:239], v0 offset:38528
  v_mfma_f32_16x16x32_bf16 v[76:79], a[76:79], a[164:167], v[76:79]
  ds_read_b128 a[160:163], v0 offset:51328
  v_mfma_f32_16x16x32_bf16 v[84:87], a[80:83], a[164:167], v[84:87]
  v_mfma_f32_16x16x32_bf16 v[100:103], a[76:79], a[168:171], v[100:103]
  ds_read_b128 a[164:167], v1 offset:128
  v_mfma_f32_16x16x32_bf16 v[108:111], a[80:83], a[168:171], v[108:111]
  v_mfma_f32_16x16x32_bf16 v[124:127], a[76:79], a[172:175], v[124:127]
  ds_read_b128 a[168:171], v1 offset:12928
  v_mfma_f32_16x16x32_bf16 v[132:135], a[80:83], a[172:175], v[132:135]
  s_waitcnt lgkmcnt(10)
  v_mfma_f32_16x16x32_bf16 v[148:151], a[76:79], a[200:203], v[148:151]
  ds_read_b128 a[172:175], v1 offset:25728
  v_mfma_f32_16x16x32_bf16 v[156:159], a[80:83], a[200:203], v[156:159]
  v_mfma_f32_16x16x32_bf16 v[172:175], a[76:79], a[204:207], v[172:175]
  ds_read_b128 a[200:203], v1 offset:38528
  v_mfma_f32_16x16x32_bf16 v[180:183], a[80:83], a[204:207], v[180:183]
  v_mfma_f32_16x16x32_bf16 v[112:115], a[76:79], a[208:211], v[112:115]
  ds_read_b128 a[204:207], v2 offset:128
  v_mfma_f32_16x16x32_bf16 v[160:163], a[80:83], a[208:211], v[160:163]
  s_waitcnt lgkmcnt(10)
  v_mfma_f32_16x16x32_bf16 v[120:123], a[76:79], a[212:215], v[120:123]
  ds_read_b128 a[208:211], v0 offset:192
  v_mfma_f32_16x16x32_bf16 v[168:171], a[80:83], a[212:215], v[168:171]
  v_mfma_f32_16x16x32_bf16 v[128:131], a[76:79], a[216:219], v[128:131]
  ds_read_b128 a[212:215], v0 offset:12992
  v_mfma_f32_16x16x32_bf16 v[176:179], a[80:83], a[216:219], v[176:179]
  v_mfma_f32_16x16x32_bf16 v[136:139], a[76:79], a[220:223], v[136:139]
  ds_read_b128 a[216:219], v0 offset:25792
  v_mfma_f32_16x16x32_bf16 v[184:187], a[80:83], a[220:223], v[184:187]
  s_waitcnt lgkmcnt(10)
  buffer_load_dwordx4 a[76:79], v3, s[8:11], s28 offen offset:2048
  v_mfma_f32_16x16x32_bf16 v[52:55], a[240:243], a[224:227], v[52:55]
  buffer_load_dwordx4 a[80:83], v3, s[8:11], s28 offen offset:3072
  s_addk_i32 s28, 4096
  v_mfma_f32_16x16x32_bf16 v[60:63], a[244:247], a[224:227], v[60:63]
  ds_read_b128 a[220:223], v0 offset:38592
  v_mfma_f32_16x16x32_bf16 v[76:79], a[240:243], a[228:231], v[76:79]
  ds_read_b128 a[224:227], v0 offset:51392
  v_mfma_f32_16x16x32_bf16 v[84:87], a[244:247], a[228:231], v[84:87]
  v_mfma_f32_16x16x32_bf16 v[100:103], a[240:243], a[232:235], v[100:103]
  ds_read_b128 a[228:231], v1 offset:192
  v_mfma_f32_16x16x32_bf16 v[108:111], a[244:247], a[232:235], v[108:111]
  s_waitcnt lgkmcnt(10)
  v_mfma_f32_16x16x32_bf16 v[124:127], a[240:243], a[236:239], v[124:127]
  ds_read_b128 a[232:235], v1 offset:12992
  v_mfma_f32_16x16x32_bf16 v[132:135], a[244:247], a[236:239], v[132:135]
  v_mfma_f32_16x16x32_bf16 v[148:151], a[240:243], a[160:163], v[148:151]
  ds_read_b128 a[236:239], v1 offset:25792
  v_mfma_f32_16x16x32_bf16 v[156:159], a[244:247], a[160:163], v[156:159]
  v_mfma_f32_16x16x32_bf16 v[172:175], a[240:243], a[164:167], v[172:175]
  ds_read_b128 a[160:163], v1 offset:38592
  v_mfma_f32_16x16x32_bf16 v[180:183], a[244:247], a[164:167], v[180:183]
  s_waitcnt lgkmcnt(10)
  v_mfma_f32_16x16x32_bf16 v[112:115], a[240:243], a[168:171], v[112:115]
  ds_read_b128 a[164:167], v2 offset:192
  v_mfma_f32_16x16x32_bf16 v[160:163], a[244:247], a[168:171], v[160:163]
  v_mfma_f32_16x16x32_bf16 v[120:123], a[240:243], a[172:175], v[120:123]
  ds_read_b128 a[168:171], v0 offset:256
  v_mfma_f32_16x16x32_bf16 v[168:171], a[244:247], a[172:175], v[168:171]
  v_mfma_f32_16x16x32_bf16 v[128:131], a[240:243], a[200:203], v[128:131]
  ds_read_b128 a[172:175], v0 offset:13056
  v_mfma_f32_16x16x32_bf16 v[176:179], a[244:247], a[200:203], v[176:179]
  s_waitcnt lgkmcnt(10)
  v_mfma_f32_16x16x32_bf16 v[136:139], a[240:243], a[204:207], v[136:139]
  ds_read_b128 a[200:203], v0 offset:25856
  v_mfma_f32_16x16x32_bf16 v[184:187], a[244:247], a[204:207], v[184:187]
  buffer_load_dwordx4 a[240:243], v3, s[8:11], s28 offen offset:0
  v_mfma_f32_16x16x32_bf16 v[52:55], a[248:251], a[208:211], v[52:55]
  s_waitcnt vmcnt(7)
  buffer_load_dwordx4 a[244:247], v3, s[8:11], s28 offen offset:1024
  v_mfma_f32_16x16x32_bf16 v[60:63], a[252:255], a[208:211], v[60:63]
  ds_read_b128 a[204:207], v0 offset:38656
  v_mfma_f32_16x16x32_bf16 v[76:79], a[248:251], a[212:215], v[76:79]
  ds_read_b128 a[208:211], v0 offset:51456
  v_mfma_f32_16x16x32_bf16 v[84:87], a[252:255], a[212:215], v[84:87]
  s_waitcnt lgkmcnt(10)
  v_mfma_f32_16x16x32_bf16 v[100:103], a[248:251], a[216:219], v[100:103]
  ds_read_b128 a[212:215], v1 offset:256
  v_mfma_f32_16x16x32_bf16 v[108:111], a[252:255], a[216:219], v[108:111]
  v_mfma_f32_16x16x32_bf16 v[124:127], a[248:251], a[220:223], v[124:127]
  ds_read_b128 a[216:219], v1 offset:13056
  v_mfma_f32_16x16x32_bf16 v[132:135], a[252:255], a[220:223], v[132:135]
  v_mfma_f32_16x16x32_bf16 v[148:151], a[248:251], a[224:227], v[148:151]
  ds_read_b128 a[220:223], v1 offset:25856
  v_mfma_f32_16x16x32_bf16 v[156:159], a[252:255], a[224:227], v[156:159]
  s_waitcnt lgkmcnt(10)
  v_mfma_f32_16x16x32_bf16 v[172:175], a[248:251], a[228:231], v[172:175]
  ds_read_b128 a[224:227], v1 offset:38656
  v_mfma_f32_16x16x32_bf16 v[180:183], a[252:255], a[228:231], v[180:183]
  v_mfma_f32_16x16x32_bf16 v[112:115], a[248:251], a[232:235], v[112:115]
  ds_read_b128 a[228:231], v2 offset:256
  v_mfma_f32_16x16x32_bf16 v[160:163], a[252:255], a[232:235], v[160:163]
  v_mfma_f32_16x16x32_bf16 v[120:123], a[248:251], a[236:239], v[120:123]
  ds_read_b128 a[232:235], v0 offset:320
  v_mfma_f32_16x16x32_bf16 v[168:171], a[252:255], a[236:239], v[168:171]
  s_waitcnt lgkmcnt(10)
  v_mfma_f32_16x16x32_bf16 v[128:131], a[248:251], a[160:163], v[128:131]
  ds_read_b128 a[236:239], v0 offset:13120
  v_mfma_f32_16x16x32_bf16 v[176:179], a[252:255], a[160:163], v[176:179]
  v_mfma_f32_16x16x32_bf16 v[136:139], a[248:251], a[164:167], v[136:139]
  ds_read_b128 a[160:163], v0 offset:25920
  v_mfma_f32_16x16x32_bf16 v[184:187], a[252:255], a[164:167], v[184:187]
  buffer_load_dwordx4 a[248:251], v3, s[8:11], s28 offen offset:2048
  v_mfma_f32_16x16x32_bf16 v[52:55], a[36:39], a[168:171], v[52:55]
  buffer_load_dwordx4 a[252:255], v3, s[8:11], s28 offen offset:3072
  s_addk_i32 s28, 4096
  s_lshr_b32 s52, s52, 20
  v_mfma_f32_16x16x32_bf16 v[60:63], a[40:43], a[168:171], v[60:63]
  s_mul_i32 s53, s52, 324
  ds_read_b128 a[164:167], v0 offset:38720
  s_sub_u32 s53, s63, s53
  s_waitcnt lgkmcnt(10)
  v_mfma_f32_16x16x32_bf16 v[76:79], a[36:39], a[172:175], v[76:79]
  s_mul_i32 s50, s53, 10923
  ds_read_b128 a[168:171], v0 offset:51520
  s_lshr_b32 s50, s50, 16
  v_mfma_f32_16x16x32_bf16 v[84:87], a[40:43], a[172:175], v[84:87]
  s_mul_i32 s51, s50, 6
  s_sub_u32 s51, s53, s51
  s_mul_i32 s52, s52, 6
  v_mfma_f32_16x16x32_bf16 v[100:103], a[36:39], a[200:203], v[100:103]
  s_add_u32 s51, s51, s52
  ds_read_b128 a[172:175], v1 offset:320
  s_mul_i32 s52, s50, 2646
  v_mfma_f32_16x16x32_bf16 v[108:111], a[40:43], a[200:203], v[108:111]
  s_mul_i32 s53, s51, 21
  s_add_u32 s52, s52, s53
  s_mul_i32 s52, s52, 768
  v_mfma_f32_16x16x32_bf16 v[124:127], a[36:39], a[204:207], v[124:127]
  s_mul_i32 s53, s16, 192
  ds_read_b128 a[200:203], v1 offset:13120
  s_add_u32 s65, s52, s53
  v_mfma_f32_16x16x32_bf16 v[132:135], a[40:43], a[204:207], v[132:135]
  s_sub_u32 s22, s52, 291072
  s_cmp_eq_u32 s50, 0
  s_cselect_b32 s23, 0, s23
  s_waitcnt lgkmcnt(10)
  v_mfma_f32_16x16x32_bf16 v[148:151], a[36:39], a[208:211], v[148:151]
  s_cmp_eq_u32 s50, 53
  ds_read_b128 a[204:207], v1 offset:25920
  s_cselect_b32 s23, 8, s23
  v_mfma_f32_16x16x32_bf16 v[156:159], a[40:43], a[208:211], v[156:159]
  s_cmp_eq_u32 s51, 0
  s_cselect_b32 s66, 0, s66
  s_cmp_eq_u32 s51, 17
  v_mfma_f32_16x16x32_bf16 v[172:175], a[36:39], a[212:215], v[172:175]
  s_cselect_b32 s66, 22, s66
  ds_read_b128 a[208:211], v1 offset:38720
  s_cmp_ge_u32 s63, 972
  v_mfma_f32_16x16x32_bf16 v[180:183], a[40:43], a[212:215], v[180:183]
  s_cselect_b32 s22, 0x80000000, s22
  v_add_u32 v17, s22, v39
  v_cndmask_b32 v17, v17, v22, vcc
  v_mfma_f32_16x16x32_bf16 v[112:115], a[36:39], a[216:219], v[112:115]
  s_and_b32 s50, s16, 1
  ds_read_b128 a[212:215], v2 offset:320
  v_cmp_eq_u32 vcc, s23, v37
  v_mfma_f32_16x16x32_bf16 v[160:163], a[40:43], a[216:219], v[160:163]
  s_mul_i32 s51, s50, 6624
  v_cndmask_b32 v17, v17, v22, vcc
  v_mul_u32_u24 v37, 2850, v36
  s_waitcnt lgkmcnt(10)
  v_mfma_f32_16x16x32_bf16 v[120:123], a[36:39], a[220:223], v[120:123]
  s_add_u32 s51, s51, 118400
  ds_read_b128 a[216:219], v0 offset:384
  v_cmp_eq_u32 vcc, s66, v38
  v_mfma_f32_16x16x32_bf16 v[168:171], a[40:43], a[220:223], v[168:171]
  v_lshrrev_b32 v37, 16, v37
  v_mul_u32_u24 v38, 23, v37
  v_mfma_f32_16x16x32_bf16 v[128:131], a[36:39], a[224:227], v[128:131]
  ds_read_b128 a[220:223], v0 offset:13184
  v_sub_u32 v38, v36, v38
  v_mfma_f32_16x16x32_bf16 v[176:179], a[40:43], a[224:227], v[176:179]
  v_mul_u32_u24 v39, 378, v37
  v_add_u32 v39, v39, v38
  v_mfma_f32_16x16x32_bf16 v[136:139], a[36:39], a[228:231], v[136:139]
  ds_read_b128 a[224:227], v0 offset:25984
  v_mul_u32_u24 v39, 768, v39
  v_mfma_f32_16x16x32_bf16 v[184:187], a[40:43], a[228:231], v[184:187]
  s_waitcnt lgkmcnt(10)
  buffer_load_dwordx4 a[36:39], v3, s[8:11], s28 offen offset:0
  v_mfma_f32_16x16x32_bf16 v[52:55], a[44:47], a[232:235], v[52:55]
  buffer_load_dwordx4 a[40:43], v3, s[8:11], s28 offen offset:1024
  v_mfma_f32_16x16x32_bf16 v[60:63], a[48:51], a[232:235], v[60:63]
  ds_read_b128 a[228:231], v0 offset:38784
  v_cndmask_b32 v17, v17, v22, vcc
  v_mfma_f32_16x16x32_bf16 v[76:79], a[44:47], a[236:239], v[76:79]
  ds_read_b128 a[232:235], v0 offset:51584
  v_lshl_add_u32 v39, v18, 4, v39
  v_mfma_f32_16x16x32_bf16 v[84:87], a[48:51], a[236:239], v[84:87]
  v_add_u32 v18, s22, v39
  v_mov_b32 v22, 0xc0000000
  v_mfma_f32_16x16x32_bf16 v[100:103], a[44:47], a[160:163], v[100:103]
  ds_read_b128 a[236:239], v1 offset:384
  v_cmp_le_u32 vcc, 207, v36
  v_mfma_f32_16x16x32_bf16 v[108:111], a[48:51], a[160:163], v[108:111]
  s_waitcnt lgkmcnt(10)
  v_cndmask_b32 v18, v18, v22, vcc
  v_cmp_eq_u32 vcc, s23, v37
  v_mfma_f32_16x16x32_bf16 v[124:127], a[44:47], a[164:167], v[124:127]
  ds_read_b128 a[160:163], v1 offset:13184
  v_lshrrev_b32 v37, 4, v4
  v_mfma_f32_16x16x32_bf16 v[132:135], a[48:51], a[164:167], v[132:135]
  v_cndmask_b32 v18, v18, v22, vcc
  v_lshrrev_b32 v39, 1, v37
  v_mfma_f32_16x16x32_bf16 v[148:151], a[44:47], a[168:171], v[148:151]
  ds_read_b128 a[164:167], v1 offset:25984
  v_cmp_eq_u32 vcc, s66, v38
  v_mfma_f32_16x16x32_bf16 v[156:159], a[48:51], a[168:171], v[156:159]
  v_mul_u32_u24 v16, 1440, v39
  v_lshlrev_b32 v39, 5, v39
  v_mfma_f32_16x16x32_bf16 v[172:175], a[44:47], a[172:175], v[172:175]
  ds_read_b128 a[168:171], v1 offset:38784
  v_and_b32 v38, 1, v37
  v_mfma_f32_16x16x32_bf16 v[180:183], a[48:51], a[172:175], v[180:183]
  s_waitcnt lgkmcnt(10)
  v_and_b32 v36, 15, v4
  v_lshl_add_u32 v39, v38, 4, v39
  v_mfma_f32_16x16x32_bf16 v[112:115], a[44:47], a[200:203], v[112:115]
  ds_read_b128 a[172:175], v2 offset:384
  v_cndmask_b32 v18, v18, v22, vcc
  v_mfma_f32_16x16x32_bf16 v[160:163], a[48:51], a[200:203], v[160:163]
  v_add_u32 v38, 0, v36
  v_mul_u32_u24 v22, 9363, v38
  v_mfma_f32_16x16x32_bf16 v[120:123], a[44:47], a[204:207], v[120:123]
  ds_read_b128 a[200:203], v0 offset:448
  v_lshrrev_b32 v22, 16, v22
  v_mfma_f32_16x16x32_bf16 v[168:171], a[48:51], a[204:207], v[168:171]
  v_lshl_add_u32 v22, v22, 4, v38
  v_add_u32 v38, 32, v36
  v_mfma_f32_16x16x32_bf16 v[128:131], a[44:47], a[208:211], v[128:131]
  ds_read_b128 a[204:207], v0 offset:13248
  v_add_u32 v39, s51, v39
  v_mfma_f32_16x16x32_bf16 v[176:179], a[48:51], a[208:211], v[176:179]
  s_lshr_b32 s51, s16, 1
  v_mul_u32_u24 v23, 9363, v38
  v_lshrrev_b32 v23, 16, v23
  s_waitcnt lgkmcnt(10)
  v_mfma_f32_16x16x32_bf16 v[136:139], a[44:47], a[212:215], v[136:139]
  s_cmp_eq_u32 s51, 0
  ds_read_b128 a[208:211], v0 offset:26048
  v_lshl_add_u32 v23, v23, 4, v38
  v_mfma_f32_16x16x32_bf16 v[184:187], a[48:51], a[212:215], v[184:187]
  s_cselect_b64 s[52:53], -1, 0
  buffer_load_dwordx4 a[44:47], v3, s[8:11], s28 offen offset:2048
  s_lshl_b32 s50, s50, 1
  v_mfma_f32_16x16x32_bf16 v[52:55], a[52:55], a[216:219], v[52:55]
  buffer_load_dwordx4 a[48:51], v3, s[8:11], s28 offen offset:3072
  v_mfma_f32_16x16x32_bf16 v[60:63], a[56:59], a[216:219], v[60:63]
  ds_read_b128 a[212:215], v0 offset:38848
  v_add_u32 v22, 0, v22
  v_mfma_f32_16x16x32_bf16 v[76:79], a[52:55], a[220:223], v[76:79]
  ds_read_b128 a[216:219], v0 offset:51648
  v_add_u32 v23, 7, v23
  v_mfma_f32_16x16x32_bf16 v[84:87], a[56:59], a[220:223], v[84:87]
  s_waitcnt lgkmcnt(10)
  v_cndmask_b32 v22, v23, v22, s[52:53]
  v_lshl_add_u32 v8, v22, 5, v39
  v_mfma_f32_16x16x32_bf16 v[100:103], a[52:55], a[224:227], v[100:103]
  ds_read_b128 a[220:223], v1 offset:448
  v_add_u32 v38, 16, v36
  v_mfma_f32_16x16x32_bf16 v[108:111], a[56:59], a[224:227], v[108:111]
  v_mul_u32_u24 v22, 9363, v38
  v_lshrrev_b32 v22, 16, v22
  v_mfma_f32_16x16x32_bf16 v[124:127], a[52:55], a[228:231], v[124:127]
  ds_read_b128 a[224:227], v1 offset:13248
  v_lshl_add_u32 v22, v22, 4, v38
  v_mfma_f32_16x16x32_bf16 v[132:135], a[56:59], a[228:231], v[132:135]
  v_add_u32 v38, 0, v36
  v_mul_u32_u24 v23, 9363, v38
  v_mfma_f32_16x16x32_bf16 v[148:151], a[52:55], a[232:235], v[148:151]
  ds_read_b128 a[228:231], v1 offset:26048
  v_lshrrev_b32 v23, 16, v23
  v_mfma_f32_16x16x32_bf16 v[156:159], a[56:59], a[232:235], v[156:159]
  s_waitcnt lgkmcnt(10)
  v_lshl_add_u32 v23, v23, 4, v38
  v_add_u32 v22, 0, v22
  v_mfma_f32_16x16x32_bf16 v[172:175], a[52:55], a[236:239], v[172:175]
  ds_read_b128 a[232:235], v1 offset:38848
  v_add_u32 v23, 14, v23
  v_mfma_f32_16x16x32_bf16 v[180:183], a[56:59], a[236:239], v[180:183]
  v_cndmask_b32 v22, v23, v22, s[52:53]
  v_lshl_add_u32 v9, v22, 5, v39
  v_mfma_f32_16x16x32_bf16 v[112:115], a[52:55], a[160:163], v[112:115]
  ds_read_b128 a[236:239], v2 offset:448
  v_add_u32 v38, 32, v36
  v_mfma_f32_16x16x32_bf16 v[160:163], a[56:59], a[160:163], v[160:163]
  v_mul_u32_u24 v22, 9363, v38
  v_lshrrev_b32 v22, 16, v22
  v_mfma_f32_16x16x32_bf16 v[120:123], a[52:55], a[164:167], v[120:123]
  ds_read_b128 a[160:163], v0 offset:512
  v_lshl_add_u32 v22, v22, 4, v38
  v_mfma_f32_16x16x32_bf16 v[168:171], a[56:59], a[164:167], v[168:171]
  s_waitcnt lgkmcnt(10)
  v_add_u32 v38, 16, v36
  v_mul_u32_u24 v23, 9363, v38
  v_mfma_f32_16x16x32_bf16 v[128:131], a[52:55], a[168:171], v[128:131]
  ds_read_b128 a[164:167], v0 offset:13312
  v_lshrrev_b32 v23, 16, v23
  v_mfma_f32_16x16x32_bf16 v[176:179], a[56:59], a[168:171], v[176:179]
  v_lshl_add_u32 v23, v23, 4, v38
  v_add_u32 v22, 0, v22
  v_mfma_f32_16x16x32_bf16 v[136:139], a[52:55], a[172:175], v[136:139]
  ds_read_b128 a[168:171], v0 offset:26112
  v_add_u32 v23, 14, v23
  v_mfma_f32_16x16x32_bf16 v[184:187], a[56:59], a[172:175], v[184:187]
  s_waitcnt vmcnt(8)
  v_cndmask_b32 v22, v23, v22, s[52:53]
  v_lshl_add_u32 v10, v22, 5, v39
  v_mfma_f32_16x16x32_bf16 v[52:55], a[60:63], a[200:203], v[52:55]
  ds_read_b128 a[172:175], v0 offset:38912
  v_add_u32 v38, 0, v36
  v_mfma_f32_16x16x32_bf16 v[60:63], a[64:67], a[200:203], v[60:63]
  s_waitcnt lgkmcnt(11)
  v_mul_u32_u24 v22, 9363, v38
  v_lshrrev_b32 v22, 16, v22
  v_mfma_f32_16x16x32_bf16 v[76:79], a[60:63], a[204:207], v[76:79]
  ds_read_b128 a[200:203], v0 offset:51712
  v_lshl_add_u32 v22, v22, 4, v38
  v_mfma_f32_16x16x32_bf16 v[84:87], a[64:67], a[204:207], v[84:87]
  v_add_u32 v38, 32, v36
  v_mul_u32_u24 v23, 9363, v38
  v_mfma_f32_16x16x32_bf16 v[100:103], a[60:63], a[208:211], v[100:103]
  ds_read_b128 a[204:207], v1 offset:512
  v_lshrrev_b32 v23, 16, v23
  v_mfma_f32_16x16x32_bf16 v[108:111], a[64:67], a[208:211], v[108:111]
  s_waitcnt lgkmcnt(10)
  v_lshl_add_u32 v23, v23, 4, v38
  v_add_u32 v22, 7, v22
  v_mfma_f32_16x16x32_bf16 v[124:127], a[60:63], a[212:215], v[124:127]
  ds_read_b128 a[208:211], v1 offset:13312
  v_add_u32 v23, 14, v23
  v_mfma_f32_16x16x32_bf16 v[132:135], a[64:67], a[212:215], v[132:135]
  v_cndmask_b32 v22, v23, v22, s[52:53]
  v_lshl_add_u32 v11, v22, 5, v39
  v_mfma_f32_16x16x32_bf16 v[148:151], a[60:63], a[216:219], v[148:151]
  ds_read_b128 a[212:215], v1 offset:26112
  v_add_u32 v38, 16, v36
  v_mfma_f32_16x16x32_bf16 v[156:159], a[64:67], a[216:219], v[156:159]
  v_mul_u32_u24 v22, 9363, v38
  v_lshrrev_b32 v22, 16, v22
  v_mfma_f32_16x16x32_bf16 v[172:175], a[60:63], a[220:223], v[172:175]
  ds_read_b128 a[216:219], v1 offset:38912
  v_min_u32 v23, 2, v36
  v_mfma_f32_16x16x32_bf16 v[180:183], a[64:67], a[220:223], v[180:183]
  s_waitcnt lgkmcnt(10)
  v_lshl_add_u32 v22, v22, 4, v38
  v_mul_u32_u24 v23, 7, v23
  v_mfma_f32_16x16x32_bf16 v[112:115], a[60:63], a[224:227], v[112:115]
  ds_read_b128 a[220:223], v2 offset:512
  v_add_u32 v22, 7, v22
  v_mfma_f32_16x16x32_bf16 v[160:163], a[64:67], a[224:227], v[160:163]
  v_add_u32 v23, 144, v23
  v_cndmask_b32 v22, v23, v22, s[52:53]
  v_mfma_f32_16x16x32_bf16 v[120:123], a[60:63], a[228:231], v[120:123]
  ds_read_b128 a[224:227], v0 offset:576
  v_lshl_add_u32 v12, v22, 5, v39
  v_mfma_f32_16x16x32_bf16 v[168:171], a[64:67], a[228:231], v[168:171]
  v_lshrrev_b32 v38, 1, v37
  v_add_u32 v38, s50, v38
  v_mfma_f32_16x16x32_bf16 v[128:131], a[60:63], a[232:235], v[128:131]
  s_mul_i32 s50, s51, 64000
  ds_read_b128 a[228:231], v0 offset:13376
  v_and_b32 v39, 1, v37
  v_mfma_f32_16x16x32_bf16 v[176:179], a[64:67], a[232:235], v[176:179]
  s_mul_i32 s51, s51, 640
  v_lshrrev_b32 v22, 2, v36
  v_lshlrev_b32 v39, 3, v39
  s_waitcnt lgkmcnt(10)
  v_mfma_f32_16x16x32_bf16 v[136:139], a[60:63], a[236:239], v[136:139]
  ds_read_b128 a[232:235], v0 offset:26176
  v_xor_b32 v22, v38, v22
  v_mfma_f32_16x16x32_bf16 v[184:187], a[64:67], a[236:239], v[184:187]
  v_lshl_add_u32 v22, v22, 4, v39
  v_mul_u32_u24 v37, 800, v36
  v_mfma_f32_16x16x32_bf16 v[52:55], a[68:71], a[160:163], v[52:55]
  ds_read_b128 a[236:239], v0 offset:38976
  v_add_u32 v22, v22, v37
  v_mfma_f32_16x16x32_bf16 v[60:63], a[72:75], a[160:163], v[60:63]
  v_add_u32 v13, s50, v22
  v_min_u32 v14, 3, v36
  v_mfma_f32_16x16x32_bf16 v[76:79], a[68:71], a[164:167], v[76:79]
  s_and_b32 s50, s16, 1
  ds_read_b128 a[160:163], v0 offset:51776
  v_lshrrev_b32 v23, 2, v14
  v_mfma_f32_16x16x32_bf16 v[84:87], a[72:75], a[164:167], v[84:87]
  s_mul_i32 s50, s50, 1280
  s_add_u32 s51, s51, s50
  v_xor_b32 v23, v38, v23
  s_waitcnt lgkmcnt(10)
  v_mfma_f32_16x16x32_bf16 v[100:103], a[68:71], a[168:171], v[100:103]
  s_add_u32 s51, s51, 159776
  ds_read_b128 a[164:167], v1 offset:576
  v_lshl_add_u32 v23, v23, 4, v39
  v_mfma_f32_16x16x32_bf16 v[108:111], a[72:75], a[168:171], v[108:111]
  s_addk_i32 s28, 4096
  buffer_load_dwordx4 a[52:55], v3, s[8:11], s28 offen offset:0
  v_mfma_f32_16x16x32_bf16 v[124:127], a[68:71], a[172:175], v[124:127]
  buffer_load_dwordx4 a[56:59], v3, s[8:11], s28 offen offset:1024
  v_mfma_f32_16x16x32_bf16 v[132:135], a[72:75], a[172:175], v[132:135]
  buffer_load_dwordx4 a[60:63], v3, s[8:11], s28 offen offset:2048
  v_mfma_f32_16x16x32_bf16 v[148:151], a[68:71], a[200:203], v[148:151]
  ds_read_b128 a[168:171], v1 offset:13376
  v_mul_u32_u24 v37, 800, v14
  v_mfma_f32_16x16x32_bf16 v[156:159], a[72:75], a[200:203], v[156:159]
  s_waitcnt lgkmcnt(9)
  ds_read_b128 a[172:175], v1 offset:26176
  v_add_u32 v23, v23, v37
  v_mfma_f32_16x16x32_bf16 v[172:175], a[68:71], a[204:207], v[172:175]
  buffer_load_dwordx4 a[64:67], v3, s[8:11], s28 offen offset:3072
  s_addk_i32 s28, 4096
  s_add_u32 s35, s24, 0
  v_mfma_f32_16x16x32_bf16 v[180:183], a[72:75], a[204:207], v[180:183]
  s_add_u32 m0, s61, 0
  ds_read_b128 a[200:203], v1 offset:38976
  v_add_u32 v23, 115200, v23
  v_mfma_f32_16x16x32_bf16 v[112:115], a[68:71], a[208:211], v[112:115]
  ds_read_b128 a[204:207], v2 offset:576
  v_mov_b32 v37, 0x30000
  v_mfma_f32_16x16x32_bf16 v[160:163], a[72:75], a[208:211], v[160:163]
  v_cmp_le_u32 vcc, 3, v36
  v_add_u32 v22, 51200, v22
  v_mfma_f32_16x16x32_bf16 v[120:123], a[68:71], a[212:215], v[120:123]
  buffer_load_dwordx4 a[184:187], v3, s[8:11], s35 offen offset:2048
  v_mfma_f32_16x16x32_bf16 v[168:171], a[72:75], a[212:215], v[168:171]
  s_waitcnt lgkmcnt(8)
  ds_read_b128 a[208:211], v0 offset:640
  v_cndmask_b32 v23, v23, v37, vcc
  v_mfma_f32_16x16x32_bf16 v[128:131], a[68:71], a[216:219], v[128:131]
  ds_read_b128 a[212:215], v0 offset:13440
  v_cndmask_b32 v14, v23, v22, s[52:53]
  v_mfma_f32_16x16x32_bf16 v[176:179], a[72:75], a[216:219], v[176:179]
  v_lshrrev_b32 v22, 2, v36
  v_lshlrev_b32 v22, 2, v22
  v_mfma_f32_16x16x32_bf16 v[136:139], a[68:71], a[220:223], v[136:139]
  buffer_load_dwordx4 a[176:179], v3, s[8:11], s35 offen offset:0
  v_mfma_f32_16x16x32_bf16 v[184:187], a[72:75], a[220:223], v[184:187]
  ds_read_b128 a[216:219], v0 offset:26240
  v_and_b32 v23, 3, v36
  v_mfma_f32_16x16x32_bf16 v[52:55], a[76:79], a[224:227], v[52:55]
  ds_read_b128 a[220:223], v0 offset:39040
  v_lshlrev_b32 v15, v22, v23
  v_mfma_f32_16x16x32_bf16 v[60:63], a[80:83], a[224:227], v[60:63]
  v_add_u32 v22, v8, v16
  v_add_u32 v23, v9, v16
  v_mfma_f32_16x16x32_bf16 v[76:79], a[76:79], a[228:231], v[76:79]
  buffer_load_dwordx4 a[68:71], v3, s[8:11], s28 offen offset:0
  v_mfma_f32_16x16x32_bf16 v[84:87], a[80:83], a[228:231], v[84:87]
  s_waitcnt lgkmcnt(8)
  ds_read_b128 a[224:227], v0 offset:51840
  v_lshlrev_b32 v21, 3, v36
  v_mfma_f32_16x16x32_bf16 v[100:103], a[76:79], a[232:235], v[100:103]
  ds_read_b128 a[228:231], v1 offset:640
  v_add_u32 v21, s51, v21
  v_mfma_f32_16x16x32_bf16 v[108:111], a[80:83], a[232:235], v[108:111]
  buffer_load_dwordx4 a[72:75], v3, s[8:11], s28 offen offset:1024
  v_mfma_f32_16x16x32_bf16 v[124:127], a[76:79], a[236:239], v[124:127]
  ds_read_b128 a[232:235], v1 offset:13440
  v_mfma_f32_16x16x32_bf16 v[132:135], a[80:83], a[236:239], v[132:135]
  v_mfma_f32_16x16x32_bf16 v[148:151], a[76:79], a[160:163], v[148:151]
  ds_read_b128 a[236:239], v1 offset:26240
  v_mfma_f32_16x16x32_bf16 v[156:159], a[80:83], a[160:163], v[156:159]
  buffer_load_dwordx4 a[180:183], v3, s[8:11], s35 offen offset:1024
  v_mfma_f32_16x16x32_bf16 v[172:175], a[76:79], a[164:167], v[172:175]
  ds_read_b128 a[160:163], v1 offset:39040
  v_mfma_f32_16x16x32_bf16 v[180:183], a[80:83], a[164:167], v[180:183]
  s_waitcnt lgkmcnt(9)
  v_mfma_f32_16x16x32_bf16 v[112:115], a[76:79], a[168:171], v[112:115]
  ds_read_b128 a[164:167], v2 offset:640
  v_mfma_f32_16x16x32_bf16 v[160:163], a[80:83], a[168:171], v[160:163]
  v_mfma_f32_16x16x32_bf16 v[120:123], a[76:79], a[172:175], v[120:123]
  ds_read_b128 a[168:171], v0 offset:704
  v_mfma_f32_16x16x32_bf16 v[168:171], a[80:83], a[172:175], v[168:171]
  v_mfma_f32_16x16x32_bf16 v[128:131], a[76:79], a[200:203], v[128:131]
  ds_read_b128 a[172:175], v0 offset:13504
  v_mfma_f32_16x16x32_bf16 v[176:179], a[80:83], a[200:203], v[176:179]
  v_mfma_f32_16x16x32_bf16 v[136:139], a[76:79], a[204:207], v[136:139]
  ds_read_b128 a[200:203], v0 offset:26304
  v_mfma_f32_16x16x32_bf16 v[184:187], a[80:83], a[204:207], v[184:187]
  s_waitcnt vmcnt(11) lgkmcnt(10)
  buffer_load_dwordx4 a[76:79], v3, s[8:11], s28 offen offset:2048
  v_mfma_f32_16x16x32_bf16 v[52:55], a[240:243], a[208:211], v[52:55]
  buffer_load_dwordx4 a[80:83], v3, s[8:11], s28 offen offset:3072
  v_mfma_f32_16x16x32_bf16 v[60:63], a[244:247], a[208:211], v[60:63]
  buffer_load_dwordx4 v17, s[4:7], s34 offen offset:0 lds
  s_add_u32 m0, s61, 6592
  v_mfma_f32_16x16x32_bf16 v[76:79], a[240:243], a[212:215], v[76:79]
  ds_read_b128 a[204:207], v0 offset:39104
  v_mfma_f32_16x16x32_bf16 v[84:87], a[244:247], a[212:215], v[84:87]
  ds_read_b128 a[208:211], v0 offset:51904
  v_mfma_f32_16x16x32_bf16 v[100:103], a[240:243], a[216:219], v[100:103]
  ds_read_b128 a[212:215], v1 offset:704
  v_mfma_f32_16x16x32_bf16 v[108:111], a[244:247], a[216:219], v[108:111]
  buffer_load_dwordx4 v17, s[4:7], s34 offen offset:32 lds
  s_add_u32 m0, s62, 0
  s_waitcnt lgkmcnt(9)
  v_mfma_f32_16x16x32_bf16 v[124:127], a[240:243], a[220:223], v[124:127]
  ds_read_b128 a[216:219], v1 offset:13504
  v_mfma_f32_16x16x32_bf16 v[132:135], a[244:247], a[220:223], v[132:135]
  v_mfma_f32_16x16x32_bf16 v[148:151], a[240:243], a[224:227], v[148:151]
  ds_read_b128 a[220:223], v1 offset:26304
  v_mfma_f32_16x16x32_bf16 v[156:159], a[244:247], a[224:227], v[156:159]
  buffer_load_dwordx4 v18, s[4:7], s34 offen offset:0 lds
  s_add_u32 m0, s62, 6592
  s_addk_i32 s28, 4096
  v_mfma_f32_16x16x32_bf16 v[172:175], a[240:243], a[228:231], v[172:175]
  ds_read_b128 a[224:227], v1 offset:39104
  v_mfma_f32_16x16x32_bf16 v[180:183], a[244:247], a[228:231], v[180:183]
  v_mfma_f32_16x16x32_bf16 v[112:115], a[240:243], a[232:235], v[112:115]
  ds_read_b128 a[228:231], v2 offset:704
  v_mfma_f32_16x16x32_bf16 v[160:163], a[244:247], a[232:235], v[160:163]
  buffer_load_dwordx4 v18, s[4:7], s34 offen offset:32 lds
  s_mov_b32 s34, 192
  s_waitcnt lgkmcnt(9)
  v_mfma_f32_16x16x32_bf16 v[120:123], a[240:243], a[236:239], v[120:123]
  ds_read_b128 a[232:235], v0 offset:0
  v_mfma_f32_16x16x32_bf16 v[168:171], a[244:247], a[236:239], v[168:171]
  v_mfma_f32_16x16x32_bf16 v[128:131], a[240:243], a[160:163], v[128:131]
  ds_read_b128 a[236:239], v0 offset:12800
  v_mfma_f32_16x16x32_bf16 v[176:179], a[244:247], a[160:163], v[176:179]
  v_mfma_f32_16x16x32_bf16 v[136:139], a[240:243], a[164:167], v[136:139]
  ds_read_b128 a[160:163], v0 offset:25600
  v_mfma_f32_16x16x32_bf16 v[184:187], a[244:247], a[164:167], v[184:187]
  buffer_load_dwordx4 a[240:243], v3, s[8:11], s28 offen offset:0
  v_mfma_f32_16x16x32_bf16 v[52:55], a[248:251], a[168:171], v[52:55]
  ds_read_b128 a[164:167], v0 offset:38400
  v_mfma_f32_16x16x32_bf16 v[60:63], a[252:255], a[168:171], v[60:63]
  s_waitcnt lgkmcnt(10)
  buffer_load_dwordx4 a[244:247], v3, s[8:11], s28 offen offset:1024
  v_mfma_f32_16x16x32_bf16 v[76:79], a[248:251], a[172:175], v[76:79]
  ds_read_b128 a[168:171], v0 offset:51200
  v_cvt_pk_bf16_f32 v52, v52, v53
  v_mfma_f32_16x16x32_bf16 v[84:87], a[252:255], a[172:175], v[84:87]
  v_cvt_pk_bf16_f32 v53, v54, v55
  v_cvt_pk_bf16_f32 v54, v60, v61
  v_mfma_f32_16x16x32_bf16 v[100:103], a[248:251], a[200:203], v[100:103]
  ds_read_b128 a[172:175], v1 offset:0
  v_cvt_pk_bf16_f32 v55, v62, v63
  v_mfma_f32_16x16x32_bf16 v[108:111], a[252:255], a[200:203], v[108:111]
  v_cvt_pk_bf16_f32 v76, v76, v77
  v_cvt_pk_bf16_f32 v77, v78, v79
  v_mfma_f32_16x16x32_bf16 v[124:127], a[248:251], a[204:207], v[124:127]
  ds_read_b128 a[200:203], v1 offset:12800
  v_cvt_pk_bf16_f32 v78, v84, v85
  v_mfma_f32_16x16x32_bf16 v[132:135], a[252:255], a[204:207], v[132:135]
  s_waitcnt lgkmcnt(10)
  v_cvt_pk_bf16_f32 v79, v86, v87
  v_cvt_pk_bf16_f32 v100, v100, v101
  v_mfma_f32_16x16x32_bf16 v[148:151], a[248:251], a[208:211], v[148:151]
  ds_read_b128 a[204:207], v1 offset:25600
  v_cvt_pk_bf16_f32 v101, v102, v103
  v_mfma_f32_16x16x32_bf16 v[156:159], a[252:255], a[208:211], v[156:159]
  v_cvt_pk_bf16_f32 v102, v108, v109
  v_cvt_pk_bf16_f32 v103, v110, v111
  v_mfma_f32_16x16x32_bf16 v[172:175], a[248:251], a[212:215], v[172:175]
  ds_read_b128 a[208:211], v1 offset:38400
  v_cvt_pk_bf16_f32 v124, v124, v125
  v_mfma_f32_16x16x32_bf16 v[180:183], a[252:255], a[212:215], v[180:183]
  v_cvt_pk_bf16_f32 v125, v126, v127
  v_cvt_pk_bf16_f32 v126, v132, v133
  v_mfma_f32_16x16x32_bf16 v[112:115], a[248:251], a[216:219], v[112:115]
  ds_read_b128 a[212:215], v2 offset:0
  v_cvt_pk_bf16_f32 v127, v134, v135
  v_mfma_f32_16x16x32_bf16 v[160:163], a[252:255], a[216:219], v[160:163]
  s_waitcnt lgkmcnt(10)
  v_cvt_pk_bf16_f32 v148, v148, v149
  v_cvt_pk_bf16_f32 v149, v150, v151
  v_mfma_f32_16x16x32_bf16 v[120:123], a[248:251], a[220:223], v[120:123]
  ds_read_b128 a[216:219], v0 offset:64
  v_cvt_pk_bf16_f32 v150, v156, v157
  v_mfma_f32_16x16x32_bf16 v[168:171], a[252:255], a[220:223], v[168:171]
  v_cvt_pk_bf16_f32 v151, v158, v159
  v_cvt_pk_bf16_f32 v172, v172, v173
  v_mfma_f32_16x16x32_bf16 v[128:131], a[248:251], a[224:227], v[128:131]
  ds_read_b128 a[220:223], v0 offset:12864
  v_cvt_pk_bf16_f32 v173, v174, v175
  v_mfma_f32_16x16x32_bf16 v[176:179], a[252:255], a[224:227], v[176:179]
  v_cvt_pk_bf16_f32 v174, v180, v181
  v_cvt_pk_bf16_f32 v175, v182, v183
  v_mfma_f32_16x16x32_bf16 v[136:139], a[248:251], a[228:231], v[136:139]
  ds_read_b128 a[224:227], v0 offset:25664
  v_cvt_pk_bf16_f32 v112, v112, v113
  v_mfma_f32_16x16x32_bf16 v[184:187], a[252:255], a[228:231], v[184:187]
  s_waitcnt lgkmcnt(10)
  buffer_load_dwordx4 a[248:251], v3, s[8:11], s28 offen offset:2048
  v_mfma_f32_16x16x32_bf16 v[196:199], a[36:39], a[232:235], v[196:199]
  buffer_load_dwordx4 a[252:255], v3, s[8:11], s28 offen offset:3072
  s_addk_i32 s28, 4096
  s_add_u32 s36, s24, 6144
  v_mfma_f32_16x16x32_bf16 v[204:207], a[40:43], a[232:235], v[204:207]
  s_add_u32 m0, s61, 13792
  buffer_load_dwordx4 a[196:199], v3, s[8:11], s36 offen offset:2048
  v_mfma_f32_16x16x32_bf16 v[220:223], a[36:39], a[236:239], v[220:223]
  ds_read_b128 a[228:231], v0 offset:38464
  v_cvt_pk_bf16_f32 v113, v114, v115
  v_mfma_f32_16x16x32_bf16 v[228:231], a[40:43], a[236:239], v[228:231]
  ds_read_b128 a[232:235], v0 offset:51264
  v_cvt_pk_bf16_f32 v114, v160, v161
  v_mfma_f32_16x16x32_bf16 v[244:247], a[36:39], a[160:163], v[244:247]
  buffer_load_dwordx4 a[188:191], v3, s[8:11], s36 offen offset:0
  v_mfma_f32_16x16x32_bf16 v[252:255], a[40:43], a[160:163], v[252:255]
  s_waitcnt lgkmcnt(9)
  ds_read_b128 a[236:239], v1 offset:64
  v_cvt_pk_bf16_f32 v115, v162, v163
  v_mfma_f32_16x16x32_bf16 v[192:195], a[36:39], a[164:167], v[192:195]
  ds_read_b128 a[160:163], v1 offset:12864
  v_cvt_pk_bf16_f32 v120, v120, v121
  v_mfma_f32_16x16x32_bf16 v[200:203], a[40:43], a[164:167], v[200:203]
  v_cvt_pk_bf16_f32 v121, v122, v123
  v_cvt_pk_bf16_f32 v122, v168, v169
  v_mfma_f32_16x16x32_bf16 v[208:211], a[36:39], a[168:171], v[208:211]
  buffer_load_dwordx4 a[192:195], v3, s[8:11], s36 offen offset:1024
  v_mfma_f32_16x16x32_bf16 v[248:251], a[40:43], a[168:171], v[248:251]
  ds_read_b128 a[164:167], v1 offset:25664
  v_cvt_pk_bf16_f32 v123, v170, v171
  v_mfma_f32_16x16x32_bf16 v[96:99], a[36:39], a[172:175], v[96:99]
  ds_read_b128 a[168:171], v1 offset:38464
  v_cvt_pk_bf16_f32 v128, v128, v129
  v_mfma_f32_16x16x32_bf16 v[144:147], a[40:43], a[172:175], v[144:147]
  s_waitcnt lgkmcnt(9)
  v_cvt_pk_bf16_f32 v129, v130, v131
  v_cvt_pk_bf16_f32 v130, v176, v177
  v_mfma_f32_16x16x32_bf16 v[104:107], a[36:39], a[200:203], v[104:107]
  ds_read_b128 a[172:175], v2 offset:64
  v_cvt_pk_bf16_f32 v131, v178, v179
  v_mfma_f32_16x16x32_bf16 v[152:155], a[40:43], a[200:203], v[152:155]
  v_cvt_pk_bf16_f32 v136, v136, v137
  v_cvt_pk_bf16_f32 v137, v138, v139
  v_mfma_f32_16x16x32_bf16 v[68:71], a[36:39], a[204:207], v[68:71]
  ds_read_b128 a[200:203], v0 offset:128
  v_cvt_pk_bf16_f32 v138, v184, v185
  v_mfma_f32_16x16x32_bf16 v[92:95], a[40:43], a[204:207], v[92:95]
  v_cvt_pk_bf16_f32 v139, v186, v187
  v_mfma_f32_16x16x32_bf16 v[116:119], a[36:39], a[208:211], v[116:119]
  ds_read_b128 a[204:207], v0 offset:12928
  v_mfma_f32_16x16x32_bf16 v[140:143], a[40:43], a[208:211], v[140:143]
  v_mfma_f32_16x16x32_bf16 v[164:167], a[36:39], a[212:215], v[164:167]
  ds_read_b128 a[208:211], v0 offset:25728
  v_mfma_f32_16x16x32_bf16 v[188:191], a[40:43], a[212:215], v[188:191]
  s_waitcnt vmcnt(18) lgkmcnt(10)
  buffer_load_dwordx4 a[36:39], v3, s[8:11], s28 offen offset:0
  v_mfma_f32_16x16x32_bf16 v[196:199], a[44:47], a[216:219], v[196:199]
  buffer_load_dwordx4 a[40:43], v3, s[8:11], s28 offen offset:1024
  v_mfma_f32_16x16x32_bf16 v[204:207], a[48:51], a[216:219], v[204:207]
  v_accvgpr_read_b32 v5, a4
  ds_read_b128 a[212:215], v0 offset:38528
  v_mfma_f32_16x16x32_bf16 v[220:223], a[44:47], a[220:223], v[220:223]
  buffer_store_dwordx4 v[52:55], v5, s[12:15], s58 offen offset:0 nt
  v_mfma_f32_16x16x32_bf16 v[228:231], a[48:51], a[220:223], v[228:231]
  ds_read_b128 a[216:219], v0 offset:51328
  v_mfma_f32_16x16x32_bf16 v[244:247], a[44:47], a[224:227], v[244:247]
  ds_read_b128 a[220:223], v1 offset:128
  v_mfma_f32_16x16x32_bf16 v[252:255], a[48:51], a[224:227], v[252:255]
  s_waitcnt lgkmcnt(9)
  v_mfma_f32_16x16x32_bf16 v[192:195], a[44:47], a[228:231], v[192:195]
  ds_read_b128 a[224:227], v1 offset:12928
  v_mfma_f32_16x16x32_bf16 v[200:203], a[48:51], a[228:231], v[200:203]
  v_mfma_f32_16x16x32_bf16 v[208:211], a[44:47], a[232:235], v[208:211]
  ds_read_b128 a[228:231], v1 offset:25728
  v_mfma_f32_16x16x32_bf16 v[248:251], a[48:51], a[232:235], v[248:251]
  v_mfma_f32_16x16x32_bf16 v[96:99], a[44:47], a[236:239], v[96:99]
  ds_read_b128 a[232:235], v1 offset:38528
  v_mfma_f32_16x16x32_bf16 v[144:147], a[48:51], a[236:239], v[144:147]
  v_mfma_f32_16x16x32_bf16 v[104:107], a[44:47], a[160:163], v[104:107]
  ds_read_b128 a[236:239], v2 offset:128
  v_mfma_f32_16x16x32_bf16 v[152:155], a[48:51], a[160:163], v[152:155]
  s_waitcnt lgkmcnt(9)
  v_mfma_f32_16x16x32_bf16 v[68:71], a[44:47], a[164:167], v[68:71]
  ds_read_b128 a[160:163], v0 offset:192
  v_mfma_f32_16x16x32_bf16 v[92:95], a[48:51], a[164:167], v[92:95]
  v_mfma_f32_16x16x32_bf16 v[116:119], a[44:47], a[168:171], v[116:119]
  ds_read_b128 a[164:167], v0 offset:12992
  v_mfma_f32_16x16x32_bf16 v[140:143], a[48:51], a[168:171], v[140:143]
  v_mfma_f32_16x16x32_bf16 v[164:167], a[44:47], a[172:175], v[164:167]
  ds_read_b128 a[168:171], v0 offset:25792
  v_mfma_f32_16x16x32_bf16 v[188:191], a[48:51], a[172:175], v[188:191]
  buffer_load_dwordx4 a[44:47], v3, s[8:11], s28 offen offset:2048
  v_mfma_f32_16x16x32_bf16 v[196:199], a[52:55], a[200:203], v[196:199]
  buffer_load_dwordx4 a[48:51], v3, s[8:11], s28 offen offset:3072
  v_mfma_f32_16x16x32_bf16 v[204:207], a[56:59], a[200:203], v[204:207]
  buffer_load_dwordx4 v17, s[4:7], s32 offen offset:0 lds
  s_add_u32 m0, s61, 20384
  s_waitcnt lgkmcnt(9)
  v_mfma_f32_16x16x32_bf16 v[220:223], a[52:55], a[204:207], v[220:223]
  v_accvgpr_read_b32 v6, a5
  ds_read_b128 a[172:175], v0 offset:38592
  v_mfma_f32_16x16x32_bf16 v[228:231], a[56:59], a[204:207], v[228:231]
  ds_read_b128 a[200:203], v0 offset:51392
  v_mfma_f32_16x16x32_bf16 v[244:247], a[52:55], a[208:211], v[244:247]
  ds_read_b128 a[204:207], v1 offset:192
  v_mfma_f32_16x16x32_bf16 v[252:255], a[56:59], a[208:211], v[252:255]
  buffer_store_dwordx4 v[76:79], v6, s[12:15], s58 offen offset:0 nt
  v_mfma_f32_16x16x32_bf16 v[192:195], a[52:55], a[212:215], v[192:195]
  ds_read_b128 a[208:211], v1 offset:12992
  v_mfma_f32_16x16x32_bf16 v[200:203], a[56:59], a[212:215], v[200:203]
  s_waitcnt lgkmcnt(9)
  v_mfma_f32_16x16x32_bf16 v[208:211], a[52:55], a[216:219], v[208:211]
  ds_read_b128 a[212:215], v1 offset:25792
  v_mfma_f32_16x16x32_bf16 v[248:251], a[56:59], a[216:219], v[248:251]
  buffer_load_dwordx4 v17, s[4:7], s32 offen offset:32 lds
  s_add_u32 m0, s62, 13792
  v_mfma_f32_16x16x32_bf16 v[96:99], a[52:55], a[220:223], v[96:99]
  ds_read_b128 a[216:219], v1 offset:38592
  v_mfma_f32_16x16x32_bf16 v[144:147], a[56:59], a[220:223], v[144:147]
  v_mfma_f32_16x16x32_bf16 v[104:107], a[52:55], a[224:227], v[104:107]
  ds_read_b128 a[220:223], v2 offset:192
  v_mfma_f32_16x16x32_bf16 v[152:155], a[56:59], a[224:227], v[152:155]
  buffer_load_dwordx4 v18, s[4:7], s32 offen offset:0 lds
  s_add_u32 m0, s62, 20384
  s_addk_i32 s28, 4096
  v_mfma_f32_16x16x32_bf16 v[68:71], a[52:55], a[228:231], v[68:71]
  ds_read_b128 a[224:227], v0 offset:256
  v_mfma_f32_16x16x32_bf16 v[92:95], a[56:59], a[228:231], v[92:95]
  s_waitcnt lgkmcnt(9)
  v_mfma_f32_16x16x32_bf16 v[116:119], a[52:55], a[232:235], v[116:119]
  ds_read_b128 a[228:231], v0 offset:13056
  v_mfma_f32_16x16x32_bf16 v[140:143], a[56:59], a[232:235], v[140:143]
  buffer_load_dwordx4 v18, s[4:7], s32 offen offset:32 lds
  v_mfma_f32_16x16x32_bf16 v[164:167], a[52:55], a[236:239], v[164:167]
  ds_read_b128 a[232:235], v0 offset:25856
  v_mfma_f32_16x16x32_bf16 v[188:191], a[56:59], a[236:239], v[188:191]
  v_mfma_f32_16x16x32_bf16 v[196:199], a[60:63], a[160:163], v[196:199]
  v_accvgpr_read_b32 v5, a6
  ds_read_b128 a[236:239], v0 offset:38656
  v_mfma_f32_16x16x32_bf16 v[204:207], a[64:67], a[160:163], v[204:207]
  buffer_store_dwordx4 v[100:103], v5, s[12:15], s58 offen offset:0 nt
  v_mfma_f32_16x16x32_bf16 v[220:223], a[60:63], a[164:167], v[220:223]
  ds_read_b128 a[160:163], v0 offset:51456
  v_mfma_f32_16x16x32_bf16 v[228:231], a[64:67], a[164:167], v[228:231]
  s_waitcnt lgkmcnt(9)
  v_mfma_f32_16x16x32_bf16 v[244:247], a[60:63], a[168:171], v[244:247]
  ds_read_b128 a[164:167], v1 offset:256
  v_mfma_f32_16x16x32_bf16 v[252:255], a[64:67], a[168:171], v[252:255]
  buffer_load_dwordx4 a[52:55], v3, s[8:11], s28 offen offset:0
  v_mfma_f32_16x16x32_bf16 v[192:195], a[60:63], a[172:175], v[192:195]
  ds_read_b128 a[168:171], v1 offset:13056
  v_mfma_f32_16x16x32_bf16 v[200:203], a[64:67], a[172:175], v[200:203]
  v_mfma_f32_16x16x32_bf16 v[208:211], a[60:63], a[200:203], v[208:211]
  ds_read_b128 a[172:175], v1 offset:25856
  v_mfma_f32_16x16x32_bf16 v[248:251], a[64:67], a[200:203], v[248:251]
  buffer_load_dwordx4 a[56:59], v3, s[8:11], s28 offen offset:1024
  v_mfma_f32_16x16x32_bf16 v[96:99], a[60:63], a[204:207], v[96:99]
  ds_read_b128 a[200:203], v1 offset:38656
  v_mfma_f32_16x16x32_bf16 v[144:147], a[64:67], a[204:207], v[144:147]
  s_waitcnt lgkmcnt(9)
  v_mfma_f32_16x16x32_bf16 v[104:107], a[60:63], a[208:211], v[104:107]
  ds_read_b128 a[204:207], v2 offset:256
  v_mfma_f32_16x16x32_bf16 v[152:155], a[64:67], a[208:211], v[152:155]
  v_mfma_f32_16x16x32_bf16 v[68:71], a[60:63], a[212:215], v[68:71]
  ds_read_b128 a[208:211], v0 offset:320
  v_mfma_f32_16x16x32_bf16 v[92:95], a[64:67], a[212:215], v[92:95]
  v_mfma_f32_16x16x32_bf16 v[116:119], a[60:63], a[216:219], v[116:119]
  ds_read_b128 a[212:215], v0 offset:13120
  v_mfma_f32_16x16x32_bf16 v[140:143], a[64:67], a[216:219], v[140:143]
  v_mfma_f32_16x16x32_bf16 v[164:167], a[60:63], a[220:223], v[164:167]
  ds_read_b128 a[216:219], v0 offset:25920
  v_mfma_f32_16x16x32_bf16 v[188:191], a[64:67], a[220:223], v[188:191]
  s_waitcnt vmcnt(21) lgkmcnt(9)
  buffer_load_dwordx4 a[60:63], v3, s[8:11], s28 offen offset:2048
  v_mfma_f32_16x16x32_bf16 v[196:199], a[68:71], a[224:227], v[196:199]
  buffer_load_dwordx4 a[64:67], v3, s[8:11], s28 offen offset:3072
  s_addk_i32 s28, 4096
  s_add_u32 m0, s61, 27584
  v_mfma_f32_16x16x32_bf16 v[204:207], a[72:75], a[224:227], v[204:207]
  v_accvgpr_read_b32 v6, a4
  ds_read_b128 a[220:223], v0 offset:38720
  v_mfma_f32_16x16x32_bf16 v[220:223], a[68:71], a[228:231], v[220:223]
  buffer_store_dwordx4 v[124:127], v6, s[12:15], s59 offen offset:0 nt
  v_mfma_f32_16x16x32_bf16 v[228:231], a[72:75], a[228:231], v[228:231]
  ds_read_b128 a[224:227], v0 offset:51520
  v_mfma_f32_16x16x32_bf16 v[244:247], a[68:71], a[232:235], v[244:247]
  ds_read_b128 a[228:231], v1 offset:320
  v_mfma_f32_16x16x32_bf16 v[252:255], a[72:75], a[232:235], v[252:255]
  v_mfma_f32_16x16x32_bf16 v[192:195], a[68:71], a[236:239], v[192:195]
  ds_read_b128 a[232:235], v1 offset:13120
  v_mfma_f32_16x16x32_bf16 v[200:203], a[72:75], a[236:239], v[200:203]
  s_waitcnt lgkmcnt(9)
  v_mfma_f32_16x16x32_bf16 v[208:211], a[68:71], a[160:163], v[208:211]
  ds_read_b128 a[236:239], v1 offset:25920
  v_mfma_f32_16x16x32_bf16 v[248:251], a[72:75], a[160:163], v[248:251]
  v_mfma_f32_16x16x32_bf16 v[96:99], a[68:71], a[164:167], v[96:99]
  ds_read_b128 a[160:163], v1 offset:38720
  v_mfma_f32_16x16x32_bf16 v[144:147], a[72:75], a[164:167], v[144:147]
  v_mfma_f32_16x16x32_bf16 v[104:107], a[68:71], a[168:171], v[104:107]
  ds_read_b128 a[164:167], v2 offset:320
  v_mfma_f32_16x16x32_bf16 v[152:155], a[72:75], a[168:171], v[152:155]
  v_mfma_f32_16x16x32_bf16 v[68:71], a[68:71], a[172:175], v[68:71]
  ds_read_b128 a[168:171], v0 offset:384
  v_mfma_f32_16x16x32_bf16 v[92:95], a[72:75], a[172:175], v[92:95]
  s_waitcnt lgkmcnt(9)
  v_mfma_f32_16x16x32_bf16 v[116:119], a[68:71], a[200:203], v[116:119]
  ds_read_b128 a[172:175], v0 offset:13184
  v_mfma_f32_16x16x32_bf16 v[140:143], a[72:75], a[200:203], v[140:143]
  v_mfma_f32_16x16x32_bf16 v[164:167], a[68:71], a[204:207], v[164:167]
  ds_read_b128 a[200:203], v0 offset:25984
  v_mfma_f32_16x16x32_bf16 v[188:191], a[72:75], a[204:207], v[188:191]
  buffer_load_dwordx4 a[68:71], v3, s[8:11], s28 offen offset:0
  v_mfma_f32_16x16x32_bf16 v[196:199], a[76:79], a[208:211], v[196:199]
  buffer_load_dwordx4 a[72:75], v3, s[8:11], s28 offen offset:1024
  v_mfma_f32_16x16x32_bf16 v[204:207], a[80:83], a[208:211], v[204:207]
  v_accvgpr_read_b32 v5, a5
  ds_read_b128 a[204:207], v0 offset:38784
  v_mfma_f32_16x16x32_bf16 v[220:223], a[76:79], a[212:215], v[220:223]
  buffer_store_dwordx4 v[148:151], v5, s[12:15], s59 offen offset:0 nt
  v_mfma_f32_16x16x32_bf16 v[228:231], a[80:83], a[212:215], v[228:231]
  s_waitcnt lgkmcnt(8)
  ds_read_b128 a[208:211], v0 offset:51584
  v_mfma_f32_16x16x32_bf16 v[244:247], a[76:79], a[216:219], v[244:247]
  ds_read_b128 a[212:215], v1 offset:384
  v_mfma_f32_16x16x32_bf16 v[252:255], a[80:83], a[216:219], v[252:255]
  v_mfma_f32_16x16x32_bf16 v[192:195], a[76:79], a[220:223], v[192:195]
  ds_read_b128 a[216:219], v1 offset:13184
  v_mfma_f32_16x16x32_bf16 v[200:203], a[80:83], a[220:223], v[200:203]
  v_mfma_f32_16x16x32_bf16 v[208:211], a[76:79], a[224:227], v[208:211]
  ds_read_b128 a[220:223], v1 offset:25984
  v_mfma_f32_16x16x32_bf16 v[248:251], a[80:83], a[224:227], v[248:251]
  v_mfma_f32_16x16x32_bf16 v[96:99], a[76:79], a[228:231], v[96:99]
  ds_read_b128 a[224:227], v1 offset:38784
  v_mfma_f32_16x16x32_bf16 v[144:147], a[80:83], a[228:231], v[144:147]
  s_waitcnt lgkmcnt(9)
  v_mfma_f32_16x16x32_bf16 v[104:107], a[76:79], a[232:235], v[104:107]
  ds_read_b128 a[228:231], v2 offset:384
  v_mfma_f32_16x16x32_bf16 v[152:155], a[80:83], a[232:235], v[152:155]
  v_mfma_f32_16x16x32_bf16 v[68:71], a[76:79], a[236:239], v[68:71]
  ds_read_b128 a[232:235], v0 offset:448
  v_mfma_f32_16x16x32_bf16 v[92:95], a[80:83], a[236:239], v[92:95]
  v_mfma_f32_16x16x32_bf16 v[116:119], a[76:79], a[160:163], v[116:119]
  ds_read_b128 a[236:239], v0 offset:13248
  v_mfma_f32_16x16x32_bf16 v[140:143], a[80:83], a[160:163], v[140:143]
  v_mfma_f32_16x16x32_bf16 v[164:167], a[76:79], a[164:167], v[164:167]
  ds_read_b128 a[160:163], v0 offset:26048
  v_mfma_f32_16x16x32_bf16 v[188:191], a[80:83], a[164:167], v[188:191]
  s_waitcnt vmcnt(12) lgkmcnt(10)
  buffer_load_dwordx4 a[76:79], v3, s[8:11], s28 offen offset:2048
  v_mfma_f32_16x16x32_bf16 v[196:199], a[240:243], a[168:171], v[196:199]
  buffer_load_dwordx4 a[80:83], v3, s[8:11], s28 offen offset:3072
  v_mfma_f32_16x16x32_bf16 v[204:207], a[244:247], a[168:171], v[204:207]
  buffer_load_dwordx4 v17, s[4:7], s33 offen offset:0 lds
  s_add_u32 m0, s61, 34176
  v_mfma_f32_16x16x32_bf16 v[220:223], a[240:243], a[172:175], v[220:223]
  v_accvgpr_read_b32 v6, a6
  ds_read_b128 a[164:167], v0 offset:38848
  v_mfma_f32_16x16x32_bf16 v[228:231], a[244:247], a[172:175], v[228:231]
  ds_read_b128 a[168:171], v0 offset:51648
  v_mfma_f32_16x16x32_bf16 v[244:247], a[240:243], a[200:203], v[244:247]
  ds_read_b128 a[172:175], v1 offset:448
  v_mfma_f32_16x16x32_bf16 v[252:255], a[244:247], a[200:203], v[252:255]
  s_waitcnt lgkmcnt(9)
  buffer_store_dwordx4 v[172:175], v6, s[12:15], s59 offen offset:0 nt
  v_mfma_f32_16x16x32_bf16 v[192:195], a[240:243], a[204:207], v[192:195]
  ds_read_b128 a[200:203], v1 offset:13248
  v_mfma_f32_16x16x32_bf16 v[200:203], a[244:247], a[204:207], v[200:203]
  v_mfma_f32_16x16x32_bf16 v[208:211], a[240:243], a[208:211], v[208:211]
  ds_read_b128 a[204:207], v1 offset:26048
  v_mfma_f32_16x16x32_bf16 v[248:251], a[244:247], a[208:211], v[248:251]
  buffer_load_dwordx4 v17, s[4:7], s33 offen offset:32 lds
  s_add_u32 m0, s62, 27584
  v_mfma_f32_16x16x32_bf16 v[96:99], a[240:243], a[212:215], v[96:99]
  ds_read_b128 a[208:211], v1 offset:38848
  v_mfma_f32_16x16x32_bf16 v[144:147], a[244:247], a[212:215], v[144:147]
  v_mfma_f32_16x16x32_bf16 v[104:107], a[240:243], a[216:219], v[104:107]
  ds_read_b128 a[212:215], v2 offset:448
  v_mfma_f32_16x16x32_bf16 v[152:155], a[244:247], a[216:219], v[152:155]
  buffer_load_dwordx4 v18, s[4:7], s33 offen offset:0 lds
  s_add_u32 m0, s62, 34176
  s_addk_i32 s28, 4096
  s_waitcnt lgkmcnt(9)
  v_mfma_f32_16x16x32_bf16 v[68:71], a[240:243], a[220:223], v[68:71]
  ds_read_b128 a[216:219], v0 offset:512
  v_mfma_f32_16x16x32_bf16 v[92:95], a[244:247], a[220:223], v[92:95]
  v_mfma_f32_16x16x32_bf16 v[116:119], a[240:243], a[224:227], v[116:119]
  ds_read_b128 a[220:223], v0 offset:13312
  v_mfma_f32_16x16x32_bf16 v[140:143], a[244:247], a[224:227], v[140:143]
  buffer_load_dwordx4 v18, s[4:7], s33 offen offset:32 lds
  v_mfma_f32_16x16x32_bf16 v[164:167], a[240:243], a[228:231], v[164:167]
  ds_read_b128 a[224:227], v0 offset:26112
  v_mfma_f32_16x16x32_bf16 v[188:191], a[244:247], a[228:231], v[188:191]
  v_mfma_f32_16x16x32_bf16 v[196:199], a[248:251], a[232:235], v[196:199]
  v_accvgpr_read_b32 v5, a4
  ds_read_b128 a[228:231], v0 offset:38912
  v_mfma_f32_16x16x32_bf16 v[204:207], a[252:255], a[232:235], v[204:207]
  s_waitcnt lgkmcnt(9)
  buffer_store_dwordx4 v[112:115], v5, s[12:15], s60 offen offset:0 nt
  v_mfma_f32_16x16x32_bf16 v[220:223], a[248:251], a[236:239], v[220:223]
  ds_read_b128 a[232:235], v0 offset:51712
  v_mfma_f32_16x16x32_bf16 v[228:231], a[252:255], a[236:239], v[228:231]
  v_mfma_f32_16x16x32_bf16 v[244:247], a[248:251], a[160:163], v[244:247]
  ds_read_b128 a[236:239], v1 offset:512
  v_mfma_f32_16x16x32_bf16 v[252:255], a[252:255], a[160:163], v[252:255]
  buffer_load_dwordx4 a[240:243], v3, s[8:11], s28 offen offset:0
  v_mfma_f32_16x16x32_bf16 v[192:195], a[248:251], a[164:167], v[192:195]
  ds_read_b128 a[160:163], v1 offset:13312
  v_mfma_f32_16x16x32_bf16 v[200:203], a[252:255], a[164:167], v[200:203]
  v_mfma_f32_16x16x32_bf16 v[208:211], a[248:251], a[168:171], v[208:211]
  ds_read_b128 a[164:167], v1 offset:26112
  v_mfma_f32_16x16x32_bf16 v[248:251], a[252:255], a[168:171], v[248:251]
  s_waitcnt lgkmcnt(9)
  buffer_load_dwordx4 a[244:247], v3, s[8:11], s28 offen offset:1024
  v_mfma_f32_16x16x32_bf16 v[96:99], a[248:251], a[172:175], v[96:99]
  ds_read_b128 a[168:171], v1 offset:38912
  v_mfma_f32_16x16x32_bf16 v[144:147], a[252:255], a[172:175], v[144:147]
  v_mfma_f32_16x16x32_bf16 v[104:107], a[248:251], a[200:203], v[104:107]
  ds_read_b128 a[172:175], v2 offset:512
  v_mfma_f32_16x16x32_bf16 v[152:155], a[252:255], a[200:203], v[152:155]
  v_mfma_f32_16x16x32_bf16 v[68:71], a[248:251], a[204:207], v[68:71]
  ds_read_b128 a[200:203], v0 offset:576
  v_mfma_f32_16x16x32_bf16 v[92:95], a[252:255], a[204:207], v[92:95]
  v_mfma_f32_16x16x32_bf16 v[116:119], a[248:251], a[208:211], v[116:119]
  ds_read_b128 a[204:207], v0 offset:13376
  v_mfma_f32_16x16x32_bf16 v[140:143], a[252:255], a[208:211], v[140:143]
  s_waitcnt lgkmcnt(9)
  v_mfma_f32_16x16x32_bf16 v[164:167], a[248:251], a[212:215], v[164:167]
  ds_read_b128 a[208:211], v0 offset:26176
  v_mfma_f32_16x16x32_bf16 v[188:191], a[252:255], a[212:215], v[188:191]
  buffer_load_dwordx4 a[248:251], v3, s[8:11], s28 offen offset:2048
  v_mfma_f32_16x16x32_bf16 v[196:199], a[36:39], a[216:219], v[196:199]
  buffer_load_dwordx4 a[252:255], v3, s[8:11], s28 offen offset:3072
  s_addk_i32 s28, 4096
  v_mfma_f32_16x16x32_bf16 v[204:207], a[40:43], a[216:219], v[204:207]
  v_accvgpr_read_b32 v6, a5
  ds_read_b128 a[212:215], v0 offset:38976
  v_mfma_f32_16x16x32_bf16 v[220:223], a[36:39], a[220:223], v[220:223]
  buffer_store_dwordx4 v[120:123], v6, s[12:15], s60 offen offset:0 nt
  v_mfma_f32_16x16x32_bf16 v[228:231], a[40:43], a[220:223], v[228:231]
  ds_read_b128 a[216:219], v0 offset:51776
  v_mfma_f32_16x16x32_bf16 v[244:247], a[36:39], a[224:227], v[244:247]
  ds_read_b128 a[220:223], v1 offset:576
  v_mfma_f32_16x16x32_bf16 v[252:255], a[40:43], a[224:227], v[252:255]
  s_waitcnt lgkmcnt(9)
  v_mfma_f32_16x16x32_bf16 v[192:195], a[36:39], a[228:231], v[192:195]
  ds_read_b128 a[224:227], v1 offset:13376
  v_mfma_f32_16x16x32_bf16 v[200:203], a[40:43], a[228:231], v[200:203]
  v_mfma_f32_16x16x32_bf16 v[208:211], a[36:39], a[232:235], v[208:211]
  ds_read_b128 a[228:231], v1 offset:26176
  v_mfma_f32_16x16x32_bf16 v[248:251], a[40:43], a[232:235], v[248:251]
  v_mfma_f32_16x16x32_bf16 v[96:99], a[36:39], a[236:239], v[96:99]
  ds_read_b128 a[232:235], v1 offset:38976
  v_mfma_f32_16x16x32_bf16 v[144:147], a[40:43], a[236:239], v[144:147]
  v_mfma_f32_16x16x32_bf16 v[104:107], a[36:39], a[160:163], v[104:107]
  ds_read_b128 a[236:239], v2 offset:576
  v_mfma_f32_16x16x32_bf16 v[152:155], a[40:43], a[160:163], v[152:155]
  s_waitcnt lgkmcnt(9)
  v_mfma_f32_16x16x32_bf16 v[68:71], a[36:39], a[164:167], v[68:71]
  ds_read_b128 a[160:163], v0 offset:640
  v_mfma_f32_16x16x32_bf16 v[92:95], a[40:43], a[164:167], v[92:95]
  v_mfma_f32_16x16x32_bf16 v[116:119], a[36:39], a[168:171], v[116:119]
  ds_read_b128 a[164:167], v0 offset:13440
  v_mfma_f32_16x16x32_bf16 v[140:143], a[40:43], a[168:171], v[140:143]
  v_mfma_f32_16x16x32_bf16 v[164:167], a[36:39], a[172:175], v[164:167]
  ds_read_b128 a[168:171], v0 offset:26240
  v_mfma_f32_16x16x32_bf16 v[188:191], a[40:43], a[172:175], v[188:191]
  s_waitcnt vmcnt(20)
  buffer_load_dwordx4 a[36:39], v3, s[8:11], s28 offen offset:0
  v_mfma_f32_16x16x32_bf16 v[196:199], a[44:47], a[200:203], v[196:199]
  buffer_load_dwordx4 a[40:43], v3, s[8:11], s28 offen offset:1024
  v_mfma_f32_16x16x32_bf16 v[204:207], a[48:51], a[200:203], v[204:207]
  s_waitcnt lgkmcnt(9)
  v_accvgpr_read_b32 v5, a6
  ds_read_b128 a[172:175], v0 offset:39040
  v_mfma_f32_16x16x32_bf16 v[220:223], a[44:47], a[204:207], v[220:223]
  buffer_store_dwordx4 v[128:131], v5, s[12:15], s60 offen offset:0 nt
  v_mfma_f32_16x16x32_bf16 v[228:231], a[48:51], a[204:207], v[228:231]
  ds_read_b128 a[200:203], v0 offset:51840
  v_mfma_f32_16x16x32_bf16 v[244:247], a[44:47], a[208:211], v[244:247]
  ds_read_b128 a[204:207], v1 offset:640
  v_mfma_f32_16x16x32_bf16 v[252:255], a[48:51], a[208:211], v[252:255]
  v_mfma_f32_16x16x32_bf16 v[192:195], a[44:47], a[212:215], v[192:195]
  ds_read_b128 a[208:211], v1 offset:13440
  v_mfma_f32_16x16x32_bf16 v[200:203], a[48:51], a[212:215], v[200:203]
  s_waitcnt lgkmcnt(9)
  v_mfma_f32_16x16x32_bf16 v[208:211], a[44:47], a[216:219], v[208:211]
  ds_read_b128 a[212:215], v1 offset:26240
  v_mfma_f32_16x16x32_bf16 v[248:251], a[48:51], a[216:219], v[248:251]
  v_mfma_f32_16x16x32_bf16 v[96:99], a[44:47], a[220:223], v[96:99]
  ds_read_b128 a[216:219], v1 offset:39040
  v_mfma_f32_16x16x32_bf16 v[144:147], a[48:51], a[220:223], v[144:147]
  v_mfma_f32_16x16x32_bf16 v[104:107], a[44:47], a[224:227], v[104:107]
  ds_read_b128 a[220:223], v2 offset:640
  v_mfma_f32_16x16x32_bf16 v[152:155], a[48:51], a[224:227], v[152:155]
  v_mfma_f32_16x16x32_bf16 v[68:71], a[44:47], a[228:231], v[68:71]
  ds_read_b128 a[224:227], v0 offset:704
  v_mfma_f32_16x16x32_bf16 v[92:95], a[48:51], a[228:231], v[92:95]
  s_waitcnt lgkmcnt(9)
  v_mfma_f32_16x16x32_bf16 v[116:119], a[44:47], a[232:235], v[116:119]
  ds_read_b128 a[228:231], v0 offset:13504
  v_mfma_f32_16x16x32_bf16 v[140:143], a[48:51], a[232:235], v[140:143]
  v_mfma_f32_16x16x32_bf16 v[164:167], a[44:47], a[236:239], v[164:167]
  ds_read_b128 a[232:235], v0 offset:26304
  v_mfma_f32_16x16x32_bf16 v[188:191], a[48:51], a[236:239], v[188:191]
  s_waitcnt vmcnt(12)
  buffer_load_dwordx4 a[44:47], v3, s[8:11], s28 offen offset:2048
  v_mfma_f32_16x16x32_bf16 v[196:199], a[52:55], a[160:163], v[196:199]
  buffer_load_dwordx4 a[48:51], v3, s[8:11], s28 offen offset:3072
  s_addk_i32 s28, 4096
  v_mfma_f32_16x16x32_bf16 v[204:207], a[56:59], a[160:163], v[204:207]
  v_accvgpr_read_b32 v6, a7
  ds_read_b128 a[236:239], v0 offset:39104
  v_mfma_f32_16x16x32_bf16 v[220:223], a[52:55], a[164:167], v[220:223]
  buffer_store_dwordx4 v[136:139], v6, s[12:15], s58 offen offset:0 nt
  v_mfma_f32_16x16x32_bf16 v[228:231], a[56:59], a[164:167], v[228:231]
  s_waitcnt lgkmcnt(8)
  ds_read_b128 a[160:163], v0 offset:51904
  v_mfma_f32_16x16x32_bf16 v[244:247], a[52:55], a[168:171], v[244:247]
  ds_read_b128 a[164:167], v1 offset:704
  v_mfma_f32_16x16x32_bf16 v[252:255], a[56:59], a[168:171], v[252:255]
  v_mfma_f32_16x16x32_bf16 v[192:195], a[52:55], a[172:175], v[192:195]
  ds_read_b128 a[168:171], v1 offset:13504
  v_mfma_f32_16x16x32_bf16 v[200:203], a[56:59], a[172:175], v[200:203]
  v_mfma_f32_16x16x32_bf16 v[208:211], a[52:55], a[200:203], v[208:211]
  ds_read_b128 a[172:175], v1 offset:26304
  v_mfma_f32_16x16x32_bf16 v[248:251], a[56:59], a[200:203], v[248:251]
  v_mfma_f32_16x16x32_bf16 v[96:99], a[52:55], a[204:207], v[96:99]
  ds_read_b128 a[200:203], v1 offset:39104
  v_mfma_f32_16x16x32_bf16 v[144:147], a[56:59], a[204:207], v[144:147]
  s_waitcnt lgkmcnt(9)
  v_mfma_f32_16x16x32_bf16 v[104:107], a[52:55], a[208:211], v[104:107]
  ds_read_b128 a[204:207], v2 offset:704
  v_mfma_f32_16x16x32_bf16 v[152:155], a[56:59], a[208:211], v[152:155]
  v_mfma_f32_16x16x32_bf16 v[68:71], a[52:55], a[212:215], v[68:71]
  ds_read_b128 a[208:211], v0 offset:0
  v_mfma_f32_16x16x32_bf16 v[92:95], a[56:59], a[212:215], v[92:95]
  v_mfma_f32_16x16x32_bf16 v[116:119], a[52:55], a[216:219], v[116:119]
  ds_read_b128 a[212:215], v0 offset:12800
  v_mfma_f32_16x16x32_bf16 v[140:143], a[56:59], a[216:219], v[140:143]
  v_mfma_f32_16x16x32_bf16 v[164:167], a[52:55], a[220:223], v[164:167]
  ds_read_b128 a[216:219], v0 offset:25600
  v_mfma_f32_16x16x32_bf16 v[188:191], a[56:59], a[220:223], v[188:191]
  s_waitcnt lgkmcnt(10)
  buffer_load_dwordx4 a[52:55], v3, s[8:11], s28 offen offset:0
  v_mfma_f32_16x16x32_bf16 v[196:199], a[60:63], a[224:227], v[196:199]
  buffer_load_dwordx4 a[56:59], v3, s[8:11], s28 offen offset:1024
  v_mfma_f32_16x16x32_bf16 v[204:207], a[64:67], a[224:227], v[204:207]
  ds_read_b128 a[220:223], v0 offset:38400
  v_mfma_f32_16x16x32_bf16 v[220:223], a[60:63], a[228:231], v[220:223]
  ds_read_b128 a[224:227], v0 offset:51200
  v_cvt_pk_bf16_f32 v196, v196, v197
  v_mfma_f32_16x16x32_bf16 v[228:231], a[64:67], a[228:231], v[228:231]
  v_cvt_pk_bf16_f32 v197, v198, v199
  v_cvt_pk_bf16_f32 v198, v204, v205
  v_mfma_f32_16x16x32_bf16 v[244:247], a[60:63], a[232:235], v[244:247]
  ds_read_b128 a[228:231], v1 offset:0
  v_cvt_pk_bf16_f32 v199, v206, v207
  v_mfma_f32_16x16x32_bf16 v[252:255], a[64:67], a[232:235], v[252:255]
  s_waitcnt lgkmcnt(10)
  v_cvt_pk_bf16_f32 v220, v220, v221
  v_cvt_pk_bf16_f32 v221, v222, v223
  v_mfma_f32_16x16x32_bf16 v[192:195], a[60:63], a[236:239], v[192:195]
  ds_read_b128 a[232:235], v1 offset:12800
  v_cvt_pk_bf16_f32 v222, v228, v229
  v_mfma_f32_16x16x32_bf16 v[200:203], a[64:67], a[236:239], v[200:203]
  v_cvt_pk_bf16_f32 v223, v230, v231
  v_cvt_pk_bf16_f32 v244, v244, v245
  v_mfma_f32_16x16x32_bf16 v[208:211], a[60:63], a[160:163], v[208:211]
  ds_read_b128 a[236:239], v1 offset:25600
  v_cvt_pk_bf16_f32 v245, v246, v247
  v_mfma_f32_16x16x32_bf16 v[248:251], a[64:67], a[160:163], v[248:251]
  v_cvt_pk_bf16_f32 v246, v252, v253
  v_cvt_pk_bf16_f32 v247, v254, v255
  v_mfma_f32_16x16x32_bf16 v[96:99], a[60:63], a[164:167], v[96:99]
  ds_read_b128 a[160:163], v1 offset:38400
  v_cvt_pk_bf16_f32 v192, v192, v193
  v_mfma_f32_16x16x32_bf16 v[144:147], a[64:67], a[164:167], v[144:147]
  s_waitcnt lgkmcnt(10)
  v_cvt_pk_bf16_f32 v193, v194, v195
  v_cvt_pk_bf16_f32 v194, v200, v201
  v_mfma_f32_16x16x32_bf16 v[104:107], a[60:63], a[168:171], v[104:107]
  ds_read_b128 a[164:167], v2 offset:0
  v_cvt_pk_bf16_f32 v195, v202, v203
  v_mfma_f32_16x16x32_bf16 v[152:155], a[64:67], a[168:171], v[152:155]
  v_cvt_pk_bf16_f32 v208, v208, v209
  v_cvt_pk_bf16_f32 v209, v210, v211
  v_mfma_f32_16x16x32_bf16 v[68:71], a[60:63], a[172:175], v[68:71]
  ds_read_b128 a[168:171], v0 offset:64
  v_cvt_pk_bf16_f32 v210, v248, v249
  v_mfma_f32_16x16x32_bf16 v[92:95], a[64:67], a[172:175], v[92:95]
  v_cvt_pk_bf16_f32 v211, v250, v251
  v_cvt_pk_bf16_f32 v96, v96, v97
  v_mfma_f32_16x16x32_bf16 v[116:119], a[60:63], a[200:203], v[116:119]
  ds_read_b128 a[172:175], v0 offset:12864
  v_cvt_pk_bf16_f32 v97, v98, v99
  v_mfma_f32_16x16x32_bf16 v[140:143], a[64:67], a[200:203], v[140:143]
  s_waitcnt lgkmcnt(10)
  v_cvt_pk_bf16_f32 v98, v144, v145
  v_cvt_pk_bf16_f32 v99, v146, v147
  v_mfma_f32_16x16x32_bf16 v[164:167], a[60:63], a[204:207], v[164:167]
  ds_read_b128 a[200:203], v0 offset:25664
  v_cvt_pk_bf16_f32 v104, v104, v105
  v_mfma_f32_16x16x32_bf16 v[188:191], a[64:67], a[204:207], v[188:191]
  buffer_load_dwordx4 a[60:63], v3, s[8:11], s28 offen offset:2048
  v_mfma_f32_16x16x32_bf16 v[52:55], a[8:11], a[20:23], 0
  buffer_load_dwordx4 a[64:67], v3, s[8:11], s28 offen offset:3072
  s_addk_i32 s28, 4096
  v_mfma_f32_16x16x32_bf16 v[60:63], a[12:15], a[20:23], 0
  ds_read_b128 a[204:207], v0 offset:38464
  v_cvt_pk_bf16_f32 v105, v106, v107
  v_mfma_f32_16x16x32_bf16 v[76:79], a[8:11], a[28:31], 0
  v_cvt_pk_bf16_f32 v106, v152, v153
  v_cvt_pk_bf16_f32 v107, v154, v155
  v_mfma_f32_16x16x32_bf16 v[84:87], a[12:15], a[28:31], 0
  v_cvt_pk_bf16_f32 v68, v68, v69
  v_cvt_pk_bf16_f32 v69, v70, v71
  v_mfma_f32_16x16x32_bf16 v[100:103], a[8:11], a[156:159], 0
  v_cvt_pk_bf16_f32 v70, v92, v93
  v_cvt_pk_bf16_f32 v71, v94, v95
  v_mfma_f32_16x16x32_bf16 v[108:111], a[12:15], a[156:159], 0
  v_cvt_pk_bf16_f32 v116, v116, v117
  v_cvt_pk_bf16_f32 v117, v118, v119
  v_mfma_f32_16x16x32_bf16 v[124:127], a[8:11], a[100:103], 0
  v_cvt_pk_bf16_f32 v118, v140, v141
  v_cvt_pk_bf16_f32 v119, v142, v143
  v_mfma_f32_16x16x32_bf16 v[132:135], a[12:15], a[100:103], 0
  v_cvt_pk_bf16_f32 v164, v164, v165
  v_cvt_pk_bf16_f32 v165, v166, v167
  v_mfma_f32_16x16x32_bf16 v[148:151], a[8:11], a[124:127], 0
  v_cvt_pk_bf16_f32 v166, v188, v189
  v_cvt_pk_bf16_f32 v167, v190, v191
  v_mfma_f32_16x16x32_bf16 v[156:159], a[12:15], a[124:127], 0
  v_mfma_f32_16x16x32_bf16 v[172:175], a[8:11], a[148:151], 0
  v_mfma_f32_16x16x32_bf16 v[180:183], a[12:15], a[148:151], 0
  v_mfma_f32_16x16x32_bf16 v[112:115], a[8:11], a[104:107], 0
  v_mfma_f32_16x16x32_bf16 v[160:163], a[12:15], a[104:107], 0
  v_mfma_f32_16x16x32_bf16 v[120:123], a[8:11], a[128:131], 0
  v_mfma_f32_16x16x32_bf16 v[168:171], a[12:15], a[128:131], 0
  v_mfma_f32_16x16x32_bf16 v[128:131], a[8:11], a[152:155], 0
  v_mfma_f32_16x16x32_bf16 v[176:179], a[12:15], a[152:155], 0
  v_mfma_f32_16x16x32_bf16 v[136:139], a[8:11], a[88:91], 0
  v_mfma_f32_16x16x32_bf16 v[184:187], a[12:15], a[88:91], 0
  v_mfma_f32_16x16x32_bf16 v[52:55], a[68:71], a[208:211], v[52:55]
  v_mfma_f32_16x16x32_bf16 v[60:63], a[72:75], a[208:211], v[60:63]
  v_mfma_f32_16x16x32_bf16 v[76:79], a[68:71], a[212:215], v[76:79]
  ds_read_b128 a[208:211], v0 offset:51264
  v_mfma_f32_16x16x32_bf16 v[84:87], a[72:75], a[212:215], v[84:87]
  s_waitcnt lgkmcnt(1)
  v_mfma_f32_16x16x32_bf16 v[100:103], a[68:71], a[216:219], v[100:103]
  ds_read_b128 a[212:215], v1 offset:64
  v_mfma_f32_16x16x32_bf16 v[108:111], a[72:75], a[216:219], v[108:111]
  v_mfma_f32_16x16x32_bf16 v[124:127], a[68:71], a[220:223], v[124:127]
  ds_read_b128 a[216:219], v1 offset:12864
  v_mfma_f32_16x16x32_bf16 v[132:135], a[72:75], a[220:223], v[132:135]
  v_mfma_f32_16x16x32_bf16 v[148:151], a[68:71], a[224:227], v[148:151]
  ds_read_b128 a[220:223], v1 offset:25664
  v_mfma_f32_16x16x32_bf16 v[156:159], a[72:75], a[224:227], v[156:159]
  v_mfma_f32_16x16x32_bf16 v[172:175], a[68:71], a[228:231], v[172:175]
  ds_read_b128 a[224:227], v1 offset:38464
  v_mfma_f32_16x16x32_bf16 v[180:183], a[72:75], a[228:231], v[180:183]
  v_mfma_f32_16x16x32_bf16 v[112:115], a[68:71], a[232:235], v[112:115]
  ds_read_b128 a[228:231], v2 offset:64
  v_mfma_f32_16x16x32_bf16 v[160:163], a[72:75], a[232:235], v[160:163]
  v_mfma_f32_16x16x32_bf16 v[120:123], a[68:71], a[236:239], v[120:123]
  ds_read_b128 a[232:235], v0 offset:128
  v_mfma_f32_16x16x32_bf16 v[168:171], a[72:75], a[236:239], v[168:171]
  v_mfma_f32_16x16x32_bf16 v[128:131], a[68:71], a[160:163], v[128:131]
  ds_read_b128 a[236:239], v0 offset:12928
  v_mfma_f32_16x16x32_bf16 v[176:179], a[72:75], a[160:163], v[176:179]
  v_mfma_f32_16x16x32_bf16 v[136:139], a[68:71], a[164:167], v[136:139]
  ds_read_b128 a[160:163], v0 offset:25728
  v_mfma_f32_16x16x32_bf16 v[184:187], a[72:75], a[164:167], v[184:187]
  s_waitcnt vmcnt(16)
  buffer_load_dwordx4 a[68:71], v3, s[8:11], s28 offen offset:0
  v_mfma_f32_16x16x32_bf16 v[52:55], a[76:79], a[168:171], v[52:55]
  buffer_load_dwordx4 a[72:75], v3, s[8:11], s28 offen offset:1024
  v_mfma_f32_16x16x32_bf16 v[60:63], a[80:83], a[168:171], v[60:63]
  v_accvgpr_read_b32 v5, a4
  ds_read_b128 a[164:167], v0 offset:38528
  v_mfma_f32_16x16x32_bf16 v[76:79], a[76:79], a[172:175], v[76:79]
  s_waitcnt lgkmcnt(4)
  s_barrier
  buffer_store_dwordx4 v[196:199], v5, s[12:15], s58 offen offset:64 nt
  v_mfma_f32_16x16x32_bf16 v[84:87], a[80:83], a[172:175], v[84:87]
  ds_read_b128 a[168:171], v0 offset:51328
  v_mfma_f32_16x16x32_bf16 v[100:103], a[76:79], a[200:203], v[100:103]
  ds_read_b128 a[172:175], v1 offset:128
  v_mfma_f32_16x16x32_bf16 v[108:111], a[80:83], a[200:203], v[108:111]
  ds_read_b128 a[116:119], v8 offset:0
  v_mfma_f32_16x16x32_bf16 v[124:127], a[76:79], a[204:207], v[124:127]
  ds_read_b128 a[200:203], v1 offset:12928
  v_mfma_f32_16x16x32_bf16 v[132:135], a[80:83], a[204:207], v[132:135]
  ds_read_b128 a[120:123], v8 offset:736
  v_mfma_f32_16x16x32_bf16 v[148:151], a[76:79], a[208:211], v[148:151]
  ds_read_b128 a[204:207], v1 offset:25728
  v_mfma_f32_16x16x32_bf16 v[156:159], a[80:83], a[208:211], v[156:159]
  ds_read_b128 a[124:127], v8 offset:768
  v_mfma_f32_16x16x32_bf16 v[172:175], a[76:79], a[212:215], v[172:175]
  ds_read_b128 a[128:131], v8 offset:1472
  v_mfma_f32_16x16x32_bf16 v[180:183], a[80:83], a[212:215], v[180:183]
  ds_read_b128 a[132:135], v22 offset:64
  v_add_u32 v22, v10, v16
  v_mfma_f32_16x16x32_bf16 v[112:115], a[76:79], a[216:219], v[112:115]
  ds_read_b128 a[208:211], v1 offset:38528
  v_mfma_f32_16x16x32_bf16 v[160:163], a[80:83], a[216:219], v[160:163]
  ds_read_b128 a[212:215], v2 offset:128
  v_mfma_f32_16x16x32_bf16 v[120:123], a[76:79], a[220:223], v[120:123]
  ds_read_b128 a[216:219], v0 offset:192
  v_mfma_f32_16x16x32_bf16 v[168:171], a[80:83], a[220:223], v[168:171]
  ds_read_b128 a[136:139], v9 offset:0
  v_mfma_f32_16x16x32_bf16 v[128:131], a[76:79], a[224:227], v[128:131]
  ds_read_b128 a[220:223], v0 offset:12992
  v_mfma_f32_16x16x32_bf16 v[176:179], a[80:83], a[224:227], v[176:179]
  ds_read_b128 a[140:143], v9 offset:736
  v_mfma_f32_16x16x32_bf16 v[136:139], a[76:79], a[228:231], v[136:139]
  ds_read_b128 a[144:147], v9 offset:768
  v_mfma_f32_16x16x32_bf16 v[184:187], a[80:83], a[228:231], v[184:187]
  s_waitcnt vmcnt(6) lgkmcnt(15)
  buffer_load_dwordx4 a[76:79], v3, s[8:11], s28 offen offset:2048
  v_mfma_f32_16x16x32_bf16 v[52:55], a[240:243], a[232:235], v[52:55]
  buffer_load_dwordx4 a[80:83], v3, s[8:11], s28 offen offset:3072
  s_addk_i32 s28, 4096
  s_add_u32 s35, s24, 12288
  v_mfma_f32_16x16x32_bf16 v[60:63], a[244:247], a[232:235], v[60:63]
  s_add_u32 m0, s61, 0
  v_accvgpr_read_b32 v6, a5
  ds_read_b128 a[148:151], v9 offset:1472
  v_mfma_f32_16x16x32_bf16 v[76:79], a[240:243], a[236:239], v[76:79]
  buffer_store_dwordx4 v[220:223], v6, s[12:15], s58 offen offset:64 nt
  v_mfma_f32_16x16x32_bf16 v[84:87], a[244:247], a[236:239], v[84:87]
  ds_read_b128 a[152:155], v23 offset:64
  v_add_u32 v23, v11, v16
  v_mfma_f32_16x16x32_bf16 v[100:103], a[240:243], a[160:163], v[100:103]
  ds_read_b128 a[224:227], v0 offset:25792
  v_mfma_f32_16x16x32_bf16 v[108:111], a[244:247], a[160:163], v[108:111]
  ds_read_b128 a[228:231], v0 offset:38592
  v_mfma_f32_16x16x32_bf16 v[124:127], a[240:243], a[164:167], v[124:127]
  ds_read_b128 a[232:235], v0 offset:51392
  v_mfma_f32_16x16x32_bf16 v[132:135], a[244:247], a[164:167], v[132:135]
  ds_read_b128 a[236:239], v1 offset:192
  v_mfma_f32_16x16x32_bf16 v[148:151], a[240:243], a[168:171], v[148:151]
  ds_read_b128 a[160:163], v1 offset:12992
  v_mfma_f32_16x16x32_bf16 v[156:159], a[244:247], a[168:171], v[156:159]
  s_waitcnt lgkmcnt(14)
  ds_read_b128 a[164:167], v1 offset:25792
  v_mfma_f32_16x16x32_bf16 v[172:175], a[240:243], a[172:175], v[172:175]
  ds_read_b128 a[168:171], v1 offset:38592
  v_mfma_f32_16x16x32_bf16 v[180:183], a[244:247], a[172:175], v[180:183]
  v_mfma_f32_16x16x32_bf16 v[112:115], a[240:243], a[200:203], v[112:115]
  ds_read_b128 a[172:175], v2 offset:192
  v_mfma_f32_16x16x32_bf16 v[160:163], a[244:247], a[200:203], v[160:163]
  v_mfma_f32_16x16x32_bf16 v[120:123], a[240:243], a[204:207], v[120:123]
  ds_read_b128 a[200:203], v0 offset:256
  v_mfma_f32_16x16x32_bf16 v[168:171], a[244:247], a[204:207], v[168:171]
  v_mfma_f32_16x16x32_bf16 v[24:27], a[176:179], a[116:119], 0
  ds_read_b128 a[204:207], v0 offset:13056
  v_smfmac_f32_16x16x64_bf16 v[24:27], a[180:183], a[120:127], v15
  ds_read_b128 a[116:119], v10 offset:0
  v_smfmac_f32_16x16x64_bf16 v[24:27], a[184:187], a[128:135], v15
  s_waitcnt lgkmcnt(13)
  ds_read_b128 a[120:123], v10 offset:736
  v_mfma_f32_16x16x32_bf16 v[128:131], a[240:243], a[208:211], v[128:131]
  ds_read_b128 a[124:127], v10 offset:768
  v_mfma_f32_16x16x32_bf16 v[176:179], a[244:247], a[208:211], v[176:179]
  ds_read_b128 a[128:131], v10 offset:1472
  v_mul_f32 v37, v24, v24
  v_mfma_f32_16x16x32_bf16 v[136:139], a[240:243], a[212:215], v[136:139]
  ds_read_b128 a[132:135], v22 offset:64
  v_add_f32 v36, v24, v25
  v_mfma_f32_16x16x32_bf16 v[184:187], a[244:247], a[212:215], v[184:187]
  buffer_load_dwordx4 a[240:243], v3, s[8:11], s28 offen offset:0
  v_mfma_f32_16x16x32_bf16 v[52:55], a[248:251], a[216:219], v[52:55]
  buffer_load_dwordx4 a[244:247], v3, s[8:11], s28 offen offset:1024
  v_mfma_f32_16x16x32_bf16 v[60:63], a[252:255], a[216:219], v[60:63]
  v_accvgpr_read_b32 v5, a6
  v_fmac_f32 v37, v25, v25
  v_mfma_f32_16x16x32_bf16 v[76:79], a[248:251], a[220:223], v[76:79]
  buffer_store_dwordx4 v[244:247], v5, s[12:15], s58 offen offset:64 nt
  v_mfma_f32_16x16x32_bf16 v[84:87], a[252:255], a[220:223], v[84:87]
  v_add_f32 v36, v36, v26
  v_fmac_f32 v37, v26, v26
  v_mfma_f32_16x16x32_bf16 v[28:31], a[176:179], a[136:139], 0
  v_cvt_pk_bf16_f32 v32, v24, v25
  v_cvt_pk_bf16_f32 v33, v26, v27
  v_smfmac_f32_16x16x64_bf16 v[28:31], a[180:183], a[140:147], v15
  s_waitcnt lgkmcnt(9)
  v_add_f32 v36, v36, v27
  v_smfmac_f32_16x16x64_bf16 v[28:31], a[184:187], a[148:155], v15
  v_fmac_f32 v37, v27, v27
  v_mfma_f32_16x16x32_bf16 v[100:103], a[248:251], a[224:227], v[100:103]
  ds_read_b128 a[136:139], v11 offset:0
  v_add_u32 v22, v12, v16
  v_mfma_f32_16x16x32_bf16 v[108:111], a[252:255], a[224:227], v[108:111]
  ds_read_b128 a[140:143], v11 offset:736
  v_mul_f32 v39, v28, v28
  v_mfma_f32_16x16x32_bf16 v[124:127], a[248:251], a[228:231], v[124:127]
  ds_read_b128 a[144:147], v11 offset:768
  v_add_f32 v38, v28, v29
  v_mfma_f32_16x16x32_bf16 v[132:135], a[252:255], a[228:231], v[132:135]
  ds_read_b128 a[148:151], v11 offset:1472
  v_fmac_f32 v39, v29, v29
  v_mfma_f32_16x16x32_bf16 v[148:151], a[248:251], a[232:235], v[148:151]
  ds_read_b128 a[152:155], v23 offset:64
  v_add_f32 v38, v38, v30
  v_mfma_f32_16x16x32_bf16 v[156:159], a[252:255], a[232:235], v[156:159]
  ds_read_b128 a[208:211], v0 offset:25856
  v_fmac_f32 v39, v30, v30
  v_mfma_f32_16x16x32_bf16 v[172:175], a[248:251], a[236:239], v[172:175]
  ds_read_b128 a[212:215], v0 offset:38656
  v_cvt_pk_bf16_f32 v34, v28, v29
  v_mfma_f32_16x16x32_bf16 v[180:183], a[252:255], a[236:239], v[180:183]
  s_waitcnt lgkmcnt(11)
  v_cvt_pk_bf16_f32 v35, v30, v31
  v_add_f32 v38, v38, v31
  v_mfma_f32_16x16x32_bf16 v[24:27], a[176:179], a[116:119], 0
  s_waitcnt lgkmcnt(9)
  v_fmac_f32 v39, v31, v31
  ds_read_b128 a[216:219], v0 offset:51456
  v_smfmac_f32_16x16x64_bf16 v[24:27], a[180:183], a[120:127], v15
  s_waitcnt lgkmcnt(8)
  ds_read_b128 a[116:119], v12 offset:0
  v_smfmac_f32_16x16x64_bf16 v[24:27], a[184:187], a[128:135], v15
  ds_read_b128 a[120:123], v12 offset:736
  v_mfma_f32_16x16x32_bf16 v[112:115], a[248:251], a[160:163], v[112:115]
  ds_read_b128 a[124:127], v12 offset:768
  v_add_u32 v23, v8, v16
  v_mfma_f32_16x16x32_bf16 v[160:163], a[252:255], a[160:163], v[160:163]
  ds_read_b128 a[128:131], v12 offset:1472
  v_mul_f32 v41, v24, v24
  v_mfma_f32_16x16x32_bf16 v[120:123], a[248:251], a[164:167], v[120:123]
  ds_read_b128 a[132:135], v22 offset:64
  v_add_f32 v40, v24, v25
  v_mfma_f32_16x16x32_bf16 v[168:171], a[252:255], a[164:167], v[168:171]
  ds_read_b128 a[220:223], v1 offset:256
  v_fmac_f32 v41, v25, v25
  v_mfma_f32_16x16x32_bf16 v[128:131], a[248:251], a[168:171], v[128:131]
  ds_read_b128 a[224:227], v1 offset:13056
  v_add_f32 v40, v40, v26
  v_mfma_f32_16x16x32_bf16 v[176:179], a[252:255], a[168:171], v[176:179]
  ds_read_b128 a[228:231], v1 offset:25856
  v_fmac_f32 v41, v26, v26
  v_mfma_f32_16x16x32_bf16 v[136:139], a[248:251], a[172:175], v[136:139]
  ds_write_b64 v13, v[32:33] offset:0
  v_mfma_f32_16x16x32_bf16 v[184:187], a[252:255], a[172:175], v[184:187]
  s_waitcnt lgkmcnt(15)
  buffer_load_dwordx4 a[248:251], v3, s[8:11], s28 offen offset:2048
  v_mfma_f32_16x16x32_bf16 v[28:31], a[176:179], a[136:139], 0
  s_waitcnt lgkmcnt(14)
  buffer_load_dwordx4 a[252:255], v3, s[8:11], s28 offen offset:3072
  v_smfmac_f32_16x16x64_bf16 v[28:31], a[180:183], a[140:147], v15
  s_waitcnt lgkmcnt(12)
  ds_read_b128 a[232:235], v1 offset:38656
  v_smfmac_f32_16x16x64_bf16 v[28:31], a[184:187], a[148:155], v15
  v_cvt_pk_bf16_f32 v32, v24, v25
  v_mfma_f32_16x16x32_bf16 v[52:55], a[36:39], a[200:203], v[52:55]
  v_accvgpr_read_b32 v6, a4
  v_cvt_pk_bf16_f32 v33, v26, v27
  v_mfma_f32_16x16x32_bf16 v[60:63], a[40:43], a[200:203], v[60:63]
  buffer_store_dwordx4 v[192:195], v6, s[12:15], s59 offen offset:64 nt
  v_mfma_f32_16x16x32_bf16 v[76:79], a[36:39], a[204:207], v[76:79]
  v_add_f32 v40, v40, v27
  v_fmac_f32 v41, v27, v27
  v_mfma_f32_16x16x32_bf16 v[84:87], a[40:43], a[204:207], v[84:87]
  s_waitcnt lgkmcnt(11)
  ds_read_b128 a[236:239], v2 offset:256
  v_mul_f32 v43, v28, v28
  v_mfma_f32_16x16x32_bf16 v[100:103], a[36:39], a[208:211], v[100:103]
  ds_read_b128 a[160:163], v0 offset:320
  v_add_f32 v42, v28, v29
  v_mfma_f32_16x16x32_bf16 v[108:111], a[40:43], a[208:211], v[108:111]
  ds_read_b128 a[164:167], v0 offset:13120
  v_fmac_f32 v43, v29, v29
  v_mfma_f32_16x16x32_bf16 v[124:127], a[36:39], a[212:215], v[124:127]
  ds_read_b128 a[168:171], v0 offset:25920
  v_add_f32 v42, v42, v30
  v_mfma_f32_16x16x32_bf16 v[132:135], a[40:43], a[212:215], v[132:135]
  s_waitcnt lgkmcnt(12)
  ds_read_b128 a[172:175], v0 offset:38720
  v_fmac_f32 v43, v30, v30
  v_mfma_f32_16x16x32_bf16 v[24:27], a[176:179], a[116:119], 0
  s_waitcnt lgkmcnt(12)
  ds_read_b128 a[200:203], v0 offset:51520
  v_add_f32 v42, v42, v31
  v_smfmac_f32_16x16x64_bf16 v[24:27], a[180:183], a[120:127], v15
  s_waitcnt lgkmcnt(11)
  ds_read_b128 a[204:207], v1 offset:320
  v_smfmac_f32_16x16x64_bf16 v[24:27], a[184:187], a[128:135], v15
  ds_read_b128 a[208:211], v1 offset:13120
  v_mfma_f32_16x16x32_bf16 v[148:151], a[36:39], a[216:219], v[148:151]
  buffer_load_dwordx4 a[184:187], v3, s[8:11], s35 offen offset:2048
  v_mfma_f32_16x16x32_bf16 v[156:159], a[40:43], a[216:219], v[156:159]
  s_waitcnt lgkmcnt(11)
  buffer_load_dwordx4 a[176:179], v3, s[8:11], s35 offen offset:0
  v_mfma_f32_16x16x32_bf16 v[172:175], a[36:39], a[220:223], v[172:175]
  buffer_load_dwordx4 a[180:183], v3, s[8:11], s35 offen offset:1024
  v_mfma_f32_16x16x32_bf16 v[180:183], a[40:43], a[220:223], v[180:183]
  ds_read_b128 a[212:215], v1 offset:25920
  v_fmac_f32 v43, v31, v31
  v_mfma_f32_16x16x32_bf16 v[112:115], a[36:39], a[224:227], v[112:115]
  ds_read_b128 a[136:139], v8 offset:13792
  v_add_u32 v22, v9, v16
  v_mfma_f32_16x16x32_bf16 v[160:163], a[40:43], a[224:227], v[160:163]
  s_waitcnt lgkmcnt(11)
  ds_read_b128 a[140:143], v8 offset:14528
  v_mul_f32 v45, v24, v24
  v_mfma_f32_16x16x32_bf16 v[120:123], a[36:39], a[228:231], v[120:123]
  ds_read_b128 a[144:147], v8 offset:14560
  v_add_f32 v44, v24, v25
  v_mfma_f32_16x16x32_bf16 v[168:171], a[40:43], a[228:231], v[168:171]
  s_waitcnt lgkmcnt(12)
  ds_read_b128 a[148:151], v8 offset:15264
  v_fmac_f32 v45, v25, v25
  v_mfma_f32_16x16x32_bf16 v[128:131], a[36:39], a[232:235], v[128:131]
  ds_read_b128 a[152:155], v23 offset:13856
  v_add_f32 v44, v44, v26
  v_mfma_f32_16x16x32_bf16 v[176:179], a[40:43], a[232:235], v[176:179]
  s_waitcnt lgkmcnt(13)
  ds_read_b128 a[216:219], v1 offset:38720
  v_fmac_f32 v45, v26, v26
  v_mfma_f32_16x16x32_bf16 v[136:139], a[36:39], a[236:239], v[136:139]
  ds_read_b128 a[220:223], v2 offset:320
  v_add_f32 v44, v44, v27
  v_mfma_f32_16x16x32_bf16 v[184:187], a[40:43], a[236:239], v[184:187]
  s_waitcnt lgkmcnt(14)
  buffer_load_dwordx4 a[36:39], v3, s[8:11], s26 offen offset:0
  v_mfma_f32_16x16x32_bf16 v[52:55], a[44:47], a[160:163], v[52:55]
  buffer_load_dwordx4 a[40:43], v3, s[8:11], s26 offen offset:1024
  v_mfma_f32_16x16x32_bf16 v[60:63], a[48:51], a[160:163], v[60:63]
  s_waitcnt lgkmcnt(13)
  v_accvgpr_read_b32 v5, a5
  ds_read_b128 a[224:227], v0 offset:384
  v_mfma_f32_16x16x32_bf16 v[76:79], a[44:47], a[164:167], v[76:79]
  buffer_store_dwordx4 v[208:211], v5, s[12:15], s59 offen offset:64 nt
  v_mfma_f32_16x16x32_bf16 v[84:87], a[48:51], a[164:167], v[84:87]
  s_waitcnt lgkmcnt(12)
  ds_read_b128 a[228:231], v0 offset:13184
  v_fmac_f32 v45, v27, v27
  v_mfma_f32_16x16x32_bf16 v[100:103], a[44:47], a[168:171], v[100:103]
  ds_write_b64 v13, v[34:35] offset:12800
  v_mfma_f32_16x16x32_bf16 v[108:111], a[48:51], a[168:171], v[108:111]
  v_cvt_pk_bf16_f32 v34, v28, v29
  v_cvt_pk_bf16_f32 v35, v30, v31
  v_mfma_f32_16x16x32_bf16 v[124:127], a[44:47], a[172:175], v[124:127]
  ds_read_b128 a[116:119], v9 offset:13792
  v_add_u32 v23, v10, v16
  v_mfma_f32_16x16x32_bf16 v[132:135], a[48:51], a[172:175], v[132:135]
  s_waitcnt lgkmcnt(12)
  ds_read_b128 a[120:123], v9 offset:14528
  v_mfma_f32_16x16x32_bf16 v[148:151], a[44:47], a[200:203], v[148:151]
  ds_read_b128 a[124:127], v9 offset:14560
  v_mfma_f32_16x16x32_bf16 v[156:159], a[48:51], a[200:203], v[156:159]
  ds_read_b128 a[128:131], v9 offset:15264
  v_mfma_f32_16x16x32_bf16 v[172:175], a[44:47], a[204:207], v[172:175]
  ds_read_b128 a[132:135], v22 offset:13856
  v_add_u32 v22, v11, v16
  v_mfma_f32_16x16x32_bf16 v[180:183], a[48:51], a[204:207], v[180:183]
  ds_read_b128 a[232:235], v0 offset:25984
  v_mfma_f32_16x16x32_bf16 v[112:115], a[44:47], a[208:211], v[112:115]
  ds_read_b128 a[236:239], v0 offset:38784
  v_mfma_f32_16x16x32_bf16 v[160:163], a[48:51], a[208:211], v[160:163]
  s_waitcnt lgkmcnt(14)
  ds_read_b128 a[160:163], v0 offset:51584
  v_mfma_f32_16x16x32_bf16 v[120:123], a[44:47], a[212:215], v[120:123]
  ds_read_b128 a[164:167], v1 offset:384
  v_mfma_f32_16x16x32_bf16 v[168:171], a[48:51], a[212:215], v[168:171]
  ds_write_b64 v13, v[32:33] offset:25600
  v_mfma_f32_16x16x32_bf16 v[28:31], a[188:191], a[136:139], 0
  v_cvt_pk_bf16_f32 v32, v24, v25
  ds_read_b128 a[168:171], v1 offset:13184
  v_smfmac_f32_16x16x64_bf16 v[28:31], a[192:195], a[140:147], v15
  s_waitcnt lgkmcnt(14)
  v_cvt_pk_bf16_f32 v33, v26, v27
  v_smfmac_f32_16x16x64_bf16 v[28:31], a[196:199], a[148:155], v15
  ds_read_b128 a[136:139], v10 offset:13792
  v_mfma_f32_16x16x32_bf16 v[128:131], a[44:47], a[216:219], v[128:131]
  ds_read_b128 a[140:143], v10 offset:14528
  v_mfma_f32_16x16x32_bf16 v[176:179], a[48:51], a[216:219], v[176:179]
  ds_read_b128 a[144:147], v10 offset:14560
  v_add_f32 v36, v36, v28
  v_mfma_f32_16x16x32_bf16 v[136:139], a[44:47], a[220:223], v[136:139]
  ds_read_b128 a[148:151], v10 offset:15264
  v_fmac_f32 v37, v28, v28
  v_mfma_f32_16x16x32_bf16 v[184:187], a[48:51], a[220:223], v[184:187]
  s_waitcnt vmcnt(9) lgkmcnt(15)
  buffer_load_dwordx4 a[44:47], v3, s[8:11], s26 offen offset:2048
  v_mfma_f32_16x16x32_bf16 v[52:55], a[52:55], a[224:227], v[52:55]
  buffer_load_dwordx4 a[48:51], v3, s[8:11], s26 offen offset:3072
  v_mfma_f32_16x16x32_bf16 v[60:63], a[56:59], a[224:227], v[60:63]
  v_accvgpr_read_b32 v6, a6
  ds_read_b128 a[152:155], v23 offset:13856
  v_mfma_f32_16x16x32_bf16 v[76:79], a[52:55], a[228:231], v[76:79]
  buffer_store_dwordx4 v[96:99], v6, s[12:15], s59 offen offset:64 nt
  v_mfma_f32_16x16x32_bf16 v[84:87], a[56:59], a[228:231], v[84:87]
  s_waitcnt lgkmcnt(14)
  ds_read_b128 a[172:175], v1 offset:25984
  v_add_f32 v36, v36, v29
  v_mfma_f32_16x16x32_bf16 v[24:27], a[188:191], a[116:119], 0
  s_waitcnt lgkmcnt(14)
  ds_read_b128 a[200:203], v1 offset:38784
  v_fmac_f32 v37, v29, v29
  v_smfmac_f32_16x16x64_bf16 v[24:27], a[192:195], a[120:127], v15
  s_waitcnt lgkmcnt(13)
  ds_read_b128 a[204:207], v2 offset:384
  v_smfmac_f32_16x16x64_bf16 v[24:27], a[196:199], a[128:135], v15
  s_waitcnt lgkmcnt(13)
  ds_read_b128 a[208:211], v0 offset:448
  v_mfma_f32_16x16x32_bf16 v[100:103], a[52:55], a[232:235], v[100:103]
  ds_write_b64 v13, v[34:35] offset:38400
  v_mfma_f32_16x16x32_bf16 v[108:111], a[56:59], a[232:235], v[108:111]
  s_waitcnt lgkmcnt(14)
  v_add_f32 v36, v36, v30
  v_fmac_f32 v37, v30, v30
  v_mfma_f32_16x16x32_bf16 v[124:127], a[52:55], a[236:239], v[124:127]
  v_cvt_pk_bf16_f32 v34, v28, v29
  v_cvt_pk_bf16_f32 v35, v30, v31
  v_mfma_f32_16x16x32_bf16 v[132:135], a[56:59], a[236:239], v[132:135]
  s_waitcnt lgkmcnt(11)
  v_add_f32 v36, v36, v31
  v_fmac_f32 v37, v31, v31
  v_mfma_f32_16x16x32_bf16 v[148:151], a[52:55], a[160:163], v[148:151]
  ds_read_b128 a[212:215], v0 offset:13248
  v_add_f32 v38, v38, v24
  v_mfma_f32_16x16x32_bf16 v[156:159], a[56:59], a[160:163], v[156:159]
  ds_read_b128 a[116:119], v11 offset:13792
  v_fmac_f32 v39, v24, v24
  v_mfma_f32_16x16x32_bf16 v[172:175], a[52:55], a[164:167], v[172:175]
  ds_read_b128 a[120:123], v11 offset:14528
  v_add_f32 v38, v38, v25
  v_mfma_f32_16x16x32_bf16 v[180:183], a[56:59], a[164:167], v[180:183]
  s_waitcnt lgkmcnt(12)
  ds_read_b128 a[124:127], v11 offset:14560
  v_fmac_f32 v39, v25, v25
  v_mfma_f32_16x16x32_bf16 v[112:115], a[52:55], a[168:171], v[112:115]
  ds_read_b128 a[128:131], v11 offset:15264
  v_add_f32 v38, v38, v26
  v_mfma_f32_16x16x32_bf16 v[160:163], a[56:59], a[168:171], v[160:163]
  ds_read_b128 a[132:135], v22 offset:13856
  v_fmac_f32 v39, v26, v26
  v_mfma_f32_16x16x32_bf16 v[28:31], a[188:191], a[136:139], 0
  s_waitcnt lgkmcnt(12)
  ds_read_b128 a[216:219], v0 offset:26048
  v_add_f32 v38, v38, v27
  v_smfmac_f32_16x16x64_bf16 v[28:31], a[192:195], a[140:147], v15
  s_waitcnt lgkmcnt(12)
  ds_write_b64 v14, v[32:33] offset:0
  v_smfmac_f32_16x16x64_bf16 v[28:31], a[196:199], a[148:155], v15
  s_waitcnt lgkmcnt(12)
  ds_read_b128 a[220:223], v0 offset:38848
  v_mfma_f32_16x16x32_bf16 v[120:123], a[52:55], a[172:175], v[120:123]
  v_cvt_pk_bf16_f32 v32, v24, v25
  ds_read_b128 a[224:227], v0 offset:51648
  v_mfma_f32_16x16x32_bf16 v[168:171], a[56:59], a[172:175], v[168:171]
  s_waitcnt lgkmcnt(13)
  v_cvt_pk_bf16_f32 v33, v26, v27
  v_fmac_f32 v39, v27, v27
  v_mfma_f32_16x16x32_bf16 v[128:131], a[52:55], a[200:203], v[128:131]
  ds_read_b128 a[228:231], v1 offset:448
  v_add_u32 v23, v12, v16
  v_mfma_f32_16x16x32_bf16 v[176:179], a[56:59], a[200:203], v[176:179]
  s_waitcnt lgkmcnt(3)
  s_barrier
  buffer_load_dwordx4 v17, s[4:7], s34 offen offset:0 lds
  s_add_u32 m0, s61, 6592
  v_mfma_f32_16x16x32_bf16 v[136:139], a[52:55], a[204:207], v[136:139]
  buffer_load_dwordx4 v17, s[4:7], s34 offen offset:32 lds
  s_add_u32 m0, s62, 0
  v_mfma_f32_16x16x32_bf16 v[184:187], a[56:59], a[204:207], v[184:187]
  ds_read_b128 a[232:235], v1 offset:13248
  v_add_f32 v40, v40, v28
  v_mfma_f32_16x16x32_bf16 v[52:55], a[60:63], a[208:211], v[52:55]
  buffer_load_dwordx4 v18, s[4:7], s34 offen offset:0 lds
  s_add_u32 m0, s62, 6592
  s_addk_i32 s26, 6144
  v_mfma_f32_16x16x32_bf16 v[60:63], a[64:67], a[208:211], v[60:63]
  v_accvgpr_read_b32 v5, a4
  ds_read_b128 a[136:139], v12 offset:13792
  v_mfma_f32_16x16x32_bf16 v[76:79], a[60:63], a[212:215], v[76:79]
  v_fmac_f32 v41, v28, v28
  ds_read_b128 a[140:143], v12 offset:14528
  v_mfma_f32_16x16x32_bf16 v[84:87], a[64:67], a[212:215], v[84:87]
  v_add_f32 v40, v40, v29
  ds_read_b128 a[144:147], v12 offset:14560
  v_mfma_f32_16x16x32_bf16 v[24:27], a[188:191], a[116:119], 0
  buffer_load_dwordx4 v18, s[4:7], s34 offen offset:32 lds
  v_smfmac_f32_16x16x64_bf16 v[24:27], a[192:195], a[120:127], v15
  v_fmac_f32 v41, v29, v29
  v_smfmac_f32_16x16x64_bf16 v[24:27], a[196:199], a[128:135], v15
  ds_read_b128 a[148:151], v12 offset:15264
  v_mfma_f32_16x16x32_bf16 v[100:103], a[60:63], a[216:219], v[100:103]
  ds_read_b128 a[152:155], v23 offset:13856
  v_add_f32 v40, v40, v30
  v_mfma_f32_16x16x32_bf16 v[108:111], a[64:67], a[216:219], v[108:111]
  s_waitcnt lgkmcnt(8)
  buffer_store_dwordx4 v[104:107], v5, s[12:15], s60 offen offset:64 nt
  v_mfma_f32_16x16x32_bf16 v[124:127], a[60:63], a[220:223], v[124:127]
  ds_read_b128 a[236:239], v1 offset:26048
  v_fmac_f32 v41, v30, v30
  v_mfma_f32_16x16x32_bf16 v[132:135], a[64:67], a[220:223], v[132:135]
  s_waitcnt lgkmcnt(8)
  ds_read_b128 a[160:163], v1 offset:38848
  v_add_f32 v40, v40, v31
  v_mfma_f32_16x16x32_bf16 v[148:151], a[60:63], a[224:227], v[148:151]
  ds_read_b128 a[164:167], v2 offset:448
  v_fmac_f32 v41, v31, v31
  v_mfma_f32_16x16x32_bf16 v[156:159], a[64:67], a[224:227], v[156:159]
  s_waitcnt lgkmcnt(9)
  buffer_load_dwordx4 a[52:55], v3, s[8:11], s27 offen offset:0
  v_mfma_f32_16x16x32_bf16 v[172:175], a[60:63], a[228:231], v[172:175]
  ds_read_b128 a[168:171], v0 offset:512
  v_add_f32 v42, v42, v24
  v_mfma_f32_16x16x32_bf16 v[180:183], a[64:67], a[228:231], v[180:183]
  s_waitcnt lgkmcnt(9)
  ds_write_b64 v13, v[34:35] offset:64
  v_mfma_f32_16x16x32_bf16 v[112:115], a[60:63], a[232:235], v[112:115]
  v_cvt_pk_bf16_f32 v34, v28, v29
  v_cvt_pk_bf16_f32 v35, v30, v31
  v_mfma_f32_16x16x32_bf16 v[160:163], a[64:67], a[232:235], v[160:163]
  buffer_load_dwordx4 a[56:59], v3, s[8:11], s27 offen offset:1024
  s_addk_i32 s27, 6144
  s_waitcnt lgkmcnt(9)
  v_mfma_f32_16x16x32_bf16 v[28:31], a[188:191], a[136:139], 0
  s_waitcnt lgkmcnt(7)
  ds_read_b128 a[172:175], v0 offset:13312
  v_fmac_f32 v43, v24, v24
  v_smfmac_f32_16x16x64_bf16 v[28:31], a[192:195], a[140:147], v15
  s_waitcnt lgkmcnt(6)
  ds_read_b128 a[200:203], v0 offset:26112
  v_smfmac_f32_16x16x64_bf16 v[28:31], a[196:199], a[148:155], v15
  ds_read_b128 a[204:207], v0 offset:38912
  v_add_f32 v42, v42, v25
  ds_read_b128 a[208:211], v0 offset:51712
  v_fmac_f32 v43, v25, v25
  v_add_f32 v42, v42, v26
  v_fmac_f32 v43, v26, v26
  s_waitcnt lgkmcnt(8)
  v_mfma_f32_16x16x32_bf16 v[120:123], a[60:63], a[236:239], v[120:123]
  ds_read_b128 a[212:215], v1 offset:512
  v_add_f32 v44, v44, v28
  v_mfma_f32_16x16x32_bf16 v[168:171], a[64:67], a[236:239], v[168:171]
  s_waitcnt lgkmcnt(8)
  ds_read_b128 a[216:219], v1 offset:13312
  v_fmac_f32 v45, v28, v28
  v_mfma_f32_16x16x32_bf16 v[128:131], a[60:63], a[160:163], v[128:131]
  ds_read_b128 a[220:223], v1 offset:26112
  v_add_f32 v44, v44, v29
  v_mfma_f32_16x16x32_bf16 v[176:179], a[64:67], a[160:163], v[176:179]
  s_waitcnt lgkmcnt(9)
  ds_read_b128 a[224:227], v1 offset:38912
  v_fmac_f32 v45, v29, v29
  v_mfma_f32_16x16x32_bf16 v[136:139], a[60:63], a[164:167], v[136:139]
  ds_read_b128 a[228:231], v2 offset:512
  v_add_f32 v44, v44, v30
  v_mfma_f32_16x16x32_bf16 v[184:187], a[64:67], a[164:167], v[184:187]
  s_waitcnt lgkmcnt(9)
  buffer_load_dwordx4 a[60:63], v3, s[8:11], s26 offen offset:0
  v_mfma_f32_16x16x32_bf16 v[52:55], a[68:71], a[168:171], v[52:55]
  buffer_load_dwordx4 a[64:67], v3, s[8:11], s26 offen offset:1024
  v_mfma_f32_16x16x32_bf16 v[60:63], a[72:75], a[168:171], v[60:63]
  v_accvgpr_read_b32 v6, a5
  ds_read_b128 a[232:235], v0 offset:576
  v_fmac_f32 v45, v30, v30
  s_waitcnt lgkmcnt(9)
  v_mfma_f32_16x16x32_bf16 v[76:79], a[68:71], a[172:175], v[76:79]
  buffer_store_dwordx4 v[68:71], v6, s[12:15], s60 offen offset:64 nt
  v_mfma_f32_16x16x32_bf16 v[84:87], a[72:75], a[172:175], v[84:87]
  s_waitcnt lgkmcnt(8)
  ds_read_b128 a[236:239], v0 offset:13376
  v_add_f32 v42, v42, v27
  v_mfma_f32_16x16x32_bf16 v[100:103], a[68:71], a[200:203], v[100:103]
  ds_read_b128 a[160:163], v0 offset:26176
  v_fmac_f32 v43, v27, v27
  v_mfma_f32_16x16x32_bf16 v[108:111], a[72:75], a[200:203], v[108:111]
  s_waitcnt lgkmcnt(9)
  ds_read_b128 a[164:167], v0 offset:38976
  v_add_f32 v44, v44, v31
  v_mfma_f32_16x16x32_bf16 v[124:127], a[68:71], a[204:207], v[124:127]
  ds_read_b128 a[168:171], v0 offset:51776
  v_fmac_f32 v45, v31, v31
  v_mfma_f32_16x16x32_bf16 v[132:135], a[72:75], a[204:207], v[132:135]
  s_waitcnt lgkmcnt(10)
  ds_read_b128 a[172:175], v1 offset:576
  v_mfma_f32_16x16x32_bf16 v[148:151], a[68:71], a[208:211], v[148:151]
  ds_read_b128 a[200:203], v1 offset:13376
  v_mfma_f32_16x16x32_bf16 v[156:159], a[72:75], a[208:211], v[156:159]
  s_waitcnt lgkmcnt(11)
  ds_read_b128 a[204:207], v1 offset:26176
  v_mfma_f32_16x16x32_bf16 v[172:175], a[68:71], a[212:215], v[172:175]
  ds_read_b128 a[208:211], v1 offset:38976
  v_mfma_f32_16x16x32_bf16 v[180:183], a[72:75], a[212:215], v[180:183]
  s_waitcnt lgkmcnt(12)
  ds_write_b64 v13, v[32:33] offset:12864
  v_mfma_f32_16x16x32_bf16 v[112:115], a[68:71], a[216:219], v[112:115]
  v_cvt_pk_bf16_f32 v32, v24, v25
  ds_read_b128 a[212:215], v2 offset:576
  v_mfma_f32_16x16x32_bf16 v[160:163], a[72:75], a[216:219], v[160:163]
  s_waitcnt lgkmcnt(13)
  v_cvt_pk_bf16_f32 v33, v26, v27
  ds_write_b64 v13, v[34:35] offset:25664
  v_mfma_f32_16x16x32_bf16 v[120:123], a[68:71], a[220:223], v[120:123]
  v_cvt_pk_bf16_f32 v34, v28, v29
  v_cvt_pk_bf16_f32 v35, v30, v31
  v_mfma_f32_16x16x32_bf16 v[168:171], a[72:75], a[220:223], v[168:171]
  s_waitcnt lgkmcnt(13)
  ds_read_b128 a[216:219], v0 offset:640
  v_mfma_f32_16x16x32_bf16 v[128:131], a[68:71], a[224:227], v[128:131]
  ds_read_b128 a[220:223], v0 offset:13440
  v_mfma_f32_16x16x32_bf16 v[176:179], a[72:75], a[224:227], v[176:179]
  s_waitcnt lgkmcnt(14)
  ds_write_b64 v13, v[32:33] offset:38464
  v_mfma_f32_16x16x32_bf16 v[136:139], a[68:71], a[228:231], v[136:139]
  v_mfma_f32_16x16x32_bf16 v[184:187], a[72:75], a[228:231], v[184:187]
  s_waitcnt lgkmcnt(14)
  buffer_load_dwordx4 a[68:71], v3, s[8:11], s26 offen offset:2048
  v_mfma_f32_16x16x32_bf16 v[52:55], a[76:79], a[232:235], v[52:55]
  buffer_load_dwordx4 a[72:75], v3, s[8:11], s26 offen offset:3072
  v_mfma_f32_16x16x32_bf16 v[60:63], a[80:83], a[232:235], v[60:63]
  s_waitcnt lgkmcnt(13)
  v_accvgpr_read_b32 v5, a6
  ds_read_b128 a[224:227], v0 offset:26240
  v_mfma_f32_16x16x32_bf16 v[76:79], a[76:79], a[236:239], v[76:79]
  buffer_store_dwordx4 v[116:119], v5, s[12:15], s60 offen offset:64 nt
  v_mfma_f32_16x16x32_bf16 v[84:87], a[80:83], a[236:239], v[84:87]
  s_waitcnt lgkmcnt(12)
  ds_read_b128 a[228:231], v0 offset:39040
  v_mfma_f32_16x16x32_bf16 v[100:103], a[76:79], a[160:163], v[100:103]
  ds_read_b128 a[232:235], v0 offset:51840
  v_mfma_f32_16x16x32_bf16 v[108:111], a[80:83], a[160:163], v[108:111]
  ds_read_b128 a[236:239], v1 offset:640
  v_mfma_f32_16x16x32_bf16 v[124:127], a[76:79], a[164:167], v[124:127]
  ds_read_b128 a[160:163], v1 offset:13440
  v_mfma_f32_16x16x32_bf16 v[132:135], a[80:83], a[164:167], v[132:135]
  s_waitcnt lgkmcnt(12)
  ds_write_b64 v14, v[34:35] offset:64
  v_mfma_f32_16x16x32_bf16 v[148:151], a[76:79], a[168:171], v[148:151]
  ds_read_b128 a[164:167], v1 offset:26240
  v_mfma_f32_16x16x32_bf16 v[156:159], a[80:83], a[168:171], v[156:159]
  v_mfma_f32_16x16x32_bf16 v[172:175], a[76:79], a[172:175], v[172:175]
  ds_read_b128 a[168:171], v1 offset:39040
  v_mfma_f32_16x16x32_bf16 v[180:183], a[80:83], a[172:175], v[180:183]
  v_mfma_f32_16x16x32_bf16 v[112:115], a[76:79], a[200:203], v[112:115]
  s_waitcnt lgkmcnt(2)
  s_barrier
  ds_read_b128 a[172:175], v2 offset:640
  v_mfma_f32_16x16x32_bf16 v[160:163], a[80:83], a[200:203], v[160:163]
  v_mfma_f32_16x16x32_bf16 v[120:123], a[76:79], a[204:207], v[120:123]
  ds_read_b128 a[200:203], v0 offset:704
  v_mfma_f32_16x16x32_bf16 v[168:171], a[80:83], a[204:207], v[168:171]
  v_mfma_f32_16x16x32_bf16 v[128:131], a[76:79], a[208:211], v[128:131]
  ds_read_b128 a[204:207], v0 offset:13504
  v_mfma_f32_16x16x32_bf16 v[176:179], a[80:83], a[208:211], v[176:179]
  v_mfma_f32_16x16x32_bf16 v[136:139], a[76:79], a[212:215], v[136:139]
  ds_read_b128 a[208:211], v0 offset:26304
  v_mfma_f32_16x16x32_bf16 v[184:187], a[80:83], a[212:215], v[184:187]
  s_waitcnt vmcnt(10)
  buffer_load_dwordx4 a[76:79], v3, s[8:11], s27 offen offset:0
  v_mfma_f32_16x16x32_bf16 v[52:55], a[240:243], a[216:219], v[52:55]
  buffer_load_dwordx4 a[80:83], v3, s[8:11], s27 offen offset:1024
  v_mfma_f32_16x16x32_bf16 v[60:63], a[244:247], a[216:219], v[60:63]
  v_accvgpr_read_b32 v6, a7
  ds_read_b128 a[212:215], v0 offset:39104
  v_mfma_f32_16x16x32_bf16 v[76:79], a[240:243], a[220:223], v[76:79]
  buffer_store_dwordx4 v[164:167], v6, s[12:15], s58 offen offset:64 nt
  s_add_u32 s58, s65, 0
  s_add_u32 s59, s65, 5376
  v_mfma_f32_16x16x32_bf16 v[84:87], a[244:247], a[220:223], v[84:87]
  s_add_u32 s60, s65, 10752
  ds_read_b128 a[216:219], v0 offset:51904
  s_add_u32 s17, s17, 243
  v_mfma_f32_16x16x32_bf16 v[100:103], a[240:243], a[224:227], v[100:103]
  s_add_u32 s18, s18, 1
  ds_read_b128 a[220:223], v1 offset:704
  v_mfma_f32_16x16x32_bf16 v[108:111], a[244:247], a[224:227], v[108:111]
  v_mfma_f32_16x16x32_bf16 v[124:127], a[240:243], a[228:231], v[124:127]
  ds_read_b128 a[224:227], v1 offset:13504
  v_mfma_f32_16x16x32_bf16 v[132:135], a[244:247], a[228:231], v[132:135]
  v_mfma_f32_16x16x32_bf16 v[148:151], a[240:243], a[232:235], v[148:151]
  ds_read_b128 a[228:231], v1 offset:26304
  v_mfma_f32_16x16x32_bf16 v[156:159], a[244:247], a[232:235], v[156:159]
  v_mfma_f32_16x16x32_bf16 v[172:175], a[240:243], a[236:239], v[172:175]
  ds_read_b128 a[232:235], v1 offset:39104
  v_mfma_f32_16x16x32_bf16 v[180:183], a[244:247], a[236:239], v[180:183]
  v_mfma_f32_16x16x32_bf16 v[112:115], a[240:243], a[160:163], v[112:115]
  ds_read_b128 a[236:239], v2 offset:704
  v_mfma_f32_16x16x32_bf16 v[160:163], a[244:247], a[160:163], v[160:163]
  s_waitcnt lgkmcnt(9)
  v_mfma_f32_16x16x32_bf16 v[120:123], a[240:243], a[164:167], v[120:123]
  v_mfma_f32_16x16x32_bf16 v[168:171], a[244:247], a[164:167], v[168:171]
  v_mfma_f32_16x16x32_bf16 v[128:131], a[240:243], a[168:171], v[128:131]
  v_mfma_f32_16x16x32_bf16 v[176:179], a[244:247], a[168:171], v[176:179]
  v_mfma_f32_16x16x32_bf16 v[136:139], a[240:243], a[172:175], v[136:139]
  v_mfma_f32_16x16x32_bf16 v[184:187], a[244:247], a[172:175], v[184:187]
  v_mfma_f32_16x16x32_bf16 v[52:55], a[248:251], a[200:203], v[52:55]
  v_mfma_f32_16x16x32_bf16 v[60:63], a[252:255], a[200:203], v[60:63]
  s_waitcnt lgkmcnt(6)
  v_mfma_f32_16x16x32_bf16 v[76:79], a[248:251], a[204:207], v[76:79]
  v_cvt_pk_bf16_f32 v52, v52, v53
  v_mfma_f32_16x16x32_bf16 v[84:87], a[252:255], a[204:207], v[84:87]
  v_cvt_pk_bf16_f32 v53, v54, v55
  v_cvt_pk_bf16_f32 v54, v60, v61
  v_mfma_f32_16x16x32_bf16 v[100:103], a[248:251], a[208:211], v[100:103]
  v_cvt_pk_bf16_f32 v55, v62, v63
  v_cvt_pk_bf16_f32 v76, v76, v77
  v_mfma_f32_16x16x32_bf16 v[108:111], a[252:255], a[208:211], v[108:111]
  v_cvt_pk_bf16_f32 v77, v78, v79
  v_cvt_pk_bf16_f32 v78, v84, v85
  v_mfma_f32_16x16x32_bf16 v[124:127], a[248:251], a[212:215], v[124:127]
  v_cvt_pk_bf16_f32 v79, v86, v87
  v_cvt_pk_bf16_f32 v100, v100, v101
  v_mfma_f32_16x16x32_bf16 v[132:135], a[252:255], a[212:215], v[132:135]
  s_waitcnt lgkmcnt(3)
  v_cvt_pk_bf16_f32 v101, v102, v103
  v_cvt_pk_bf16_f32 v102, v108, v109
  v_mfma_f32_16x16x32_bf16 v[148:151], a[248:251], a[216:219], v[148:151]
  v_cvt_pk_bf16_f32 v103, v110, v111
  v_cvt_pk_bf16_f32 v124, v124, v125
  v_mfma_f32_16x16x32_bf16 v[156:159], a[252:255], a[216:219], v[156:159]
  v_cvt_pk_bf16_f32 v125, v126, v127
  v_cvt_pk_bf16_f32 v126, v132, v133
  v_mfma_f32_16x16x32_bf16 v[172:175], a[248:251], a[220:223], v[172:175]
  v_cvt_pk_bf16_f32 v127, v134, v135
  v_cvt_pk_bf16_f32 v148, v148, v149
  v_mfma_f32_16x16x32_bf16 v[180:183], a[252:255], a[220:223], v[180:183]
  v_cvt_pk_bf16_f32 v149, v150, v151
  v_cvt_pk_bf16_f32 v150, v156, v157
  v_mfma_f32_16x16x32_bf16 v[112:115], a[248:251], a[224:227], v[112:115]
  v_cvt_pk_bf16_f32 v151, v158, v159
  v_cvt_pk_bf16_f32 v172, v172, v173
  v_mfma_f32_16x16x32_bf16 v[160:163], a[252:255], a[224:227], v[160:163]
  s_waitcnt lgkmcnt(0)
  v_cvt_pk_bf16_f32 v173, v174, v175
  v_cvt_pk_bf16_f32 v174, v180, v181
  v_mfma_f32_16x16x32_bf16 v[120:123], a[248:251], a[228:231], v[120:123]
  v_cvt_pk_bf16_f32 v175, v182, v183
  v_cvt_pk_bf16_f32 v112, v112, v113
  v_mfma_f32_16x16x32_bf16 v[168:171], a[252:255], a[228:231], v[168:171]
  v_cvt_pk_bf16_f32 v113, v114, v115
  v_cvt_pk_bf16_f32 v114, v160, v161
  v_mfma_f32_16x16x32_bf16 v[128:131], a[248:251], a[232:235], v[128:131]
  v_cvt_pk_bf16_f32 v115, v162, v163
  v_cvt_pk_bf16_f32 v120, v120, v121
  v_mfma_f32_16x16x32_bf16 v[176:179], a[252:255], a[232:235], v[176:179]
  v_cvt_pk_bf16_f32 v121, v122, v123
  v_cvt_pk_bf16_f32 v122, v168, v169
  v_mfma_f32_16x16x32_bf16 v[136:139], a[248:251], a[236:239], v[136:139]
  v_cvt_pk_bf16_f32 v123, v170, v171
  v_cvt_pk_bf16_f32 v128, v128, v129
  v_mfma_f32_16x16x32_bf16 v[184:187], a[252:255], a[236:239], v[184:187]
  v_cvt_pk_bf16_f32 v129, v130, v131
  v_cvt_pk_bf16_f32 v130, v176, v177
  v_cvt_pk_bf16_f32 v131, v178, v179
  v_accvgpr_write_b32 a200, v52
  v_accvgpr_write_b32 a201, v53
  v_cvt_pk_bf16_f32 v136, v136, v137
  v_cvt_pk_bf16_f32 v137, v138, v139
  v_accvgpr_write_b32 a202, v54
  v_accvgpr_write_b32 a203, v55
  v_cvt_pk_bf16_f32 v138, v184, v185
  v_cvt_pk_bf16_f32 v139, v186, v187
  v_accvgpr_write_b32 a204, v76
  v_accvgpr_write_b32 a205, v77
  v_accvgpr_write_b32 a206, v78
  v_accvgpr_write_b32 a207, v79
  v_accvgpr_write_b32 a208, v100
  v_accvgpr_write_b32 a209, v101
  v_accvgpr_write_b32 a210, v102
  v_accvgpr_write_b32 a211, v103
  v_accvgpr_write_b32 a212, v124
  v_accvgpr_write_b32 a213, v125
  v_accvgpr_write_b32 a214, v126
  v_accvgpr_write_b32 a215, v127
  v_accvgpr_write_b32 a216, v148
  v_accvgpr_write_b32 a217, v149
  v_accvgpr_write_b32 a218, v150
  v_accvgpr_write_b32 a219, v151
  v_accvgpr_write_b32 a220, v172
  v_accvgpr_write_b32 a221, v173
  v_accvgpr_write_b32 a222, v174
  v_accvgpr_write_b32 a223, v175
  v_accvgpr_write_b32 a224, v112
  v_accvgpr_write_b32 a225, v113
  v_accvgpr_write_b32 a226, v114
  v_accvgpr_write_b32 a227, v115
  v_accvgpr_write_b32 a228, v120
  v_accvgpr_write_b32 a229, v121
  v_accvgpr_write_b32 a230, v122
  v_accvgpr_write_b32 a231, v123
  v_accvgpr_write_b32 a232, v128
  v_accvgpr_write_b32 a233, v129
  v_accvgpr_write_b32 a234, v130
  v_accvgpr_write_b32 a235, v131
  v_accvgpr_write_b32 a236, v136
  v_accvgpr_write_b32 a237, v137
  v_accvgpr_write_b32 a238, v138
  v_accvgpr_write_b32 a239, v139
  s_cmp_lt_u32 s18, 4
  s_cbranch_scc1 L_loop
  s_nop 7
  v_accvgpr_read_b32 v5, a4
  buffer_store_dwordx4 a[200:203], v5, s[12:15], s19 offen offset:128 nt
  v_accvgpr_read_b32 v6, a5
  buffer_store_dwordx4 a[204:207], v6, s[12:15], s19 offen offset:128 nt
  v_accvgpr_read_b32 v5, a6
  buffer_store_dwordx4 a[208:211], v5, s[12:15], s19 offen offset:128 nt
  v_accvgpr_read_b32 v6, a4
  buffer_store_dwordx4 a[212:215], v6, s[12:15], s20 offen offset:128 nt
  v_accvgpr_read_b32 v5, a5
  buffer_store_dwordx4 a[216:219], v5, s[12:15], s20 offen offset:128 nt
  v_accvgpr_read_b32 v6, a6
  buffer_store_dwordx4 a[220:223], v6, s[12:15], s20 offen offset:128 nt
  v_accvgpr_read_b32 v5, a4
  buffer_store_dwordx4 a[224:227], v5, s[12:15], s21 offen offset:128 nt
  v_accvgpr_read_b32 v6, a5
  buffer_store_dwordx4 a[228:231], v6, s[12:15], s21 offen offset:128 nt
  v_accvgpr_read_b32 v5, a6
  buffer_store_dwordx4 a[232:235], v5, s[12:15], s21 offen offset:128 nt
  v_accvgpr_read_b32 v6, a7
  buffer_store_dwordx4 a[236:239], v6, s[12:15], s19 offen offset:128 nt
  s_endpgm
L_help:
  s_cmp_ge_u32 s2, 243
  s_cbranch_scc1 L_end
  s_branch L_end
L_end:
  s_endpgm
.section .rodata,"a"
.p2align 6
.amdhsa_kernel standalone__window_attn_davit__vision_kernel
  .amdhsa_next_free_vgpr 512
  .amdhsa_next_free_sgpr 102
  .amdhsa_accum_offset 256
  .amdhsa_group_segment_fixed_size 0
  .amdhsa_kernarg_size 56
  .amdhsa_user_sgpr_count 2
  .amdhsa_user_sgpr_kernarg_segment_ptr 1
  .amdhsa_system_sgpr_workgroup_id_x 1
  .amdhsa_float_denorm_mode_32 3
.end_amdhsa_kernel
```
